```python
import torch

def _softmax(x, axis=-1):
    return torch.softmax(x, dim=axis)
def _gelu(x):
    return torch.nn.functional.gelu(x, approximate="tanh")
def _silu(x):
    return torch.nn.functional.silu(x)
def _sigmoid(x):
    return torch.sigmoid(x)
def _layernorm(x, axis=-1, eps=1e-5):
    m = x.mean(dim=axis, keepdim=True)
    v = x.var(dim=axis, keepdim=True, unbiased=False)
    return (x - m) / torch.sqrt(v + eps)
def _scatter_add(tgt, idx, src, axis=0):
    return tgt.clone().index_add_(axis, idx, src)
def _segment_sum(src, seg, n):
    out = torch.zeros((n,) + src.shape[1:], dtype=src.dtype)
    return out.index_add_(0, seg, src)
def _pad(x, pw):
    flat = tuple(v for pair in reversed(pw) for v in pair)
    return torch.nn.functional.pad(x, flat)

kernel_name = 'recurrent_scan__sliding_block_cached__mixer_token_mlp__prompt'

def setup_inputs():

    _w = (lambda a: (lambda t: t.to(torch.bfloat16) if t.is_floating_point() else t)(torch.as_tensor(a)))
    def _A_setup():
        B, Sq, D = 1, 2048, 576
        Hq, Hkv, Sk, Dh = 32, 16, 2048, 128
        assert Hq % Hkv == 0, (Hq, Hkv)
        return {
            "x": _w((lambda *s: torch.randn(*s, dtype=torch.bfloat16) * 0.05)(B, Sq, D)),
            "k_cache": _w((lambda *s: torch.randn(*s, dtype=torch.bfloat16) * 3.2)(B, Hkv, Sk, Dh)),
            "v_cache": _w((lambda *s: torch.randn(*s, dtype=torch.bfloat16) * 3.2)(B, Hkv, Sk, Dh)),
            "wq": _w((lambda *s: torch.randn(*s, dtype=torch.bfloat16) * 3.2)(D, Hq * Dh) * (D ** -0.5)),
            "wo": _w((lambda *s: torch.randn(*s, dtype=torch.bfloat16) * 3.2)(Hq * Dh, D) * ((Hq * Dh) ** -0.5)),
        }
    _A_in = _A_setup()

    def _B_setup():
        B, S, D, F = 1, 2048, 576, 4608
        return {
            "x": _w((lambda *s: torch.randn(*s, dtype=torch.bfloat16) * 0.05)(B, S, D)),
            "w1": _w((lambda *s: torch.randn(*s, dtype=torch.bfloat16) * 3.2)(S, F) * (S ** -0.5)),
            "b1": _w((lambda *s: torch.randn(*s, dtype=torch.bfloat16) * 3.2)(F) * 0.02),
            "w2": _w((lambda *s: torch.randn(*s, dtype=torch.bfloat16) * 0.4)(F, S) * (F ** -0.5)),
            "b2": _w((lambda *s: torch.randn(*s, dtype=torch.bfloat16) * 0.4)(S) * 0.02),
        }
    _B_in = _B_setup()

    return {
        "A_x": _A_in["x"],
        "A_k_cache": _A_in["k_cache"],
        "A_v_cache": _A_in["v_cache"],
        "A_wq": _A_in["wq"],
        "A_wo": _A_in["wo"],
        "B_x": _B_in["x"],
        "B_w1": _B_in["w1"],
        "B_b1": _B_in["b1"],
        "B_w2": _B_in["w2"],
        "B_b2": _B_in["b2"],
    }

def reference(A_x, A_k_cache, A_v_cache, A_wq, A_wo, B_x, B_w1, B_b1, B_w2, B_b2):
    def _A_ref(x, k_cache, v_cache, wq, wo):
        B, Sq, D = x.shape
        Hq, Dh = 32, 128
        Hkv, Sk = k_cache.shape[1], k_cache.shape[2]
        W = min(4096, max(256, Sk // 4))
        rep = Hq // Hkv
        q = (lambda x, *d: x.permute(*d))((x @ wq).reshape(B, Sq, Hq, Dh), 0, 2, 1, 3)
        k = (lambda x, n, axis: torch.repeat_interleave(x, n, dim=axis))(k_cache[:, :, Sk - W:, :], rep, axis=1)
        v = (lambda x, n, axis: torch.repeat_interleave(x, n, dim=axis))(v_cache[:, :, Sk - W:, :], rep, axis=1)
        scores = torch.einsum("bhqd,bhkd->bhqk", q, k) * (Dh ** -0.5)
        p = _softmax(scores, axis=-1)
        o = torch.einsum("bhqk,bhkd->bhqd", p, v)
        return (lambda x, *d: x.permute(*d))(o, 0, 2, 1, 3).reshape(B, Sq, Hq * Dh) @ wo

    def _B_ref(x, w1, b1, w2, b2):
        B, S, D = x.shape
        h = _layernorm(x, axis=-1)
        u = torch.einsum("bsd,sf->bdf", h, w1) + b1
        u = _gelu(u)
        y = torch.einsum("bdf,fs->bds", u, w2) + b2
        return (lambda x, *d: x.permute(*d))(y, 0, 2, 1)

    x = A_x
    xn = _layernorm(x, axis=-1)
    s = _A_ref(xn, A_k_cache, A_v_cache, A_wq, A_wo)
    g = _silu(_B_ref(xn, B_w1, B_b1, B_w2, B_b2))
    return x + s * g
```

```asm
; @launch grid=(256,1,1) block=(256,1,1) lds=163840
.amdgcn_target "amdgcn-amd-amdhsa--gfx950"
.text
.p2align 8
.globl recurrent_scan__sliding_block_cached__mixer_token_mlp__prompt_kernel
.type recurrent_scan__sliding_block_cached__mixer_token_mlp__prompt_kernel,@function
recurrent_scan__sliding_block_cached__mixer_token_mlp__prompt_kernel:
  s_cmp_ge_u32 s2, 256
  s_cbranch_scc1 K_end
  s_load_dwordx8 s[20:27], s[0:1], 0
  s_load_dwordx2 s[40:41], s[0:1], 32
  s_load_dwordx4 s[36:39], s[0:1], 48
  s_load_dwordx8 s[44:51], s[0:1], 64
  s_load_dwordx2 s[12:13], s[0:1], 96
  s_getpc_b64 s[10:11]
K_pc:
  s_lshr_b32 s63, s2, 3
  s_lshl_b32 s3, s63, 12
  v_lshl_add_u32 v4, v0, 4, s3
  v_min_u32 v4, K_end - K_pc - 16, v4
  global_load_dwordx4 v[240:243], v4, s[10:11]
  v_and_b32 v2, 63, v0
  v_lshrrev_b32 v3, 6, v0
  s_and_b32 s16, s2, 3
  v_readfirstlane_b32 s18, v3
  s_bfe_u32 s4, s2, 0x10002
  s_lshl1_add_u32 s62, s16, s4
  s_and_b32 s3, s63, 4
  s_add_u32 s16, s16, s3
  s_lshr_b32 s17, s63, 3
  s_lshl2_add_u32 s17, s4, s17
  s_and_b32 s3, s63, 3
  s_lshl2_add_u32 s17, s17, s3
  s_and_b32 s19, s16, 3
  s_lshl_b32 s19, s19, 3
  s_lshr_b32 s3, s16, 2
  s_lshl_b32 s3, s3, 2
  s_add_u32 s19, s19, s3
  s_and_b32 s3, s17, 3
  s_add_u32 s19, s19, s3
  s_lshr_b32 s5, s17, 2
  s_lshl_b32 s5, s5, 2
  s_add_u32 s5, s5, s18
  v_lshlrev_b32 v3, 4, v2
  v_lshrrev_b32 v4, 3, v2
  v_and_b32 v5, 7, v2
  v_lshrrev_b32 v6, 1, v4
  v_xor_b32 v6, v6, v5
  v_mul_u32_u24 v4, 1152, v4
  s_mul_i32 s3, s5, 73728
  v_add_u32 v4, s3, v4
  v_lshl_add_u32 v10, v6, 4, v4
  v_xor_b32 v6, 4, v6
  v_lshl_add_u32 v11, v6, 4, v4
  v_add_u32 v11, 8192, v11
  v_add_u32 v12, 16384, v10
  v_add_u32 v13, 16384, v11
  v_add_u32 v14, 36864, v10
  v_add_u32 v15, 36864, v11
  v_add_u32 v16, 53248, v10
  v_add_u32 v17, 53248, v11
  v_lshrrev_b32 v4, 4, v2
  v_and_b32 v5, 1, v4
  v_lshlrev_b32 v5, 2, v5
  v_lshrrev_b32 v4, 1, v4
  v_lshl_add_u32 v4, v4, 4, v5
  s_and_b32 s3, s18, 1
  s_lshl_b32 s3, s3, 1
  s_lshr_b32 s4, s18, 1
  s_lshl_b32 s4, s4, 3
  s_add_u32 s3, s3, s4
  v_add_u32 v4, s3, v4
  v_lshlrev_b32 v4, 13, v4
  v_and_b32 v5, 15, v2
  v_lshl_add_u32 v4, v5, 4, v4
  s_lshl_b32 s3, s19, 8
  v_add_u32 v18, s3, v4
  v_add_u32 v19, 7136, v18
  s_lshl_b32 s56, s18, 13
  s_mul_i32 s57, s18, 2112
  s_mov_b32 s58, 0
  s_mov_b32 s59, 0
  v_and_b32 v196, 31, v0
  v_lshrrev_b32 v197, 5, v0
  v_and_b32 v198, 3, v197
  v_lshrrev_b32 v199, 2, v197
  v_lshl_add_u32 v198, v199, 4, v198
  s_lshr_b32 s3, s2, 2
  s_lshl_b32 s3, s3, 5
  s_and_b32 s4, s2, 3
  s_lshl_b32 s4, s4, 2
  s_add_u32 s3, s3, s4
  v_add_u32 v198, s3, v198
  v_mul_u32_u24 v199, 1152, v198
  v_lshl_add_u32 v199, v196, 2, v199
  s_waitcnt lgkmcnt(0)
  s_mov_b32 s28, s22
  s_mov_b32 s29, s23
  s_mov_b32 s30, 8388608
  s_mov_b32 s31, 0x20000
  s_mov_b32 s32, s24
  s_mov_b32 s33, s25
  s_mov_b32 s34, 8388608
  s_mov_b32 s35, 0x20000
  s_mov_b32 s24, s26
  s_mov_b32 s25, s27
  s_mov_b32 s26, 4718592
  s_mov_b32 s27, 0x20000
  s_mov_b32 s22, 2359296
  s_mov_b32 s23, 0x20000
  buffer_load_dword v202, v199, s[20:23], 0 offen offset:0
  buffer_load_dword v203, v199, s[20:23], 0 offen offset:128
  buffer_load_dword v204, v199, s[20:23], 0 offen offset:256
  buffer_load_dword v205, v199, s[20:23], 0 offen offset:384
  buffer_load_dword v206, v199, s[20:23], 0 offen offset:512
  buffer_load_dword v207, v199, s[20:23], 0 offen offset:640
  buffer_load_dword v208, v199, s[20:23], 0 offen offset:768
  buffer_load_dword v209, v199, s[20:23], 0 offen offset:896
  buffer_load_dword v210, v199, s[20:23], 0 offen offset:1024
  s_add_u32 m0, s57, 98304
  s_nop 0
  buffer_load_dwordx4 v18, s[24:27], s59 offen lds
  buffer_load_dwordx4 v19, s[24:27], s59 offen offset:1056 lds
  s_add_u32 s59, s59, 262144
  s_add_u32 m0, s56, 0
  s_nop 0
  buffer_load_dwordx4 v10, s[20:23], s58 offen offset:0 lds
  buffer_load_dwordx4 v11, s[20:23], s58 offen offset:1024 lds
  buffer_load_dwordx4 v12, s[20:23], s58 offen offset:2048 lds
  buffer_load_dwordx4 v13, s[20:23], s58 offen offset:3072 lds
  s_add_u32 m0, s56, 4096
  s_nop 0
  buffer_load_dwordx4 v14, s[20:23], s58 offen offset:0 lds
  buffer_load_dwordx4 v15, s[20:23], s58 offen offset:1024 lds
  buffer_load_dwordx4 v16, s[20:23], s58 offen offset:2048 lds
  buffer_load_dwordx4 v17, s[20:23], s58 offen offset:3072 lds
  s_add_u32 s58, s58, 128
  s_add_u32 m0, s57, 106752
  s_nop 0
  buffer_load_dwordx4 v18, s[24:27], s59 offen lds
  buffer_load_dwordx4 v19, s[24:27], s59 offen offset:1056 lds
  s_add_u32 s59, s59, 262144
  s_mov_b32 s14, 67108864
  s_mov_b32 s15, 0x20000
  s_mov_b32 s100, s38
  s_mov_b32 s101, s39
  s_mov_b32 s38, 18874368
  s_mov_b32 s39, 0x20000
  s_mov_b32 s6, s44
  s_mov_b32 s7, s45
  s_cmp_lt_u32 s16, 4
  s_cselect_b32 s40, s40, s44
  s_cselect_b32 s41, s41, s45
  s_mov_b32 s3, 18874368
  s_cselect_b32 s42, 4718592, s3
  s_mov_b32 s43, 0x20000
  s_mov_b32 s52, s50
  s_mov_b32 s53, s51
  s_mov_b32 s54, 256
  s_mov_b32 s55, 0x20000
  s_mov_b32 s50, 2359296
  s_mov_b32 s51, 0x20000
  v_mov_b32 v201, 0x7fff0000
  v_cmp_eq_u32 vcc, 0, v0
  v_mov_b32 v9, 1
  v_mov_b32 v7, 0
  v_cndmask_b32 v8, v201, v7, vcc
  s_min_u32 s3, s63, 26
  s_mul_i32 s4, s62, 27
  s_add_u32 s3, s3, s4
  s_mul_i32 s8, s3, 10923
  s_lshr_b32 s8, s8, 16
  s_mul_i32 s4, s8, 6
  s_sub_u32 s9, s3, s4
  s_lshr_b32 s4, s62, 1
  s_mul_i32 s4, s4, 10
  s_add_u32 s3, s3, s4
  s_lshl_b32 s3, s3, 2
  s_add_u32 s45, s3, 26284032
  s_lshl_b32 s4, s2, 2
  s_add_u32 s4, s4, 26285056
  s_cmp_ge_u32 s63, 27
  s_cselect_b32 s45, s4, s45
  s_cselect_b32 s94, 0x7f000000, 0
  s_lshr_b32 s3, s19, 3
  s_lshl_b32 s3, s3, 3
  s_lshr_b32 s4, s17, 2
  s_add_u32 s3, s3, s4
  s_lshl_b32 s3, s3, 5
  s_and_b32 s4, s19, 7
  s_add_u32 s3, s3, s4
  s_lshl_b32 s3, s3, 2
  s_add_u32 s44, s3, 26279936
  s_lshl_b32 s95, s17, 5
  s_add_u32 s95, s95, s16
  s_lshl_b32 s95, s95, 2
  s_add_u32 s95, s95, 26288128
  v_lshrrev_b32 v4, 4, v2
  v_bfe_u32 v5, v2, 2, 2
  v_and_b32 v6, 1, v4
  v_lshl_add_u32 v5, v6, 2, v5
  v_mul_u32_u24 v5, 1056, v5
  v_lshrrev_b32 v6, 1, v4
  v_lshl_add_u32 v5, v6, 9, v5
  v_and_b32 v6, 3, v2
  v_lshl_add_u32 v5, v6, 3, v5
  v_add_u32 v5, 98304, v5
  s_xor_b32 s3, s18, 0
  s_lshl_b32 s3, s3, 6
  v_add_u32 v20, s3, v5
  s_xor_b32 s3, s18, 1
  s_lshl_b32 s3, s3, 6
  v_add_u32 v21, s3, v5
  s_xor_b32 s3, s18, 2
  s_lshl_b32 s3, s3, 6
  v_add_u32 v22, s3, v5
  s_xor_b32 s3, s18, 3
  s_lshl_b32 s3, s3, 6
  v_add_u32 v23, s3, v5
  v_and_b32 v5, 15, v2
  v_lshrrev_b32 v6, 1, v5
  v_xor_b32 v6, v6, v4
  v_lshlrev_b32 v5, 7, v5
  v_add_u32 v5, s56, v5
  v_lshl_add_u32 v24, v6, 4, v5
  v_xor_b32 v6, 4, v6
  v_lshl_add_u32 v25, v6, 4, v5
  v_add_u32 v26, 65536, v24
  v_add_u32 v27, 65536, v25
  v_mov_b32 v36, 0x3f803f80
  v_mov_b32 v37, 0x3f803f80
  v_mov_b32 v38, 0x3f803f80
  v_mov_b32 v39, 0x3f803f80
  v_lshrrev_b32 v4, 4, v2
  v_lshlrev_b32 v4, 3, v4
  s_lshr_b32 s3, s18, 1
  s_lshl_b32 s3, s3, 5
  s_and_b32 s4, s18, 1
  s_lshl_b32 s4, s4, 2
  s_add_u32 s3, s3, s4
  v_add_u32 v4, s3, v4
  v_mul_u32_u24 v4, 9216, v4
  v_and_b32 v5, 15, v2
  v_lshl_add_u32 v4, v5, 4, v4
  s_lshl_b32 s3, s8, 8
  s_add_u32 s3, s3, s94
  v_add_u32 v28, s3, v4
  v_add_u32 v29, 8160, v28
  v_add_u32 v30, 16320, v28
  v_add_u32 v31, 24480, v28
  s_lshr_b32 s3, s18, 1
  s_mul_i32 s3, s3, 36
  s_mul_i32 s4, s9, 6
  s_add_u32 s3, s3, s4
  s_and_b32 s4, s18, 1
  s_mul_i32 s4, s4, 3
  s_add_u32 s3, s3, s4
  s_lshl_b32 s3, s3, 10
  s_add_u32 s3, s3, 23068672
  s_add_u32 s3, s3, s94
  v_add_u32 v32, s3, v3
  s_mul_i32 s60, s18, 4224
  s_mul_i32 s61, s18, 3072
  s_add_u32 s61, s61, 16896
  v_and_b32 v5, 15, v2
  s_lshl_b32 s3, s5, 9
  s_add_u32 s3, s3, 26214400
  v_lshl_add_u32 v33, v5, 3, s3
  v_lshlrev_b32 v192, 2, v2
  s_lshl2_add_u32 s99, s63, s18
  s_mul_i32 s3, s99, 9216
  s_mul_i32 s4, s62, 9
  s_lshr_b32 s4, s4, 1
  s_lshl_b32 s4, s4, 8
  s_add_u32 s3, s3, s4
  s_mov_b32 s62, 0
  s_mov_b32 s63, 0
  v_lshl_add_u32 v5, v2, 7, s3
  v_cmp_gt_u32 vcc, 10, v2
  s_mov_b32 s11, 0
  s_lshl_b32 s3, s8, 8
  v_cndmask_b32 v237, v201, v5, vcc
  s_and_b32 s4, s18, 1
  s_lshl_b32 s4, s4, 7
  s_add_u32 s3, s3, s4
  v_lshrrev_b32 v4, 4, v2
  v_lshl_add_u32 v233, v4, 3, s3
  v_lshlrev_b32 v200, 3, v198
  v_add_u32 v200, 26214400, v200
  v_cmp_eq_u32 vcc, 0, v196
  v_mul_u32_u24 v195, 1152, v197
  v_lshl_add_u32 v195, v196, 2, v195
  v_cndmask_b32 v200, v201, v200, vcc
  v_add_u32 v195, 148992, v195
  v_bfe_u32 v4, v0, 2, 2
  v_mul_u32_u24 v4, 1152, v4
  v_and_b32 v5, 3, v0
  v_lshl_add_u32 v4, v5, 3, v4
  v_lshrrev_b32 v5, 4, v0
  v_lshl_add_u32 v194, v5, 5, v4
  v_add_u32 v194, 148992, v194
  v_and_b32 v4, 15, v0
  v_lshlrev_b32 v4, 4, v4
  v_lshl_add_u32 v4, v5, 10, v4
  s_lshr_b32 s3, s2, 2
  s_mul_i32 s3, s3, 36864
  s_and_b32 s4, s2, 3
  s_lshl_b32 s4, s4, 8
  s_add_u32 s3, s3, s4
  s_add_u32 s3, s3, 23068672
  v_add_u32 v238, s3, v4
  v_cmp_gt_u32 vcc, 64, v0
  v_add_u32 v239, 16384, v238
  v_add_u32 v211, 32768, v238
  v_cndmask_b32 v211, v201, v211, vcc
  s_and_b32 s93, s2, 0xfc
  s_add_u32 m0, s56, 32768
  s_nop 0
  buffer_load_dwordx4 v10, s[20:23], s58 offen offset:0 lds
  buffer_load_dwordx4 v11, s[20:23], s58 offen offset:1024 lds
  buffer_load_dwordx4 v12, s[20:23], s58 offen offset:2048 lds
  buffer_load_dwordx4 v13, s[20:23], s58 offen offset:3072 lds
  s_add_u32 m0, s57, 115200
  s_nop 0
  buffer_load_dwordx4 v18, s[24:27], s59 offen lds
  buffer_load_dwordx4 v19, s[24:27], s59 offen offset:1056 lds
  s_add_u32 s59, s59, 262144
  s_add_u32 m0, s56, 36864
  s_nop 0
  buffer_load_dwordx4 v14, s[20:23], s58 offen offset:0 lds
  buffer_load_dwordx4 v15, s[20:23], s58 offen offset:1024 lds
  buffer_load_dwordx4 v16, s[20:23], s58 offen offset:2048 lds
  buffer_load_dwordx4 v17, s[20:23], s58 offen offset:3072 lds
  s_add_u32 s58, s58, 128
  s_add_u32 m0, s57, 123648
  s_nop 0
  buffer_load_dwordx4 v18, s[24:27], s59 offen lds
  buffer_load_dwordx4 v19, s[24:27], s59 offen offset:1056 lds
  s_add_u32 s59, s59, 262144
  s_waitcnt vmcnt(24)
  v_lshlrev_b32 v212, 16, v202
  v_and_b32 v213, 0xffff0000, v202
  v_lshlrev_b32 v214, 16, v203
  v_and_b32 v215, 0xffff0000, v203
  v_lshlrev_b32 v216, 16, v204
  v_and_b32 v217, 0xffff0000, v204
  v_lshlrev_b32 v218, 16, v205
  v_and_b32 v219, 0xffff0000, v205
  v_lshlrev_b32 v220, 16, v206
  v_and_b32 v221, 0xffff0000, v206
  v_lshlrev_b32 v222, 16, v207
  v_and_b32 v223, 0xffff0000, v207
  v_lshlrev_b32 v224, 16, v208
  v_and_b32 v225, 0xffff0000, v208
  v_lshlrev_b32 v226, 16, v209
  v_and_b32 v227, 0xffff0000, v209
  v_lshlrev_b32 v228, 16, v210
  v_and_b32 v229, 0xffff0000, v210
  v_pk_add_f32 v[230:231], v[212:213], v[214:215]
  v_pk_add_f32 v[230:231], v[230:231], v[216:217]
  v_pk_add_f32 v[230:231], v[230:231], v[218:219]
  v_pk_add_f32 v[230:231], v[230:231], v[220:221]
  v_pk_add_f32 v[230:231], v[230:231], v[222:223]
  v_pk_add_f32 v[230:231], v[230:231], v[224:225]
  v_pk_add_f32 v[230:231], v[230:231], v[226:227]
  v_pk_add_f32 v[230:231], v[230:231], v[228:229]
  v_add_f32 v234, v230, v231
  s_nop 1
  v_add_f32_dpp v234, v234, v234 row_ror:8 row_mask:0xf bank_mask:0xf
  s_nop 1
  v_add_f32_dpp v234, v234, v234 row_ror:4 row_mask:0xf bank_mask:0xf
  s_nop 1
  v_add_f32_dpp v234, v234, v234 row_ror:2 row_mask:0xf bank_mask:0xf
  s_nop 1
  v_add_f32_dpp v234, v234, v234 row_ror:1 row_mask:0xf bank_mask:0xf
  v_mov_b32 v230, v234
  s_nop 1
  v_permlane16_swap_b32 v234, v230
  v_add_f32 v234, v234, v230
  v_mul_f32 v234, 0xbae38e39, v234
  v_pk_add_f32 v[212:213], v[212:213], v[234:235] op_sel_hi:[1,0]
  v_pk_add_f32 v[214:215], v[214:215], v[234:235] op_sel_hi:[1,0]
  v_pk_add_f32 v[216:217], v[216:217], v[234:235] op_sel_hi:[1,0]
  v_pk_add_f32 v[218:219], v[218:219], v[234:235] op_sel_hi:[1,0]
  v_pk_add_f32 v[220:221], v[220:221], v[234:235] op_sel_hi:[1,0]
  v_pk_add_f32 v[222:223], v[222:223], v[234:235] op_sel_hi:[1,0]
  v_pk_add_f32 v[224:225], v[224:225], v[234:235] op_sel_hi:[1,0]
  v_pk_add_f32 v[226:227], v[226:227], v[234:235] op_sel_hi:[1,0]
  v_pk_add_f32 v[228:229], v[228:229], v[234:235] op_sel_hi:[1,0]
  v_pk_mul_f32 v[230:231], v[212:213], v[212:213]
  v_pk_fma_f32 v[230:231], v[214:215], v[214:215], v[230:231]
  v_pk_fma_f32 v[230:231], v[216:217], v[216:217], v[230:231]
  v_pk_fma_f32 v[230:231], v[218:219], v[218:219], v[230:231]
  v_pk_fma_f32 v[230:231], v[220:221], v[220:221], v[230:231]
  v_pk_fma_f32 v[230:231], v[222:223], v[222:223], v[230:231]
  v_pk_fma_f32 v[230:231], v[224:225], v[224:225], v[230:231]
  v_pk_fma_f32 v[230:231], v[226:227], v[226:227], v[230:231]
  v_pk_fma_f32 v[230:231], v[228:229], v[228:229], v[230:231]
  v_add_f32 v231, v230, v231
  s_nop 1
  v_add_f32_dpp v231, v231, v231 row_ror:8 row_mask:0xf bank_mask:0xf
  s_nop 1
  v_add_f32_dpp v231, v231, v231 row_ror:4 row_mask:0xf bank_mask:0xf
  s_nop 1
  v_add_f32_dpp v231, v231, v231 row_ror:2 row_mask:0xf bank_mask:0xf
  s_nop 1
  v_add_f32_dpp v231, v231, v231 row_ror:1 row_mask:0xf bank_mask:0xf
  v_mov_b32 v230, v231
  s_nop 1
  v_permlane16_swap_b32 v231, v230
  v_add_f32 v231, v231, v230
  v_mov_b32 v230, 0x3727c5ac
  v_fmac_f32 v230, 0x3ae38e39, v231
  v_rsq_f32 v230, v230
  s_nop 0
  v_pk_mul_f32 v[212:213], v[212:213], v[230:231] op_sel_hi:[1,0]
  v_pk_mul_f32 v[214:215], v[214:215], v[230:231] op_sel_hi:[1,0]
  v_pk_mul_f32 v[216:217], v[216:217], v[230:231] op_sel_hi:[1,0]
  v_pk_mul_f32 v[218:219], v[218:219], v[230:231] op_sel_hi:[1,0]
  v_pk_mul_f32 v[220:221], v[220:221], v[230:231] op_sel_hi:[1,0]
  v_pk_mul_f32 v[222:223], v[222:223], v[230:231] op_sel_hi:[1,0]
  v_pk_mul_f32 v[224:225], v[224:225], v[230:231] op_sel_hi:[1,0]
  v_pk_mul_f32 v[226:227], v[226:227], v[230:231] op_sel_hi:[1,0]
  v_pk_mul_f32 v[228:229], v[228:229], v[230:231] op_sel_hi:[1,0]
  v_cvt_pk_bf16_f32 v202, v212, v213
  v_cvt_pk_bf16_f32 v203, v214, v215
  v_cvt_pk_bf16_f32 v204, v216, v217
  v_cvt_pk_bf16_f32 v205, v218, v219
  v_cvt_pk_bf16_f32 v206, v220, v221
  v_cvt_pk_bf16_f32 v207, v222, v223
  v_cvt_pk_bf16_f32 v208, v224, v225
  v_cvt_pk_bf16_f32 v209, v226, v227
  v_cvt_pk_bf16_f32 v210, v228, v229
  v_mul_f32 v235, 0x3e0293ee, v230
  v_lshlrev_b32 v212, 16, v202
  v_and_b32 v213, 0xffff0000, v202
  v_lshlrev_b32 v214, 16, v203
  v_and_b32 v215, 0xffff0000, v203
  v_lshlrev_b32 v216, 16, v204
  v_and_b32 v217, 0xffff0000, v204
  v_lshlrev_b32 v218, 16, v205
  v_and_b32 v219, 0xffff0000, v205
  v_lshlrev_b32 v220, 16, v206
  v_and_b32 v221, 0xffff0000, v206
  v_lshlrev_b32 v222, 16, v207
  v_and_b32 v223, 0xffff0000, v207
  v_lshlrev_b32 v224, 16, v208
  v_and_b32 v225, 0xffff0000, v208
  v_lshlrev_b32 v226, 16, v209
  v_and_b32 v227, 0xffff0000, v209
  v_lshlrev_b32 v228, 16, v210
  v_and_b32 v229, 0xffff0000, v210
  v_pk_add_f32 v[230:231], v[212:213], v[214:215]
  v_pk_mul_f32 v[244:245], v[212:213], v[212:213]
  v_pk_fma_f32 v[244:245], v[214:215], v[214:215], v[244:245]
  v_pk_add_f32 v[230:231], v[230:231], v[216:217]
  v_pk_fma_f32 v[244:245], v[216:217], v[216:217], v[244:245]
  v_pk_add_f32 v[230:231], v[230:231], v[218:219]
  v_pk_fma_f32 v[244:245], v[218:219], v[218:219], v[244:245]
  v_pk_add_f32 v[230:231], v[230:231], v[220:221]
  v_pk_fma_f32 v[244:245], v[220:221], v[220:221], v[244:245]
  v_pk_add_f32 v[230:231], v[230:231], v[222:223]
  v_pk_fma_f32 v[244:245], v[222:223], v[222:223], v[244:245]
  v_pk_add_f32 v[230:231], v[230:231], v[224:225]
  v_pk_fma_f32 v[244:245], v[224:225], v[224:225], v[244:245]
  v_pk_add_f32 v[230:231], v[230:231], v[226:227]
  v_pk_fma_f32 v[244:245], v[226:227], v[226:227], v[244:245]
  v_pk_add_f32 v[230:231], v[230:231], v[228:229]
  v_pk_fma_f32 v[244:245], v[228:229], v[228:229], v[244:245]
  v_add_f32 v231, v230, v231
  v_add_f32 v232, v244, v245
  s_nop 0
  v_add_f32_dpp v231, v231, v231 row_ror:8 row_mask:0xf bank_mask:0xf
  v_add_f32_dpp v232, v232, v232 row_ror:8 row_mask:0xf bank_mask:0xf
  s_nop 0
  v_add_f32_dpp v231, v231, v231 row_ror:4 row_mask:0xf bank_mask:0xf
  v_add_f32_dpp v232, v232, v232 row_ror:4 row_mask:0xf bank_mask:0xf
  s_nop 0
  v_add_f32_dpp v231, v231, v231 row_ror:2 row_mask:0xf bank_mask:0xf
  v_add_f32_dpp v232, v232, v232 row_ror:2 row_mask:0xf bank_mask:0xf
  s_nop 0
  v_add_f32_dpp v231, v231, v231 row_ror:1 row_mask:0xf bank_mask:0xf
  v_add_f32_dpp v232, v232, v232 row_ror:1 row_mask:0xf bank_mask:0xf
  v_mov_b32 v230, v231
  v_mov_b32 v193, v232
  s_nop 1
  v_permlane16_swap_b32 v231, v230
  v_permlane16_swap_b32 v232, v193
  v_add_f32 v231, v231, v230
  v_add_f32 v232, v232, v193
  v_mul_f32 v231, 0xbae38e39, v231
  v_mov_b32 v230, 0x3727c5ac
  v_fmac_f32 v230, 0x3ae38e39, v232
  v_fma_f32 v230, -v231, v231, v230
  v_rsq_f32 v230, v230
  s_nop 0
  v_mul_f32 v231, v231, v230
  v_pk_fma_f32 v[212:213], v[212:213], v[230:231], v[230:231] op_sel:[0,0,1] op_sel_hi:[1,0,1]
  v_pk_fma_f32 v[214:215], v[214:215], v[230:231], v[230:231] op_sel:[0,0,1] op_sel_hi:[1,0,1]
  v_pk_fma_f32 v[216:217], v[216:217], v[230:231], v[230:231] op_sel:[0,0,1] op_sel_hi:[1,0,1]
  v_pk_fma_f32 v[218:219], v[218:219], v[230:231], v[230:231] op_sel:[0,0,1] op_sel_hi:[1,0,1]
  v_pk_fma_f32 v[220:221], v[220:221], v[230:231], v[230:231] op_sel:[0,0,1] op_sel_hi:[1,0,1]
  v_pk_fma_f32 v[222:223], v[222:223], v[230:231], v[230:231] op_sel:[0,0,1] op_sel_hi:[1,0,1]
  v_pk_fma_f32 v[224:225], v[224:225], v[230:231], v[230:231] op_sel:[0,0,1] op_sel_hi:[1,0,1]
  v_pk_fma_f32 v[226:227], v[226:227], v[230:231], v[230:231] op_sel:[0,0,1] op_sel_hi:[1,0,1]
  v_pk_fma_f32 v[228:229], v[228:229], v[230:231], v[230:231] op_sel:[0,0,1] op_sel_hi:[1,0,1]
  v_cvt_pk_bf16_f32 v202, v212, v213
  v_cvt_pk_bf16_f32 v203, v214, v215
  v_cvt_pk_bf16_f32 v204, v216, v217
  v_cvt_pk_bf16_f32 v205, v218, v219
  v_cvt_pk_bf16_f32 v206, v220, v221
  v_cvt_pk_bf16_f32 v207, v222, v223
  v_cvt_pk_bf16_f32 v208, v224, v225
  v_cvt_pk_bf16_f32 v209, v226, v227
  v_cvt_pk_bf16_f32 v210, v228, v229
  ds_write_b32 v195, v202 offset:0
  ds_write_b32 v195, v203 offset:128
  ds_write_b32 v195, v204 offset:256
  ds_write_b32 v195, v205 offset:384
  ds_write_b32 v195, v206 offset:512
  ds_write_b32 v195, v207 offset:640
  ds_write_b32 v195, v208 offset:768
  ds_write_b32 v195, v209 offset:896
  ds_write_b32 v195, v210 offset:1024
  s_mov_b64 exec, 0
  s_cmp_eq_u32 s18, 0
  s_cbranch_scc1 TP_0
  s_cmp_eq_u32 s18, 1
  s_cbranch_scc1 TP_1
  s_cmp_eq_u32 s18, 2
  s_cbranch_scc1 TP_2
  s_branch TP_3
TR_1:
  s_mov_b64 exec, -1
  s_branch K_main
.p2align 12
K_main:
TP_0:
  s_cbranch_execz TP_4
  s_waitcnt vmcnt(14) lgkmcnt(0)
  s_barrier
  ds_read_b128 a[32:35], v24 offset:0
  ds_read_b128 a[36:39], v24 offset:2048
  ds_read_b128 a[40:43], v24 offset:4096
  ds_read_b128 a[44:47], v24 offset:6144
  ds_read_b64_tr_b16 a[0:1], v20 offset:0
  ds_read_b64_tr_b16 a[2:3], v20 offset:256
  ds_read_b64_tr_b16 a[4:5], v20 offset:32
  ds_read_b64_tr_b16 a[6:7], v20 offset:288
  ds_read_b64_tr_b16 a[8:9], v21 offset:0
  ds_read_b64_tr_b16 a[10:11], v21 offset:256
  ds_read_b64_tr_b16 a[12:13], v21 offset:32
  ds_read_b64_tr_b16 a[14:15], v21 offset:288
  ds_read_b64_tr_b16 a[16:17], v22 offset:0
  ds_read_b64_tr_b16 a[18:19], v22 offset:256
  ds_read_b64_tr_b16 a[20:21], v22 offset:32
  ds_read_b64_tr_b16 a[22:23], v22 offset:288
  ds_read_b64_tr_b16 a[24:25], v23 offset:0
  ds_read_b64_tr_b16 a[26:27], v23 offset:256
  ds_read_b64_tr_b16 a[28:29], v23 offset:32
  ds_read_b64_tr_b16 a[30:31], v23 offset:288
  ds_read_b64_tr_b16 v[244:245], v194 offset:0
  ds_read_b64_tr_b16 v[246:247], v194 offset:4608
  ds_read_b64_tr_b16 v[248:249], v194 offset:512
  ds_read_b64_tr_b16 v[250:251], v194 offset:5120
  ds_read_b64_tr_b16 v[252:253], v194 offset:1024
  ds_read_b64_tr_b16 v[254:255], v194 offset:5632
  s_waitcnt vmcnt(12) lgkmcnt(0)
  s_barrier
  v_mfma_f32_16x16x32_bf16 v[64:67], a[0:3], a[32:35], 0
  buffer_store_dwordx4 v[244:247], v238, s[12:15], 0 offen sc1
  ds_read_b128 a[80:83], v25 offset:0
  v_mfma_f32_16x16x32_bf16 v[68:71], a[0:3], a[36:39], 0
  buffer_store_dwordx4 v[248:251], v239, s[12:15], 0 offen sc1
  ds_read_b128 a[84:87], v25 offset:2048
  v_mfma_f32_16x16x32_bf16 v[72:75], a[0:3], a[40:43], 0
  buffer_store_dwordx4 v[252:255], v211, s[12:15], 0 offen sc1
  ds_read_b128 a[88:91], v25 offset:4096
  v_mfma_f32_16x16x32_bf16 v[76:79], a[0:3], a[44:47], 0
  v_mfma_f32_16x16x32_bf16 v[56:59], a[0:3], v[36:39], 0
  buffer_store_dwordx2 v[234:235], v200, s[12:15], 0 offen sc1
  ds_read_b128 a[92:95], v25 offset:6144
  v_mfma_f32_16x16x32_bf16 v[80:83], a[4:7], a[32:35], 0
  buffer_store_dword v7, v8, s[12:15], s44 offen sc1
  ds_read_b64_tr_b16 a[48:49], v20 offset:8448
  v_mfma_f32_16x16x32_bf16 v[84:87], a[4:7], a[36:39], 0
  ds_read_b64_tr_b16 a[50:51], v20 offset:8704
  v_mfma_f32_16x16x32_bf16 v[88:91], a[4:7], a[40:43], 0
  buffer_store_dword v7, v8, s[12:15], s45 offen sc1
  v_mfma_f32_16x16x32_bf16 v[92:95], a[4:7], a[44:47], 0
  buffer_store_dword v7, v8, s[12:15], s95 offen sc1
  ds_read_b64_tr_b16 a[52:53], v20 offset:8480
  v_mfma_f32_16x16x32_bf16 v[60:63], a[4:7], v[36:39], 0
  ds_read_b64_tr_b16 a[54:55], v20 offset:8736
  v_mfma_f32_16x16x32_bf16 v[96:99], a[8:11], a[32:35], 0
  s_add_u32 m0, s56, 65536
  ds_read_b64_tr_b16 a[56:57], v21 offset:8448
  v_mfma_f32_16x16x32_bf16 v[100:103], a[8:11], a[36:39], 0
  buffer_load_dwordx4 v10, s[20:23], s58 offen offset:0 lds
  v_mfma_f32_16x16x32_bf16 v[104:107], a[8:11], a[40:43], 0
  ds_read_b64_tr_b16 a[58:59], v21 offset:8704
  v_mfma_f32_16x16x32_bf16 v[108:111], a[8:11], a[44:47], 0
  buffer_load_dwordx4 v11, s[20:23], s58 offen offset:1024 lds
  ds_read_b64_tr_b16 a[60:61], v21 offset:8480
  v_mfma_f32_16x16x32_bf16 v[112:115], a[12:15], a[32:35], 0
  buffer_load_dwordx4 v12, s[20:23], s58 offen offset:2048 lds
  ds_read_b64_tr_b16 a[62:63], v21 offset:8736
  v_mfma_f32_16x16x32_bf16 v[116:119], a[12:15], a[36:39], 0
  v_mfma_f32_16x16x32_bf16 v[120:123], a[12:15], a[40:43], 0
  buffer_load_dwordx4 v13, s[20:23], s58 offen offset:3072 lds
  ds_read_b64_tr_b16 a[64:65], v22 offset:8448
  v_mfma_f32_16x16x32_bf16 v[124:127], a[12:15], a[44:47], 0
  s_add_u32 m0, s56, 69632
  ds_read_b64_tr_b16 a[66:67], v22 offset:8704
  v_mfma_f32_16x16x32_bf16 v[128:131], a[16:19], a[32:35], 0
  buffer_load_dwordx4 v14, s[20:23], s58 offen offset:0 lds
  ds_read_b64_tr_b16 a[68:69], v22 offset:8480
  v_mfma_f32_16x16x32_bf16 v[132:135], a[16:19], a[36:39], 0
  v_mfma_f32_16x16x32_bf16 v[136:139], a[16:19], a[40:43], 0
  buffer_load_dwordx4 v15, s[20:23], s58 offen offset:1024 lds
  ds_read_b64_tr_b16 a[70:71], v22 offset:8736
  v_mfma_f32_16x16x32_bf16 v[140:143], a[16:19], a[44:47], 0
  buffer_load_dwordx4 v16, s[20:23], s58 offen offset:2048 lds
  ds_read_b64_tr_b16 a[72:73], v23 offset:8448
  v_mfma_f32_16x16x32_bf16 v[144:147], a[20:23], a[32:35], 0
  ds_read_b64_tr_b16 a[74:75], v23 offset:8704
  v_mfma_f32_16x16x32_bf16 v[148:151], a[20:23], a[36:39], 0
  buffer_load_dwordx4 v17, s[20:23], s58 offen offset:3072 lds
  v_mfma_f32_16x16x32_bf16 v[152:155], a[20:23], a[40:43], 0
  s_add_u32 s58, s58, 128
  ds_read_b64_tr_b16 a[76:77], v23 offset:8480
  v_mfma_f32_16x16x32_bf16 v[156:159], a[20:23], a[44:47], 0
  ds_read_b64_tr_b16 a[78:79], v23 offset:8736
  v_mfma_f32_16x16x32_bf16 v[160:163], a[24:27], a[32:35], 0
  s_add_u32 m0, s57, 132096
  v_mfma_f32_16x16x32_bf16 v[164:167], a[24:27], a[36:39], 0
  buffer_load_dwordx4 v18, s[24:27], s59 offen lds
  v_mfma_f32_16x16x32_bf16 v[168:171], a[24:27], a[40:43], 0
  v_mfma_f32_16x16x32_bf16 v[172:175], a[24:27], a[44:47], 0
  buffer_load_dwordx4 v19, s[24:27], s59 offen offset:1056 lds
  v_mfma_f32_16x16x32_bf16 v[176:179], a[28:31], a[32:35], 0
  s_add_u32 s59, s59, 262144
  v_mfma_f32_16x16x32_bf16 v[180:183], a[28:31], a[36:39], 0
  v_mfma_f32_16x16x32_bf16 v[184:187], a[28:31], a[40:43], 0
  v_mfma_f32_16x16x32_bf16 v[188:191], a[28:31], a[44:47], 0
  s_waitcnt vmcnt(19) lgkmcnt(0)
  s_barrier
  v_mfma_f32_16x16x32_bf16 v[64:67], a[48:51], a[80:83], v[64:67]
  s_add_u32 m0, s56, 0
  ds_read_b128 a[32:35], v24 offset:32768
  v_mfma_f32_16x16x32_bf16 v[68:71], a[48:51], a[84:87], v[68:71]
  ds_read_b128 a[36:39], v24 offset:34816
  v_mfma_f32_16x16x32_bf16 v[72:75], a[48:51], a[88:91], v[72:75]
  buffer_load_dwordx4 v10, s[20:23], s58 offen offset:0 lds
  ds_read_b128 a[40:43], v24 offset:36864
  v_mfma_f32_16x16x32_bf16 v[76:79], a[48:51], a[92:95], v[76:79]
  v_mfma_f32_16x16x32_bf16 v[56:59], a[48:51], v[36:39], v[56:59]
  buffer_load_dwordx4 v11, s[20:23], s58 offen offset:1024 lds
  ds_read_b128 a[44:47], v24 offset:38912
  v_mfma_f32_16x16x32_bf16 v[80:83], a[52:55], a[80:83], v[80:83]
  ds_read_b64_tr_b16 a[0:1], v20 offset:16896
  v_mfma_f32_16x16x32_bf16 v[84:87], a[52:55], a[84:87], v[84:87]
  ds_read_b64_tr_b16 a[2:3], v20 offset:17152
  v_mfma_f32_16x16x32_bf16 v[88:91], a[52:55], a[88:91], v[88:91]
  buffer_load_dwordx4 v12, s[20:23], s58 offen offset:2048 lds
  v_mfma_f32_16x16x32_bf16 v[92:95], a[52:55], a[92:95], v[92:95]
  ds_read_b64_tr_b16 a[4:5], v20 offset:16928
  v_mfma_f32_16x16x32_bf16 v[60:63], a[52:55], v[36:39], v[60:63]
  buffer_load_dwordx4 v13, s[20:23], s58 offen offset:3072 lds
  ds_read_b64_tr_b16 a[6:7], v20 offset:17184
  v_mfma_f32_16x16x32_bf16 v[96:99], a[56:59], a[80:83], v[96:99]
  ds_read_b64_tr_b16 a[8:9], v21 offset:16896
  v_mfma_f32_16x16x32_bf16 v[100:103], a[56:59], a[84:87], v[100:103]
  v_mfma_f32_16x16x32_bf16 v[104:107], a[56:59], a[88:91], v[104:107]
  s_add_u32 m0, s57, 140544
  ds_read_b64_tr_b16 a[10:11], v21 offset:17152
  v_mfma_f32_16x16x32_bf16 v[108:111], a[56:59], a[92:95], v[108:111]
  ds_read_b64_tr_b16 a[12:13], v21 offset:16928
  v_mfma_f32_16x16x32_bf16 v[112:115], a[60:63], a[80:83], v[112:115]
  buffer_load_dwordx4 v18, s[24:27], s59 offen lds
  ds_read_b64_tr_b16 a[14:15], v21 offset:17184
  v_mfma_f32_16x16x32_bf16 v[116:119], a[60:63], a[84:87], v[116:119]
  v_mfma_f32_16x16x32_bf16 v[120:123], a[60:63], a[88:91], v[120:123]
  ds_read_b64_tr_b16 a[16:17], v22 offset:16896
  v_mfma_f32_16x16x32_bf16 v[124:127], a[60:63], a[92:95], v[124:127]
  buffer_load_dwordx4 v19, s[24:27], s59 offen offset:1056 lds
  ds_read_b64_tr_b16 a[18:19], v22 offset:17152
  v_mfma_f32_16x16x32_bf16 v[128:131], a[64:67], a[80:83], v[128:131]
  ds_read_b64_tr_b16 a[20:21], v22 offset:16928
  v_mfma_f32_16x16x32_bf16 v[132:135], a[64:67], a[84:87], v[132:135]
  s_add_u32 s59, s59, 262144
  v_mfma_f32_16x16x32_bf16 v[136:139], a[64:67], a[88:91], v[136:139]
  ds_read_b64_tr_b16 a[22:23], v22 offset:17184
  v_mfma_f32_16x16x32_bf16 v[140:143], a[64:67], a[92:95], v[140:143]
  ds_read_b64_tr_b16 a[24:25], v23 offset:16896
  v_mfma_f32_16x16x32_bf16 v[144:147], a[68:71], a[80:83], v[144:147]
  s_add_u32 m0, s57, 98304
  ds_read_b64_tr_b16 a[26:27], v23 offset:17152
  v_mfma_f32_16x16x32_bf16 v[148:151], a[68:71], a[84:87], v[148:151]
  v_mfma_f32_16x16x32_bf16 v[152:155], a[68:71], a[88:91], v[152:155]
  buffer_load_dwordx4 v18, s[24:27], s59 offen lds
  ds_read_b64_tr_b16 a[28:29], v23 offset:16928
  v_mfma_f32_16x16x32_bf16 v[156:159], a[68:71], a[92:95], v[156:159]
  ds_read_b64_tr_b16 a[30:31], v23 offset:17184
  v_mfma_f32_16x16x32_bf16 v[160:163], a[72:75], a[80:83], v[160:163]
  v_mfma_f32_16x16x32_bf16 v[164:167], a[72:75], a[84:87], v[164:167]
  buffer_load_dwordx4 v19, s[24:27], s59 offen offset:1056 lds
  v_mfma_f32_16x16x32_bf16 v[168:171], a[72:75], a[88:91], v[168:171]
  v_mfma_f32_16x16x32_bf16 v[172:175], a[72:75], a[92:95], v[172:175]
  s_add_u32 s59, s59, 262144
  v_mfma_f32_16x16x32_bf16 v[176:179], a[76:79], a[80:83], v[176:179]
  v_mfma_f32_16x16x32_bf16 v[180:183], a[76:79], a[84:87], v[180:183]
  v_mfma_f32_16x16x32_bf16 v[184:187], a[76:79], a[88:91], v[184:187]
  v_mfma_f32_16x16x32_bf16 v[188:191], a[76:79], a[92:95], v[188:191]
  s_waitcnt vmcnt(25) lgkmcnt(0)
  s_barrier
  v_mfma_f32_16x16x32_bf16 v[64:67], a[0:3], a[32:35], v[64:67]
  s_add_u32 m0, s56, 4096
  ds_read_b128 a[80:83], v25 offset:32768
  v_mfma_f32_16x16x32_bf16 v[68:71], a[0:3], a[36:39], v[68:71]
  ds_read_b128 a[84:87], v25 offset:34816
  v_mfma_f32_16x16x32_bf16 v[72:75], a[0:3], a[40:43], v[72:75]
  buffer_load_dwordx4 v14, s[20:23], s58 offen offset:0 lds
  ds_read_b128 a[88:91], v25 offset:36864
  v_mfma_f32_16x16x32_bf16 v[76:79], a[0:3], a[44:47], v[76:79]
  v_mfma_f32_16x16x32_bf16 v[56:59], a[0:3], v[36:39], v[56:59]
  buffer_load_dwordx4 v15, s[20:23], s58 offen offset:1024 lds
  ds_read_b128 a[92:95], v25 offset:38912
  v_mfma_f32_16x16x32_bf16 v[80:83], a[4:7], a[32:35], v[80:83]
  ds_read_b64_tr_b16 a[48:49], v20 offset:25344
  v_mfma_f32_16x16x32_bf16 v[84:87], a[4:7], a[36:39], v[84:87]
  buffer_load_dwordx4 v16, s[20:23], s58 offen offset:2048 lds
  ds_read_b64_tr_b16 a[50:51], v20 offset:25600
  v_mfma_f32_16x16x32_bf16 v[88:91], a[4:7], a[40:43], v[88:91]
  v_mfma_f32_16x16x32_bf16 v[92:95], a[4:7], a[44:47], v[92:95]
  ds_read_b64_tr_b16 a[52:53], v20 offset:25376
  v_mfma_f32_16x16x32_bf16 v[60:63], a[4:7], v[36:39], v[60:63]
  buffer_load_dwordx4 v17, s[20:23], s58 offen offset:3072 lds
  ds_read_b64_tr_b16 a[54:55], v20 offset:25632
  v_mfma_f32_16x16x32_bf16 v[96:99], a[8:11], a[32:35], v[96:99]
  ds_read_b64_tr_b16 a[56:57], v21 offset:25344
  v_mfma_f32_16x16x32_bf16 v[100:103], a[8:11], a[36:39], v[100:103]
  s_add_u32 s58, s58, 128
  v_mfma_f32_16x16x32_bf16 v[104:107], a[8:11], a[40:43], v[104:107]
  ds_read_b64_tr_b16 a[58:59], v21 offset:25600
  v_mfma_f32_16x16x32_bf16 v[108:111], a[8:11], a[44:47], v[108:111]
  s_add_u32 m0, s57, 106752
  ds_read_b64_tr_b16 a[60:61], v21 offset:25376
  v_mfma_f32_16x16x32_bf16 v[112:115], a[12:15], a[32:35], v[112:115]
  ds_read_b64_tr_b16 a[62:63], v21 offset:25632
  v_mfma_f32_16x16x32_bf16 v[116:119], a[12:15], a[36:39], v[116:119]
  v_mfma_f32_16x16x32_bf16 v[120:123], a[12:15], a[40:43], v[120:123]
  buffer_load_dwordx4 v18, s[24:27], s59 offen lds
  ds_read_b64_tr_b16 a[64:65], v22 offset:25344
  v_mfma_f32_16x16x32_bf16 v[124:127], a[12:15], a[44:47], v[124:127]
  ds_read_b64_tr_b16 a[66:67], v22 offset:25600
  v_mfma_f32_16x16x32_bf16 v[128:131], a[16:19], a[32:35], v[128:131]
  buffer_load_dwordx4 v19, s[24:27], s59 offen offset:1056 lds
  ds_read_b64_tr_b16 a[68:69], v22 offset:25376
  v_mfma_f32_16x16x32_bf16 v[132:135], a[16:19], a[36:39], v[132:135]
  v_mfma_f32_16x16x32_bf16 v[136:139], a[16:19], a[40:43], v[136:139]
  s_add_u32 s59, s59, 262144
  ds_read_b64_tr_b16 a[70:71], v22 offset:25632
  v_mfma_f32_16x16x32_bf16 v[140:143], a[16:19], a[44:47], v[140:143]
  ds_read_b64_tr_b16 a[72:73], v23 offset:25344
  v_mfma_f32_16x16x32_bf16 v[144:147], a[20:23], a[32:35], v[144:147]
  s_add_u32 m0, s57, 115200
  ds_read_b64_tr_b16 a[74:75], v23 offset:25600
  v_mfma_f32_16x16x32_bf16 v[148:151], a[20:23], a[36:39], v[148:151]
  v_mfma_f32_16x16x32_bf16 v[152:155], a[20:23], a[40:43], v[152:155]
  ds_read_b64_tr_b16 a[76:77], v23 offset:25376
  v_mfma_f32_16x16x32_bf16 v[156:159], a[20:23], a[44:47], v[156:159]
  buffer_load_dwordx4 v18, s[24:27], s59 offen lds
  ds_read_b64_tr_b16 a[78:79], v23 offset:25632
  v_mfma_f32_16x16x32_bf16 v[160:163], a[24:27], a[32:35], v[160:163]
  v_mfma_f32_16x16x32_bf16 v[164:167], a[24:27], a[36:39], v[164:167]
  buffer_load_dwordx4 v19, s[24:27], s59 offen offset:1056 lds
  v_mfma_f32_16x16x32_bf16 v[168:171], a[24:27], a[40:43], v[168:171]
  v_mfma_f32_16x16x32_bf16 v[172:175], a[24:27], a[44:47], v[172:175]
  s_add_u32 s59, s59, 262144
  v_mfma_f32_16x16x32_bf16 v[176:179], a[28:31], a[32:35], v[176:179]
  v_mfma_f32_16x16x32_bf16 v[180:183], a[28:31], a[36:39], v[180:183]
  v_mfma_f32_16x16x32_bf16 v[184:187], a[28:31], a[40:43], v[184:187]
  v_mfma_f32_16x16x32_bf16 v[188:191], a[28:31], a[44:47], v[188:191]
  s_waitcnt vmcnt(16) lgkmcnt(0)
  s_barrier
  v_mfma_f32_16x16x32_bf16 v[64:67], a[48:51], a[80:83], v[64:67]
  buffer_atomic_add v9, v8, s[52:55], s93 offen sc1
  ds_read_b128 a[32:35], v26 offset:0
  v_mfma_f32_16x16x32_bf16 v[68:71], a[48:51], a[84:87], v[68:71]
  ds_read_b128 a[36:39], v26 offset:2048
  v_mfma_f32_16x16x32_bf16 v[72:75], a[48:51], a[88:91], v[72:75]
  ds_read_b128 a[40:43], v26 offset:4096
  v_mfma_f32_16x16x32_bf16 v[76:79], a[48:51], a[92:95], v[76:79]
  s_add_u32 m0, s56, 32768
  v_mfma_f32_16x16x32_bf16 v[56:59], a[48:51], v[36:39], v[56:59]
  ds_read_b128 a[44:47], v26 offset:6144
  v_mfma_f32_16x16x32_bf16 v[80:83], a[52:55], a[80:83], v[80:83]
  ds_read_b64_tr_b16 a[0:1], v20 offset:33792
  v_mfma_f32_16x16x32_bf16 v[84:87], a[52:55], a[84:87], v[84:87]
  buffer_load_dwordx4 v10, s[20:23], s58 offen offset:0 lds
  ds_read_b64_tr_b16 a[2:3], v20 offset:34048
  v_mfma_f32_16x16x32_bf16 v[88:91], a[52:55], a[88:91], v[88:91]
  v_mfma_f32_16x16x32_bf16 v[92:95], a[52:55], a[92:95], v[92:95]
  ds_read_b64_tr_b16 a[4:5], v20 offset:33824
  v_mfma_f32_16x16x32_bf16 v[60:63], a[52:55], v[36:39], v[60:63]
  buffer_load_dwordx4 v11, s[20:23], s58 offen offset:1024 lds
  ds_read_b64_tr_b16 a[6:7], v20 offset:34080
  v_mfma_f32_16x16x32_bf16 v[96:99], a[56:59], a[80:83], v[96:99]
  ds_read_b64_tr_b16 a[8:9], v21 offset:33792
  v_mfma_f32_16x16x32_bf16 v[100:103], a[56:59], a[84:87], v[100:103]
  v_mfma_f32_16x16x32_bf16 v[104:107], a[56:59], a[88:91], v[104:107]
  buffer_load_dwordx4 v12, s[20:23], s58 offen offset:2048 lds
  ds_read_b64_tr_b16 a[10:11], v21 offset:34048
  v_mfma_f32_16x16x32_bf16 v[108:111], a[56:59], a[92:95], v[108:111]
  ds_read_b64_tr_b16 a[12:13], v21 offset:33824
  v_mfma_f32_16x16x32_bf16 v[112:115], a[60:63], a[80:83], v[112:115]
  ds_read_b64_tr_b16 a[14:15], v21 offset:34080
  v_mfma_f32_16x16x32_bf16 v[116:119], a[60:63], a[84:87], v[116:119]
  v_mfma_f32_16x16x32_bf16 v[120:123], a[60:63], a[88:91], v[120:123]
  buffer_load_dwordx4 v13, s[20:23], s58 offen offset:3072 lds
  ds_read_b64_tr_b16 a[16:17], v22 offset:33792
  v_mfma_f32_16x16x32_bf16 v[124:127], a[60:63], a[92:95], v[124:127]
  ds_read_b64_tr_b16 a[18:19], v22 offset:34048
  v_mfma_f32_16x16x32_bf16 v[128:131], a[64:67], a[80:83], v[128:131]
  ds_read_b64_tr_b16 a[20:21], v22 offset:33824
  v_mfma_f32_16x16x32_bf16 v[132:135], a[64:67], a[84:87], v[132:135]
  s_add_u32 m0, s57, 123648
  v_mfma_f32_16x16x32_bf16 v[136:139], a[64:67], a[88:91], v[136:139]
  ds_read_b64_tr_b16 a[22:23], v22 offset:34080
  v_mfma_f32_16x16x32_bf16 v[140:143], a[64:67], a[92:95], v[140:143]
  ds_read_b64_tr_b16 a[24:25], v23 offset:33792
  v_mfma_f32_16x16x32_bf16 v[144:147], a[68:71], a[80:83], v[144:147]
  buffer_load_dwordx4 v18, s[24:27], s59 offen lds
  ds_read_b64_tr_b16 a[26:27], v23 offset:34048
  v_mfma_f32_16x16x32_bf16 v[148:151], a[68:71], a[84:87], v[148:151]
  v_mfma_f32_16x16x32_bf16 v[152:155], a[68:71], a[88:91], v[152:155]
  ds_read_b64_tr_b16 a[28:29], v23 offset:33824
  v_mfma_f32_16x16x32_bf16 v[156:159], a[68:71], a[92:95], v[156:159]
  buffer_load_dwordx4 v19, s[24:27], s59 offen offset:1056 lds
  ds_read_b64_tr_b16 a[30:31], v23 offset:34080
  v_mfma_f32_16x16x32_bf16 v[160:163], a[72:75], a[80:83], v[160:163]
  v_mfma_f32_16x16x32_bf16 v[164:167], a[72:75], a[84:87], v[164:167]
  v_mfma_f32_16x16x32_bf16 v[168:171], a[72:75], a[88:91], v[168:171]
  s_add_u32 s59, s59, 262144
  v_mfma_f32_16x16x32_bf16 v[172:175], a[72:75], a[92:95], v[172:175]
  v_mfma_f32_16x16x32_bf16 v[176:179], a[76:79], a[80:83], v[176:179]
  v_mfma_f32_16x16x32_bf16 v[180:183], a[76:79], a[84:87], v[180:183]
  v_mfma_f32_16x16x32_bf16 v[184:187], a[76:79], a[88:91], v[184:187]
  v_mfma_f32_16x16x32_bf16 v[188:191], a[76:79], a[92:95], v[188:191]
  s_waitcnt vmcnt(17) lgkmcnt(0)
  s_barrier
  v_mfma_f32_16x16x32_bf16 v[64:67], a[0:3], a[32:35], v[64:67]
  s_add_u32 m0, s56, 36864
  ds_read_b128 a[80:83], v27 offset:0
  v_mfma_f32_16x16x32_bf16 v[68:71], a[0:3], a[36:39], v[68:71]
  ds_read_b128 a[84:87], v27 offset:2048
  v_mfma_f32_16x16x32_bf16 v[72:75], a[0:3], a[40:43], v[72:75]
  buffer_load_dwordx4 v14, s[20:23], s58 offen offset:0 lds
  ds_read_b128 a[88:91], v27 offset:4096
  v_mfma_f32_16x16x32_bf16 v[76:79], a[0:3], a[44:47], v[76:79]
  v_mfma_f32_16x16x32_bf16 v[56:59], a[0:3], v[36:39], v[56:59]
  buffer_load_dwordx4 v15, s[20:23], s58 offen offset:1024 lds
  ds_read_b128 a[92:95], v27 offset:6144
  v_mfma_f32_16x16x32_bf16 v[80:83], a[4:7], a[32:35], v[80:83]
  ds_read_b64_tr_b16 a[48:49], v20 offset:42240
  v_mfma_f32_16x16x32_bf16 v[84:87], a[4:7], a[36:39], v[84:87]
  buffer_load_dwordx4 v16, s[20:23], s58 offen offset:2048 lds
  ds_read_b64_tr_b16 a[50:51], v20 offset:42496
  v_mfma_f32_16x16x32_bf16 v[88:91], a[4:7], a[40:43], v[88:91]
  v_mfma_f32_16x16x32_bf16 v[92:95], a[4:7], a[44:47], v[92:95]
  ds_read_b64_tr_b16 a[52:53], v20 offset:42272
  v_mfma_f32_16x16x32_bf16 v[60:63], a[4:7], v[36:39], v[60:63]
  buffer_load_dwordx4 v17, s[20:23], s58 offen offset:3072 lds
  ds_read_b64_tr_b16 a[54:55], v20 offset:42528
  v_mfma_f32_16x16x32_bf16 v[96:99], a[8:11], a[32:35], v[96:99]
  ds_read_b64_tr_b16 a[56:57], v21 offset:42240
  v_mfma_f32_16x16x32_bf16 v[100:103], a[8:11], a[36:39], v[100:103]
  s_add_u32 s58, s58, 128
  v_mfma_f32_16x16x32_bf16 v[104:107], a[8:11], a[40:43], v[104:107]
  ds_read_b64_tr_b16 a[58:59], v21 offset:42496
  v_mfma_f32_16x16x32_bf16 v[108:111], a[8:11], a[44:47], v[108:111]
  s_add_u32 m0, s57, 132096
  ds_read_b64_tr_b16 a[60:61], v21 offset:42272
  v_mfma_f32_16x16x32_bf16 v[112:115], a[12:15], a[32:35], v[112:115]
  ds_read_b64_tr_b16 a[62:63], v21 offset:42528
  v_mfma_f32_16x16x32_bf16 v[116:119], a[12:15], a[36:39], v[116:119]
  v_mfma_f32_16x16x32_bf16 v[120:123], a[12:15], a[40:43], v[120:123]
  buffer_load_dwordx4 v18, s[24:27], s59 offen lds
  ds_read_b64_tr_b16 a[64:65], v22 offset:42240
  v_mfma_f32_16x16x32_bf16 v[124:127], a[12:15], a[44:47], v[124:127]
  ds_read_b64_tr_b16 a[66:67], v22 offset:42496
  v_mfma_f32_16x16x32_bf16 v[128:131], a[16:19], a[32:35], v[128:131]
  buffer_load_dwordx4 v19, s[24:27], s59 offen offset:1056 lds
  ds_read_b64_tr_b16 a[68:69], v22 offset:42272
  v_mfma_f32_16x16x32_bf16 v[132:135], a[16:19], a[36:39], v[132:135]
  v_mfma_f32_16x16x32_bf16 v[136:139], a[16:19], a[40:43], v[136:139]
  s_add_u32 s59, s59, 262144
  ds_read_b64_tr_b16 a[70:71], v22 offset:42528
  v_mfma_f32_16x16x32_bf16 v[140:143], a[16:19], a[44:47], v[140:143]
  ds_read_b64_tr_b16 a[72:73], v23 offset:42240
  v_mfma_f32_16x16x32_bf16 v[144:147], a[20:23], a[32:35], v[144:147]
  global_load_dwordx2 v[40:41], v233, s[100:101] offset:0
  ds_read_b64_tr_b16 a[74:75], v23 offset:42496
  v_mfma_f32_16x16x32_bf16 v[148:151], a[20:23], a[36:39], v[148:151]
  v_mfma_f32_16x16x32_bf16 v[152:155], a[20:23], a[40:43], v[152:155]
  ds_read_b64_tr_b16 a[76:77], v23 offset:42272
  v_mfma_f32_16x16x32_bf16 v[156:159], a[20:23], a[44:47], v[156:159]
  global_load_dwordx2 v[42:43], v233, s[100:101] offset:32
  ds_read_b64_tr_b16 a[78:79], v23 offset:42528
  v_mfma_f32_16x16x32_bf16 v[160:163], a[24:27], a[32:35], v[160:163]
  v_mfma_f32_16x16x32_bf16 v[164:167], a[24:27], a[36:39], v[164:167]
  global_load_dwordx2 v[44:45], v233, s[100:101] offset:64
  v_mfma_f32_16x16x32_bf16 v[168:171], a[24:27], a[40:43], v[168:171]
  v_mfma_f32_16x16x32_bf16 v[172:175], a[24:27], a[44:47], v[172:175]
  global_load_dwordx2 v[46:47], v233, s[100:101] offset:96
  v_mfma_f32_16x16x32_bf16 v[176:179], a[28:31], a[32:35], v[176:179]
  v_mfma_f32_16x16x32_bf16 v[180:183], a[28:31], a[36:39], v[180:183]
  v_mfma_f32_16x16x32_bf16 v[184:187], a[28:31], a[40:43], v[184:187]
  v_mfma_f32_16x16x32_bf16 v[188:191], a[28:31], a[44:47], v[188:191]
  s_waitcnt vmcnt(21) lgkmcnt(0)
  s_barrier
  v_mfma_f32_16x16x32_bf16 v[64:67], a[48:51], a[80:83], v[64:67]
  s_add_u32 m0, s56, 65536
  ds_read_b128 a[32:35], v24 offset:0
  v_mfma_f32_16x16x32_bf16 v[68:71], a[48:51], a[84:87], v[68:71]
  ds_read_b128 a[36:39], v24 offset:2048
  v_mfma_f32_16x16x32_bf16 v[72:75], a[48:51], a[88:91], v[72:75]
  buffer_load_dwordx4 v10, s[20:23], s58 offen offset:0 lds
  ds_read_b128 a[40:43], v24 offset:4096
  v_mfma_f32_16x16x32_bf16 v[76:79], a[48:51], a[92:95], v[76:79]
  v_mfma_f32_16x16x32_bf16 v[56:59], a[48:51], v[36:39], v[56:59]
  ds_read_b128 a[44:47], v24 offset:6144
  v_mfma_f32_16x16x32_bf16 v[80:83], a[52:55], a[80:83], v[80:83]
  buffer_load_dwordx4 v11, s[20:23], s58 offen offset:1024 lds
  ds_read_b64_tr_b16 a[0:1], v20 offset:0
  v_mfma_f32_16x16x32_bf16 v[84:87], a[52:55], a[84:87], v[84:87]
  ds_read_b64_tr_b16 a[2:3], v20 offset:256
  v_mfma_f32_16x16x32_bf16 v[88:91], a[52:55], a[88:91], v[88:91]
  v_mfma_f32_16x16x32_bf16 v[92:95], a[52:55], a[92:95], v[92:95]
  buffer_load_dwordx4 v12, s[20:23], s58 offen offset:2048 lds
  ds_read_b64_tr_b16 a[4:5], v20 offset:32
  v_mfma_f32_16x16x32_bf16 v[60:63], a[52:55], v[36:39], v[60:63]
  ds_read_b64_tr_b16 a[6:7], v20 offset:288
  v_mfma_f32_16x16x32_bf16 v[96:99], a[56:59], a[80:83], v[96:99]
  ds_read_b64_tr_b16 a[8:9], v21 offset:0
  v_mfma_f32_16x16x32_bf16 v[100:103], a[56:59], a[84:87], v[100:103]
  buffer_load_dwordx4 v13, s[20:23], s58 offen offset:3072 lds
  v_mfma_f32_16x16x32_bf16 v[104:107], a[56:59], a[88:91], v[104:107]
  ds_read_b64_tr_b16 a[10:11], v21 offset:256
  v_mfma_f32_16x16x32_bf16 v[108:111], a[56:59], a[92:95], v[108:111]
  ds_read_b64_tr_b16 a[12:13], v21 offset:32
  v_mfma_f32_16x16x32_bf16 v[112:115], a[60:63], a[80:83], v[112:115]
  s_add_u32 m0, s57, 140544
  ds_read_b64_tr_b16 a[14:15], v21 offset:288
  v_mfma_f32_16x16x32_bf16 v[116:119], a[60:63], a[84:87], v[116:119]
  v_mfma_f32_16x16x32_bf16 v[120:123], a[60:63], a[88:91], v[120:123]
  ds_read_b64_tr_b16 a[16:17], v22 offset:0
  v_mfma_f32_16x16x32_bf16 v[124:127], a[60:63], a[92:95], v[124:127]
  buffer_load_dwordx4 v18, s[24:27], s59 offen lds
  ds_read_b64_tr_b16 a[18:19], v22 offset:256
  v_mfma_f32_16x16x32_bf16 v[128:131], a[64:67], a[80:83], v[128:131]
  ds_read_b64_tr_b16 a[20:21], v22 offset:32
  v_mfma_f32_16x16x32_bf16 v[132:135], a[64:67], a[84:87], v[132:135]
  v_mfma_f32_16x16x32_bf16 v[136:139], a[64:67], a[88:91], v[136:139]
  buffer_load_dwordx4 v19, s[24:27], s59 offen offset:1056 lds
  ds_read_b64_tr_b16 a[22:23], v22 offset:288
  v_mfma_f32_16x16x32_bf16 v[140:143], a[64:67], a[92:95], v[140:143]
  ds_read_b64_tr_b16 a[24:25], v23 offset:0
  v_mfma_f32_16x16x32_bf16 v[144:147], a[68:71], a[80:83], v[144:147]
  ds_read_b64_tr_b16 a[26:27], v23 offset:256
  v_mfma_f32_16x16x32_bf16 v[148:151], a[68:71], a[84:87], v[148:151]
  s_add_u32 s59, s59, 262144
  v_mfma_f32_16x16x32_bf16 v[152:155], a[68:71], a[88:91], v[152:155]
  ds_read_b64_tr_b16 a[28:29], v23 offset:32
  v_mfma_f32_16x16x32_bf16 v[156:159], a[68:71], a[92:95], v[156:159]
  ds_read_b64_tr_b16 a[30:31], v23 offset:288
  v_mfma_f32_16x16x32_bf16 v[160:163], a[72:75], a[80:83], v[160:163]
  buffer_load_dword v236, v237, s[36:39], s11 offen
  v_mfma_f32_16x16x32_bf16 v[164:167], a[72:75], a[84:87], v[164:167]
  v_mfma_f32_16x16x32_bf16 v[168:171], a[72:75], a[88:91], v[168:171]
  v_mfma_f32_16x16x32_bf16 v[172:175], a[72:75], a[92:95], v[172:175]
  s_add_u32 s11, s11, 1179648
  v_mfma_f32_16x16x32_bf16 v[176:179], a[76:79], a[80:83], v[176:179]
  v_mfma_f32_16x16x32_bf16 v[180:183], a[76:79], a[84:87], v[180:183]
  v_mfma_f32_16x16x32_bf16 v[184:187], a[76:79], a[88:91], v[184:187]
  v_mfma_f32_16x16x32_bf16 v[188:191], a[76:79], a[92:95], v[188:191]
  s_waitcnt vmcnt(26) lgkmcnt(0)
  s_barrier
  v_mfma_f32_16x16x32_bf16 v[64:67], a[0:3], a[32:35], v[64:67]
  s_add_u32 m0, s56, 69632
  ds_read_b128 a[80:83], v25 offset:0
  v_mfma_f32_16x16x32_bf16 v[68:71], a[0:3], a[36:39], v[68:71]
  ds_read_b128 a[84:87], v25 offset:2048
  v_mfma_f32_16x16x32_bf16 v[72:75], a[0:3], a[40:43], v[72:75]
  buffer_load_dwordx4 v14, s[20:23], s58 offen offset:0 lds
  ds_read_b128 a[88:91], v25 offset:4096
  v_mfma_f32_16x16x32_bf16 v[76:79], a[0:3], a[44:47], v[76:79]
  v_mfma_f32_16x16x32_bf16 v[56:59], a[0:3], v[36:39], v[56:59]
  ds_read_b128 a[92:95], v25 offset:6144
  v_mfma_f32_16x16x32_bf16 v[80:83], a[4:7], a[32:35], v[80:83]
  buffer_load_dwordx4 v15, s[20:23], s58 offen offset:1024 lds
  ds_read_b64_tr_b16 a[48:49], v20 offset:8448
  v_mfma_f32_16x16x32_bf16 v[84:87], a[4:7], a[36:39], v[84:87]
  ds_read_b64_tr_b16 a[50:51], v20 offset:8704
  v_mfma_f32_16x16x32_bf16 v[88:91], a[4:7], a[40:43], v[88:91]
  v_mfma_f32_16x16x32_bf16 v[92:95], a[4:7], a[44:47], v[92:95]
  buffer_load_dwordx4 v16, s[20:23], s58 offen offset:2048 lds
  ds_read_b64_tr_b16 a[52:53], v20 offset:8480
  v_mfma_f32_16x16x32_bf16 v[60:63], a[4:7], v[36:39], v[60:63]
  ds_read_b64_tr_b16 a[54:55], v20 offset:8736
  v_mfma_f32_16x16x32_bf16 v[96:99], a[8:11], a[32:35], v[96:99]
  buffer_load_dwordx4 v17, s[20:23], s58 offen offset:3072 lds
  ds_read_b64_tr_b16 a[56:57], v21 offset:8448
  v_mfma_f32_16x16x32_bf16 v[100:103], a[8:11], a[36:39], v[100:103]
  v_mfma_f32_16x16x32_bf16 v[104:107], a[8:11], a[40:43], v[104:107]
  ds_read_b64_tr_b16 a[58:59], v21 offset:8704
  v_mfma_f32_16x16x32_bf16 v[108:111], a[8:11], a[44:47], v[108:111]
  s_add_u32 s58, s58, 128
  ds_read_b64_tr_b16 a[60:61], v21 offset:8480
  v_mfma_f32_16x16x32_bf16 v[112:115], a[12:15], a[32:35], v[112:115]
  ds_read_b64_tr_b16 a[62:63], v21 offset:8736
  v_mfma_f32_16x16x32_bf16 v[116:119], a[12:15], a[36:39], v[116:119]
  v_mfma_f32_16x16x32_bf16 v[120:123], a[12:15], a[40:43], v[120:123]
  s_add_u32 m0, s57, 98304
  ds_read_b64_tr_b16 a[64:65], v22 offset:8448
  v_mfma_f32_16x16x32_bf16 v[124:127], a[12:15], a[44:47], v[124:127]
  ds_read_b64_tr_b16 a[66:67], v22 offset:8704
  v_mfma_f32_16x16x32_bf16 v[128:131], a[16:19], a[32:35], v[128:131]
  buffer_load_dwordx4 v18, s[24:27], s59 offen lds
  ds_read_b64_tr_b16 a[68:69], v22 offset:8480
  v_mfma_f32_16x16x32_bf16 v[132:135], a[16:19], a[36:39], v[132:135]
  v_mfma_f32_16x16x32_bf16 v[136:139], a[16:19], a[40:43], v[136:139]
  ds_read_b64_tr_b16 a[70:71], v22 offset:8736
  v_mfma_f32_16x16x32_bf16 v[140:143], a[16:19], a[44:47], v[140:143]
  buffer_load_dwordx4 v19, s[24:27], s59 offen offset:1056 lds
  ds_read_b64_tr_b16 a[72:73], v23 offset:8448
  v_mfma_f32_16x16x32_bf16 v[144:147], a[20:23], a[32:35], v[144:147]
  ds_read_b64_tr_b16 a[74:75], v23 offset:8704
  v_mfma_f32_16x16x32_bf16 v[148:151], a[20:23], a[36:39], v[148:151]
  v_mfma_f32_16x16x32_bf16 v[152:155], a[20:23], a[40:43], v[152:155]
  s_add_u32 s59, s59, 262144
  ds_read_b64_tr_b16 a[76:77], v23 offset:8480
  v_mfma_f32_16x16x32_bf16 v[156:159], a[20:23], a[44:47], v[156:159]
  ds_read_b64_tr_b16 a[78:79], v23 offset:8736
  v_mfma_f32_16x16x32_bf16 v[160:163], a[24:27], a[32:35], v[160:163]
  buffer_load_dword v236, v237, s[36:39], s11 offen
  v_mfma_f32_16x16x32_bf16 v[164:167], a[24:27], a[36:39], v[164:167]
  v_mfma_f32_16x16x32_bf16 v[168:171], a[24:27], a[40:43], v[168:171]
  v_mfma_f32_16x16x32_bf16 v[172:175], a[24:27], a[44:47], v[172:175]
  s_add_u32 s11, s11, 1179648
  v_mfma_f32_16x16x32_bf16 v[176:179], a[28:31], a[32:35], v[176:179]
  v_mfma_f32_16x16x32_bf16 v[180:183], a[28:31], a[36:39], v[180:183]
  v_mfma_f32_16x16x32_bf16 v[184:187], a[28:31], a[40:43], v[184:187]
  v_mfma_f32_16x16x32_bf16 v[188:191], a[28:31], a[44:47], v[188:191]
  s_waitcnt vmcnt(20) lgkmcnt(0)
  s_barrier
  v_mfma_f32_16x16x32_bf16 v[64:67], a[48:51], a[80:83], v[64:67]
  s_add_u32 m0, s56, 0
  ds_read_b128 a[32:35], v24 offset:32768
  v_mfma_f32_16x16x32_bf16 v[68:71], a[48:51], a[84:87], v[68:71]
TP_1:
  s_cbranch_execz TP_5
  ds_read_b128 a[36:39], v24 offset:34816
  v_mfma_f32_16x16x32_bf16 v[72:75], a[48:51], a[88:91], v[72:75]
  buffer_load_dwordx4 v10, s[20:23], s58 offen offset:0 lds
  ds_read_b128 a[40:43], v24 offset:36864
  v_mfma_f32_16x16x32_bf16 v[76:79], a[48:51], a[92:95], v[76:79]
  v_mfma_f32_16x16x32_bf16 v[56:59], a[48:51], v[36:39], v[56:59]
  ds_read_b128 a[44:47], v24 offset:38912
  v_mfma_f32_16x16x32_bf16 v[80:83], a[52:55], a[80:83], v[80:83]
  buffer_load_dwordx4 v11, s[20:23], s58 offen offset:1024 lds
  ds_read_b64_tr_b16 a[0:1], v20 offset:16896
  v_mfma_f32_16x16x32_bf16 v[84:87], a[52:55], a[84:87], v[84:87]
  ds_read_b64_tr_b16 a[2:3], v20 offset:17152
  v_mfma_f32_16x16x32_bf16 v[88:91], a[52:55], a[88:91], v[88:91]
  v_mfma_f32_16x16x32_bf16 v[92:95], a[52:55], a[92:95], v[92:95]
  buffer_load_dwordx4 v12, s[20:23], s58 offen offset:2048 lds
  ds_read_b64_tr_b16 a[4:5], v20 offset:16928
  v_mfma_f32_16x16x32_bf16 v[60:63], a[52:55], v[36:39], v[60:63]
  ds_read_b64_tr_b16 a[6:7], v20 offset:17184
  v_mfma_f32_16x16x32_bf16 v[96:99], a[56:59], a[80:83], v[96:99]
  ds_read_b64_tr_b16 a[8:9], v21 offset:16896
  v_mfma_f32_16x16x32_bf16 v[100:103], a[56:59], a[84:87], v[100:103]
  buffer_load_dwordx4 v13, s[20:23], s58 offen offset:3072 lds
  v_mfma_f32_16x16x32_bf16 v[104:107], a[56:59], a[88:91], v[104:107]
  ds_read_b64_tr_b16 a[10:11], v21 offset:17152
  v_mfma_f32_16x16x32_bf16 v[108:111], a[56:59], a[92:95], v[108:111]
  ds_read_b64_tr_b16 a[12:13], v21 offset:16928
  v_mfma_f32_16x16x32_bf16 v[112:115], a[60:63], a[80:83], v[112:115]
  s_add_u32 m0, s57, 106752
  ds_read_b64_tr_b16 a[14:15], v21 offset:17184
  v_mfma_f32_16x16x32_bf16 v[116:119], a[60:63], a[84:87], v[116:119]
  v_mfma_f32_16x16x32_bf16 v[120:123], a[60:63], a[88:91], v[120:123]
  ds_read_b64_tr_b16 a[16:17], v22 offset:16896
  v_mfma_f32_16x16x32_bf16 v[124:127], a[60:63], a[92:95], v[124:127]
  buffer_load_dwordx4 v18, s[24:27], s59 offen lds
  ds_read_b64_tr_b16 a[18:19], v22 offset:17152
  v_mfma_f32_16x16x32_bf16 v[128:131], a[64:67], a[80:83], v[128:131]
  ds_read_b64_tr_b16 a[20:21], v22 offset:16928
  v_mfma_f32_16x16x32_bf16 v[132:135], a[64:67], a[84:87], v[132:135]
  v_mfma_f32_16x16x32_bf16 v[136:139], a[64:67], a[88:91], v[136:139]
  buffer_load_dwordx4 v19, s[24:27], s59 offen offset:1056 lds
  ds_read_b64_tr_b16 a[22:23], v22 offset:17184
  v_mfma_f32_16x16x32_bf16 v[140:143], a[64:67], a[92:95], v[140:143]
  ds_read_b64_tr_b16 a[24:25], v23 offset:16896
  v_mfma_f32_16x16x32_bf16 v[144:147], a[68:71], a[80:83], v[144:147]
  ds_read_b64_tr_b16 a[26:27], v23 offset:17152
  v_mfma_f32_16x16x32_bf16 v[148:151], a[68:71], a[84:87], v[148:151]
  s_add_u32 s59, s59, 262144
  v_mfma_f32_16x16x32_bf16 v[152:155], a[68:71], a[88:91], v[152:155]
  ds_read_b64_tr_b16 a[28:29], v23 offset:16928
  v_mfma_f32_16x16x32_bf16 v[156:159], a[68:71], a[92:95], v[156:159]
  ds_read_b64_tr_b16 a[30:31], v23 offset:17184
  v_mfma_f32_16x16x32_bf16 v[160:163], a[72:75], a[80:83], v[160:163]
  buffer_load_dword v236, v237, s[36:39], s11 offen
  v_mfma_f32_16x16x32_bf16 v[164:167], a[72:75], a[84:87], v[164:167]
  v_mfma_f32_16x16x32_bf16 v[168:171], a[72:75], a[88:91], v[168:171]
  v_mfma_f32_16x16x32_bf16 v[172:175], a[72:75], a[92:95], v[172:175]
  s_add_u32 s11, s11, 1179648
  v_mfma_f32_16x16x32_bf16 v[176:179], a[76:79], a[80:83], v[176:179]
  v_mfma_f32_16x16x32_bf16 v[180:183], a[76:79], a[84:87], v[180:183]
  v_mfma_f32_16x16x32_bf16 v[184:187], a[76:79], a[88:91], v[184:187]
  v_mfma_f32_16x16x32_bf16 v[188:191], a[76:79], a[92:95], v[188:191]
  s_waitcnt lgkmcnt(0)
  s_barrier
  v_mfma_f32_16x16x32_bf16 v[64:67], a[0:3], a[32:35], v[64:67]
  s_add_u32 m0, s56, 4096
  ds_read_b128 a[80:83], v25 offset:32768
  v_mfma_f32_16x16x32_bf16 v[68:71], a[0:3], a[36:39], v[68:71]
  ds_read_b128 a[84:87], v25 offset:34816
  v_mfma_f32_16x16x32_bf16 v[72:75], a[0:3], a[40:43], v[72:75]
  buffer_load_dwordx4 v14, s[20:23], s58 offen offset:0 lds
  ds_read_b128 a[88:91], v25 offset:36864
  v_mfma_f32_16x16x32_bf16 v[76:79], a[0:3], a[44:47], v[76:79]
  v_mfma_f32_16x16x32_bf16 v[56:59], a[0:3], v[36:39], v[56:59]
  ds_read_b128 a[92:95], v25 offset:38912
  v_mfma_f32_16x16x32_bf16 v[80:83], a[4:7], a[32:35], v[80:83]
  buffer_load_dwordx4 v15, s[20:23], s58 offen offset:1024 lds
  ds_read_b64_tr_b16 a[48:49], v20 offset:25344
  v_mfma_f32_16x16x32_bf16 v[84:87], a[4:7], a[36:39], v[84:87]
  ds_read_b64_tr_b16 a[50:51], v20 offset:25600
  v_mfma_f32_16x16x32_bf16 v[88:91], a[4:7], a[40:43], v[88:91]
  v_mfma_f32_16x16x32_bf16 v[92:95], a[4:7], a[44:47], v[92:95]
  buffer_load_dwordx4 v16, s[20:23], s58 offen offset:2048 lds
  ds_read_b64_tr_b16 a[52:53], v20 offset:25376
  v_mfma_f32_16x16x32_bf16 v[60:63], a[4:7], v[36:39], v[60:63]
  ds_read_b64_tr_b16 a[54:55], v20 offset:25632
  v_mfma_f32_16x16x32_bf16 v[96:99], a[8:11], a[32:35], v[96:99]
  buffer_load_dwordx4 v17, s[20:23], s58 offen offset:3072 lds
  ds_read_b64_tr_b16 a[56:57], v21 offset:25344
  v_mfma_f32_16x16x32_bf16 v[100:103], a[8:11], a[36:39], v[100:103]
  v_mfma_f32_16x16x32_bf16 v[104:107], a[8:11], a[40:43], v[104:107]
  ds_read_b64_tr_b16 a[58:59], v21 offset:25600
  v_mfma_f32_16x16x32_bf16 v[108:111], a[8:11], a[44:47], v[108:111]
  s_add_u32 s58, s58, 128
  ds_read_b64_tr_b16 a[60:61], v21 offset:25376
  v_mfma_f32_16x16x32_bf16 v[112:115], a[12:15], a[32:35], v[112:115]
  ds_read_b64_tr_b16 a[62:63], v21 offset:25632
  v_mfma_f32_16x16x32_bf16 v[116:119], a[12:15], a[36:39], v[116:119]
  v_mfma_f32_16x16x32_bf16 v[120:123], a[12:15], a[40:43], v[120:123]
  s_add_u32 m0, s57, 115200
  ds_read_b64_tr_b16 a[64:65], v22 offset:25344
  v_mfma_f32_16x16x32_bf16 v[124:127], a[12:15], a[44:47], v[124:127]
  ds_read_b64_tr_b16 a[66:67], v22 offset:25600
  v_mfma_f32_16x16x32_bf16 v[128:131], a[16:19], a[32:35], v[128:131]
  buffer_load_dwordx4 v18, s[24:27], s59 offen lds
  ds_read_b64_tr_b16 a[68:69], v22 offset:25376
  v_mfma_f32_16x16x32_bf16 v[132:135], a[16:19], a[36:39], v[132:135]
  v_mfma_f32_16x16x32_bf16 v[136:139], a[16:19], a[40:43], v[136:139]
  ds_read_b64_tr_b16 a[70:71], v22 offset:25632
  v_mfma_f32_16x16x32_bf16 v[140:143], a[16:19], a[44:47], v[140:143]
  buffer_load_dwordx4 v19, s[24:27], s59 offen offset:1056 lds
  ds_read_b64_tr_b16 a[72:73], v23 offset:25344
  v_mfma_f32_16x16x32_bf16 v[144:147], a[20:23], a[32:35], v[144:147]
  ds_read_b64_tr_b16 a[74:75], v23 offset:25600
  v_mfma_f32_16x16x32_bf16 v[148:151], a[20:23], a[36:39], v[148:151]
  v_mfma_f32_16x16x32_bf16 v[152:155], a[20:23], a[40:43], v[152:155]
  s_add_u32 s59, s59, 262144
  ds_read_b64_tr_b16 a[76:77], v23 offset:25376
  v_mfma_f32_16x16x32_bf16 v[156:159], a[20:23], a[44:47], v[156:159]
  ds_read_b64_tr_b16 a[78:79], v23 offset:25632
  v_mfma_f32_16x16x32_bf16 v[160:163], a[24:27], a[32:35], v[160:163]
  buffer_load_dword v236, v237, s[36:39], s11 offen
  v_mfma_f32_16x16x32_bf16 v[164:167], a[24:27], a[36:39], v[164:167]
  v_mfma_f32_16x16x32_bf16 v[168:171], a[24:27], a[40:43], v[168:171]
  v_mfma_f32_16x16x32_bf16 v[172:175], a[24:27], a[44:47], v[172:175]
  s_add_u32 s11, s11, 1179648
  v_mfma_f32_16x16x32_bf16 v[176:179], a[28:31], a[32:35], v[176:179]
  v_mfma_f32_16x16x32_bf16 v[180:183], a[28:31], a[36:39], v[180:183]
  v_mfma_f32_16x16x32_bf16 v[184:187], a[28:31], a[40:43], v[184:187]
  v_mfma_f32_16x16x32_bf16 v[188:191], a[28:31], a[44:47], v[188:191]
  s_waitcnt vmcnt(17) lgkmcnt(0)
  s_barrier
  v_mfma_f32_16x16x32_bf16 v[64:67], a[48:51], a[80:83], v[64:67]
  s_add_u32 m0, s56, 32768
  ds_read_b128 a[32:35], v26 offset:0
  v_mfma_f32_16x16x32_bf16 v[68:71], a[48:51], a[84:87], v[68:71]
  ds_read_b128 a[36:39], v26 offset:2048
  v_mfma_f32_16x16x32_bf16 v[72:75], a[48:51], a[88:91], v[72:75]
  buffer_load_dwordx4 v10, s[20:23], s58 offen offset:0 lds
  ds_read_b128 a[40:43], v26 offset:4096
  v_mfma_f32_16x16x32_bf16 v[76:79], a[48:51], a[92:95], v[76:79]
  v_mfma_f32_16x16x32_bf16 v[56:59], a[48:51], v[36:39], v[56:59]
  ds_read_b128 a[44:47], v26 offset:6144
  v_mfma_f32_16x16x32_bf16 v[80:83], a[52:55], a[80:83], v[80:83]
  buffer_load_dwordx4 v11, s[20:23], s58 offen offset:1024 lds
  ds_read_b64_tr_b16 a[0:1], v20 offset:33792
  v_mfma_f32_16x16x32_bf16 v[84:87], a[52:55], a[84:87], v[84:87]
  ds_read_b64_tr_b16 a[2:3], v20 offset:34048
  v_mfma_f32_16x16x32_bf16 v[88:91], a[52:55], a[88:91], v[88:91]
  v_mfma_f32_16x16x32_bf16 v[92:95], a[52:55], a[92:95], v[92:95]
  buffer_load_dwordx4 v12, s[20:23], s58 offen offset:2048 lds
  ds_read_b64_tr_b16 a[4:5], v20 offset:33824
  v_mfma_f32_16x16x32_bf16 v[60:63], a[52:55], v[36:39], v[60:63]
  ds_read_b64_tr_b16 a[6:7], v20 offset:34080
  v_mfma_f32_16x16x32_bf16 v[96:99], a[56:59], a[80:83], v[96:99]
  ds_read_b64_tr_b16 a[8:9], v21 offset:33792
  v_mfma_f32_16x16x32_bf16 v[100:103], a[56:59], a[84:87], v[100:103]
  buffer_load_dwordx4 v13, s[20:23], s58 offen offset:3072 lds
  v_mfma_f32_16x16x32_bf16 v[104:107], a[56:59], a[88:91], v[104:107]
  ds_read_b64_tr_b16 a[10:11], v21 offset:34048
  v_mfma_f32_16x16x32_bf16 v[108:111], a[56:59], a[92:95], v[108:111]
  ds_read_b64_tr_b16 a[12:13], v21 offset:33824
  v_mfma_f32_16x16x32_bf16 v[112:115], a[60:63], a[80:83], v[112:115]
  s_add_u32 m0, s57, 123648
  ds_read_b64_tr_b16 a[14:15], v21 offset:34080
  v_mfma_f32_16x16x32_bf16 v[116:119], a[60:63], a[84:87], v[116:119]
  v_mfma_f32_16x16x32_bf16 v[120:123], a[60:63], a[88:91], v[120:123]
  ds_read_b64_tr_b16 a[16:17], v22 offset:33792
  v_mfma_f32_16x16x32_bf16 v[124:127], a[60:63], a[92:95], v[124:127]
  buffer_load_dwordx4 v18, s[24:27], s59 offen lds
  ds_read_b64_tr_b16 a[18:19], v22 offset:34048
  v_mfma_f32_16x16x32_bf16 v[128:131], a[64:67], a[80:83], v[128:131]
  ds_read_b64_tr_b16 a[20:21], v22 offset:33824
  v_mfma_f32_16x16x32_bf16 v[132:135], a[64:67], a[84:87], v[132:135]
  v_mfma_f32_16x16x32_bf16 v[136:139], a[64:67], a[88:91], v[136:139]
  buffer_load_dwordx4 v19, s[24:27], s59 offen offset:1056 lds
  ds_read_b64_tr_b16 a[22:23], v22 offset:34080
  v_mfma_f32_16x16x32_bf16 v[140:143], a[64:67], a[92:95], v[140:143]
  ds_read_b64_tr_b16 a[24:25], v23 offset:33792
  v_mfma_f32_16x16x32_bf16 v[144:147], a[68:71], a[80:83], v[144:147]
  ds_read_b64_tr_b16 a[26:27], v23 offset:34048
  v_mfma_f32_16x16x32_bf16 v[148:151], a[68:71], a[84:87], v[148:151]
  s_add_u32 s59, s59, 262144
  v_mfma_f32_16x16x32_bf16 v[152:155], a[68:71], a[88:91], v[152:155]
  ds_read_b64_tr_b16 a[28:29], v23 offset:33824
  v_mfma_f32_16x16x32_bf16 v[156:159], a[68:71], a[92:95], v[156:159]
  ds_read_b64_tr_b16 a[30:31], v23 offset:34080
  v_mfma_f32_16x16x32_bf16 v[160:163], a[72:75], a[80:83], v[160:163]
  buffer_load_dword v236, v237, s[36:39], s11 offen
  v_mfma_f32_16x16x32_bf16 v[164:167], a[72:75], a[84:87], v[164:167]
  v_mfma_f32_16x16x32_bf16 v[168:171], a[72:75], a[88:91], v[168:171]
  v_mfma_f32_16x16x32_bf16 v[172:175], a[72:75], a[92:95], v[172:175]
  s_add_u32 s11, s11, 1179648
  v_mfma_f32_16x16x32_bf16 v[176:179], a[76:79], a[80:83], v[176:179]
  v_mfma_f32_16x16x32_bf16 v[180:183], a[76:79], a[84:87], v[180:183]
  v_mfma_f32_16x16x32_bf16 v[184:187], a[76:79], a[88:91], v[184:187]
  v_mfma_f32_16x16x32_bf16 v[188:191], a[76:79], a[92:95], v[188:191]
  s_waitcnt lgkmcnt(0)
  s_barrier
  v_mfma_f32_16x16x32_bf16 v[64:67], a[0:3], a[32:35], v[64:67]
  s_add_u32 m0, s56, 36864
  ds_read_b128 a[80:83], v27 offset:0
  v_mfma_f32_16x16x32_bf16 v[68:71], a[0:3], a[36:39], v[68:71]
  ds_read_b128 a[84:87], v27 offset:2048
  v_mfma_f32_16x16x32_bf16 v[72:75], a[0:3], a[40:43], v[72:75]
  buffer_load_dwordx4 v14, s[20:23], s58 offen offset:0 lds
  ds_read_b128 a[88:91], v27 offset:4096
  v_mfma_f32_16x16x32_bf16 v[76:79], a[0:3], a[44:47], v[76:79]
  v_mfma_f32_16x16x32_bf16 v[56:59], a[0:3], v[36:39], v[56:59]
  ds_read_b128 a[92:95], v27 offset:6144
  v_mfma_f32_16x16x32_bf16 v[80:83], a[4:7], a[32:35], v[80:83]
  buffer_load_dwordx4 v15, s[20:23], s58 offen offset:1024 lds
  ds_read_b64_tr_b16 a[48:49], v20 offset:42240
  v_mfma_f32_16x16x32_bf16 v[84:87], a[4:7], a[36:39], v[84:87]
  ds_read_b64_tr_b16 a[50:51], v20 offset:42496
  v_mfma_f32_16x16x32_bf16 v[88:91], a[4:7], a[40:43], v[88:91]
  v_mfma_f32_16x16x32_bf16 v[92:95], a[4:7], a[44:47], v[92:95]
  buffer_load_dwordx4 v16, s[20:23], s58 offen offset:2048 lds
  ds_read_b64_tr_b16 a[52:53], v20 offset:42272
  v_mfma_f32_16x16x32_bf16 v[60:63], a[4:7], v[36:39], v[60:63]
  ds_read_b64_tr_b16 a[54:55], v20 offset:42528
  v_mfma_f32_16x16x32_bf16 v[96:99], a[8:11], a[32:35], v[96:99]
  buffer_load_dwordx4 v17, s[20:23], s58 offen offset:3072 lds
  ds_read_b64_tr_b16 a[56:57], v21 offset:42240
  v_mfma_f32_16x16x32_bf16 v[100:103], a[8:11], a[36:39], v[100:103]
  v_mfma_f32_16x16x32_bf16 v[104:107], a[8:11], a[40:43], v[104:107]
  ds_read_b64_tr_b16 a[58:59], v21 offset:42496
  v_mfma_f32_16x16x32_bf16 v[108:111], a[8:11], a[44:47], v[108:111]
  s_add_u32 s58, s58, 128
  ds_read_b64_tr_b16 a[60:61], v21 offset:42272
  v_mfma_f32_16x16x32_bf16 v[112:115], a[12:15], a[32:35], v[112:115]
  ds_read_b64_tr_b16 a[62:63], v21 offset:42528
  v_mfma_f32_16x16x32_bf16 v[116:119], a[12:15], a[36:39], v[116:119]
  v_mfma_f32_16x16x32_bf16 v[120:123], a[12:15], a[40:43], v[120:123]
  s_add_u32 m0, s57, 132096
  ds_read_b64_tr_b16 a[64:65], v22 offset:42240
  v_mfma_f32_16x16x32_bf16 v[124:127], a[12:15], a[44:47], v[124:127]
  ds_read_b64_tr_b16 a[66:67], v22 offset:42496
  v_mfma_f32_16x16x32_bf16 v[128:131], a[16:19], a[32:35], v[128:131]
  buffer_load_dwordx4 v18, s[24:27], s59 offen lds
  ds_read_b64_tr_b16 a[68:69], v22 offset:42272
  v_mfma_f32_16x16x32_bf16 v[132:135], a[16:19], a[36:39], v[132:135]
  v_mfma_f32_16x16x32_bf16 v[136:139], a[16:19], a[40:43], v[136:139]
  ds_read_b64_tr_b16 a[70:71], v22 offset:42528
  v_mfma_f32_16x16x32_bf16 v[140:143], a[16:19], a[44:47], v[140:143]
  buffer_load_dwordx4 v19, s[24:27], s59 offen offset:1056 lds
  ds_read_b64_tr_b16 a[72:73], v23 offset:42240
  v_mfma_f32_16x16x32_bf16 v[144:147], a[20:23], a[32:35], v[144:147]
  ds_read_b64_tr_b16 a[74:75], v23 offset:42496
  v_mfma_f32_16x16x32_bf16 v[148:151], a[20:23], a[36:39], v[148:151]
  v_mfma_f32_16x16x32_bf16 v[152:155], a[20:23], a[40:43], v[152:155]
  s_add_u32 s59, s59, 262144
  ds_read_b64_tr_b16 a[76:77], v23 offset:42272
  v_mfma_f32_16x16x32_bf16 v[156:159], a[20:23], a[44:47], v[156:159]
  ds_read_b64_tr_b16 a[78:79], v23 offset:42528
  v_mfma_f32_16x16x32_bf16 v[160:163], a[24:27], a[32:35], v[160:163]
  buffer_load_dword v236, v237, s[36:39], s11 offen
  v_mfma_f32_16x16x32_bf16 v[164:167], a[24:27], a[36:39], v[164:167]
  v_mfma_f32_16x16x32_bf16 v[168:171], a[24:27], a[40:43], v[168:171]
  v_mfma_f32_16x16x32_bf16 v[172:175], a[24:27], a[44:47], v[172:175]
  s_add_u32 s11, s11, 1179648
  v_mfma_f32_16x16x32_bf16 v[176:179], a[28:31], a[32:35], v[176:179]
  v_mfma_f32_16x16x32_bf16 v[180:183], a[28:31], a[36:39], v[180:183]
  v_mfma_f32_16x16x32_bf16 v[184:187], a[28:31], a[40:43], v[184:187]
  v_mfma_f32_16x16x32_bf16 v[188:191], a[28:31], a[44:47], v[188:191]
  s_waitcnt vmcnt(17) lgkmcnt(0)
  s_barrier
  v_mfma_f32_16x16x32_bf16 v[64:67], a[48:51], a[80:83], v[64:67]
  s_add_u32 m0, s56, 65536
  ds_read_b128 a[32:35], v24 offset:0
  v_mfma_f32_16x16x32_bf16 v[68:71], a[48:51], a[84:87], v[68:71]
  ds_read_b128 a[36:39], v24 offset:2048
  v_mfma_f32_16x16x32_bf16 v[72:75], a[48:51], a[88:91], v[72:75]
  buffer_load_dwordx4 v10, s[20:23], s58 offen offset:0 lds
  ds_read_b128 a[40:43], v24 offset:4096
  v_mfma_f32_16x16x32_bf16 v[76:79], a[48:51], a[92:95], v[76:79]
  v_mfma_f32_16x16x32_bf16 v[56:59], a[48:51], v[36:39], v[56:59]
  ds_read_b128 a[44:47], v24 offset:6144
  v_mfma_f32_16x16x32_bf16 v[80:83], a[52:55], a[80:83], v[80:83]
  buffer_load_dwordx4 v11, s[20:23], s58 offen offset:1024 lds
  ds_read_b64_tr_b16 a[0:1], v20 offset:0
  v_mfma_f32_16x16x32_bf16 v[84:87], a[52:55], a[84:87], v[84:87]
  ds_read_b64_tr_b16 a[2:3], v20 offset:256
  v_mfma_f32_16x16x32_bf16 v[88:91], a[52:55], a[88:91], v[88:91]
  v_mfma_f32_16x16x32_bf16 v[92:95], a[52:55], a[92:95], v[92:95]
  buffer_load_dwordx4 v12, s[20:23], s58 offen offset:2048 lds
  ds_read_b64_tr_b16 a[4:5], v20 offset:32
  v_mfma_f32_16x16x32_bf16 v[60:63], a[52:55], v[36:39], v[60:63]
  ds_read_b64_tr_b16 a[6:7], v20 offset:288
  v_mfma_f32_16x16x32_bf16 v[96:99], a[56:59], a[80:83], v[96:99]
  ds_read_b64_tr_b16 a[8:9], v21 offset:0
  v_mfma_f32_16x16x32_bf16 v[100:103], a[56:59], a[84:87], v[100:103]
  buffer_load_dwordx4 v13, s[20:23], s58 offen offset:3072 lds
  v_mfma_f32_16x16x32_bf16 v[104:107], a[56:59], a[88:91], v[104:107]
  ds_read_b64_tr_b16 a[10:11], v21 offset:256
  v_mfma_f32_16x16x32_bf16 v[108:111], a[56:59], a[92:95], v[108:111]
  ds_read_b64_tr_b16 a[12:13], v21 offset:32
  v_mfma_f32_16x16x32_bf16 v[112:115], a[60:63], a[80:83], v[112:115]
  s_add_u32 m0, s57, 140544
  ds_read_b64_tr_b16 a[14:15], v21 offset:288
  v_mfma_f32_16x16x32_bf16 v[116:119], a[60:63], a[84:87], v[116:119]
  v_mfma_f32_16x16x32_bf16 v[120:123], a[60:63], a[88:91], v[120:123]
  ds_read_b64_tr_b16 a[16:17], v22 offset:0
  v_mfma_f32_16x16x32_bf16 v[124:127], a[60:63], a[92:95], v[124:127]
  buffer_load_dwordx4 v18, s[24:27], s59 offen lds
  ds_read_b64_tr_b16 a[18:19], v22 offset:256
  v_mfma_f32_16x16x32_bf16 v[128:131], a[64:67], a[80:83], v[128:131]
  ds_read_b64_tr_b16 a[20:21], v22 offset:32
  v_mfma_f32_16x16x32_bf16 v[132:135], a[64:67], a[84:87], v[132:135]
  v_mfma_f32_16x16x32_bf16 v[136:139], a[64:67], a[88:91], v[136:139]
  buffer_load_dwordx4 v19, s[24:27], s59 offen offset:1056 lds
  ds_read_b64_tr_b16 a[22:23], v22 offset:288
  v_mfma_f32_16x16x32_bf16 v[140:143], a[64:67], a[92:95], v[140:143]
  ds_read_b64_tr_b16 a[24:25], v23 offset:0
  v_mfma_f32_16x16x32_bf16 v[144:147], a[68:71], a[80:83], v[144:147]
  ds_read_b64_tr_b16 a[26:27], v23 offset:256
  v_mfma_f32_16x16x32_bf16 v[148:151], a[68:71], a[84:87], v[148:151]
  s_add_u32 s59, s59, 262144
  v_mfma_f32_16x16x32_bf16 v[152:155], a[68:71], a[88:91], v[152:155]
  ds_read_b64_tr_b16 a[28:29], v23 offset:32
  v_mfma_f32_16x16x32_bf16 v[156:159], a[68:71], a[92:95], v[156:159]
  ds_read_b64_tr_b16 a[30:31], v23 offset:288
  v_mfma_f32_16x16x32_bf16 v[160:163], a[72:75], a[80:83], v[160:163]
  buffer_load_dword v236, v237, s[36:39], s11 offen
  v_mfma_f32_16x16x32_bf16 v[164:167], a[72:75], a[84:87], v[164:167]
  v_mfma_f32_16x16x32_bf16 v[168:171], a[72:75], a[88:91], v[168:171]
  v_mfma_f32_16x16x32_bf16 v[172:175], a[72:75], a[92:95], v[172:175]
  s_add_u32 s11, s11, 1179648
  v_mfma_f32_16x16x32_bf16 v[176:179], a[76:79], a[80:83], v[176:179]
  v_mfma_f32_16x16x32_bf16 v[180:183], a[76:79], a[84:87], v[180:183]
  v_mfma_f32_16x16x32_bf16 v[184:187], a[76:79], a[88:91], v[184:187]
  v_mfma_f32_16x16x32_bf16 v[188:191], a[76:79], a[92:95], v[188:191]
  s_waitcnt lgkmcnt(0)
  s_barrier
  v_mfma_f32_16x16x32_bf16 v[64:67], a[0:3], a[32:35], v[64:67]
  s_mov_b32 s24, s6
  ds_read_b128 a[80:83], v25 offset:0
  v_mfma_f32_16x16x32_bf16 v[68:71], a[0:3], a[36:39], v[68:71]
  ds_read_b128 a[84:87], v25 offset:2048
  v_mfma_f32_16x16x32_bf16 v[72:75], a[0:3], a[40:43], v[72:75]
  s_mov_b32 s25, s7
  ds_read_b128 a[88:91], v25 offset:4096
  v_mfma_f32_16x16x32_bf16 v[76:79], a[0:3], a[44:47], v[76:79]
  v_mfma_f32_16x16x32_bf16 v[56:59], a[0:3], v[36:39], v[56:59]
  ds_read_b128 a[92:95], v25 offset:6144
  v_mfma_f32_16x16x32_bf16 v[80:83], a[4:7], a[32:35], v[80:83]
  s_mov_b32 s26, 18874368
  ds_read_b64_tr_b16 a[48:49], v20 offset:8448
  v_mfma_f32_16x16x32_bf16 v[84:87], a[4:7], a[36:39], v[84:87]
  ds_read_b64_tr_b16 a[50:51], v20 offset:8704
  v_mfma_f32_16x16x32_bf16 v[88:91], a[4:7], a[40:43], v[88:91]
  v_mfma_f32_16x16x32_bf16 v[92:95], a[4:7], a[44:47], v[92:95]
  s_add_u32 m0, s56, 69632
  ds_read_b64_tr_b16 a[52:53], v20 offset:8480
  v_mfma_f32_16x16x32_bf16 v[60:63], a[4:7], v[36:39], v[60:63]
  ds_read_b64_tr_b16 a[54:55], v20 offset:8736
  v_mfma_f32_16x16x32_bf16 v[96:99], a[8:11], a[32:35], v[96:99]
  buffer_load_dwordx4 v14, s[20:23], s58 offen offset:0 lds
  ds_read_b64_tr_b16 a[56:57], v21 offset:8448
  v_mfma_f32_16x16x32_bf16 v[100:103], a[8:11], a[36:39], v[100:103]
  v_mfma_f32_16x16x32_bf16 v[104:107], a[8:11], a[40:43], v[104:107]
  ds_read_b64_tr_b16 a[58:59], v21 offset:8704
  v_mfma_f32_16x16x32_bf16 v[108:111], a[8:11], a[44:47], v[108:111]
  buffer_load_dwordx4 v15, s[20:23], s58 offen offset:1024 lds
  ds_read_b64_tr_b16 a[60:61], v21 offset:8480
  v_mfma_f32_16x16x32_bf16 v[112:115], a[12:15], a[32:35], v[112:115]
  ds_read_b64_tr_b16 a[62:63], v21 offset:8736
  v_mfma_f32_16x16x32_bf16 v[116:119], a[12:15], a[36:39], v[116:119]
  v_mfma_f32_16x16x32_bf16 v[120:123], a[12:15], a[40:43], v[120:123]
  buffer_load_dwordx4 v16, s[20:23], s58 offen offset:2048 lds
  ds_read_b64_tr_b16 a[64:65], v22 offset:8448
  v_mfma_f32_16x16x32_bf16 v[124:127], a[12:15], a[44:47], v[124:127]
  ds_read_b64_tr_b16 a[66:67], v22 offset:8704
  v_mfma_f32_16x16x32_bf16 v[128:131], a[16:19], a[32:35], v[128:131]
  buffer_load_dwordx4 v17, s[20:23], s58 offen offset:3072 lds
  ds_read_b64_tr_b16 a[68:69], v22 offset:8480
  v_mfma_f32_16x16x32_bf16 v[132:135], a[16:19], a[36:39], v[132:135]
  v_mfma_f32_16x16x32_bf16 v[136:139], a[16:19], a[40:43], v[136:139]
  ds_read_b64_tr_b16 a[70:71], v22 offset:8736
  v_mfma_f32_16x16x32_bf16 v[140:143], a[16:19], a[44:47], v[140:143]
  s_add_u32 s58, s58, 128
  ds_read_b64_tr_b16 a[72:73], v23 offset:8448
  v_mfma_f32_16x16x32_bf16 v[144:147], a[20:23], a[32:35], v[144:147]
  ds_read_b64_tr_b16 a[74:75], v23 offset:8704
  v_mfma_f32_16x16x32_bf16 v[148:151], a[20:23], a[36:39], v[148:151]
  v_mfma_f32_16x16x32_bf16 v[152:155], a[20:23], a[40:43], v[152:155]
  buffer_load_dword v193, v192, s[52:55], 0 offen sc1
  ds_read_b64_tr_b16 a[76:77], v23 offset:8480
  v_mfma_f32_16x16x32_bf16 v[156:159], a[20:23], a[44:47], v[156:159]
  ds_read_b64_tr_b16 a[78:79], v23 offset:8736
  v_mfma_f32_16x16x32_bf16 v[160:163], a[24:27], a[32:35], v[160:163]
  buffer_load_dword v236, v237, s[36:39], s11 offen
  v_mfma_f32_16x16x32_bf16 v[164:167], a[24:27], a[36:39], v[164:167]
  v_mfma_f32_16x16x32_bf16 v[168:171], a[24:27], a[40:43], v[168:171]
  v_mfma_f32_16x16x32_bf16 v[172:175], a[24:27], a[44:47], v[172:175]
  s_add_u32 s11, s11, 1179648
  v_mfma_f32_16x16x32_bf16 v[176:179], a[28:31], a[32:35], v[176:179]
  v_mfma_f32_16x16x32_bf16 v[180:183], a[28:31], a[36:39], v[180:183]
  v_mfma_f32_16x16x32_bf16 v[184:187], a[28:31], a[40:43], v[184:187]
  v_mfma_f32_16x16x32_bf16 v[188:191], a[28:31], a[44:47], v[188:191]
  s_waitcnt vmcnt(16) lgkmcnt(0)
  s_barrier
  v_mfma_f32_16x16x32_bf16 v[64:67], a[48:51], a[80:83], v[64:67]
  s_add_u32 m0, s60, 0
  ds_read_b128 a[32:35], v24 offset:32768
  v_lshrrev_b32 v4, 4, v2
  v_mfma_f32_16x16x32_bf16 v[68:71], a[48:51], a[84:87], v[68:71]
  s_lshl_b32 s3, s18, 3
  ds_read_b128 a[36:39], v24 offset:34816
  v_add_u32 v4, s3, v4
  v_mfma_f32_16x16x32_bf16 v[72:75], a[48:51], a[88:91], v[72:75]
  ds_read_b128 a[40:43], v24 offset:36864
  v_and_b32 v5, 15, v2
  v_mfma_f32_16x16x32_bf16 v[76:79], a[48:51], a[92:95], v[76:79]
  v_and_b32 v6, 15, v4
  v_xor_b32 v6, v5, v6
  v_mfma_f32_16x16x32_bf16 v[56:59], a[48:51], v[36:39], v[56:59]
  buffer_load_dwordx4 v28, s[36:39], s62 offen offset:0 lds
  ds_read_b128 a[44:47], v24 offset:38912
  v_mfma_f32_16x16x32_bf16 v[80:83], a[52:55], a[80:83], v[80:83]
  ds_read_b64_tr_b16 a[0:1], v20 offset:16896
  v_lshlrev_b32 v6, 4, v6
  v_mfma_f32_16x16x32_bf16 v[84:87], a[52:55], a[84:87], v[84:87]
  ds_read_b64_tr_b16 a[2:3], v20 offset:17152
  v_lshl_add_u32 v10, v4, 8, v6
  v_mfma_f32_16x16x32_bf16 v[88:91], a[52:55], a[88:91], v[88:91]
  v_add_u32 v4, 4, v4
  v_and_b32 v6, 15, v4
  v_mfma_f32_16x16x32_bf16 v[92:95], a[52:55], a[92:95], v[92:95]
  buffer_load_dwordx4 v29, s[36:39], s62 offen offset:1056 lds
  ds_read_b64_tr_b16 a[4:5], v20 offset:16928
  v_mfma_f32_16x16x32_bf16 v[60:63], a[52:55], v[36:39], v[60:63]
  ds_read_b64_tr_b16 a[6:7], v20 offset:17184
  v_xor_b32 v6, v5, v6
  v_mfma_f32_16x16x32_bf16 v[96:99], a[56:59], a[80:83], v[96:99]
  ds_read_b64_tr_b16 a[8:9], v21 offset:16896
  v_lshlrev_b32 v6, 4, v6
  v_mfma_f32_16x16x32_bf16 v[100:103], a[56:59], a[84:87], v[100:103]
  v_lshl_add_u32 v11, v4, 8, v6
  v_subrev_u32 v11, 1024, v11
  v_mfma_f32_16x16x32_bf16 v[104:107], a[56:59], a[88:91], v[104:107]
  buffer_load_dwordx4 v30, s[36:39], s62 offen offset:2112 lds
  ds_read_b64_tr_b16 a[10:11], v21 offset:17152
  v_mfma_f32_16x16x32_bf16 v[108:111], a[56:59], a[92:95], v[108:111]
  ds_read_b64_tr_b16 a[12:13], v21 offset:16928
  v_lshrrev_b32 v4, 4, v2
  v_mfma_f32_16x16x32_bf16 v[112:115], a[60:63], a[80:83], v[112:115]
  ds_read_b64_tr_b16 a[14:15], v21 offset:17184
  v_lshlrev_b32 v4, 3, v4
  v_mfma_f32_16x16x32_bf16 v[116:119], a[60:63], a[84:87], v[116:119]
  s_lshl_b32 s3, s18, 1
  v_add_u32 v4, s3, v4
  v_lshlrev_b32 v5, 4, v5
  v_mfma_f32_16x16x32_bf16 v[120:123], a[60:63], a[88:91], v[120:123]
  buffer_load_dwordx4 v31, s[36:39], s62 offen offset:3168 lds
  ds_read_b64_tr_b16 a[16:17], v22 offset:16896
  v_mfma_f32_16x16x32_bf16 v[124:127], a[60:63], a[92:95], v[124:127]
  ds_read_b64_tr_b16 a[18:19], v22 offset:17152
  v_lshl_add_u32 v12, v4, 8, v5
  v_mfma_f32_16x16x32_bf16 v[128:131], a[64:67], a[80:83], v[128:131]
  ds_read_b64_tr_b16 a[20:21], v22 offset:16928
  v_add_u32 v12, 1024, v12
  v_mfma_f32_16x16x32_bf16 v[132:135], a[64:67], a[84:87], v[132:135]
  v_add_u32 v13, -800, v12
  v_mfma_f32_16x16x32_bf16 v[136:139], a[64:67], a[88:91], v[136:139]
  s_add_u32 s62, s62, 589824
  s_lshr_b32 s58, s19, 1
  ds_read_b64_tr_b16 a[22:23], v22 offset:17184
  v_mfma_f32_16x16x32_bf16 v[140:143], a[64:67], a[92:95], v[140:143]
  s_lshl_b32 s58, s58, 19
  s_add_u32 s58, s58, 393216
  ds_read_b64_tr_b16 a[24:25], v23 offset:16896
  v_mfma_f32_16x16x32_bf16 v[144:147], a[68:71], a[80:83], v[144:147]
  s_sub_u32 s59, s58, 1024
  s_lshl_b32 s56, s18, 11
  ds_read_b64_tr_b16 a[26:27], v23 offset:17152
  v_mfma_f32_16x16x32_bf16 v[148:151], a[68:71], a[84:87], v[148:151]
  s_mul_i32 s57, s18, 2112
  v_and_b32 v4, 15, v2
  v_lshrrev_b32 v5, 4, v2
  v_mfma_f32_16x16x32_bf16 v[152:155], a[68:71], a[88:91], v[152:155]
  buffer_load_dword v236, v237, s[36:39], s11 offen
  ds_read_b64_tr_b16 a[28:29], v23 offset:16928
  v_mfma_f32_16x16x32_bf16 v[156:159], a[68:71], a[92:95], v[156:159]
  ds_read_b64_tr_b16 a[30:31], v23 offset:17184
  v_lshrrev_b32 v6, 1, v5
  v_mfma_f32_16x16x32_bf16 v[160:163], a[72:75], a[80:83], v[160:163]
  v_and_b32 v7, 1, v5
  v_lshl_add_u32 v5, v7, 1, v6
  v_mfma_f32_16x16x32_bf16 v[164:167], a[72:75], a[84:87], v[164:167]
  v_lshlrev_b32 v7, 8, v4
  v_add_u32 v7, 58368, v7
  v_mfma_f32_16x16x32_bf16 v[168:171], a[72:75], a[88:91], v[168:171]
  s_add_u32 s11, s11, 1179648
  s_xor_b32 s3, s18, 0
  s_lshl_b32 s3, s3, 2
  v_mfma_f32_16x16x32_bf16 v[172:175], a[72:75], a[92:95], v[172:175]
  v_add_u32 v6, s3, v5
  v_xor_b32 v6, v6, v4
  v_mfma_f32_16x16x32_bf16 v[176:179], a[76:79], a[80:83], v[176:179]
  v_lshl_add_u32 v14, v6, 4, v7
  v_mfma_f32_16x16x32_bf16 v[180:183], a[76:79], a[84:87], v[180:183]
  s_xor_b32 s3, s18, 1
  s_lshl_b32 s3, s3, 2
  v_add_u32 v6, s3, v5
  v_mfma_f32_16x16x32_bf16 v[184:187], a[76:79], a[88:91], v[184:187]
  v_xor_b32 v6, v6, v4
  v_lshl_add_u32 v15, v6, 4, v7
  v_mfma_f32_16x16x32_bf16 v[188:191], a[76:79], a[92:95], v[188:191]
  s_waitcnt lgkmcnt(0)
  s_barrier
  v_mfma_f32_16x16x32_bf16 v[64:67], a[0:3], a[32:35], v[64:67]
  s_waitcnt vmcnt(6)
  v_cmp_gt_u32 s[6:7], 4, v193
  s_cmp_lg_u64 s[6:7], 0
  s_cbranch_scc1 SP_pH
RT_pH:
  v_mfma_f32_16x16x32_bf16 v[68:71], a[0:3], a[36:39], v[68:71]
  s_xor_b32 s3, s18, 2
  ds_read_b128 a[80:83], v25 offset:32768
  ds_read_b128 a[84:87], v25 offset:34816
  v_mfma_f32_16x16x32_bf16 v[72:75], a[0:3], a[40:43], v[72:75]
  s_add_u32 m0, s61, 0
  s_lshl_b32 s3, s3, 2
  ds_read_b128 a[88:91], v25 offset:36864
  v_mfma_f32_16x16x32_bf16 v[76:79], a[0:3], a[44:47], v[76:79]
  v_add_u32 v6, s3, v5
  v_xor_b32 v6, v6, v4
  v_mfma_f32_16x16x32_bf16 v[56:59], a[0:3], v[36:39], v[56:59]
  ds_read_b128 a[92:95], v25 offset:38912
  v_lshl_add_u32 v16, v6, 4, v7
  v_mfma_f32_16x16x32_bf16 v[80:83], a[4:7], a[32:35], v[80:83]
  s_xor_b32 s3, s18, 3
  buffer_load_dwordx4 v32, s[12:15], s63 offen offset:0 sc1 lds
  ds_read_b64_tr_b16 a[48:49], v20 offset:25344
  v_mfma_f32_16x16x32_bf16 v[84:87], a[4:7], a[36:39], v[84:87]
  s_lshl_b32 s3, s3, 2
  ds_read_b64_tr_b16 a[50:51], v20 offset:25600
  v_add_u32 v6, s3, v5
  v_mfma_f32_16x16x32_bf16 v[88:91], a[4:7], a[40:43], v[88:91]
  v_xor_b32 v6, v6, v4
  v_lshl_add_u32 v17, v6, 4, v7
  v_mfma_f32_16x16x32_bf16 v[92:95], a[4:7], a[44:47], v[92:95]
  buffer_load_dwordx4 v32, s[12:15], s63 offen offset:1024 sc1 lds
  ds_read_b64_tr_b16 a[52:53], v20 offset:25376
  v_mfma_f32_16x16x32_bf16 v[60:63], a[4:7], v[36:39], v[60:63]
TP_2:
  s_cbranch_execz TP_6
  ds_read_b64_tr_b16 a[54:55], v20 offset:25632
  v_lshrrev_b32 v4, 2, v2
  v_mfma_f32_16x16x32_bf16 v[96:99], a[8:11], a[32:35], v[96:99]
  buffer_load_dwordx4 v32, s[12:15], s63 offen offset:2048 sc1 lds
  ds_read_b64_tr_b16 a[56:57], v21 offset:25344
  v_mfma_f32_16x16x32_bf16 v[100:103], a[8:11], a[36:39], v[100:103]
  v_and_b32 v5, 7, v4
  v_mul_u32_u24 v5, 1056, v5
  v_mfma_f32_16x16x32_bf16 v[104:107], a[8:11], a[40:43], v[104:107]
  ds_read_b64_tr_b16 a[58:59], v21 offset:25600
  v_lshrrev_b32 v4, 3, v4
  v_mfma_f32_16x16x32_bf16 v[108:111], a[8:11], a[44:47], v[108:111]
  s_add_u32 s63, s63, 73728
  ds_read_b64_tr_b16 a[60:61], v21 offset:25376
  v_lshl_add_u32 v5, v4, 8, v5
  v_mfma_f32_16x16x32_bf16 v[112:115], a[12:15], a[32:35], v[112:115]
  ds_read_b64_tr_b16 a[62:63], v21 offset:25632
  v_and_b32 v4, 3, v2
  v_mfma_f32_16x16x32_bf16 v[116:119], a[12:15], a[36:39], v[116:119]
  v_lshl_add_u32 v19, v4, 3, v5
  v_add_u32 v18, 58368, v19
  v_mfma_f32_16x16x32_bf16 v[120:123], a[12:15], a[40:43], v[120:123]
  s_lshr_b32 s3, s16, 2
  buffer_load_dwordx2 v[48:49], v33, s[12:15], 0 offen offset:0 sc1
  ds_read_b64_tr_b16 a[64:65], v22 offset:25344
  v_mfma_f32_16x16x32_bf16 v[124:127], a[12:15], a[44:47], v[124:127]
  s_lshl1_add_u32 s3, s17, s3
  s_lshl2_add_u32 s3, s3, s18
  ds_read_b64_tr_b16 a[66:67], v22 offset:25600
  v_mfma_f32_16x16x32_bf16 v[128:131], a[16:19], a[32:35], v[128:131]
  s_mul_i32 s3, s3, 12
  buffer_load_dwordx2 v[50:51], v33, s[12:15], 0 offen offset:128 sc1
  ds_read_b64_tr_b16 a[68:69], v22 offset:25376
  v_mfma_f32_16x16x32_bf16 v[132:135], a[16:19], a[36:39], v[132:135]
  v_add_u32 v34, s3, v2
  v_lshlrev_b32 v34, 7, v34
  v_mfma_f32_16x16x32_bf16 v[136:139], a[16:19], a[40:43], v[136:139]
  ds_read_b64_tr_b16 a[70:71], v22 offset:25632
  v_mov_b32 v4, 0x7fff0000
  v_mfma_f32_16x16x32_bf16 v[140:143], a[16:19], a[44:47], v[140:143]
  buffer_load_dwordx2 v[52:53], v33, s[12:15], 0 offen offset:256 sc1
  ds_read_b64_tr_b16 a[72:73], v23 offset:25344
  v_mfma_f32_16x16x32_bf16 v[144:147], a[20:23], a[32:35], v[144:147]
  ds_read_b64_tr_b16 a[74:75], v23 offset:25600
  v_cmp_gt_u32 vcc, 12, v2
  v_mfma_f32_16x16x32_bf16 v[148:151], a[20:23], a[36:39], v[148:151]
  s_and_b32 s3, s16, 3
  s_mul_i32 s101, s3, 4718592
  v_cndmask_b32 v34, v4, v34, vcc
  v_mfma_f32_16x16x32_bf16 v[152:155], a[20:23], a[40:43], v[152:155]
  s_mov_b32 s100, s101
  buffer_load_dwordx2 v[54:55], v33, s[12:15], 0 offen offset:384 sc1
  ds_read_b64_tr_b16 a[76:77], v23 offset:25376
  v_mfma_f32_16x16x32_bf16 v[156:159], a[20:23], a[44:47], v[156:159]
  ds_read_b64_tr_b16 a[78:79], v23 offset:25632
  v_lshlrev_b32 v4, 16, v40
  v_mfma_f32_16x16x32_bf16 v[160:163], a[24:27], a[32:35], v[160:163]
  buffer_load_dword v236, v237, s[36:39], s11 offen
  v_and_b32 v5, 0xffff0000, v40
  v_mfma_f32_16x16x32_bf16 v[164:167], a[24:27], a[36:39], v[164:167]
  v_lshlrev_b32 v6, 16, v41
  v_and_b32 v7, 0xffff0000, v41
  v_mfma_f32_16x16x32_bf16 v[168:171], a[24:27], a[40:43], v[168:171]
  v_accvgpr_write_b32 a240, v4
  v_accvgpr_write_b32 a241, v5
  v_mfma_f32_16x16x32_bf16 v[172:175], a[24:27], a[44:47], v[172:175]
  s_add_u32 s11, s11, 1179648
  v_accvgpr_write_b32 a242, v6
  v_accvgpr_write_b32 a243, v7
  v_mfma_f32_16x16x32_bf16 v[176:179], a[28:31], a[32:35], v[176:179]
  v_lshlrev_b32 v4, 16, v42
  v_and_b32 v5, 0xffff0000, v42
  v_mfma_f32_16x16x32_bf16 v[180:183], a[28:31], a[36:39], v[180:183]
  v_lshlrev_b32 v6, 16, v43
  v_and_b32 v7, 0xffff0000, v43
  v_mfma_f32_16x16x32_bf16 v[184:187], a[28:31], a[40:43], v[184:187]
  v_accvgpr_write_b32 a244, v4
  v_accvgpr_write_b32 a245, v5
  v_mfma_f32_16x16x32_bf16 v[188:191], a[28:31], a[44:47], v[188:191]
  s_waitcnt lgkmcnt(0)
  s_barrier
  v_mfma_f32_16x16x32_bf16 v[64:67], a[48:51], a[80:83], v[64:67]
  s_add_u32 m0, s60, 29184
  ds_read_b128 a[32:35], v26 offset:0
  v_accvgpr_write_b32 a246, v6
  v_mfma_f32_16x16x32_bf16 v[68:71], a[48:51], a[84:87], v[68:71]
  ds_read_b128 a[36:39], v26 offset:2048
  v_accvgpr_write_b32 a247, v7
  v_mfma_f32_16x16x32_bf16 v[72:75], a[48:51], a[88:91], v[72:75]
  buffer_load_dwordx4 v28, s[36:39], s62 offen offset:0 lds
  ds_read_b128 a[40:43], v26 offset:4096
  v_mfma_f32_16x16x32_bf16 v[76:79], a[48:51], a[92:95], v[76:79]
  v_lshlrev_b32 v4, 16, v44
  v_and_b32 v5, 0xffff0000, v44
  v_mfma_f32_16x16x32_bf16 v[56:59], a[48:51], v[36:39], v[56:59]
  buffer_load_dwordx4 v29, s[36:39], s62 offen offset:1056 lds
  ds_read_b128 a[44:47], v26 offset:6144
  v_mfma_f32_16x16x32_bf16 v[80:83], a[52:55], a[80:83], v[80:83]
  ds_read_b64_tr_b16 a[0:1], v20 offset:33792
  v_lshlrev_b32 v6, 16, v45
  v_mfma_f32_16x16x32_bf16 v[84:87], a[52:55], a[84:87], v[84:87]
  ds_read_b64_tr_b16 a[2:3], v20 offset:34048
  v_and_b32 v7, 0xffff0000, v45
  v_mfma_f32_16x16x32_bf16 v[88:91], a[52:55], a[88:91], v[88:91]
  buffer_load_dwordx4 v30, s[36:39], s62 offen offset:2112 lds
  v_accvgpr_write_b32 a248, v4
  v_mfma_f32_16x16x32_bf16 v[92:95], a[52:55], a[92:95], v[92:95]
  ds_read_b64_tr_b16 a[4:5], v20 offset:33824
  v_accvgpr_write_b32 a249, v5
  v_mfma_f32_16x16x32_bf16 v[60:63], a[52:55], v[36:39], v[60:63]
  buffer_load_dwordx4 v31, s[36:39], s62 offen offset:3168 lds
  ds_read_b64_tr_b16 a[6:7], v20 offset:34080
  v_mfma_f32_16x16x32_bf16 v[96:99], a[56:59], a[80:83], v[96:99]
  ds_read_b64_tr_b16 a[8:9], v21 offset:33792
  v_accvgpr_write_b32 a250, v6
  v_mfma_f32_16x16x32_bf16 v[100:103], a[56:59], a[84:87], v[100:103]
  v_accvgpr_write_b32 a251, v7
  v_lshlrev_b32 v4, 16, v46
  v_mfma_f32_16x16x32_bf16 v[104:107], a[56:59], a[88:91], v[104:107]
  s_add_u32 s62, s62, 589824
  ds_read_b64_tr_b16 a[10:11], v21 offset:34048
  v_and_b32 v5, 0xffff0000, v46
  v_mfma_f32_16x16x32_bf16 v[108:111], a[56:59], a[92:95], v[108:111]
  ds_read_b64_tr_b16 a[12:13], v21 offset:33824
  v_lshlrev_b32 v6, 16, v47
  v_mfma_f32_16x16x32_bf16 v[112:115], a[60:63], a[80:83], v[112:115]
  s_add_u32 m0, s61, 29184
  ds_read_b64_tr_b16 a[14:15], v21 offset:34080
  v_and_b32 v7, 0xffff0000, v47
  v_mfma_f32_16x16x32_bf16 v[116:119], a[60:63], a[84:87], v[116:119]
  v_accvgpr_write_b32 a252, v4
  v_accvgpr_write_b32 a253, v5
  v_mfma_f32_16x16x32_bf16 v[120:123], a[60:63], a[88:91], v[120:123]
  ds_read_b64_tr_b16 a[16:17], v22 offset:33792
  v_accvgpr_write_b32 a254, v6
  v_mfma_f32_16x16x32_bf16 v[124:127], a[60:63], a[92:95], v[124:127]
  buffer_load_dwordx4 v32, s[12:15], s63 offen offset:0 sc1 lds
  ds_read_b64_tr_b16 a[18:19], v22 offset:34048
  v_mfma_f32_16x16x32_bf16 v[128:131], a[64:67], a[80:83], v[128:131]
  ds_read_b64_tr_b16 a[20:21], v22 offset:33824
  v_accvgpr_write_b32 a255, v7
  v_mfma_f32_16x16x32_bf16 v[132:135], a[64:67], a[84:87], v[132:135]
  buffer_load_dwordx4 v32, s[12:15], s63 offen offset:1024 sc1 lds
  v_mfma_f32_16x16x32_bf16 v[136:139], a[64:67], a[88:91], v[136:139]
  ds_read_b64_tr_b16 a[22:23], v22 offset:34080
  v_mfma_f32_16x16x32_bf16 v[140:143], a[64:67], a[92:95], v[140:143]
  ds_read_b64_tr_b16 a[24:25], v23 offset:33792
  v_mfma_f32_16x16x32_bf16 v[144:147], a[68:71], a[80:83], v[144:147]
  buffer_load_dwordx4 v32, s[12:15], s63 offen offset:2048 sc1 lds
  ds_read_b64_tr_b16 a[26:27], v23 offset:34048
  v_mfma_f32_16x16x32_bf16 v[148:151], a[68:71], a[84:87], v[148:151]
  v_mfma_f32_16x16x32_bf16 v[152:155], a[68:71], a[88:91], v[152:155]
  s_add_u32 s63, s63, 73728
  ds_read_b64_tr_b16 a[28:29], v23 offset:33824
  v_mfma_f32_16x16x32_bf16 v[156:159], a[68:71], a[92:95], v[156:159]
  ds_read_b64_tr_b16 a[30:31], v23 offset:34080
  v_mfma_f32_16x16x32_bf16 v[160:163], a[72:75], a[80:83], v[160:163]
  v_mfma_f32_16x16x32_bf16 v[164:167], a[72:75], a[84:87], v[164:167]
  buffer_load_dword v236, v237, s[36:39], s11 offen
  v_mfma_f32_16x16x32_bf16 v[168:171], a[72:75], a[88:91], v[168:171]
  v_mfma_f32_16x16x32_bf16 v[172:175], a[72:75], a[92:95], v[172:175]
  s_add_u32 s11, s11, 1179648
  v_mfma_f32_16x16x32_bf16 v[176:179], a[76:79], a[80:83], v[176:179]
  v_mfma_f32_16x16x32_bf16 v[180:183], a[76:79], a[84:87], v[180:183]
  v_mfma_f32_16x16x32_bf16 v[184:187], a[76:79], a[88:91], v[184:187]
  v_mfma_f32_16x16x32_bf16 v[188:191], a[76:79], a[92:95], v[188:191]
  s_waitcnt lgkmcnt(0)
  s_barrier
  v_mfma_f32_16x16x32_bf16 v[64:67], a[0:3], a[32:35], v[64:67]
  buffer_load_dword v236, v237, s[36:39], s11 offen
  ds_read_b128 a[80:83], v27 offset:0
  v_mfma_f32_16x16x32_bf16 v[68:71], a[0:3], a[36:39], v[68:71]
  ds_read_b128 a[84:87], v27 offset:2048
  v_mfma_f32_16x16x32_bf16 v[72:75], a[0:3], a[40:43], v[72:75]
  ds_read_b128 a[88:91], v27 offset:4096
  v_mfma_f32_16x16x32_bf16 v[76:79], a[0:3], a[44:47], v[76:79]
  v_mfma_f32_16x16x32_bf16 v[56:59], a[0:3], v[36:39], v[56:59]
  ds_read_b128 a[92:95], v27 offset:6144
  v_mfma_f32_16x16x32_bf16 v[80:83], a[4:7], a[32:35], v[80:83]
  ds_read_b64_tr_b16 a[48:49], v20 offset:42240
  v_mfma_f32_16x16x32_bf16 v[84:87], a[4:7], a[36:39], v[84:87]
  ds_read_b64_tr_b16 a[50:51], v20 offset:42496
  v_mfma_f32_16x16x32_bf16 v[88:91], a[4:7], a[40:43], v[88:91]
  v_mfma_f32_16x16x32_bf16 v[92:95], a[4:7], a[44:47], v[92:95]
  ds_read_b64_tr_b16 a[52:53], v20 offset:42272
  v_mfma_f32_16x16x32_bf16 v[60:63], a[4:7], v[36:39], v[60:63]
  ds_read_b64_tr_b16 a[54:55], v20 offset:42528
  v_mfma_f32_16x16x32_bf16 v[96:99], a[8:11], a[32:35], v[96:99]
  ds_read_b64_tr_b16 a[56:57], v21 offset:42240
  v_mfma_f32_16x16x32_bf16 v[100:103], a[8:11], a[36:39], v[100:103]
  v_mfma_f32_16x16x32_bf16 v[104:107], a[8:11], a[40:43], v[104:107]
  ds_read_b64_tr_b16 a[58:59], v21 offset:42496
  v_mfma_f32_16x16x32_bf16 v[108:111], a[8:11], a[44:47], v[108:111]
  ds_read_b64_tr_b16 a[60:61], v21 offset:42272
  v_mfma_f32_16x16x32_bf16 v[112:115], a[12:15], a[32:35], v[112:115]
  ds_read_b64_tr_b16 a[62:63], v21 offset:42528
  v_mfma_f32_16x16x32_bf16 v[116:119], a[12:15], a[36:39], v[116:119]
  v_mfma_f32_16x16x32_bf16 v[120:123], a[12:15], a[40:43], v[120:123]
  s_add_u32 s11, s11, 1179648
  ds_read_b64_tr_b16 a[64:65], v22 offset:42240
  v_mfma_f32_16x16x32_bf16 v[124:127], a[12:15], a[44:47], v[124:127]
  ds_read_b64_tr_b16 a[66:67], v22 offset:42496
  v_mfma_f32_16x16x32_bf16 v[128:131], a[16:19], a[32:35], v[128:131]
  ds_read_b64_tr_b16 a[68:69], v22 offset:42272
  v_mfma_f32_16x16x32_bf16 v[132:135], a[16:19], a[36:39], v[132:135]
  v_mfma_f32_16x16x32_bf16 v[136:139], a[16:19], a[40:43], v[136:139]
  ds_read_b64_tr_b16 a[70:71], v22 offset:42528
  v_mfma_f32_16x16x32_bf16 v[140:143], a[16:19], a[44:47], v[140:143]
  ds_read_b64_tr_b16 a[72:73], v23 offset:42240
  v_mfma_f32_16x16x32_bf16 v[144:147], a[20:23], a[32:35], v[144:147]
  ds_read_b64_tr_b16 a[74:75], v23 offset:42496
  v_mfma_f32_16x16x32_bf16 v[148:151], a[20:23], a[36:39], v[148:151]
  v_mfma_f32_16x16x32_bf16 v[152:155], a[20:23], a[40:43], v[152:155]
  ds_read_b64_tr_b16 a[76:77], v23 offset:42272
  v_mfma_f32_16x16x32_bf16 v[156:159], a[20:23], a[44:47], v[156:159]
  ds_read_b64_tr_b16 a[78:79], v23 offset:42528
  v_mfma_f32_16x16x32_bf16 v[160:163], a[24:27], a[32:35], v[160:163]
  v_mfma_f32_16x16x32_bf16 v[164:167], a[24:27], a[36:39], v[164:167]
  v_mfma_f32_16x16x32_bf16 v[168:171], a[24:27], a[40:43], v[168:171]
  v_mfma_f32_16x16x32_bf16 v[172:175], a[24:27], a[44:47], v[172:175]
  v_mfma_f32_16x16x32_bf16 v[176:179], a[28:31], a[32:35], v[176:179]
  v_mfma_f32_16x16x32_bf16 v[180:183], a[28:31], a[36:39], v[180:183]
  v_mfma_f32_16x16x32_bf16 v[184:187], a[28:31], a[40:43], v[184:187]
  v_mfma_f32_16x16x32_bf16 v[188:191], a[28:31], a[44:47], v[188:191]
  s_waitcnt lgkmcnt(0)
  s_barrier
  v_mfma_f32_16x16x32_bf16 v[64:67], a[48:51], a[80:83], v[64:67]
  s_add_u32 m0, s60, 58368
  v_lshrrev_b32 v4, 4, v2
  v_mfma_f32_16x16x32_bf16 v[68:71], a[48:51], a[84:87], v[68:71]
  s_lshl_b32 s3, s18, 7
  s_add_u32 s3, s3, 158208
  v_lshl_add_u32 v20, v4, 4, s3
  v_mfma_f32_16x16x32_bf16 v[72:75], a[48:51], a[88:91], v[72:75]
  buffer_load_dwordx4 v28, s[36:39], s62 offen offset:0 lds
  v_xor_b32 v21, 128, v20
  v_mfma_f32_16x16x32_bf16 v[76:79], a[48:51], a[92:95], v[76:79]
  v_xor_b32 v22, 256, v20
  v_xor_b32 v23, 384, v20
  v_mfma_f32_16x16x32_bf16 v[56:59], a[48:51], v[36:39], v[56:59]
  s_and_b32 s3, s18, 1
  s_lshl_b32 s3, s3, 7
  v_add_u32 v26, s3, v19
  v_mfma_f32_16x16x32_bf16 v[80:83], a[52:55], a[80:83], v[80:83]
  s_lshr_b32 s3, s18, 1
  s_mul_i32 s3, s3, 3072
  buffer_load_dwordx4 v29, s[36:39], s62 offen offset:1056 lds
  v_mfma_f32_16x16x32_bf16 v[84:87], a[52:55], a[84:87], v[84:87]
  s_add_u32 s3, s3, 16896
  v_add_u32 v27, s3, v3
  v_mov_b32 v24, v26
  v_mfma_f32_16x16x32_bf16 v[88:91], a[52:55], a[88:91], v[88:91]
  v_mov_b32 v25, v27
  v_mfma_f32_16x16x32_bf16 v[92:95], a[52:55], a[92:95], v[92:95]
  s_mov_b32 s92, 0
  buffer_load_dwordx4 v30, s[36:39], s62 offen offset:2112 lds
  v_mfma_f32_16x16x32_bf16 v[60:63], a[52:55], v[36:39], v[60:63]
  v_mfma_f32_16x16x32_bf16 v[96:99], a[56:59], a[80:83], v[96:99]
  v_mfma_f32_16x16x32_bf16 v[100:103], a[56:59], a[84:87], v[100:103]
  buffer_load_dwordx4 v31, s[36:39], s62 offen offset:3168 lds
  v_mfma_f32_16x16x32_bf16 v[104:107], a[56:59], a[88:91], v[104:107]
  v_mfma_f32_16x16x32_bf16 v[108:111], a[56:59], a[92:95], v[108:111]
  v_mfma_f32_16x16x32_bf16 v[112:115], a[60:63], a[80:83], v[112:115]
  s_add_u32 s62, s62, 589824
  v_mfma_f32_16x16x32_bf16 v[116:119], a[60:63], a[84:87], v[116:119]
  v_mfma_f32_16x16x32_bf16 v[120:123], a[60:63], a[88:91], v[120:123]
  v_mfma_f32_16x16x32_bf16 v[124:127], a[60:63], a[92:95], v[124:127]
  s_add_u32 m0, s61, 58368
  v_mfma_f32_16x16x32_bf16 v[128:131], a[64:67], a[80:83], v[128:131]
  v_mfma_f32_16x16x32_bf16 v[132:135], a[64:67], a[84:87], v[132:135]
  v_mfma_f32_16x16x32_bf16 v[136:139], a[64:67], a[88:91], v[136:139]
  buffer_load_dwordx4 v32, s[12:15], s63 offen offset:0 sc1 lds
  ds_write_b128 v20, v[56:59]
  v_mfma_f32_16x16x32_bf16 v[140:143], a[64:67], a[92:95], v[140:143]
  v_mfma_f32_16x16x32_bf16 v[144:147], a[68:71], a[80:83], v[144:147]
  ds_write_b128 v20, v[60:63] offset:64
  v_mfma_f32_16x16x32_bf16 v[148:151], a[68:71], a[84:87], v[148:151]
  buffer_load_dwordx4 v32, s[12:15], s63 offen offset:1024 sc1 lds
  v_mfma_f32_16x16x32_bf16 v[152:155], a[68:71], a[88:91], v[152:155]
  v_mfma_f32_16x16x32_bf16 v[156:159], a[68:71], a[92:95], v[156:159]
  v_mfma_f32_16x16x32_bf16 v[160:163], a[72:75], a[80:83], v[160:163]
  buffer_load_dwordx4 v32, s[12:15], s63 offen offset:2048 sc1 lds
  v_mfma_f32_16x16x32_bf16 v[164:167], a[72:75], a[84:87], v[164:167]
  v_mfma_f32_16x16x32_bf16 v[168:171], a[72:75], a[88:91], v[168:171]
  v_mfma_f32_16x16x32_bf16 v[172:175], a[72:75], a[92:95], v[172:175]
  s_add_u32 s63, s63, 73728
  v_mfma_f32_16x16x32_bf16 v[176:179], a[76:79], a[80:83], v[176:179]
  v_mfma_f32_16x16x32_bf16 v[180:183], a[76:79], a[84:87], v[180:183]
  v_mfma_f32_16x16x32_bf16 v[184:187], a[76:79], a[88:91], v[184:187]
  v_mfma_f32_16x16x32_bf16 v[188:191], a[76:79], a[92:95], v[188:191]
  s_cmp_lg_u32 s94, 0
  s_cbranch_scc1 K_skip
  s_waitcnt vmcnt(17) lgkmcnt(0)
  s_barrier
  ds_read_b128 a[16:19], v25 offset:0
  ds_read_b128 a[20:23], v25 offset:1024
  ds_read_b128 a[24:27], v25 offset:2048
  ds_read_b64_tr_b16 a[0:1], v24 offset:0
  ds_read_b64_tr_b16 a[2:3], v24 offset:512
  ds_read_b64_tr_b16 a[4:5], v24 offset:32
  ds_read_b64_tr_b16 a[6:7], v24 offset:544
  ds_read_b64_tr_b16 a[8:9], v24 offset:64
  ds_read_b64_tr_b16 a[10:11], v24 offset:576
  ds_read_b64_tr_b16 a[12:13], v24 offset:96
  ds_read_b64_tr_b16 a[14:15], v24 offset:608
  ds_read_b128 v[40:43], v20
  ds_read_b128 v[44:47], v20 offset:64
  ds_read_b128 v[56:59], v21
  ds_read_b128 v[60:63], v21 offset:64
  s_add_u32 m0, s60, 87552
  s_nop 0
  buffer_load_dwordx4 v28, s[36:39], s62 offen offset:0 lds
  buffer_load_dwordx4 v29, s[36:39], s62 offen offset:1056 lds
  buffer_load_dwordx4 v30, s[36:39], s62 offen offset:2112 lds
  buffer_load_dwordx4 v31, s[36:39], s62 offen offset:3168 lds
  s_add_u32 s62, s62, 589824
  s_add_u32 m0, s61, 87552
  s_nop 0
  buffer_load_dwordx4 v32, s[12:15], s63 offen offset:0 sc1 lds
  buffer_load_dwordx4 v32, s[12:15], s63 offen offset:1024 sc1 lds
  buffer_load_dwordx4 v32, s[12:15], s63 offen offset:2048 sc1 lds
  s_add_u32 s63, s63, 73728
  s_waitcnt lgkmcnt(0)
  v_mfma_f32_16x16x32_bf16 a[192:195], a[0:3], a[16:19], a[240:243]
  s_add_u32 m0, s60, 116736
  ds_read_b128 a[44:47], v25 offset:6144
  ds_read_b128 a[48:51], v25 offset:7168
  v_mfma_f32_16x16x32_bf16 a[196:199], a[0:3], a[20:23], a[240:243]
  ds_read_b128 a[52:55], v25 offset:8192
  ds_read_b64_tr_b16 a[28:29], v24 offset:8448
  v_mfma_f32_16x16x32_bf16 a[200:203], a[0:3], a[24:27], a[240:243]
  ds_read_b64_tr_b16 a[30:31], v24 offset:8960
  buffer_load_dwordx4 v28, s[36:39], s62 offen offset:0 lds
  v_mfma_f32_16x16x32_bf16 a[204:207], a[4:7], a[16:19], a[244:247]
  ds_read_b64_tr_b16 a[32:33], v24 offset:8480
  ds_read_b64_tr_b16 a[34:35], v24 offset:8992
  v_mfma_f32_16x16x32_bf16 a[208:211], a[4:7], a[20:23], a[244:247]
  ds_read_b64_tr_b16 a[36:37], v24 offset:8512
  buffer_load_dwordx4 v29, s[36:39], s62 offen offset:1056 lds
  buffer_load_dwordx4 v30, s[36:39], s62 offen offset:2112 lds
  v_mfma_f32_16x16x32_bf16 a[212:215], a[4:7], a[24:27], a[244:247]
  ds_read_b64_tr_b16 a[38:39], v24 offset:9024
  ds_read_b64_tr_b16 a[40:41], v24 offset:8544
  v_mfma_f32_16x16x32_bf16 a[216:219], a[8:11], a[16:19], a[248:251]
  ds_read_b64_tr_b16 a[42:43], v24 offset:9056
  buffer_load_dwordx4 v31, s[36:39], s62 offen offset:3168 lds
  v_mfma_f32_16x16x32_bf16 a[220:223], a[8:11], a[20:23], a[248:251]
  s_add_u32 s62, s62, 589824
  s_add_u32 m0, s61, 116736
  s_mov_b32 s93, s92
  v_mfma_f32_16x16x32_bf16 a[224:227], a[8:11], a[24:27], a[248:251]
  s_add_u32 s92, s92, 29184
  buffer_load_dwordx4 v32, s[12:15], s63 offen offset:0 sc1 lds
  buffer_load_dwordx4 v32, s[12:15], s63 offen offset:1024 sc1 lds
  v_mfma_f32_16x16x32_bf16 a[228:231], a[12:15], a[16:19], a[252:255]
  s_cmp_eq_u32 s92, 145920
  s_cselect_b32 s92, 0, s92
  buffer_load_dwordx4 v32, s[12:15], s63 offen offset:2048 sc1 lds
  v_mfma_f32_16x16x32_bf16 a[232:235], a[12:15], a[20:23], a[252:255]
  s_add_u32 s63, s63, 73728
  v_add_u32 v24, s92, v26
  v_add_u32 v25, s92, v27
  v_mfma_f32_16x16x32_bf16 a[236:239], a[12:15], a[24:27], a[252:255]
  s_waitcnt vmcnt(23) lgkmcnt(0)
  s_barrier
  v_mfma_f32_16x16x32_bf16 a[192:195], a[28:31], a[44:47], a[192:195]
  s_add_u32 m0, s60, s93
  ds_read_b128 a[16:19], v25 offset:0
  ds_read_b128 a[20:23], v25 offset:1024
  v_fmac_f32 v64, v40, v48
  v_mfma_f32_16x16x32_bf16 a[196:199], a[28:31], a[48:51], a[196:199]
  ds_read_b128 a[24:27], v25 offset:2048
  ds_read_b64_tr_b16 a[0:1], v24 offset:0
  v_fmac_f32 v65, v41, v48
  v_mfma_f32_16x16x32_bf16 a[200:203], a[28:31], a[52:55], a[200:203]
  ds_read_b64_tr_b16 a[2:3], v24 offset:512
  buffer_load_dwordx4 v28, s[36:39], s62 offen offset:0 lds
  v_fmac_f32 v66, v42, v48
  v_mfma_f32_16x16x32_bf16 a[204:207], a[32:35], a[44:47], a[204:207]
  ds_read_b64_tr_b16 a[4:5], v24 offset:32
  ds_read_b64_tr_b16 a[6:7], v24 offset:544
  v_fmac_f32 v67, v43, v48
  v_mfma_f32_16x16x32_bf16 a[208:211], a[32:35], a[48:51], a[208:211]
  ds_read_b64_tr_b16 a[8:9], v24 offset:64
  buffer_load_dwordx4 v29, s[36:39], s62 offen offset:1056 lds
  v_fmac_f32 v80, v44, v48
  v_mfma_f32_16x16x32_bf16 a[212:215], a[32:35], a[52:55], a[212:215]
  ds_read_b64_tr_b16 a[10:11], v24 offset:576
  ds_read_b64_tr_b16 a[12:13], v24 offset:96
  v_fmac_f32 v81, v45, v48
  v_mfma_f32_16x16x32_bf16 a[216:219], a[36:39], a[44:47], a[216:219]
  ds_read_b64_tr_b16 a[14:15], v24 offset:608
  buffer_load_dwordx4 v30, s[36:39], s62 offen offset:2112 lds
  v_fmac_f32 v82, v46, v48
  v_mfma_f32_16x16x32_bf16 a[220:223], a[36:39], a[48:51], a[220:223]
  buffer_load_dwordx4 v31, s[36:39], s62 offen offset:3168 lds
  v_fmac_f32 v83, v47, v48
  v_mul_f32 v64, v64, v49
  v_mfma_f32_16x16x32_bf16 a[224:227], a[36:39], a[52:55], a[224:227]
  v_mul_f32 v65, v65, v49
  v_mul_f32 v66, v66, v49
  v_mul_f32 v67, v67, v49
  v_mfma_f32_16x16x32_bf16 a[228:231], a[40:43], a[44:47], a[228:231]
  s_add_u32 s62, s62, 589824
  v_mul_f32 v80, v80, v49
  v_mul_f32 v81, v81, v49
  v_mul_f32 v82, v82, v49
  v_mfma_f32_16x16x32_bf16 a[232:235], a[40:43], a[48:51], a[232:235]
  v_mul_f32 v83, v83, v49
  v_cvt_pk_bf16_f32 v192, v64, v65
  v_cvt_pk_bf16_f32 v193, v66, v67
  v_mfma_f32_16x16x32_bf16 a[236:239], a[40:43], a[52:55], a[236:239]
  s_waitcnt lgkmcnt(0)
  v_mfma_f32_16x16x32_bf16 a[192:195], a[0:3], a[16:19], a[192:195]
  s_add_u32 m0, s61, s93
  ds_read_b128 a[44:47], v25 offset:6144
  ds_read_b128 a[48:51], v25 offset:7168
  v_mfma_f32_16x16x32_bf16 a[196:199], a[0:3], a[20:23], a[196:199]
  ds_read_b128 a[52:55], v25 offset:8192
  ds_read_b64_tr_b16 a[28:29], v24 offset:8448
  v_mfma_f32_16x16x32_bf16 a[200:203], a[0:3], a[24:27], a[200:203]
  ds_read_b64_tr_b16 a[30:31], v24 offset:8960
  buffer_load_dwordx4 v32, s[12:15], s63 offen offset:0 sc1 lds
  v_mfma_f32_16x16x32_bf16 a[204:207], a[4:7], a[16:19], a[204:207]
  ds_read_b64_tr_b16 a[32:33], v24 offset:8480
  ds_read_b64_tr_b16 a[34:35], v24 offset:8992
  v_mfma_f32_16x16x32_bf16 a[208:211], a[4:7], a[20:23], a[208:211]
  ds_read_b64_tr_b16 a[36:37], v24 offset:8512
  buffer_load_dwordx4 v32, s[12:15], s63 offen offset:1024 sc1 lds
  v_mfma_f32_16x16x32_bf16 a[212:215], a[4:7], a[24:27], a[212:215]
  ds_read_b64_tr_b16 a[38:39], v24 offset:9024
  ds_read_b64_tr_b16 a[40:41], v24 offset:8544
  v_mfma_f32_16x16x32_bf16 a[216:219], a[8:11], a[16:19], a[216:219]
  ds_read_b64_tr_b16 a[42:43], v24 offset:9056
  buffer_load_dwordx4 v32, s[12:15], s63 offen offset:2048 sc1 lds
  v_mfma_f32_16x16x32_bf16 a[220:223], a[8:11], a[20:23], a[220:223]
  s_mov_b32 s93, s92
  s_add_u32 s92, s92, 29184
  v_cvt_pk_bf16_f32 v194, v80, v81
  v_mfma_f32_16x16x32_bf16 a[224:227], a[8:11], a[24:27], a[224:227]
  s_add_u32 s63, s63, 73728
  s_cmp_eq_u32 s92, 145920
  s_cselect_b32 s92, 0, s92
  v_mfma_f32_16x16x32_bf16 a[228:231], a[12:15], a[16:19], a[228:231]
  v_add_u32 v24, s92, v26
  v_cvt_pk_bf16_f32 v195, v82, v83
  v_mfma_f32_16x16x32_bf16 a[232:235], a[12:15], a[20:23], a[232:235]
  v_add_u32 v25, s92, v27
  v_fmac_f32 v68, v40, v50
  v_mfma_f32_16x16x32_bf16 a[236:239], a[12:15], a[24:27], a[236:239]
  s_waitcnt vmcnt(21) lgkmcnt(0)
  s_barrier
  v_mfma_f32_16x16x32_bf16 a[192:195], a[28:31], a[44:47], a[192:195]
  s_add_u32 m0, s60, s93
  ds_read_b128 a[16:19], v25 offset:0
  ds_read_b128 a[20:23], v25 offset:1024
  v_mfma_f32_16x16x32_bf16 a[196:199], a[28:31], a[48:51], a[196:199]
  ds_read_b128 a[24:27], v25 offset:2048
  ds_read_b64_tr_b16 a[0:1], v24 offset:0
  v_mfma_f32_16x16x32_bf16 a[200:203], a[28:31], a[52:55], a[200:203]
  ds_read_b64_tr_b16 a[2:3], v24 offset:512
  buffer_load_dwordx4 v28, s[36:39], s62 offen offset:0 lds
  v_mfma_f32_16x16x32_bf16 a[204:207], a[32:35], a[44:47], a[204:207]
  ds_read_b64_tr_b16 a[4:5], v24 offset:32
  ds_read_b64_tr_b16 a[6:7], v24 offset:544
  v_mfma_f32_16x16x32_bf16 a[208:211], a[32:35], a[48:51], a[208:211]
  ds_read_b64_tr_b16 a[8:9], v24 offset:64
  buffer_load_dwordx4 v29, s[36:39], s62 offen offset:1056 lds
  v_mfma_f32_16x16x32_bf16 a[212:215], a[32:35], a[52:55], a[212:215]
  ds_read_b64_tr_b16 a[10:11], v24 offset:576
  ds_read_b64_tr_b16 a[12:13], v24 offset:96
  v_mfma_f32_16x16x32_bf16 a[216:219], a[36:39], a[44:47], a[216:219]
  ds_read_b64_tr_b16 a[14:15], v24 offset:608
  buffer_load_dwordx4 v30, s[36:39], s62 offen offset:2112 lds
  v_mfma_f32_16x16x32_bf16 a[220:223], a[36:39], a[48:51], a[220:223]
  buffer_load_dwordx4 v31, s[36:39], s62 offen offset:3168 lds
  v_fmac_f32 v69, v41, v50
  v_mfma_f32_16x16x32_bf16 a[224:227], a[36:39], a[52:55], a[224:227]
  v_fmac_f32 v70, v42, v50
  v_fmac_f32 v71, v43, v50
  v_mfma_f32_16x16x32_bf16 a[228:231], a[40:43], a[44:47], a[228:231]
  s_add_u32 s62, s62, 589824
  v_fmac_f32 v84, v44, v50
  v_fmac_f32 v85, v45, v50
  v_mfma_f32_16x16x32_bf16 a[232:235], a[40:43], a[48:51], a[232:235]
  v_fmac_f32 v86, v46, v50
  v_fmac_f32 v87, v47, v50
  v_mfma_f32_16x16x32_bf16 a[236:239], a[40:43], a[52:55], a[236:239]
  s_waitcnt lgkmcnt(0)
  v_mfma_f32_16x16x32_bf16 a[192:195], a[0:3], a[16:19], a[192:195]
  s_add_u32 m0, s61, s93
  ds_read_b128 a[44:47], v25 offset:6144
  ds_read_b128 a[48:51], v25 offset:7168
  v_mfma_f32_16x16x32_bf16 a[196:199], a[0:3], a[20:23], a[196:199]
  ds_read_b128 a[52:55], v25 offset:8192
  ds_read_b64_tr_b16 a[28:29], v24 offset:8448
  v_mfma_f32_16x16x32_bf16 a[200:203], a[0:3], a[24:27], a[200:203]
  ds_read_b64_tr_b16 a[30:31], v24 offset:8960
  buffer_load_dwordx4 v32, s[12:15], s63 offen offset:0 sc1 lds
  v_mfma_f32_16x16x32_bf16 a[204:207], a[4:7], a[16:19], a[204:207]
  ds_read_b64_tr_b16 a[32:33], v24 offset:8480
  ds_read_b64_tr_b16 a[34:35], v24 offset:8992
  v_mfma_f32_16x16x32_bf16 a[208:211], a[4:7], a[20:23], a[208:211]
  ds_read_b64_tr_b16 a[36:37], v24 offset:8512
  buffer_load_dwordx4 v32, s[12:15], s63 offen offset:1024 sc1 lds
  v_mfma_f32_16x16x32_bf16 a[212:215], a[4:7], a[24:27], a[212:215]
  ds_read_b64_tr_b16 a[38:39], v24 offset:9024
  ds_read_b64_tr_b16 a[40:41], v24 offset:8544
  v_mfma_f32_16x16x32_bf16 a[216:219], a[8:11], a[16:19], a[216:219]
  ds_read_b64_tr_b16 a[42:43], v24 offset:9056
  buffer_load_dwordx4 v32, s[12:15], s63 offen offset:2048 sc1 lds
  v_mfma_f32_16x16x32_bf16 a[220:223], a[8:11], a[20:23], a[220:223]
  s_mov_b32 s93, s92
  s_add_u32 s92, s92, 29184
  v_mul_f32 v68, v68, v51
  v_mfma_f32_16x16x32_bf16 a[224:227], a[8:11], a[24:27], a[224:227]
  s_add_u32 s63, s63, 73728
  s_cmp_eq_u32 s92, 145920
  s_cselect_b32 s92, 0, s92
  v_mfma_f32_16x16x32_bf16 a[228:231], a[12:15], a[16:19], a[228:231]
  v_add_u32 v24, s92, v26
  v_mul_f32 v69, v69, v51
  v_mfma_f32_16x16x32_bf16 a[232:235], a[12:15], a[20:23], a[232:235]
  v_add_u32 v25, s92, v27
  v_mul_f32 v70, v70, v51
  v_mfma_f32_16x16x32_bf16 a[236:239], a[12:15], a[24:27], a[236:239]
  s_waitcnt vmcnt(21) lgkmcnt(0)
  s_barrier
  v_mfma_f32_16x16x32_bf16 a[192:195], a[28:31], a[44:47], a[192:195]
  s_add_u32 m0, s60, s93
  ds_read_b128 a[16:19], v25 offset:0
  ds_read_b128 a[20:23], v25 offset:1024
  v_mul_f32 v71, v71, v51
  v_mfma_f32_16x16x32_bf16 a[196:199], a[28:31], a[48:51], a[196:199]
  ds_read_b128 a[24:27], v25 offset:2048
  ds_read_b64_tr_b16 a[0:1], v24 offset:0
  v_mul_f32 v84, v84, v51
  v_mfma_f32_16x16x32_bf16 a[200:203], a[28:31], a[52:55], a[200:203]
  ds_read_b64_tr_b16 a[2:3], v24 offset:512
  buffer_load_dwordx4 v28, s[36:39], s62 offen offset:0 lds
  v_mul_f32 v85, v85, v51
  v_mfma_f32_16x16x32_bf16 a[204:207], a[32:35], a[44:47], a[204:207]
  ds_read_b64_tr_b16 a[4:5], v24 offset:32
  ds_read_b64_tr_b16 a[6:7], v24 offset:544
  v_mul_f32 v86, v86, v51
  v_mfma_f32_16x16x32_bf16 a[208:211], a[32:35], a[48:51], a[208:211]
  ds_read_b64_tr_b16 a[8:9], v24 offset:64
  buffer_load_dwordx4 v29, s[36:39], s62 offen offset:1056 lds
  v_mul_f32 v87, v87, v51
  v_mfma_f32_16x16x32_bf16 a[212:215], a[32:35], a[52:55], a[212:215]
  ds_read_b64_tr_b16 a[10:11], v24 offset:576
  ds_read_b64_tr_b16 a[12:13], v24 offset:96
  v_cvt_pk_bf16_f32 v208, v68, v69
  v_mfma_f32_16x16x32_bf16 a[216:219], a[36:39], a[44:47], a[216:219]
  ds_read_b64_tr_b16 a[14:15], v24 offset:608
  buffer_load_dwordx4 v30, s[36:39], s62 offen offset:2112 lds
  v_cvt_pk_bf16_f32 v209, v70, v71
  v_mfma_f32_16x16x32_bf16 a[220:223], a[36:39], a[48:51], a[220:223]
  buffer_load_dwordx4 v31, s[36:39], s62 offen offset:3168 lds
  v_cvt_pk_bf16_f32 v210, v84, v85
  v_cvt_pk_bf16_f32 v211, v86, v87
  v_mfma_f32_16x16x32_bf16 a[224:227], a[36:39], a[52:55], a[224:227]
TP_3:
  s_cbranch_execz TP_7
  v_fmac_f32 v72, v40, v52
  v_fmac_f32 v73, v41, v52
  v_fmac_f32 v74, v42, v52
  v_mfma_f32_16x16x32_bf16 a[228:231], a[40:43], a[44:47], a[228:231]
  s_add_u32 s62, s62, 589824
  v_fmac_f32 v75, v43, v52
  v_fmac_f32 v88, v44, v52
  v_fmac_f32 v89, v45, v52
  v_mfma_f32_16x16x32_bf16 a[232:235], a[40:43], a[48:51], a[232:235]
  v_fmac_f32 v90, v46, v52
  v_fmac_f32 v91, v47, v52
  v_mul_f32 v72, v72, v53
  v_mfma_f32_16x16x32_bf16 a[236:239], a[40:43], a[52:55], a[236:239]
  s_waitcnt lgkmcnt(0)
  v_mfma_f32_16x16x32_bf16 a[192:195], a[0:3], a[16:19], a[192:195]
  s_add_u32 m0, s61, s93
  ds_read_b128 a[44:47], v25 offset:6144
  ds_read_b128 a[48:51], v25 offset:7168
  v_mfma_f32_16x16x32_bf16 a[196:199], a[0:3], a[20:23], a[196:199]
  ds_read_b128 a[52:55], v25 offset:8192
  ds_read_b64_tr_b16 a[28:29], v24 offset:8448
  v_mfma_f32_16x16x32_bf16 a[200:203], a[0:3], a[24:27], a[200:203]
  ds_read_b64_tr_b16 a[30:31], v24 offset:8960
  buffer_load_dwordx4 v32, s[12:15], s63 offen offset:0 sc1 lds
  v_mfma_f32_16x16x32_bf16 a[204:207], a[4:7], a[16:19], a[204:207]
  ds_read_b64_tr_b16 a[32:33], v24 offset:8480
  ds_read_b64_tr_b16 a[34:35], v24 offset:8992
  v_mfma_f32_16x16x32_bf16 a[208:211], a[4:7], a[20:23], a[208:211]
  ds_read_b64_tr_b16 a[36:37], v24 offset:8512
  buffer_load_dwordx4 v32, s[12:15], s63 offen offset:1024 sc1 lds
  v_mfma_f32_16x16x32_bf16 a[212:215], a[4:7], a[24:27], a[212:215]
  ds_read_b64_tr_b16 a[38:39], v24 offset:9024
  ds_read_b64_tr_b16 a[40:41], v24 offset:8544
  v_mfma_f32_16x16x32_bf16 a[216:219], a[8:11], a[16:19], a[216:219]
  ds_read_b64_tr_b16 a[42:43], v24 offset:9056
  buffer_load_dwordx4 v32, s[12:15], s63 offen offset:2048 sc1 lds
  v_mfma_f32_16x16x32_bf16 a[220:223], a[8:11], a[20:23], a[220:223]
  s_mov_b32 s93, s92
  s_add_u32 s92, s92, 29184
  v_mul_f32 v73, v73, v53
  v_mfma_f32_16x16x32_bf16 a[224:227], a[8:11], a[24:27], a[224:227]
  s_add_u32 s63, s63, 73728
  s_cmp_eq_u32 s92, 145920
  s_cselect_b32 s92, 0, s92
  v_mfma_f32_16x16x32_bf16 a[228:231], a[12:15], a[16:19], a[228:231]
  v_add_u32 v24, s92, v26
  v_mul_f32 v74, v74, v53
  v_mfma_f32_16x16x32_bf16 a[232:235], a[12:15], a[20:23], a[232:235]
  v_add_u32 v25, s92, v27
  v_mul_f32 v75, v75, v53
  v_mfma_f32_16x16x32_bf16 a[236:239], a[12:15], a[24:27], a[236:239]
  s_waitcnt vmcnt(21) lgkmcnt(0)
  s_barrier
  v_mfma_f32_16x16x32_bf16 a[192:195], a[28:31], a[44:47], a[192:195]
  s_add_u32 m0, s60, s93
  ds_read_b128 a[16:19], v25 offset:0
  ds_read_b128 a[20:23], v25 offset:1024
  v_mfma_f32_16x16x32_bf16 a[196:199], a[28:31], a[48:51], a[196:199]
  ds_read_b128 a[24:27], v25 offset:2048
  ds_read_b64_tr_b16 a[0:1], v24 offset:0
  v_mfma_f32_16x16x32_bf16 a[200:203], a[28:31], a[52:55], a[200:203]
  ds_read_b64_tr_b16 a[2:3], v24 offset:512
  buffer_load_dwordx4 v28, s[36:39], s62 offen offset:0 lds
  v_mfma_f32_16x16x32_bf16 a[204:207], a[32:35], a[44:47], a[204:207]
  ds_read_b64_tr_b16 a[4:5], v24 offset:32
  ds_read_b64_tr_b16 a[6:7], v24 offset:544
  v_mfma_f32_16x16x32_bf16 a[208:211], a[32:35], a[48:51], a[208:211]
  ds_read_b64_tr_b16 a[8:9], v24 offset:64
  buffer_load_dwordx4 v29, s[36:39], s62 offen offset:1056 lds
  v_mfma_f32_16x16x32_bf16 a[212:215], a[32:35], a[52:55], a[212:215]
  ds_read_b64_tr_b16 a[10:11], v24 offset:576
  ds_read_b64_tr_b16 a[12:13], v24 offset:96
  v_mfma_f32_16x16x32_bf16 a[216:219], a[36:39], a[44:47], a[216:219]
  ds_read_b64_tr_b16 a[14:15], v24 offset:608
  buffer_load_dwordx4 v30, s[36:39], s62 offen offset:2112 lds
  v_mfma_f32_16x16x32_bf16 a[220:223], a[36:39], a[48:51], a[220:223]
  buffer_load_dwordx4 v31, s[36:39], s62 offen offset:3168 lds
  v_mul_f32 v88, v88, v53
  v_mfma_f32_16x16x32_bf16 a[224:227], a[36:39], a[52:55], a[224:227]
  v_mul_f32 v89, v89, v53
  v_mul_f32 v90, v90, v53
  v_mfma_f32_16x16x32_bf16 a[228:231], a[40:43], a[44:47], a[228:231]
  s_add_u32 s62, s62, 589824
  v_mul_f32 v91, v91, v53
  v_cvt_pk_bf16_f32 v224, v72, v73
  v_mfma_f32_16x16x32_bf16 a[232:235], a[40:43], a[48:51], a[232:235]
  v_cvt_pk_bf16_f32 v225, v74, v75
  v_cvt_pk_bf16_f32 v226, v88, v89
  v_mfma_f32_16x16x32_bf16 a[236:239], a[40:43], a[52:55], a[236:239]
  s_waitcnt lgkmcnt(0)
  v_mfma_f32_16x16x32_bf16 a[192:195], a[0:3], a[16:19], a[192:195]
  s_add_u32 m0, s61, s93
  ds_read_b128 a[44:47], v25 offset:6144
  ds_read_b128 a[48:51], v25 offset:7168
  v_mfma_f32_16x16x32_bf16 a[196:199], a[0:3], a[20:23], a[196:199]
  ds_read_b128 a[52:55], v25 offset:8192
  ds_read_b64_tr_b16 a[28:29], v24 offset:8448
  v_mfma_f32_16x16x32_bf16 a[200:203], a[0:3], a[24:27], a[200:203]
  ds_read_b64_tr_b16 a[30:31], v24 offset:8960
  buffer_load_dwordx4 v32, s[12:15], s63 offen offset:0 sc1 lds
  v_mfma_f32_16x16x32_bf16 a[204:207], a[4:7], a[16:19], a[204:207]
  ds_read_b64_tr_b16 a[32:33], v24 offset:8480
  ds_read_b64_tr_b16 a[34:35], v24 offset:8992
  v_mfma_f32_16x16x32_bf16 a[208:211], a[4:7], a[20:23], a[208:211]
  ds_read_b64_tr_b16 a[36:37], v24 offset:8512
  buffer_load_dwordx4 v32, s[12:15], s63 offen offset:1024 sc1 lds
  v_mfma_f32_16x16x32_bf16 a[212:215], a[4:7], a[24:27], a[212:215]
  ds_read_b64_tr_b16 a[38:39], v24 offset:9024
  ds_read_b64_tr_b16 a[40:41], v24 offset:8544
  v_mfma_f32_16x16x32_bf16 a[216:219], a[8:11], a[16:19], a[216:219]
  ds_read_b64_tr_b16 a[42:43], v24 offset:9056
  buffer_load_dwordx4 v32, s[12:15], s63 offen offset:2048 sc1 lds
  v_mfma_f32_16x16x32_bf16 a[220:223], a[8:11], a[20:23], a[220:223]
  s_mov_b32 s93, s92
  s_add_u32 s92, s92, 29184
  v_cvt_pk_bf16_f32 v227, v90, v91
  v_mfma_f32_16x16x32_bf16 a[224:227], a[8:11], a[24:27], a[224:227]
  s_add_u32 s63, s63, 73728
  s_cmp_eq_u32 s92, 145920
  s_cselect_b32 s92, 0, s92
  v_mfma_f32_16x16x32_bf16 a[228:231], a[12:15], a[16:19], a[228:231]
  v_add_u32 v24, s92, v26
  v_fmac_f32 v76, v40, v54
  v_mfma_f32_16x16x32_bf16 a[232:235], a[12:15], a[20:23], a[232:235]
  v_add_u32 v25, s92, v27
  v_fmac_f32 v77, v41, v54
  v_mfma_f32_16x16x32_bf16 a[236:239], a[12:15], a[24:27], a[236:239]
  s_waitcnt vmcnt(21) lgkmcnt(0)
  s_barrier
  v_mfma_f32_16x16x32_bf16 a[192:195], a[28:31], a[44:47], a[192:195]
  s_add_u32 m0, s60, s93
  ds_read_b128 a[16:19], v25 offset:0
  ds_read_b128 a[20:23], v25 offset:1024
  v_fmac_f32 v78, v42, v54
  v_mfma_f32_16x16x32_bf16 a[196:199], a[28:31], a[48:51], a[196:199]
  ds_read_b128 a[24:27], v25 offset:2048
  ds_read_b64_tr_b16 a[0:1], v24 offset:0
  v_fmac_f32 v79, v43, v54
  v_mfma_f32_16x16x32_bf16 a[200:203], a[28:31], a[52:55], a[200:203]
  ds_read_b64_tr_b16 a[2:3], v24 offset:512
  buffer_load_dwordx4 v28, s[36:39], s62 offen offset:0 lds
  v_fmac_f32 v92, v44, v54
  v_mfma_f32_16x16x32_bf16 a[204:207], a[32:35], a[44:47], a[204:207]
  ds_read_b64_tr_b16 a[4:5], v24 offset:32
  ds_read_b64_tr_b16 a[6:7], v24 offset:544
  v_fmac_f32 v93, v45, v54
  v_mfma_f32_16x16x32_bf16 a[208:211], a[32:35], a[48:51], a[208:211]
  ds_read_b64_tr_b16 a[8:9], v24 offset:64
  buffer_load_dwordx4 v29, s[36:39], s62 offen offset:1056 lds
  v_fmac_f32 v94, v46, v54
  v_mfma_f32_16x16x32_bf16 a[212:215], a[32:35], a[52:55], a[212:215]
  ds_read_b64_tr_b16 a[10:11], v24 offset:576
  ds_read_b64_tr_b16 a[12:13], v24 offset:96
  v_fmac_f32 v95, v47, v54
  v_mfma_f32_16x16x32_bf16 a[216:219], a[36:39], a[44:47], a[216:219]
  ds_read_b64_tr_b16 a[14:15], v24 offset:608
  buffer_load_dwordx4 v30, s[36:39], s62 offen offset:2112 lds
  v_mul_f32 v76, v76, v55
  v_mfma_f32_16x16x32_bf16 a[220:223], a[36:39], a[48:51], a[220:223]
  buffer_load_dwordx4 v31, s[36:39], s62 offen offset:3168 lds
  v_mul_f32 v77, v77, v55
  v_mul_f32 v78, v78, v55
  v_mfma_f32_16x16x32_bf16 a[224:227], a[36:39], a[52:55], a[224:227]
  v_mul_f32 v79, v79, v55
  v_mul_f32 v92, v92, v55
  v_mul_f32 v93, v93, v55
  v_mfma_f32_16x16x32_bf16 a[228:231], a[40:43], a[44:47], a[228:231]
  s_add_u32 s62, s62, 589824
  v_mul_f32 v94, v94, v55
  v_mul_f32 v95, v95, v55
  v_cvt_pk_bf16_f32 v240, v76, v77
  v_mfma_f32_16x16x32_bf16 a[232:235], a[40:43], a[48:51], a[232:235]
  v_cvt_pk_bf16_f32 v241, v78, v79
  v_cvt_pk_bf16_f32 v242, v92, v93
  v_cvt_pk_bf16_f32 v243, v94, v95
  v_mfma_f32_16x16x32_bf16 a[236:239], a[40:43], a[52:55], a[236:239]
  s_waitcnt lgkmcnt(0)
  v_mfma_f32_16x16x32_bf16 a[192:195], a[0:3], a[16:19], a[192:195]
  s_add_u32 m0, s61, s93
  ds_read_b128 a[44:47], v25 offset:6144
  ds_read_b128 a[48:51], v25 offset:7168
  v_mfma_f32_16x16x32_bf16 a[196:199], a[0:3], a[20:23], a[196:199]
  ds_read_b128 a[52:55], v25 offset:8192
  ds_read_b64_tr_b16 a[28:29], v24 offset:8448
  v_mfma_f32_16x16x32_bf16 a[200:203], a[0:3], a[24:27], a[200:203]
  ds_read_b64_tr_b16 a[30:31], v24 offset:8960
  buffer_load_dwordx4 v32, s[12:15], s63 offen offset:0 sc1 lds
  v_mfma_f32_16x16x32_bf16 a[204:207], a[4:7], a[16:19], a[204:207]
  ds_read_b64_tr_b16 a[32:33], v24 offset:8480
  ds_read_b64_tr_b16 a[34:35], v24 offset:8992
  v_mfma_f32_16x16x32_bf16 a[208:211], a[4:7], a[20:23], a[208:211]
  ds_read_b64_tr_b16 a[36:37], v24 offset:8512
  buffer_load_dwordx4 v32, s[12:15], s63 offen offset:1024 sc1 lds
  v_mfma_f32_16x16x32_bf16 a[212:215], a[4:7], a[24:27], a[212:215]
  ds_read_b64_tr_b16 a[38:39], v24 offset:9024
  ds_read_b64_tr_b16 a[40:41], v24 offset:8544
  v_mfma_f32_16x16x32_bf16 a[216:219], a[8:11], a[16:19], a[216:219]
  ds_read_b64_tr_b16 a[42:43], v24 offset:9056
  buffer_load_dwordx4 v32, s[12:15], s63 offen offset:2048 sc1 lds
  v_mfma_f32_16x16x32_bf16 a[220:223], a[8:11], a[20:23], a[220:223]
  s_mov_b32 s93, s92
  s_add_u32 s92, s92, 29184
  v_mfma_f32_16x16x32_bf16 a[224:227], a[8:11], a[24:27], a[224:227]
  s_add_u32 s63, s63, 73728
  s_cmp_eq_u32 s92, 145920
  s_cselect_b32 s92, 0, s92
  v_mfma_f32_16x16x32_bf16 a[228:231], a[12:15], a[16:19], a[228:231]
  v_add_u32 v24, s92, v26
  v_mfma_f32_16x16x32_bf16 a[232:235], a[12:15], a[20:23], a[232:235]
  v_add_u32 v25, s92, v27
  v_mfma_f32_16x16x32_bf16 a[236:239], a[12:15], a[24:27], a[236:239]
  s_waitcnt vmcnt(21) lgkmcnt(0)
  s_barrier
  v_mfma_f32_16x16x32_bf16 a[192:195], a[28:31], a[44:47], a[192:195]
  s_add_u32 m0, s60, s93
  ds_read_b128 a[16:19], v25 offset:0
  ds_read_b128 a[20:23], v25 offset:1024
  v_mfma_f32_16x16x32_bf16 a[196:199], a[28:31], a[48:51], a[196:199]
  ds_read_b128 a[24:27], v25 offset:2048
  ds_read_b64_tr_b16 a[0:1], v24 offset:0
  v_mfma_f32_16x16x32_bf16 a[200:203], a[28:31], a[52:55], a[200:203]
  ds_read_b64_tr_b16 a[2:3], v24 offset:512
  buffer_load_dwordx4 v28, s[36:39], s62 offen offset:0 lds
  v_mfma_f32_16x16x32_bf16 a[204:207], a[32:35], a[44:47], a[204:207]
  ds_read_b64_tr_b16 a[4:5], v24 offset:32
  ds_read_b64_tr_b16 a[6:7], v24 offset:544
  v_mfma_f32_16x16x32_bf16 a[208:211], a[32:35], a[48:51], a[208:211]
  ds_read_b64_tr_b16 a[8:9], v24 offset:64
  buffer_load_dwordx4 v29, s[36:39], s62 offen offset:1056 lds
  v_mfma_f32_16x16x32_bf16 a[212:215], a[32:35], a[52:55], a[212:215]
  ds_read_b64_tr_b16 a[10:11], v24 offset:576
  ds_read_b64_tr_b16 a[12:13], v24 offset:96
  v_mfma_f32_16x16x32_bf16 a[216:219], a[36:39], a[44:47], a[216:219]
  ds_read_b64_tr_b16 a[14:15], v24 offset:608
  buffer_load_dwordx4 v30, s[36:39], s62 offen offset:2112 lds
  v_mfma_f32_16x16x32_bf16 a[220:223], a[36:39], a[48:51], a[220:223]
  buffer_load_dwordx4 v31, s[36:39], s62 offen offset:3168 lds
  v_mfma_f32_16x16x32_bf16 a[224:227], a[36:39], a[52:55], a[224:227]
  v_permlane16_swap_b32 v192, v194
  v_mfma_f32_16x16x32_bf16 a[228:231], a[40:43], a[44:47], a[228:231]
  s_add_u32 s62, s62, 589824
  v_permlane16_swap_b32 v193, v195
  v_mfma_f32_16x16x32_bf16 a[232:235], a[40:43], a[48:51], a[232:235]
  v_permlane16_swap_b32 v208, v210
  v_mfma_f32_16x16x32_bf16 a[236:239], a[40:43], a[52:55], a[236:239]
  s_waitcnt lgkmcnt(0)
  v_mfma_f32_16x16x32_bf16 a[192:195], a[0:3], a[16:19], a[192:195]
  s_add_u32 m0, s61, s93
  ds_read_b128 a[44:47], v25 offset:6144
  ds_read_b128 a[48:51], v25 offset:7168
  v_mfma_f32_16x16x32_bf16 a[196:199], a[0:3], a[20:23], a[196:199]
  ds_read_b128 a[52:55], v25 offset:8192
  ds_read_b64_tr_b16 a[28:29], v24 offset:8448
  v_mfma_f32_16x16x32_bf16 a[200:203], a[0:3], a[24:27], a[200:203]
  ds_read_b64_tr_b16 a[30:31], v24 offset:8960
  buffer_load_dwordx4 v32, s[12:15], s63 offen offset:0 sc1 lds
  v_mfma_f32_16x16x32_bf16 a[204:207], a[4:7], a[16:19], a[204:207]
  ds_read_b64_tr_b16 a[32:33], v24 offset:8480
  ds_read_b64_tr_b16 a[34:35], v24 offset:8992
  v_mfma_f32_16x16x32_bf16 a[208:211], a[4:7], a[20:23], a[208:211]
  ds_read_b64_tr_b16 a[36:37], v24 offset:8512
  buffer_load_dwordx4 v32, s[12:15], s63 offen offset:1024 sc1 lds
  v_mfma_f32_16x16x32_bf16 a[212:215], a[4:7], a[24:27], a[212:215]
  ds_read_b64_tr_b16 a[38:39], v24 offset:9024
  ds_read_b64_tr_b16 a[40:41], v24 offset:8544
  v_mfma_f32_16x16x32_bf16 a[216:219], a[8:11], a[16:19], a[216:219]
  ds_read_b64_tr_b16 a[42:43], v24 offset:9056
  buffer_load_dwordx4 v32, s[12:15], s63 offen offset:2048 sc1 lds
  v_mfma_f32_16x16x32_bf16 a[220:223], a[8:11], a[20:23], a[220:223]
  s_mov_b32 s93, s92
  s_add_u32 s92, s92, 29184
  v_mfma_f32_16x16x32_bf16 a[224:227], a[8:11], a[24:27], a[224:227]
  s_add_u32 s63, s63, 73728
  s_cmp_eq_u32 s92, 145920
  s_cselect_b32 s92, 0, s92
  v_mfma_f32_16x16x32_bf16 a[228:231], a[12:15], a[16:19], a[228:231]
  v_add_u32 v24, s92, v26
  v_mfma_f32_16x16x32_bf16 a[232:235], a[12:15], a[20:23], a[232:235]
  v_add_u32 v25, s92, v27
  v_mfma_f32_16x16x32_bf16 a[236:239], a[12:15], a[24:27], a[236:239]
  s_waitcnt vmcnt(21) lgkmcnt(0)
  s_barrier
  v_mfma_f32_16x16x32_bf16 a[192:195], a[28:31], a[44:47], a[192:195]
  s_add_u32 m0, s60, s93
  ds_read_b128 a[16:19], v25 offset:0
  ds_read_b128 a[20:23], v25 offset:1024
  v_mfma_f32_16x16x32_bf16 a[196:199], a[28:31], a[48:51], a[196:199]
  ds_read_b128 a[24:27], v25 offset:2048
  ds_read_b64_tr_b16 a[0:1], v24 offset:0
  v_mfma_f32_16x16x32_bf16 a[200:203], a[28:31], a[52:55], a[200:203]
  ds_read_b64_tr_b16 a[2:3], v24 offset:512
  buffer_load_dwordx4 v28, s[36:39], s62 offen offset:0 lds
  v_mfma_f32_16x16x32_bf16 a[204:207], a[32:35], a[44:47], a[204:207]
  ds_read_b64_tr_b16 a[4:5], v24 offset:32
  ds_read_b64_tr_b16 a[6:7], v24 offset:544
  v_mfma_f32_16x16x32_bf16 a[208:211], a[32:35], a[48:51], a[208:211]
  ds_read_b64_tr_b16 a[8:9], v24 offset:64
  buffer_load_dwordx4 v29, s[36:39], s62 offen offset:1056 lds
  v_mfma_f32_16x16x32_bf16 a[212:215], a[32:35], a[52:55], a[212:215]
  ds_read_b64_tr_b16 a[10:11], v24 offset:576
  ds_read_b64_tr_b16 a[12:13], v24 offset:96
  v_mfma_f32_16x16x32_bf16 a[216:219], a[36:39], a[44:47], a[216:219]
  ds_read_b64_tr_b16 a[14:15], v24 offset:608
  buffer_load_dwordx4 v30, s[36:39], s62 offen offset:2112 lds
  v_mfma_f32_16x16x32_bf16 a[220:223], a[36:39], a[48:51], a[220:223]
  buffer_load_dwordx4 v31, s[36:39], s62 offen offset:3168 lds
  v_permlane16_swap_b32 v209, v211
  v_mfma_f32_16x16x32_bf16 a[224:227], a[36:39], a[52:55], a[224:227]
  v_permlane16_swap_b32 v224, v226
  v_mfma_f32_16x16x32_bf16 a[228:231], a[40:43], a[44:47], a[228:231]
  s_add_u32 s62, s62, 589824
  v_permlane16_swap_b32 v225, v227
  v_mfma_f32_16x16x32_bf16 a[232:235], a[40:43], a[48:51], a[232:235]
  v_permlane16_swap_b32 v240, v242
  v_mfma_f32_16x16x32_bf16 a[236:239], a[40:43], a[52:55], a[236:239]
  s_waitcnt lgkmcnt(0)
  v_mfma_f32_16x16x32_bf16 a[192:195], a[0:3], a[16:19], a[192:195]
  s_add_u32 m0, s61, s93
  ds_read_b128 a[44:47], v25 offset:6144
  ds_read_b128 a[48:51], v25 offset:7168
  v_mfma_f32_16x16x32_bf16 a[196:199], a[0:3], a[20:23], a[196:199]
  ds_read_b128 a[52:55], v25 offset:8192
  ds_read_b64_tr_b16 a[28:29], v24 offset:8448
  v_mfma_f32_16x16x32_bf16 a[200:203], a[0:3], a[24:27], a[200:203]
  ds_read_b64_tr_b16 a[30:31], v24 offset:8960
  buffer_load_dwordx4 v32, s[12:15], s63 offen offset:0 sc1 lds
  v_mfma_f32_16x16x32_bf16 a[204:207], a[4:7], a[16:19], a[204:207]
  ds_read_b64_tr_b16 a[32:33], v24 offset:8480
  ds_read_b64_tr_b16 a[34:35], v24 offset:8992
  v_mfma_f32_16x16x32_bf16 a[208:211], a[4:7], a[20:23], a[208:211]
  ds_read_b64_tr_b16 a[36:37], v24 offset:8512
  buffer_load_dwordx4 v32, s[12:15], s63 offen offset:1024 sc1 lds
  v_mfma_f32_16x16x32_bf16 a[212:215], a[4:7], a[24:27], a[212:215]
  ds_read_b64_tr_b16 a[38:39], v24 offset:9024
  ds_read_b64_tr_b16 a[40:41], v24 offset:8544
  v_mfma_f32_16x16x32_bf16 a[216:219], a[8:11], a[16:19], a[216:219]
  ds_read_b64_tr_b16 a[42:43], v24 offset:9056
  buffer_load_dwordx4 v32, s[12:15], s63 offen offset:2048 sc1 lds
  v_mfma_f32_16x16x32_bf16 a[220:223], a[8:11], a[20:23], a[220:223]
  s_mov_b32 s93, s92
  s_add_u32 s92, s92, 29184
  v_mfma_f32_16x16x32_bf16 a[224:227], a[8:11], a[24:27], a[224:227]
  s_add_u32 s63, s63, 73728
  s_cmp_eq_u32 s92, 145920
  s_cselect_b32 s92, 0, s92
  v_mfma_f32_16x16x32_bf16 a[228:231], a[12:15], a[16:19], a[228:231]
  v_add_u32 v24, s92, v26
  v_mfma_f32_16x16x32_bf16 a[232:235], a[12:15], a[20:23], a[232:235]
  v_add_u32 v25, s92, v27
  v_mfma_f32_16x16x32_bf16 a[236:239], a[12:15], a[24:27], a[236:239]
  s_waitcnt vmcnt(21) lgkmcnt(0)
  s_barrier
  v_mfma_f32_16x16x32_bf16 a[192:195], a[28:31], a[44:47], a[192:195]
  s_add_u32 m0, s60, s93
  ds_read_b128 a[16:19], v25 offset:0
  ds_read_b128 a[20:23], v25 offset:1024
  v_mfma_f32_16x16x32_bf16 a[196:199], a[28:31], a[48:51], a[196:199]
  ds_read_b128 a[24:27], v25 offset:2048
  ds_read_b64_tr_b16 a[0:1], v24 offset:0
  v_mfma_f32_16x16x32_bf16 a[200:203], a[28:31], a[52:55], a[200:203]
  ds_read_b64_tr_b16 a[2:3], v24 offset:512
  buffer_load_dwordx4 v28, s[36:39], s62 offen offset:0 lds
  v_mfma_f32_16x16x32_bf16 a[204:207], a[32:35], a[44:47], a[204:207]
  ds_read_b64_tr_b16 a[4:5], v24 offset:32
  ds_read_b64_tr_b16 a[6:7], v24 offset:544
  v_mfma_f32_16x16x32_bf16 a[208:211], a[32:35], a[48:51], a[208:211]
  ds_read_b64_tr_b16 a[8:9], v24 offset:64
  buffer_load_dwordx4 v29, s[36:39], s62 offen offset:1056 lds
  v_mfma_f32_16x16x32_bf16 a[212:215], a[32:35], a[52:55], a[212:215]
  ds_read_b64_tr_b16 a[10:11], v24 offset:576
  ds_read_b64_tr_b16 a[12:13], v24 offset:96
  v_mfma_f32_16x16x32_bf16 a[216:219], a[36:39], a[44:47], a[216:219]
  ds_read_b64_tr_b16 a[14:15], v24 offset:608
  buffer_load_dwordx4 v30, s[36:39], s62 offen offset:2112 lds
  v_mfma_f32_16x16x32_bf16 a[220:223], a[36:39], a[48:51], a[220:223]
  buffer_load_dwordx4 v31, s[36:39], s62 offen offset:3168 lds
  v_mfma_f32_16x16x32_bf16 a[224:227], a[36:39], a[52:55], a[224:227]
  v_permlane16_swap_b32 v241, v243
  v_mfma_f32_16x16x32_bf16 a[228:231], a[40:43], a[44:47], a[228:231]
  s_add_u32 s62, s62, 589824
  ds_read_b128 v[40:43], v22
  ds_read_b128 v[44:47], v22 offset:64
  v_mfma_f32_16x16x32_bf16 a[232:235], a[40:43], a[48:51], a[232:235]
  v_fmac_f32 v96, v56, v48
  v_fmac_f32 v97, v57, v48
  v_mfma_f32_16x16x32_bf16 a[236:239], a[40:43], a[52:55], a[236:239]
  s_waitcnt lgkmcnt(0)
  v_mfma_f32_16x16x32_bf16 a[192:195], a[0:3], a[16:19], a[192:195]
  s_add_u32 m0, s61, s93
  ds_read_b128 a[44:47], v25 offset:6144
  ds_read_b128 a[48:51], v25 offset:7168
  v_mfma_f32_16x16x32_bf16 a[196:199], a[0:3], a[20:23], a[196:199]
  ds_read_b128 a[52:55], v25 offset:8192
  ds_read_b64_tr_b16 a[28:29], v24 offset:8448
  v_mfma_f32_16x16x32_bf16 a[200:203], a[0:3], a[24:27], a[200:203]
  ds_read_b64_tr_b16 a[30:31], v24 offset:8960
  buffer_load_dwordx4 v32, s[12:15], s63 offen offset:0 sc1 lds
  v_mfma_f32_16x16x32_bf16 a[204:207], a[4:7], a[16:19], a[204:207]
  ds_read_b64_tr_b16 a[32:33], v24 offset:8480
  ds_read_b64_tr_b16 a[34:35], v24 offset:8992
  v_mfma_f32_16x16x32_bf16 a[208:211], a[4:7], a[20:23], a[208:211]
  ds_read_b64_tr_b16 a[36:37], v24 offset:8512
  buffer_load_dwordx4 v32, s[12:15], s63 offen offset:1024 sc1 lds
  v_mfma_f32_16x16x32_bf16 a[212:215], a[4:7], a[24:27], a[212:215]
  ds_read_b64_tr_b16 a[38:39], v24 offset:9024
  ds_read_b64_tr_b16 a[40:41], v24 offset:8544
  v_mfma_f32_16x16x32_bf16 a[216:219], a[8:11], a[16:19], a[216:219]
  ds_read_b64_tr_b16 a[42:43], v24 offset:9056
  buffer_load_dwordx4 v32, s[12:15], s63 offen offset:2048 sc1 lds
  v_mfma_f32_16x16x32_bf16 a[220:223], a[8:11], a[20:23], a[220:223]
  s_mov_b32 s93, s92
  s_add_u32 s92, s92, 29184
  v_fmac_f32 v98, v58, v48
  v_mfma_f32_16x16x32_bf16 a[224:227], a[8:11], a[24:27], a[224:227]
  s_add_u32 s63, s63, 73728
  s_cmp_eq_u32 s92, 145920
  s_cselect_b32 s92, 0, s92
  v_mfma_f32_16x16x32_bf16 a[228:231], a[12:15], a[16:19], a[228:231]
  v_add_u32 v24, s92, v26
  v_fmac_f32 v99, v59, v48
  v_mfma_f32_16x16x32_bf16 a[232:235], a[12:15], a[20:23], a[232:235]
  v_add_u32 v25, s92, v27
  v_fmac_f32 v112, v60, v48
  v_mfma_f32_16x16x32_bf16 a[236:239], a[12:15], a[24:27], a[236:239]
  s_waitcnt vmcnt(21) lgkmcnt(0)
  s_barrier
  v_mfma_f32_16x16x32_bf16 a[192:195], a[28:31], a[44:47], a[192:195]
  s_add_u32 m0, s60, s93
  ds_read_b128 a[16:19], v25 offset:0
  ds_read_b128 a[20:23], v25 offset:1024
  v_fmac_f32 v113, v61, v48
  v_mfma_f32_16x16x32_bf16 a[196:199], a[28:31], a[48:51], a[196:199]
  ds_read_b128 a[24:27], v25 offset:2048
  ds_read_b64_tr_b16 a[0:1], v24 offset:0
  v_fmac_f32 v114, v62, v48
  v_mfma_f32_16x16x32_bf16 a[200:203], a[28:31], a[52:55], a[200:203]
  ds_read_b64_tr_b16 a[2:3], v24 offset:512
  buffer_load_dwordx4 v28, s[36:39], s62 offen offset:0 lds
  v_fmac_f32 v115, v63, v48
  v_mfma_f32_16x16x32_bf16 a[204:207], a[32:35], a[44:47], a[204:207]
  ds_read_b64_tr_b16 a[4:5], v24 offset:32
  ds_read_b64_tr_b16 a[6:7], v24 offset:544
  v_mul_f32 v96, v96, v49
  v_mfma_f32_16x16x32_bf16 a[208:211], a[32:35], a[48:51], a[208:211]
  ds_read_b64_tr_b16 a[8:9], v24 offset:64
  buffer_load_dwordx4 v29, s[36:39], s62 offen offset:1056 lds
  v_mul_f32 v97, v97, v49
  v_mfma_f32_16x16x32_bf16 a[212:215], a[32:35], a[52:55], a[212:215]
  ds_read_b64_tr_b16 a[10:11], v24 offset:576
  ds_read_b64_tr_b16 a[12:13], v24 offset:96
  v_mul_f32 v98, v98, v49
  v_mfma_f32_16x16x32_bf16 a[216:219], a[36:39], a[44:47], a[216:219]
  ds_read_b64_tr_b16 a[14:15], v24 offset:608
  buffer_load_dwordx4 v30, s[36:39], s62 offen offset:2112 lds
  v_mul_f32 v99, v99, v49
  v_mfma_f32_16x16x32_bf16 a[220:223], a[36:39], a[48:51], a[220:223]
  buffer_load_dwordx4 v31, s[36:39], s62 offen offset:3168 lds
  v_mul_f32 v112, v112, v49
  v_mul_f32 v113, v113, v49
  v_mfma_f32_16x16x32_bf16 a[224:227], a[36:39], a[52:55], a[224:227]
  v_mul_f32 v114, v114, v49
  v_mul_f32 v115, v115, v49
  v_cvt_pk_bf16_f32 v196, v96, v97
  v_mfma_f32_16x16x32_bf16 a[228:231], a[40:43], a[44:47], a[228:231]
  s_add_u32 s62, s62, 589824
  v_cvt_pk_bf16_f32 v197, v98, v99
  v_cvt_pk_bf16_f32 v198, v112, v113
  v_cvt_pk_bf16_f32 v199, v114, v115
  v_mfma_f32_16x16x32_bf16 a[232:235], a[40:43], a[48:51], a[232:235]
  v_fmac_f32 v100, v56, v50
  v_fmac_f32 v101, v57, v50
  v_fmac_f32 v102, v58, v50
  v_mfma_f32_16x16x32_bf16 a[236:239], a[40:43], a[52:55], a[236:239]
  s_waitcnt lgkmcnt(0)
  v_mfma_f32_16x16x32_bf16 a[192:195], a[0:3], a[16:19], a[192:195]
  s_add_u32 m0, s61, s93
  ds_read_b128 a[44:47], v25 offset:6144
  ds_read_b128 a[48:51], v25 offset:7168
  v_mfma_f32_16x16x32_bf16 a[196:199], a[0:3], a[20:23], a[196:199]
  ds_read_b128 a[52:55], v25 offset:8192
  ds_read_b64_tr_b16 a[28:29], v24 offset:8448
  v_mfma_f32_16x16x32_bf16 a[200:203], a[0:3], a[24:27], a[200:203]
  ds_read_b64_tr_b16 a[30:31], v24 offset:8960
  buffer_load_dwordx4 v32, s[12:15], s63 offen offset:0 sc1 lds
  v_mfma_f32_16x16x32_bf16 a[204:207], a[4:7], a[16:19], a[204:207]
  ds_read_b64_tr_b16 a[32:33], v24 offset:8480
  ds_read_b64_tr_b16 a[34:35], v24 offset:8992
  v_mfma_f32_16x16x32_bf16 a[208:211], a[4:7], a[20:23], a[208:211]
  ds_read_b64_tr_b16 a[36:37], v24 offset:8512
  buffer_load_dwordx4 v32, s[12:15], s63 offen offset:1024 sc1 lds
  v_mfma_f32_16x16x32_bf16 a[212:215], a[4:7], a[24:27], a[212:215]
  ds_read_b64_tr_b16 a[38:39], v24 offset:9024
  ds_read_b64_tr_b16 a[40:41], v24 offset:8544
  v_mfma_f32_16x16x32_bf16 a[216:219], a[8:11], a[16:19], a[216:219]
  ds_read_b64_tr_b16 a[42:43], v24 offset:9056
  buffer_load_dwordx4 v32, s[12:15], s63 offen offset:2048 sc1 lds
  v_mfma_f32_16x16x32_bf16 a[220:223], a[8:11], a[20:23], a[220:223]
  s_mov_b32 s93, s92
  s_add_u32 s92, s92, 29184
  v_fmac_f32 v103, v59, v50
  v_mfma_f32_16x16x32_bf16 a[224:227], a[8:11], a[24:27], a[224:227]
  s_add_u32 s63, s63, 73728
  s_cmp_eq_u32 s92, 145920
  s_cselect_b32 s92, 0, s92
  v_mfma_f32_16x16x32_bf16 a[228:231], a[12:15], a[16:19], a[228:231]
  v_add_u32 v24, s92, v26
  v_fmac_f32 v116, v60, v50
  v_mfma_f32_16x16x32_bf16 a[232:235], a[12:15], a[20:23], a[232:235]
  v_add_u32 v25, s92, v27
  v_fmac_f32 v117, v61, v50
  v_mfma_f32_16x16x32_bf16 a[236:239], a[12:15], a[24:27], a[236:239]
  s_waitcnt vmcnt(21) lgkmcnt(0)
  s_barrier
  v_mfma_f32_16x16x32_bf16 a[192:195], a[28:31], a[44:47], a[192:195]
  s_add_u32 m0, s60, s93
  ds_read_b128 a[16:19], v25 offset:0
  ds_read_b128 a[20:23], v25 offset:1024
  v_mfma_f32_16x16x32_bf16 a[196:199], a[28:31], a[48:51], a[196:199]
  ds_read_b128 a[24:27], v25 offset:2048
  ds_read_b64_tr_b16 a[0:1], v24 offset:0
  v_mfma_f32_16x16x32_bf16 a[200:203], a[28:31], a[52:55], a[200:203]
  ds_read_b64_tr_b16 a[2:3], v24 offset:512
  buffer_load_dwordx4 v28, s[36:39], s62 offen offset:0 lds
  v_mfma_f32_16x16x32_bf16 a[204:207], a[32:35], a[44:47], a[204:207]
  ds_read_b64_tr_b16 a[4:5], v24 offset:32
  ds_read_b64_tr_b16 a[6:7], v24 offset:544
  v_mfma_f32_16x16x32_bf16 a[208:211], a[32:35], a[48:51], a[208:211]
  ds_read_b64_tr_b16 a[8:9], v24 offset:64
  buffer_load_dwordx4 v29, s[36:39], s62 offen offset:1056 lds
  v_mfma_f32_16x16x32_bf16 a[212:215], a[32:35], a[52:55], a[212:215]
  ds_read_b64_tr_b16 a[10:11], v24 offset:576
  ds_read_b64_tr_b16 a[12:13], v24 offset:96
  v_mfma_f32_16x16x32_bf16 a[216:219], a[36:39], a[44:47], a[216:219]
  ds_read_b64_tr_b16 a[14:15], v24 offset:608
  buffer_load_dwordx4 v30, s[36:39], s62 offen offset:2112 lds
  v_mfma_f32_16x16x32_bf16 a[220:223], a[36:39], a[48:51], a[220:223]
  buffer_load_dwordx4 v31, s[36:39], s62 offen offset:3168 lds
  v_fmac_f32 v118, v62, v50
  v_mfma_f32_16x16x32_bf16 a[224:227], a[36:39], a[52:55], a[224:227]
  v_fmac_f32 v119, v63, v50
  v_mul_f32 v100, v100, v51
  v_mfma_f32_16x16x32_bf16 a[228:231], a[40:43], a[44:47], a[228:231]
  s_add_u32 s62, s62, 589824
  v_mul_f32 v101, v101, v51
  v_mul_f32 v102, v102, v51
  v_mfma_f32_16x16x32_bf16 a[232:235], a[40:43], a[48:51], a[232:235]
  v_mul_f32 v103, v103, v51
  v_mul_f32 v116, v116, v51
  v_mfma_f32_16x16x32_bf16 a[236:239], a[40:43], a[52:55], a[236:239]
  s_waitcnt lgkmcnt(0)
  v_mfma_f32_16x16x32_bf16 a[192:195], a[0:3], a[16:19], a[192:195]
  s_add_u32 m0, s61, s93
  ds_read_b128 a[44:47], v25 offset:6144
  ds_read_b128 a[48:51], v25 offset:7168
  v_mfma_f32_16x16x32_bf16 a[196:199], a[0:3], a[20:23], a[196:199]
  ds_read_b128 a[52:55], v25 offset:8192
  ds_read_b64_tr_b16 a[28:29], v24 offset:8448
  v_mfma_f32_16x16x32_bf16 a[200:203], a[0:3], a[24:27], a[200:203]
  ds_read_b64_tr_b16 a[30:31], v24 offset:8960
  buffer_load_dwordx4 v32, s[12:15], s63 offen offset:0 sc1 lds
  v_mfma_f32_16x16x32_bf16 a[204:207], a[4:7], a[16:19], a[204:207]
  ds_read_b64_tr_b16 a[32:33], v24 offset:8480
  ds_read_b64_tr_b16 a[34:35], v24 offset:8992
  v_mfma_f32_16x16x32_bf16 a[208:211], a[4:7], a[20:23], a[208:211]
  ds_read_b64_tr_b16 a[36:37], v24 offset:8512
  buffer_load_dwordx4 v32, s[12:15], s63 offen offset:1024 sc1 lds
  v_mfma_f32_16x16x32_bf16 a[212:215], a[4:7], a[24:27], a[212:215]
  ds_read_b64_tr_b16 a[38:39], v24 offset:9024
  ds_read_b64_tr_b16 a[40:41], v24 offset:8544
  v_mfma_f32_16x16x32_bf16 a[216:219], a[8:11], a[16:19], a[216:219]
  ds_read_b64_tr_b16 a[42:43], v24 offset:9056
  buffer_load_dwordx4 v32, s[12:15], s63 offen offset:2048 sc1 lds
  v_mfma_f32_16x16x32_bf16 a[220:223], a[8:11], a[20:23], a[220:223]
  s_mov_b32 s93, s92
  s_add_u32 s92, s92, 29184
  v_mul_f32 v117, v117, v51
  v_mfma_f32_16x16x32_bf16 a[224:227], a[8:11], a[24:27], a[224:227]
  s_add_u32 s63, s63, 73728
  s_cmp_eq_u32 s92, 145920
  s_cselect_b32 s92, 0, s92
  v_mfma_f32_16x16x32_bf16 a[228:231], a[12:15], a[16:19], a[228:231]
TP_4:
  s_cbranch_execz TR_1
  v_add_u32 v24, s92, v26
  v_mul_f32 v118, v118, v51
  v_mfma_f32_16x16x32_bf16 a[232:235], a[12:15], a[20:23], a[232:235]
  v_add_u32 v25, s92, v27
  v_mul_f32 v119, v119, v51
  v_mfma_f32_16x16x32_bf16 a[236:239], a[12:15], a[24:27], a[236:239]
  s_waitcnt vmcnt(21) lgkmcnt(0)
  s_barrier
  v_mfma_f32_16x16x32_bf16 a[192:195], a[28:31], a[44:47], a[192:195]
  s_add_u32 m0, s60, s93
  ds_read_b128 a[16:19], v25 offset:0
  ds_read_b128 a[20:23], v25 offset:1024
  v_cvt_pk_bf16_f32 v212, v100, v101
  v_mfma_f32_16x16x32_bf16 a[196:199], a[28:31], a[48:51], a[196:199]
  ds_read_b128 a[24:27], v25 offset:2048
  ds_read_b64_tr_b16 a[0:1], v24 offset:0
  v_cvt_pk_bf16_f32 v213, v102, v103
  v_mfma_f32_16x16x32_bf16 a[200:203], a[28:31], a[52:55], a[200:203]
  ds_read_b64_tr_b16 a[2:3], v24 offset:512
  buffer_load_dwordx4 v28, s[36:39], s62 offen offset:0 lds
  v_cvt_pk_bf16_f32 v214, v116, v117
  v_mfma_f32_16x16x32_bf16 a[204:207], a[32:35], a[44:47], a[204:207]
  ds_read_b64_tr_b16 a[4:5], v24 offset:32
  ds_read_b64_tr_b16 a[6:7], v24 offset:544
  v_cvt_pk_bf16_f32 v215, v118, v119
  v_mfma_f32_16x16x32_bf16 a[208:211], a[32:35], a[48:51], a[208:211]
  ds_read_b64_tr_b16 a[8:9], v24 offset:64
  buffer_load_dwordx4 v29, s[36:39], s62 offen offset:1056 lds
  v_fmac_f32 v104, v56, v52
  v_mfma_f32_16x16x32_bf16 a[212:215], a[32:35], a[52:55], a[212:215]
  ds_read_b64_tr_b16 a[10:11], v24 offset:576
  ds_read_b64_tr_b16 a[12:13], v24 offset:96
  v_fmac_f32 v105, v57, v52
  v_mfma_f32_16x16x32_bf16 a[216:219], a[36:39], a[44:47], a[216:219]
  ds_read_b64_tr_b16 a[14:15], v24 offset:608
  buffer_load_dwordx4 v30, s[36:39], s62 offen offset:2112 lds
  v_fmac_f32 v106, v58, v52
  v_mfma_f32_16x16x32_bf16 a[220:223], a[36:39], a[48:51], a[220:223]
  buffer_load_dwordx4 v31, s[36:39], s62 offen offset:3168 lds
  v_fmac_f32 v107, v59, v52
  v_fmac_f32 v120, v60, v52
  v_mfma_f32_16x16x32_bf16 a[224:227], a[36:39], a[52:55], a[224:227]
  v_fmac_f32 v121, v61, v52
  v_fmac_f32 v122, v62, v52
  v_fmac_f32 v123, v63, v52
  v_mfma_f32_16x16x32_bf16 a[228:231], a[40:43], a[44:47], a[228:231]
  s_add_u32 s62, s62, 589824
  v_mul_f32 v104, v104, v53
  v_mul_f32 v105, v105, v53
  v_mul_f32 v106, v106, v53
  v_mfma_f32_16x16x32_bf16 a[232:235], a[40:43], a[48:51], a[232:235]
  v_mul_f32 v107, v107, v53
  v_mul_f32 v120, v120, v53
  v_mul_f32 v121, v121, v53
  v_mfma_f32_16x16x32_bf16 a[236:239], a[40:43], a[52:55], a[236:239]
  s_waitcnt lgkmcnt(0)
  v_mfma_f32_16x16x32_bf16 a[192:195], a[0:3], a[16:19], a[192:195]
  s_add_u32 m0, s61, s93
  ds_read_b128 a[44:47], v25 offset:6144
  ds_read_b128 a[48:51], v25 offset:7168
  v_mfma_f32_16x16x32_bf16 a[196:199], a[0:3], a[20:23], a[196:199]
  ds_read_b128 a[52:55], v25 offset:8192
  ds_read_b64_tr_b16 a[28:29], v24 offset:8448
  v_mfma_f32_16x16x32_bf16 a[200:203], a[0:3], a[24:27], a[200:203]
  ds_read_b64_tr_b16 a[30:31], v24 offset:8960
  buffer_load_dwordx4 v32, s[12:15], s63 offen offset:0 sc1 lds
  v_mfma_f32_16x16x32_bf16 a[204:207], a[4:7], a[16:19], a[204:207]
  ds_read_b64_tr_b16 a[32:33], v24 offset:8480
  ds_read_b64_tr_b16 a[34:35], v24 offset:8992
  v_mfma_f32_16x16x32_bf16 a[208:211], a[4:7], a[20:23], a[208:211]
  ds_read_b64_tr_b16 a[36:37], v24 offset:8512
  buffer_load_dwordx4 v32, s[12:15], s63 offen offset:1024 sc1 lds
  v_mfma_f32_16x16x32_bf16 a[212:215], a[4:7], a[24:27], a[212:215]
  ds_read_b64_tr_b16 a[38:39], v24 offset:9024
  ds_read_b64_tr_b16 a[40:41], v24 offset:8544
  v_mfma_f32_16x16x32_bf16 a[216:219], a[8:11], a[16:19], a[216:219]
  ds_read_b64_tr_b16 a[42:43], v24 offset:9056
  buffer_load_dwordx4 v32, s[12:15], s63 offen offset:2048 sc1 lds
  v_mfma_f32_16x16x32_bf16 a[220:223], a[8:11], a[20:23], a[220:223]
  s_mov_b32 s93, s92
  s_add_u32 s92, s92, 29184
  v_mul_f32 v122, v122, v53
  v_mfma_f32_16x16x32_bf16 a[224:227], a[8:11], a[24:27], a[224:227]
  s_add_u32 s63, s63, 73728
  s_cmp_eq_u32 s92, 145920
  s_cselect_b32 s92, 0, s92
  v_mfma_f32_16x16x32_bf16 a[228:231], a[12:15], a[16:19], a[228:231]
  v_add_u32 v24, s92, v26
  v_mul_f32 v123, v123, v53
  v_mfma_f32_16x16x32_bf16 a[232:235], a[12:15], a[20:23], a[232:235]
  v_add_u32 v25, s92, v27
  v_cvt_pk_bf16_f32 v228, v104, v105
  v_mfma_f32_16x16x32_bf16 a[236:239], a[12:15], a[24:27], a[236:239]
  s_waitcnt vmcnt(21) lgkmcnt(0)
  s_barrier
  v_mfma_f32_16x16x32_bf16 a[192:195], a[28:31], a[44:47], a[192:195]
  s_add_u32 m0, s60, s93
  ds_read_b128 a[16:19], v25 offset:0
  ds_read_b128 a[20:23], v25 offset:1024
  v_mfma_f32_16x16x32_bf16 a[196:199], a[28:31], a[48:51], a[196:199]
  ds_read_b128 a[24:27], v25 offset:2048
  ds_read_b64_tr_b16 a[0:1], v24 offset:0
  v_mfma_f32_16x16x32_bf16 a[200:203], a[28:31], a[52:55], a[200:203]
  ds_read_b64_tr_b16 a[2:3], v24 offset:512
  buffer_load_dwordx4 v28, s[36:39], s62 offen offset:0 lds
  v_mfma_f32_16x16x32_bf16 a[204:207], a[32:35], a[44:47], a[204:207]
  ds_read_b64_tr_b16 a[4:5], v24 offset:32
  ds_read_b64_tr_b16 a[6:7], v24 offset:544
  v_mfma_f32_16x16x32_bf16 a[208:211], a[32:35], a[48:51], a[208:211]
  ds_read_b64_tr_b16 a[8:9], v24 offset:64
  buffer_load_dwordx4 v29, s[36:39], s62 offen offset:1056 lds
  v_mfma_f32_16x16x32_bf16 a[212:215], a[32:35], a[52:55], a[212:215]
  ds_read_b64_tr_b16 a[10:11], v24 offset:576
  ds_read_b64_tr_b16 a[12:13], v24 offset:96
  v_mfma_f32_16x16x32_bf16 a[216:219], a[36:39], a[44:47], a[216:219]
  ds_read_b64_tr_b16 a[14:15], v24 offset:608
  buffer_load_dwordx4 v30, s[36:39], s62 offen offset:2112 lds
  v_mfma_f32_16x16x32_bf16 a[220:223], a[36:39], a[48:51], a[220:223]
  buffer_load_dwordx4 v31, s[36:39], s62 offen offset:3168 lds
  v_cvt_pk_bf16_f32 v229, v106, v107
  v_mfma_f32_16x16x32_bf16 a[224:227], a[36:39], a[52:55], a[224:227]
  v_cvt_pk_bf16_f32 v230, v120, v121
  v_cvt_pk_bf16_f32 v231, v122, v123
  v_mfma_f32_16x16x32_bf16 a[228:231], a[40:43], a[44:47], a[228:231]
  s_add_u32 s62, s62, 589824
  v_fmac_f32 v108, v56, v54
  v_fmac_f32 v109, v57, v54
  v_mfma_f32_16x16x32_bf16 a[232:235], a[40:43], a[48:51], a[232:235]
  v_fmac_f32 v110, v58, v54
  v_fmac_f32 v111, v59, v54
  v_mfma_f32_16x16x32_bf16 a[236:239], a[40:43], a[52:55], a[236:239]
  s_waitcnt lgkmcnt(0)
  v_mfma_f32_16x16x32_bf16 a[192:195], a[0:3], a[16:19], a[192:195]
  s_add_u32 m0, s61, s93
  ds_read_b128 a[44:47], v25 offset:6144
  ds_read_b128 a[48:51], v25 offset:7168
  v_mfma_f32_16x16x32_bf16 a[196:199], a[0:3], a[20:23], a[196:199]
  ds_read_b128 a[52:55], v25 offset:8192
  ds_read_b64_tr_b16 a[28:29], v24 offset:8448
  v_mfma_f32_16x16x32_bf16 a[200:203], a[0:3], a[24:27], a[200:203]
  ds_read_b64_tr_b16 a[30:31], v24 offset:8960
  buffer_load_dwordx4 v32, s[12:15], s63 offen offset:0 sc1 lds
  v_mfma_f32_16x16x32_bf16 a[204:207], a[4:7], a[16:19], a[204:207]
  ds_read_b64_tr_b16 a[32:33], v24 offset:8480
  ds_read_b64_tr_b16 a[34:35], v24 offset:8992
  v_mfma_f32_16x16x32_bf16 a[208:211], a[4:7], a[20:23], a[208:211]
  ds_read_b64_tr_b16 a[36:37], v24 offset:8512
  buffer_load_dwordx4 v32, s[12:15], s63 offen offset:1024 sc1 lds
  v_mfma_f32_16x16x32_bf16 a[212:215], a[4:7], a[24:27], a[212:215]
  ds_read_b64_tr_b16 a[38:39], v24 offset:9024
  ds_read_b64_tr_b16 a[40:41], v24 offset:8544
  v_mfma_f32_16x16x32_bf16 a[216:219], a[8:11], a[16:19], a[216:219]
  ds_read_b64_tr_b16 a[42:43], v24 offset:9056
  buffer_load_dwordx4 v32, s[12:15], s63 offen offset:2048 sc1 lds
  v_mfma_f32_16x16x32_bf16 a[220:223], a[8:11], a[20:23], a[220:223]
  s_mov_b32 s93, s92
  s_add_u32 s92, s92, 29184
  v_fmac_f32 v124, v60, v54
  v_mfma_f32_16x16x32_bf16 a[224:227], a[8:11], a[24:27], a[224:227]
  s_add_u32 s63, s63, 73728
  s_cmp_eq_u32 s92, 145920
  s_cselect_b32 s92, 0, s92
  v_mfma_f32_16x16x32_bf16 a[228:231], a[12:15], a[16:19], a[228:231]
  v_add_u32 v24, s92, v26
  v_fmac_f32 v125, v61, v54
  v_mfma_f32_16x16x32_bf16 a[232:235], a[12:15], a[20:23], a[232:235]
  v_add_u32 v25, s92, v27
  v_fmac_f32 v126, v62, v54
  v_mfma_f32_16x16x32_bf16 a[236:239], a[12:15], a[24:27], a[236:239]
  s_waitcnt vmcnt(21) lgkmcnt(0)
  s_barrier
  v_mfma_f32_16x16x32_bf16 a[192:195], a[28:31], a[44:47], a[192:195]
  s_add_u32 m0, s60, s93
  ds_read_b128 a[16:19], v25 offset:0
  ds_read_b128 a[20:23], v25 offset:1024
  v_fmac_f32 v127, v63, v54
  v_mfma_f32_16x16x32_bf16 a[196:199], a[28:31], a[48:51], a[196:199]
  ds_read_b128 a[24:27], v25 offset:2048
  ds_read_b64_tr_b16 a[0:1], v24 offset:0
  v_mul_f32 v108, v108, v55
  v_mfma_f32_16x16x32_bf16 a[200:203], a[28:31], a[52:55], a[200:203]
  ds_read_b64_tr_b16 a[2:3], v24 offset:512
  buffer_load_dwordx4 v28, s[36:39], s62 offen offset:0 lds
  v_mul_f32 v109, v109, v55
  v_mfma_f32_16x16x32_bf16 a[204:207], a[32:35], a[44:47], a[204:207]
  ds_read_b64_tr_b16 a[4:5], v24 offset:32
  ds_read_b64_tr_b16 a[6:7], v24 offset:544
  v_mul_f32 v110, v110, v55
  v_mfma_f32_16x16x32_bf16 a[208:211], a[32:35], a[48:51], a[208:211]
  ds_read_b64_tr_b16 a[8:9], v24 offset:64
  buffer_load_dwordx4 v29, s[36:39], s62 offen offset:1056 lds
  v_mul_f32 v111, v111, v55
  v_mfma_f32_16x16x32_bf16 a[212:215], a[32:35], a[52:55], a[212:215]
  ds_read_b64_tr_b16 a[10:11], v24 offset:576
  ds_read_b64_tr_b16 a[12:13], v24 offset:96
  v_mul_f32 v124, v124, v55
  v_mfma_f32_16x16x32_bf16 a[216:219], a[36:39], a[44:47], a[216:219]
  ds_read_b64_tr_b16 a[14:15], v24 offset:608
  buffer_load_dwordx4 v30, s[36:39], s62 offen offset:2112 lds
  v_mul_f32 v125, v125, v55
  v_mfma_f32_16x16x32_bf16 a[220:223], a[36:39], a[48:51], a[220:223]
  buffer_load_dwordx4 v31, s[36:39], s62 offen offset:3168 lds
  v_mul_f32 v126, v126, v55
  v_mul_f32 v127, v127, v55
  v_mfma_f32_16x16x32_bf16 a[224:227], a[36:39], a[52:55], a[224:227]
  v_cvt_pk_bf16_f32 v244, v108, v109
  v_cvt_pk_bf16_f32 v245, v110, v111
  v_cvt_pk_bf16_f32 v246, v124, v125
  v_mfma_f32_16x16x32_bf16 a[228:231], a[40:43], a[44:47], a[228:231]
  s_add_u32 s62, s62, 589824
  v_cvt_pk_bf16_f32 v247, v126, v127
  v_permlane16_swap_b32 v196, v198
  v_mfma_f32_16x16x32_bf16 a[232:235], a[40:43], a[48:51], a[232:235]
  v_permlane16_swap_b32 v197, v199
  v_mfma_f32_16x16x32_bf16 a[236:239], a[40:43], a[52:55], a[236:239]
  s_waitcnt lgkmcnt(0)
  v_mfma_f32_16x16x32_bf16 a[192:195], a[0:3], a[16:19], a[192:195]
  s_add_u32 m0, s61, s93
  ds_read_b128 a[44:47], v25 offset:6144
  ds_read_b128 a[48:51], v25 offset:7168
  v_mfma_f32_16x16x32_bf16 a[196:199], a[0:3], a[20:23], a[196:199]
  ds_read_b128 a[52:55], v25 offset:8192
  ds_read_b64_tr_b16 a[28:29], v24 offset:8448
  v_mfma_f32_16x16x32_bf16 a[200:203], a[0:3], a[24:27], a[200:203]
  ds_read_b64_tr_b16 a[30:31], v24 offset:8960
  buffer_load_dwordx4 v32, s[12:15], s63 offen offset:0 sc1 lds
  v_mfma_f32_16x16x32_bf16 a[204:207], a[4:7], a[16:19], a[204:207]
  ds_read_b64_tr_b16 a[32:33], v24 offset:8480
  ds_read_b64_tr_b16 a[34:35], v24 offset:8992
  v_mfma_f32_16x16x32_bf16 a[208:211], a[4:7], a[20:23], a[208:211]
  ds_read_b64_tr_b16 a[36:37], v24 offset:8512
  buffer_load_dwordx4 v32, s[12:15], s63 offen offset:1024 sc1 lds
  v_mfma_f32_16x16x32_bf16 a[212:215], a[4:7], a[24:27], a[212:215]
  ds_read_b64_tr_b16 a[38:39], v24 offset:9024
  ds_read_b64_tr_b16 a[40:41], v24 offset:8544
  v_mfma_f32_16x16x32_bf16 a[216:219], a[8:11], a[16:19], a[216:219]
  ds_read_b64_tr_b16 a[42:43], v24 offset:9056
  buffer_load_dwordx4 v32, s[12:15], s63 offen offset:2048 sc1 lds
  v_mfma_f32_16x16x32_bf16 a[220:223], a[8:11], a[20:23], a[220:223]
  s_mov_b32 s93, s92
  s_add_u32 s92, s92, 29184
  v_mfma_f32_16x16x32_bf16 a[224:227], a[8:11], a[24:27], a[224:227]
  s_add_u32 s63, s63, 73728
  s_cmp_eq_u32 s92, 145920
  s_cselect_b32 s92, 0, s92
  v_mfma_f32_16x16x32_bf16 a[228:231], a[12:15], a[16:19], a[228:231]
  v_add_u32 v24, s92, v26
  v_mfma_f32_16x16x32_bf16 a[232:235], a[12:15], a[20:23], a[232:235]
  v_add_u32 v25, s92, v27
  v_mfma_f32_16x16x32_bf16 a[236:239], a[12:15], a[24:27], a[236:239]
  s_waitcnt vmcnt(21) lgkmcnt(0)
  s_barrier
  v_mfma_f32_16x16x32_bf16 a[192:195], a[28:31], a[44:47], a[192:195]
  s_add_u32 m0, s60, s93
  ds_read_b128 a[16:19], v25 offset:0
  ds_read_b128 a[20:23], v25 offset:1024
  v_mfma_f32_16x16x32_bf16 a[196:199], a[28:31], a[48:51], a[196:199]
  ds_read_b128 a[24:27], v25 offset:2048
  ds_read_b64_tr_b16 a[0:1], v24 offset:0
  v_mfma_f32_16x16x32_bf16 a[200:203], a[28:31], a[52:55], a[200:203]
  ds_read_b64_tr_b16 a[2:3], v24 offset:512
  buffer_load_dwordx4 v28, s[36:39], s62 offen offset:0 lds
  v_mfma_f32_16x16x32_bf16 a[204:207], a[32:35], a[44:47], a[204:207]
  ds_read_b64_tr_b16 a[4:5], v24 offset:32
  ds_read_b64_tr_b16 a[6:7], v24 offset:544
  v_mfma_f32_16x16x32_bf16 a[208:211], a[32:35], a[48:51], a[208:211]
  ds_read_b64_tr_b16 a[8:9], v24 offset:64
  buffer_load_dwordx4 v29, s[36:39], s62 offen offset:1056 lds
  v_mfma_f32_16x16x32_bf16 a[212:215], a[32:35], a[52:55], a[212:215]
  ds_read_b64_tr_b16 a[10:11], v24 offset:576
  ds_read_b64_tr_b16 a[12:13], v24 offset:96
  v_mfma_f32_16x16x32_bf16 a[216:219], a[36:39], a[44:47], a[216:219]
  ds_read_b64_tr_b16 a[14:15], v24 offset:608
  buffer_load_dwordx4 v30, s[36:39], s62 offen offset:2112 lds
  v_mfma_f32_16x16x32_bf16 a[220:223], a[36:39], a[48:51], a[220:223]
  buffer_load_dwordx4 v31, s[36:39], s62 offen offset:3168 lds
  v_mfma_f32_16x16x32_bf16 a[224:227], a[36:39], a[52:55], a[224:227]
  v_permlane16_swap_b32 v212, v214
  v_mfma_f32_16x16x32_bf16 a[228:231], a[40:43], a[44:47], a[228:231]
  s_add_u32 s62, s62, 589824
  v_permlane16_swap_b32 v213, v215
  v_mfma_f32_16x16x32_bf16 a[232:235], a[40:43], a[48:51], a[232:235]
  v_permlane16_swap_b32 v228, v230
  v_mfma_f32_16x16x32_bf16 a[236:239], a[40:43], a[52:55], a[236:239]
  s_waitcnt lgkmcnt(0)
  v_mfma_f32_16x16x32_bf16 a[192:195], a[0:3], a[16:19], a[192:195]
  s_add_u32 m0, s61, s93
  ds_read_b128 a[44:47], v25 offset:6144
  ds_read_b128 a[48:51], v25 offset:7168
  v_mfma_f32_16x16x32_bf16 a[196:199], a[0:3], a[20:23], a[196:199]
  ds_read_b128 a[52:55], v25 offset:8192
  ds_read_b64_tr_b16 a[28:29], v24 offset:8448
  v_mfma_f32_16x16x32_bf16 a[200:203], a[0:3], a[24:27], a[200:203]
  ds_read_b64_tr_b16 a[30:31], v24 offset:8960
  buffer_load_dwordx4 v32, s[12:15], s63 offen offset:0 sc1 lds
  v_mfma_f32_16x16x32_bf16 a[204:207], a[4:7], a[16:19], a[204:207]
  ds_read_b64_tr_b16 a[32:33], v24 offset:8480
  ds_read_b64_tr_b16 a[34:35], v24 offset:8992
  v_mfma_f32_16x16x32_bf16 a[208:211], a[4:7], a[20:23], a[208:211]
  ds_read_b64_tr_b16 a[36:37], v24 offset:8512
  buffer_load_dwordx4 v32, s[12:15], s63 offen offset:1024 sc1 lds
  v_mfma_f32_16x16x32_bf16 a[212:215], a[4:7], a[24:27], a[212:215]
  ds_read_b64_tr_b16 a[38:39], v24 offset:9024
  ds_read_b64_tr_b16 a[40:41], v24 offset:8544
  v_mfma_f32_16x16x32_bf16 a[216:219], a[8:11], a[16:19], a[216:219]
  ds_read_b64_tr_b16 a[42:43], v24 offset:9056
  buffer_load_dwordx4 v32, s[12:15], s63 offen offset:2048 sc1 lds
  v_mfma_f32_16x16x32_bf16 a[220:223], a[8:11], a[20:23], a[220:223]
  s_mov_b32 s93, s92
  s_add_u32 s92, s92, 29184
  v_mfma_f32_16x16x32_bf16 a[224:227], a[8:11], a[24:27], a[224:227]
  s_add_u32 s63, s63, 73728
  s_cmp_eq_u32 s92, 145920
  s_cselect_b32 s92, 0, s92
  v_mfma_f32_16x16x32_bf16 a[228:231], a[12:15], a[16:19], a[228:231]
  v_add_u32 v24, s92, v26
  v_mfma_f32_16x16x32_bf16 a[232:235], a[12:15], a[20:23], a[232:235]
  v_add_u32 v25, s92, v27
  v_mfma_f32_16x16x32_bf16 a[236:239], a[12:15], a[24:27], a[236:239]
  s_waitcnt vmcnt(21) lgkmcnt(0)
  s_barrier
  v_mfma_f32_16x16x32_bf16 a[192:195], a[28:31], a[44:47], a[192:195]
  s_add_u32 m0, s60, s93
  ds_read_b128 a[16:19], v25 offset:0
  ds_read_b128 a[20:23], v25 offset:1024
  v_mfma_f32_16x16x32_bf16 a[196:199], a[28:31], a[48:51], a[196:199]
  ds_read_b128 a[24:27], v25 offset:2048
  ds_read_b64_tr_b16 a[0:1], v24 offset:0
  v_mfma_f32_16x16x32_bf16 a[200:203], a[28:31], a[52:55], a[200:203]
  ds_read_b64_tr_b16 a[2:3], v24 offset:512
  buffer_load_dwordx4 v28, s[36:39], s62 offen offset:0 lds
  v_mfma_f32_16x16x32_bf16 a[204:207], a[32:35], a[44:47], a[204:207]
  ds_read_b64_tr_b16 a[4:5], v24 offset:32
  ds_read_b64_tr_b16 a[6:7], v24 offset:544
  v_mfma_f32_16x16x32_bf16 a[208:211], a[32:35], a[48:51], a[208:211]
  ds_read_b64_tr_b16 a[8:9], v24 offset:64
  buffer_load_dwordx4 v29, s[36:39], s62 offen offset:1056 lds
  v_mfma_f32_16x16x32_bf16 a[212:215], a[32:35], a[52:55], a[212:215]
  ds_read_b64_tr_b16 a[10:11], v24 offset:576
  ds_read_b64_tr_b16 a[12:13], v24 offset:96
  v_mfma_f32_16x16x32_bf16 a[216:219], a[36:39], a[44:47], a[216:219]
  ds_read_b64_tr_b16 a[14:15], v24 offset:608
  buffer_load_dwordx4 v30, s[36:39], s62 offen offset:2112 lds
  v_mfma_f32_16x16x32_bf16 a[220:223], a[36:39], a[48:51], a[220:223]
  buffer_load_dwordx4 v31, s[36:39], s62 offen offset:3168 lds
  v_permlane16_swap_b32 v229, v231
  v_mfma_f32_16x16x32_bf16 a[224:227], a[36:39], a[52:55], a[224:227]
  v_permlane16_swap_b32 v244, v246
  v_mfma_f32_16x16x32_bf16 a[228:231], a[40:43], a[44:47], a[228:231]
  s_add_u32 s62, s62, 589824
  v_permlane16_swap_b32 v245, v247
  v_mfma_f32_16x16x32_bf16 a[232:235], a[40:43], a[48:51], a[232:235]
  ds_read_b128 v[56:59], v23
  ds_read_b128 v[60:63], v23 offset:64
  v_fmac_f32 v128, v40, v48
  v_mfma_f32_16x16x32_bf16 a[236:239], a[40:43], a[52:55], a[236:239]
  s_waitcnt lgkmcnt(0)
  v_mfma_f32_16x16x32_bf16 a[192:195], a[0:3], a[16:19], a[192:195]
  s_add_u32 m0, s61, s93
  ds_read_b128 a[44:47], v25 offset:6144
  ds_read_b128 a[48:51], v25 offset:7168
  v_mfma_f32_16x16x32_bf16 a[196:199], a[0:3], a[20:23], a[196:199]
  ds_read_b128 a[52:55], v25 offset:8192
  ds_read_b64_tr_b16 a[28:29], v24 offset:8448
  v_mfma_f32_16x16x32_bf16 a[200:203], a[0:3], a[24:27], a[200:203]
  ds_read_b64_tr_b16 a[30:31], v24 offset:8960
  buffer_load_dwordx4 v32, s[12:15], s63 offen offset:0 sc1 lds
  v_mfma_f32_16x16x32_bf16 a[204:207], a[4:7], a[16:19], a[204:207]
  ds_read_b64_tr_b16 a[32:33], v24 offset:8480
  ds_read_b64_tr_b16 a[34:35], v24 offset:8992
  v_mfma_f32_16x16x32_bf16 a[208:211], a[4:7], a[20:23], a[208:211]
  ds_read_b64_tr_b16 a[36:37], v24 offset:8512
  buffer_load_dwordx4 v32, s[12:15], s63 offen offset:1024 sc1 lds
  v_mfma_f32_16x16x32_bf16 a[212:215], a[4:7], a[24:27], a[212:215]
  ds_read_b64_tr_b16 a[38:39], v24 offset:9024
  ds_read_b64_tr_b16 a[40:41], v24 offset:8544
  v_mfma_f32_16x16x32_bf16 a[216:219], a[8:11], a[16:19], a[216:219]
  ds_read_b64_tr_b16 a[42:43], v24 offset:9056
  buffer_load_dwordx4 v32, s[12:15], s63 offen offset:2048 sc1 lds
  v_mfma_f32_16x16x32_bf16 a[220:223], a[8:11], a[20:23], a[220:223]
  s_mov_b32 s93, s92
  s_add_u32 s92, s92, 29184
  v_fmac_f32 v129, v41, v48
  v_mfma_f32_16x16x32_bf16 a[224:227], a[8:11], a[24:27], a[224:227]
  s_add_u32 s63, s63, 73728
  s_cmp_eq_u32 s92, 145920
  s_cselect_b32 s92, 0, s92
  v_mfma_f32_16x16x32_bf16 a[228:231], a[12:15], a[16:19], a[228:231]
  v_add_u32 v24, s92, v26
  v_fmac_f32 v130, v42, v48
  v_mfma_f32_16x16x32_bf16 a[232:235], a[12:15], a[20:23], a[232:235]
  v_add_u32 v25, s92, v27
  v_fmac_f32 v131, v43, v48
  v_mfma_f32_16x16x32_bf16 a[236:239], a[12:15], a[24:27], a[236:239]
  s_waitcnt vmcnt(21) lgkmcnt(0)
  s_barrier
  v_mfma_f32_16x16x32_bf16 a[192:195], a[28:31], a[44:47], a[192:195]
  s_add_u32 m0, s60, s93
  ds_read_b128 a[16:19], v25 offset:0
  ds_read_b128 a[20:23], v25 offset:1024
  v_mfma_f32_16x16x32_bf16 a[196:199], a[28:31], a[48:51], a[196:199]
  ds_read_b128 a[24:27], v25 offset:2048
  ds_read_b64_tr_b16 a[0:1], v24 offset:0
  v_mfma_f32_16x16x32_bf16 a[200:203], a[28:31], a[52:55], a[200:203]
  ds_read_b64_tr_b16 a[2:3], v24 offset:512
  buffer_load_dwordx4 v28, s[36:39], s62 offen offset:0 lds
  v_mfma_f32_16x16x32_bf16 a[204:207], a[32:35], a[44:47], a[204:207]
  ds_read_b64_tr_b16 a[4:5], v24 offset:32
  ds_read_b64_tr_b16 a[6:7], v24 offset:544
  v_mfma_f32_16x16x32_bf16 a[208:211], a[32:35], a[48:51], a[208:211]
  ds_read_b64_tr_b16 a[8:9], v24 offset:64
  buffer_load_dwordx4 v29, s[36:39], s62 offen offset:1056 lds
  v_mfma_f32_16x16x32_bf16 a[212:215], a[32:35], a[52:55], a[212:215]
  ds_read_b64_tr_b16 a[10:11], v24 offset:576
  ds_read_b64_tr_b16 a[12:13], v24 offset:96
  v_mfma_f32_16x16x32_bf16 a[216:219], a[36:39], a[44:47], a[216:219]
  ds_read_b64_tr_b16 a[14:15], v24 offset:608
  buffer_load_dwordx4 v30, s[36:39], s62 offen offset:2112 lds
  v_mfma_f32_16x16x32_bf16 a[220:223], a[36:39], a[48:51], a[220:223]
  buffer_load_dwordx4 v31, s[36:39], s62 offen offset:3168 lds
  v_fmac_f32 v144, v44, v48
  v_mfma_f32_16x16x32_bf16 a[224:227], a[36:39], a[52:55], a[224:227]
  v_fmac_f32 v145, v45, v48
  v_fmac_f32 v146, v46, v48
  v_mfma_f32_16x16x32_bf16 a[228:231], a[40:43], a[44:47], a[228:231]
  s_add_u32 s62, s62, 589824
  v_fmac_f32 v147, v47, v48
  v_mul_f32 v128, v128, v49
  v_mfma_f32_16x16x32_bf16 a[232:235], a[40:43], a[48:51], a[232:235]
  v_mul_f32 v129, v129, v49
  v_mul_f32 v130, v130, v49
  v_mfma_f32_16x16x32_bf16 a[236:239], a[40:43], a[52:55], a[236:239]
  s_waitcnt lgkmcnt(0)
  v_mfma_f32_16x16x32_bf16 a[192:195], a[0:3], a[16:19], a[192:195]
  s_add_u32 m0, s61, s93
  ds_read_b128 a[44:47], v25 offset:6144
  ds_read_b128 a[48:51], v25 offset:7168
  v_mfma_f32_16x16x32_bf16 a[196:199], a[0:3], a[20:23], a[196:199]
  ds_read_b128 a[52:55], v25 offset:8192
  ds_read_b64_tr_b16 a[28:29], v24 offset:8448
  v_mfma_f32_16x16x32_bf16 a[200:203], a[0:3], a[24:27], a[200:203]
  ds_read_b64_tr_b16 a[30:31], v24 offset:8960
  buffer_load_dwordx4 v32, s[12:15], s63 offen offset:0 sc1 lds
  v_mfma_f32_16x16x32_bf16 a[204:207], a[4:7], a[16:19], a[204:207]
  ds_read_b64_tr_b16 a[32:33], v24 offset:8480
  ds_read_b64_tr_b16 a[34:35], v24 offset:8992
  v_mfma_f32_16x16x32_bf16 a[208:211], a[4:7], a[20:23], a[208:211]
  ds_read_b64_tr_b16 a[36:37], v24 offset:8512
  buffer_load_dwordx4 v32, s[12:15], s63 offen offset:1024 sc1 lds
  v_mfma_f32_16x16x32_bf16 a[212:215], a[4:7], a[24:27], a[212:215]
  ds_read_b64_tr_b16 a[38:39], v24 offset:9024
  ds_read_b64_tr_b16 a[40:41], v24 offset:8544
  v_mfma_f32_16x16x32_bf16 a[216:219], a[8:11], a[16:19], a[216:219]
  ds_read_b64_tr_b16 a[42:43], v24 offset:9056
  buffer_load_dwordx4 v32, s[12:15], s63 offen offset:2048 sc1 lds
  v_mfma_f32_16x16x32_bf16 a[220:223], a[8:11], a[20:23], a[220:223]
  s_mov_b32 s93, s92
  s_add_u32 s92, s92, 29184
  v_mul_f32 v131, v131, v49
  v_mfma_f32_16x16x32_bf16 a[224:227], a[8:11], a[24:27], a[224:227]
  s_add_u32 s63, s63, 73728
  s_cmp_eq_u32 s92, 145920
  s_cselect_b32 s92, 0, s92
  v_mfma_f32_16x16x32_bf16 a[228:231], a[12:15], a[16:19], a[228:231]
  v_add_u32 v24, s92, v26
  v_mul_f32 v144, v144, v49
  v_mfma_f32_16x16x32_bf16 a[232:235], a[12:15], a[20:23], a[232:235]
  v_add_u32 v25, s92, v27
  v_mul_f32 v145, v145, v49
  v_mfma_f32_16x16x32_bf16 a[236:239], a[12:15], a[24:27], a[236:239]
  s_waitcnt vmcnt(21) lgkmcnt(0)
  s_barrier
  v_mfma_f32_16x16x32_bf16 a[192:195], a[28:31], a[44:47], a[192:195]
  s_add_u32 m0, s60, s93
  ds_read_b128 a[16:19], v25 offset:0
  ds_read_b128 a[20:23], v25 offset:1024
  v_mul_f32 v146, v146, v49
  v_mfma_f32_16x16x32_bf16 a[196:199], a[28:31], a[48:51], a[196:199]
  ds_read_b128 a[24:27], v25 offset:2048
  ds_read_b64_tr_b16 a[0:1], v24 offset:0
  v_mul_f32 v147, v147, v49
  v_mfma_f32_16x16x32_bf16 a[200:203], a[28:31], a[52:55], a[200:203]
  ds_read_b64_tr_b16 a[2:3], v24 offset:512
  buffer_load_dwordx4 v28, s[36:39], s62 offen offset:0 lds
  v_cvt_pk_bf16_f32 v200, v128, v129
  v_mfma_f32_16x16x32_bf16 a[204:207], a[32:35], a[44:47], a[204:207]
  ds_read_b64_tr_b16 a[4:5], v24 offset:32
  ds_read_b64_tr_b16 a[6:7], v24 offset:544
  v_cvt_pk_bf16_f32 v201, v130, v131
  v_mfma_f32_16x16x32_bf16 a[208:211], a[32:35], a[48:51], a[208:211]
  ds_read_b64_tr_b16 a[8:9], v24 offset:64
  buffer_load_dwordx4 v29, s[36:39], s62 offen offset:1056 lds
  v_cvt_pk_bf16_f32 v202, v144, v145
  v_mfma_f32_16x16x32_bf16 a[212:215], a[32:35], a[52:55], a[212:215]
  ds_read_b64_tr_b16 a[10:11], v24 offset:576
  ds_read_b64_tr_b16 a[12:13], v24 offset:96
  v_cvt_pk_bf16_f32 v203, v146, v147
  v_mfma_f32_16x16x32_bf16 a[216:219], a[36:39], a[44:47], a[216:219]
  ds_read_b64_tr_b16 a[14:15], v24 offset:608
  buffer_load_dwordx4 v30, s[36:39], s62 offen offset:2112 lds
  v_fmac_f32 v132, v40, v50
  v_mfma_f32_16x16x32_bf16 a[220:223], a[36:39], a[48:51], a[220:223]
  buffer_load_dwordx4 v31, s[36:39], s62 offen offset:3168 lds
  v_fmac_f32 v133, v41, v50
  v_fmac_f32 v134, v42, v50
  v_mfma_f32_16x16x32_bf16 a[224:227], a[36:39], a[52:55], a[224:227]
  v_fmac_f32 v135, v43, v50
  v_fmac_f32 v148, v44, v50
  v_fmac_f32 v149, v45, v50
  v_mfma_f32_16x16x32_bf16 a[228:231], a[40:43], a[44:47], a[228:231]
  s_add_u32 s62, s62, 589824
  v_fmac_f32 v150, v46, v50
  v_fmac_f32 v151, v47, v50
  v_mul_f32 v132, v132, v51
  v_mfma_f32_16x16x32_bf16 a[232:235], a[40:43], a[48:51], a[232:235]
  v_mul_f32 v133, v133, v51
  v_mul_f32 v134, v134, v51
  v_mul_f32 v135, v135, v51
  v_mfma_f32_16x16x32_bf16 a[236:239], a[40:43], a[52:55], a[236:239]
  s_waitcnt lgkmcnt(0)
  v_mfma_f32_16x16x32_bf16 a[192:195], a[0:3], a[16:19], a[192:195]
  s_add_u32 m0, s61, s93
  ds_read_b128 a[44:47], v25 offset:6144
  ds_read_b128 a[48:51], v25 offset:7168
  v_mfma_f32_16x16x32_bf16 a[196:199], a[0:3], a[20:23], a[196:199]
  ds_read_b128 a[52:55], v25 offset:8192
  ds_read_b64_tr_b16 a[28:29], v24 offset:8448
  v_mfma_f32_16x16x32_bf16 a[200:203], a[0:3], a[24:27], a[200:203]
  ds_read_b64_tr_b16 a[30:31], v24 offset:8960
  buffer_load_dwordx4 v32, s[12:15], s63 offen offset:0 sc1 lds
  v_mfma_f32_16x16x32_bf16 a[204:207], a[4:7], a[16:19], a[204:207]
  ds_read_b64_tr_b16 a[32:33], v24 offset:8480
  ds_read_b64_tr_b16 a[34:35], v24 offset:8992
  v_mfma_f32_16x16x32_bf16 a[208:211], a[4:7], a[20:23], a[208:211]
  ds_read_b64_tr_b16 a[36:37], v24 offset:8512
  buffer_load_dwordx4 v32, s[12:15], s63 offen offset:1024 sc1 lds
  v_mfma_f32_16x16x32_bf16 a[212:215], a[4:7], a[24:27], a[212:215]
  ds_read_b64_tr_b16 a[38:39], v24 offset:9024
  ds_read_b64_tr_b16 a[40:41], v24 offset:8544
  v_mfma_f32_16x16x32_bf16 a[216:219], a[8:11], a[16:19], a[216:219]
  ds_read_b64_tr_b16 a[42:43], v24 offset:9056
  buffer_load_dwordx4 v32, s[12:15], s63 offen offset:2048 sc1 lds
  v_mfma_f32_16x16x32_bf16 a[220:223], a[8:11], a[20:23], a[220:223]
  s_mov_b32 s93, s92
  s_add_u32 s92, s92, 29184
  v_mul_f32 v148, v148, v51
  v_mfma_f32_16x16x32_bf16 a[224:227], a[8:11], a[24:27], a[224:227]
  s_add_u32 s63, s63, 73728
  s_cmp_eq_u32 s92, 145920
  s_cselect_b32 s92, 0, s92
  v_mfma_f32_16x16x32_bf16 a[228:231], a[12:15], a[16:19], a[228:231]
  v_add_u32 v24, s92, v26
  v_mul_f32 v149, v149, v51
  v_mfma_f32_16x16x32_bf16 a[232:235], a[12:15], a[20:23], a[232:235]
  v_add_u32 v25, s92, v27
  v_mul_f32 v150, v150, v51
  v_mfma_f32_16x16x32_bf16 a[236:239], a[12:15], a[24:27], a[236:239]
  s_waitcnt vmcnt(21) lgkmcnt(0)
  s_barrier
  v_mfma_f32_16x16x32_bf16 a[192:195], a[28:31], a[44:47], a[192:195]
  s_add_u32 m0, s60, s93
  ds_read_b128 a[16:19], v25 offset:0
  ds_read_b128 a[20:23], v25 offset:1024
  v_mfma_f32_16x16x32_bf16 a[196:199], a[28:31], a[48:51], a[196:199]
  ds_read_b128 a[24:27], v25 offset:2048
  ds_read_b64_tr_b16 a[0:1], v24 offset:0
  v_mfma_f32_16x16x32_bf16 a[200:203], a[28:31], a[52:55], a[200:203]
  ds_read_b64_tr_b16 a[2:3], v24 offset:512
  buffer_load_dwordx4 v28, s[36:39], s62 offen offset:0 lds
  v_mfma_f32_16x16x32_bf16 a[204:207], a[32:35], a[44:47], a[204:207]
  ds_read_b64_tr_b16 a[4:5], v24 offset:32
  ds_read_b64_tr_b16 a[6:7], v24 offset:544
  v_mfma_f32_16x16x32_bf16 a[208:211], a[32:35], a[48:51], a[208:211]
  ds_read_b64_tr_b16 a[8:9], v24 offset:64
  buffer_load_dwordx4 v29, s[36:39], s62 offen offset:1056 lds
  v_mfma_f32_16x16x32_bf16 a[212:215], a[32:35], a[52:55], a[212:215]
  ds_read_b64_tr_b16 a[10:11], v24 offset:576
  ds_read_b64_tr_b16 a[12:13], v24 offset:96
  v_mfma_f32_16x16x32_bf16 a[216:219], a[36:39], a[44:47], a[216:219]
TP_5:
  s_cbranch_execz TR_1
  ds_read_b64_tr_b16 a[14:15], v24 offset:608
  buffer_load_dwordx4 v30, s[36:39], s62 offen offset:2112 lds
  v_mfma_f32_16x16x32_bf16 a[220:223], a[36:39], a[48:51], a[220:223]
  buffer_load_dwordx4 v31, s[36:39], s62 offen offset:3168 lds
  v_mul_f32 v151, v151, v51
  v_mfma_f32_16x16x32_bf16 a[224:227], a[36:39], a[52:55], a[224:227]
  v_cvt_pk_bf16_f32 v216, v132, v133
  v_cvt_pk_bf16_f32 v217, v134, v135
  v_mfma_f32_16x16x32_bf16 a[228:231], a[40:43], a[44:47], a[228:231]
  s_add_u32 s62, s62, 589824
  v_cvt_pk_bf16_f32 v218, v148, v149
  v_cvt_pk_bf16_f32 v219, v150, v151
  v_mfma_f32_16x16x32_bf16 a[232:235], a[40:43], a[48:51], a[232:235]
  v_fmac_f32 v136, v40, v52
  v_fmac_f32 v137, v41, v52
  v_mfma_f32_16x16x32_bf16 a[236:239], a[40:43], a[52:55], a[236:239]
  s_waitcnt lgkmcnt(0)
  v_mfma_f32_16x16x32_bf16 a[192:195], a[0:3], a[16:19], a[192:195]
  s_add_u32 m0, s61, s93
  ds_read_b128 a[44:47], v25 offset:6144
  ds_read_b128 a[48:51], v25 offset:7168
  v_mfma_f32_16x16x32_bf16 a[196:199], a[0:3], a[20:23], a[196:199]
  ds_read_b128 a[52:55], v25 offset:8192
  ds_read_b64_tr_b16 a[28:29], v24 offset:8448
  v_mfma_f32_16x16x32_bf16 a[200:203], a[0:3], a[24:27], a[200:203]
  ds_read_b64_tr_b16 a[30:31], v24 offset:8960
  buffer_load_dwordx4 v32, s[12:15], s63 offen offset:0 sc1 lds
  v_mfma_f32_16x16x32_bf16 a[204:207], a[4:7], a[16:19], a[204:207]
  ds_read_b64_tr_b16 a[32:33], v24 offset:8480
  ds_read_b64_tr_b16 a[34:35], v24 offset:8992
  v_mfma_f32_16x16x32_bf16 a[208:211], a[4:7], a[20:23], a[208:211]
  ds_read_b64_tr_b16 a[36:37], v24 offset:8512
  buffer_load_dwordx4 v32, s[12:15], s63 offen offset:1024 sc1 lds
  v_mfma_f32_16x16x32_bf16 a[212:215], a[4:7], a[24:27], a[212:215]
  ds_read_b64_tr_b16 a[38:39], v24 offset:9024
  ds_read_b64_tr_b16 a[40:41], v24 offset:8544
  v_mfma_f32_16x16x32_bf16 a[216:219], a[8:11], a[16:19], a[216:219]
  ds_read_b64_tr_b16 a[42:43], v24 offset:9056
  buffer_load_dwordx4 v32, s[12:15], s63 offen offset:2048 sc1 lds
  v_mfma_f32_16x16x32_bf16 a[220:223], a[8:11], a[20:23], a[220:223]
  s_mov_b32 s93, s92
  s_add_u32 s92, s92, 29184
  v_fmac_f32 v138, v42, v52
  v_mfma_f32_16x16x32_bf16 a[224:227], a[8:11], a[24:27], a[224:227]
  s_add_u32 s63, s63, 73728
  s_cmp_eq_u32 s92, 145920
  s_cselect_b32 s92, 0, s92
  v_mfma_f32_16x16x32_bf16 a[228:231], a[12:15], a[16:19], a[228:231]
  v_add_u32 v24, s92, v26
  v_fmac_f32 v139, v43, v52
  v_mfma_f32_16x16x32_bf16 a[232:235], a[12:15], a[20:23], a[232:235]
  v_add_u32 v25, s92, v27
  v_fmac_f32 v152, v44, v52
  v_mfma_f32_16x16x32_bf16 a[236:239], a[12:15], a[24:27], a[236:239]
  s_waitcnt vmcnt(21) lgkmcnt(0)
  s_barrier
  v_mfma_f32_16x16x32_bf16 a[192:195], a[28:31], a[44:47], a[192:195]
  s_add_u32 m0, s60, s93
  ds_read_b128 a[16:19], v25 offset:0
  ds_read_b128 a[20:23], v25 offset:1024
  v_fmac_f32 v153, v45, v52
  v_mfma_f32_16x16x32_bf16 a[196:199], a[28:31], a[48:51], a[196:199]
  ds_read_b128 a[24:27], v25 offset:2048
  ds_read_b64_tr_b16 a[0:1], v24 offset:0
  v_fmac_f32 v154, v46, v52
  v_mfma_f32_16x16x32_bf16 a[200:203], a[28:31], a[52:55], a[200:203]
  ds_read_b64_tr_b16 a[2:3], v24 offset:512
  buffer_load_dwordx4 v28, s[36:39], s62 offen offset:0 lds
  v_fmac_f32 v155, v47, v52
  v_mfma_f32_16x16x32_bf16 a[204:207], a[32:35], a[44:47], a[204:207]
  ds_read_b64_tr_b16 a[4:5], v24 offset:32
  ds_read_b64_tr_b16 a[6:7], v24 offset:544
  v_mul_f32 v136, v136, v53
  v_mfma_f32_16x16x32_bf16 a[208:211], a[32:35], a[48:51], a[208:211]
  ds_read_b64_tr_b16 a[8:9], v24 offset:64
  buffer_load_dwordx4 v29, s[36:39], s62 offen offset:1056 lds
  v_mul_f32 v137, v137, v53
  v_mfma_f32_16x16x32_bf16 a[212:215], a[32:35], a[52:55], a[212:215]
  ds_read_b64_tr_b16 a[10:11], v24 offset:576
  ds_read_b64_tr_b16 a[12:13], v24 offset:96
  v_mul_f32 v138, v138, v53
  v_mfma_f32_16x16x32_bf16 a[216:219], a[36:39], a[44:47], a[216:219]
  ds_read_b64_tr_b16 a[14:15], v24 offset:608
  buffer_load_dwordx4 v30, s[36:39], s62 offen offset:2112 lds
  v_mul_f32 v139, v139, v53
  v_mfma_f32_16x16x32_bf16 a[220:223], a[36:39], a[48:51], a[220:223]
  buffer_load_dwordx4 v31, s[36:39], s62 offen offset:3168 lds
  v_mul_f32 v152, v152, v53
  v_mul_f32 v153, v153, v53
  v_mfma_f32_16x16x32_bf16 a[224:227], a[36:39], a[52:55], a[224:227]
  v_mul_f32 v154, v154, v53
  v_mul_f32 v155, v155, v53
  v_cvt_pk_bf16_f32 v232, v136, v137
  v_mfma_f32_16x16x32_bf16 a[228:231], a[40:43], a[44:47], a[228:231]
  s_add_u32 s62, s62, 589824
  v_cvt_pk_bf16_f32 v233, v138, v139
  v_cvt_pk_bf16_f32 v234, v152, v153
  v_cvt_pk_bf16_f32 v235, v154, v155
  v_mfma_f32_16x16x32_bf16 a[232:235], a[40:43], a[48:51], a[232:235]
  v_fmac_f32 v140, v40, v54
  v_fmac_f32 v141, v41, v54
  v_fmac_f32 v142, v42, v54
  v_mfma_f32_16x16x32_bf16 a[236:239], a[40:43], a[52:55], a[236:239]
  s_waitcnt lgkmcnt(0)
  v_mfma_f32_16x16x32_bf16 a[192:195], a[0:3], a[16:19], a[192:195]
  s_add_u32 m0, s61, s93
  ds_read_b128 a[44:47], v25 offset:6144
  ds_read_b128 a[48:51], v25 offset:7168
  v_mfma_f32_16x16x32_bf16 a[196:199], a[0:3], a[20:23], a[196:199]
  ds_read_b128 a[52:55], v25 offset:8192
  ds_read_b64_tr_b16 a[28:29], v24 offset:8448
  v_mfma_f32_16x16x32_bf16 a[200:203], a[0:3], a[24:27], a[200:203]
  ds_read_b64_tr_b16 a[30:31], v24 offset:8960
  buffer_load_dwordx4 v32, s[12:15], s63 offen offset:0 sc1 lds
  v_mfma_f32_16x16x32_bf16 a[204:207], a[4:7], a[16:19], a[204:207]
  ds_read_b64_tr_b16 a[32:33], v24 offset:8480
  ds_read_b64_tr_b16 a[34:35], v24 offset:8992
  v_mfma_f32_16x16x32_bf16 a[208:211], a[4:7], a[20:23], a[208:211]
  ds_read_b64_tr_b16 a[36:37], v24 offset:8512
  buffer_load_dwordx4 v32, s[12:15], s63 offen offset:1024 sc1 lds
  v_mfma_f32_16x16x32_bf16 a[212:215], a[4:7], a[24:27], a[212:215]
  ds_read_b64_tr_b16 a[38:39], v24 offset:9024
  ds_read_b64_tr_b16 a[40:41], v24 offset:8544
  v_mfma_f32_16x16x32_bf16 a[216:219], a[8:11], a[16:19], a[216:219]
  ds_read_b64_tr_b16 a[42:43], v24 offset:9056
  buffer_load_dwordx4 v32, s[12:15], s63 offen offset:2048 sc1 lds
  v_mfma_f32_16x16x32_bf16 a[220:223], a[8:11], a[20:23], a[220:223]
  s_mov_b32 s93, s92
  s_add_u32 s92, s92, 29184
  v_fmac_f32 v143, v43, v54
  v_mfma_f32_16x16x32_bf16 a[224:227], a[8:11], a[24:27], a[224:227]
  s_add_u32 s63, s63, 73728
  s_cmp_eq_u32 s92, 145920
  s_cselect_b32 s92, 0, s92
  v_mfma_f32_16x16x32_bf16 a[228:231], a[12:15], a[16:19], a[228:231]
  v_add_u32 v24, s92, v26
  v_fmac_f32 v156, v44, v54
  v_mfma_f32_16x16x32_bf16 a[232:235], a[12:15], a[20:23], a[232:235]
  v_add_u32 v25, s92, v27
  v_fmac_f32 v157, v45, v54
  v_mfma_f32_16x16x32_bf16 a[236:239], a[12:15], a[24:27], a[236:239]
  s_waitcnt vmcnt(21) lgkmcnt(0)
  s_barrier
  v_mfma_f32_16x16x32_bf16 a[192:195], a[28:31], a[44:47], a[192:195]
  s_add_u32 m0, s60, s93
  ds_read_b128 a[16:19], v25 offset:0
  ds_read_b128 a[20:23], v25 offset:1024
  v_mfma_f32_16x16x32_bf16 a[196:199], a[28:31], a[48:51], a[196:199]
  ds_read_b128 a[24:27], v25 offset:2048
  ds_read_b64_tr_b16 a[0:1], v24 offset:0
  v_mfma_f32_16x16x32_bf16 a[200:203], a[28:31], a[52:55], a[200:203]
  ds_read_b64_tr_b16 a[2:3], v24 offset:512
  buffer_load_dwordx4 v28, s[36:39], s62 offen offset:0 lds
  v_mfma_f32_16x16x32_bf16 a[204:207], a[32:35], a[44:47], a[204:207]
  ds_read_b64_tr_b16 a[4:5], v24 offset:32
  ds_read_b64_tr_b16 a[6:7], v24 offset:544
  v_mfma_f32_16x16x32_bf16 a[208:211], a[32:35], a[48:51], a[208:211]
  ds_read_b64_tr_b16 a[8:9], v24 offset:64
  buffer_load_dwordx4 v29, s[36:39], s62 offen offset:1056 lds
  v_mfma_f32_16x16x32_bf16 a[212:215], a[32:35], a[52:55], a[212:215]
  ds_read_b64_tr_b16 a[10:11], v24 offset:576
  ds_read_b64_tr_b16 a[12:13], v24 offset:96
  v_mfma_f32_16x16x32_bf16 a[216:219], a[36:39], a[44:47], a[216:219]
  ds_read_b64_tr_b16 a[14:15], v24 offset:608
  buffer_load_dwordx4 v30, s[36:39], s62 offen offset:2112 lds
  v_mfma_f32_16x16x32_bf16 a[220:223], a[36:39], a[48:51], a[220:223]
  buffer_load_dwordx4 v31, s[36:39], s62 offen offset:3168 lds
  v_fmac_f32 v158, v46, v54
  v_mfma_f32_16x16x32_bf16 a[224:227], a[36:39], a[52:55], a[224:227]
  v_fmac_f32 v159, v47, v54
  v_mul_f32 v140, v140, v55
  v_mfma_f32_16x16x32_bf16 a[228:231], a[40:43], a[44:47], a[228:231]
  s_add_u32 s62, s62, 589824
  v_mul_f32 v141, v141, v55
  v_mul_f32 v142, v142, v55
  v_mfma_f32_16x16x32_bf16 a[232:235], a[40:43], a[48:51], a[232:235]
  v_mul_f32 v143, v143, v55
  v_mul_f32 v156, v156, v55
  v_mfma_f32_16x16x32_bf16 a[236:239], a[40:43], a[52:55], a[236:239]
  s_waitcnt lgkmcnt(0)
  v_mfma_f32_16x16x32_bf16 a[192:195], a[0:3], a[16:19], a[192:195]
  s_add_u32 m0, s61, s93
  ds_read_b128 a[44:47], v25 offset:6144
  ds_read_b128 a[48:51], v25 offset:7168
  v_mfma_f32_16x16x32_bf16 a[196:199], a[0:3], a[20:23], a[196:199]
  ds_read_b128 a[52:55], v25 offset:8192
  ds_read_b64_tr_b16 a[28:29], v24 offset:8448
  v_mfma_f32_16x16x32_bf16 a[200:203], a[0:3], a[24:27], a[200:203]
  ds_read_b64_tr_b16 a[30:31], v24 offset:8960
  buffer_load_dwordx4 v32, s[12:15], s63 offen offset:0 sc1 lds
  v_mfma_f32_16x16x32_bf16 a[204:207], a[4:7], a[16:19], a[204:207]
  ds_read_b64_tr_b16 a[32:33], v24 offset:8480
  ds_read_b64_tr_b16 a[34:35], v24 offset:8992
  v_mfma_f32_16x16x32_bf16 a[208:211], a[4:7], a[20:23], a[208:211]
  ds_read_b64_tr_b16 a[36:37], v24 offset:8512
  buffer_load_dwordx4 v32, s[12:15], s63 offen offset:1024 sc1 lds
  v_mfma_f32_16x16x32_bf16 a[212:215], a[4:7], a[24:27], a[212:215]
  ds_read_b64_tr_b16 a[38:39], v24 offset:9024
  ds_read_b64_tr_b16 a[40:41], v24 offset:8544
  v_mfma_f32_16x16x32_bf16 a[216:219], a[8:11], a[16:19], a[216:219]
  ds_read_b64_tr_b16 a[42:43], v24 offset:9056
  buffer_load_dwordx4 v32, s[12:15], s63 offen offset:2048 sc1 lds
  v_mfma_f32_16x16x32_bf16 a[220:223], a[8:11], a[20:23], a[220:223]
  s_mov_b32 s93, s92
  s_add_u32 s92, s92, 29184
  v_mul_f32 v157, v157, v55
  v_mfma_f32_16x16x32_bf16 a[224:227], a[8:11], a[24:27], a[224:227]
  s_add_u32 s63, s63, 73728
  s_cmp_eq_u32 s92, 145920
  s_cselect_b32 s92, 0, s92
  v_mfma_f32_16x16x32_bf16 a[228:231], a[12:15], a[16:19], a[228:231]
  v_add_u32 v24, s92, v26
  v_mul_f32 v158, v158, v55
  v_mfma_f32_16x16x32_bf16 a[232:235], a[12:15], a[20:23], a[232:235]
  v_add_u32 v25, s92, v27
  v_mul_f32 v159, v159, v55
  v_mfma_f32_16x16x32_bf16 a[236:239], a[12:15], a[24:27], a[236:239]
  s_waitcnt vmcnt(21) lgkmcnt(0)
  s_barrier
  v_mfma_f32_16x16x32_bf16 a[192:195], a[28:31], a[44:47], a[192:195]
  s_add_u32 m0, s60, s93
  ds_read_b128 a[16:19], v25 offset:0
  ds_read_b128 a[20:23], v25 offset:1024
  v_cvt_pk_bf16_f32 v248, v140, v141
  v_mfma_f32_16x16x32_bf16 a[196:199], a[28:31], a[48:51], a[196:199]
  ds_read_b128 a[24:27], v25 offset:2048
  ds_read_b64_tr_b16 a[0:1], v24 offset:0
  v_cvt_pk_bf16_f32 v249, v142, v143
  v_mfma_f32_16x16x32_bf16 a[200:203], a[28:31], a[52:55], a[200:203]
  ds_read_b64_tr_b16 a[2:3], v24 offset:512
  buffer_load_dwordx4 v28, s[36:39], s62 offen offset:0 lds
  v_cvt_pk_bf16_f32 v250, v156, v157
  v_mfma_f32_16x16x32_bf16 a[204:207], a[32:35], a[44:47], a[204:207]
  ds_read_b64_tr_b16 a[4:5], v24 offset:32
  ds_read_b64_tr_b16 a[6:7], v24 offset:544
  v_cvt_pk_bf16_f32 v251, v158, v159
  v_mfma_f32_16x16x32_bf16 a[208:211], a[32:35], a[48:51], a[208:211]
  ds_read_b64_tr_b16 a[8:9], v24 offset:64
  buffer_load_dwordx4 v29, s[36:39], s62 offen offset:1056 lds
  v_mfma_f32_16x16x32_bf16 a[212:215], a[32:35], a[52:55], a[212:215]
  ds_read_b64_tr_b16 a[10:11], v24 offset:576
  ds_read_b64_tr_b16 a[12:13], v24 offset:96
  v_mfma_f32_16x16x32_bf16 a[216:219], a[36:39], a[44:47], a[216:219]
  ds_read_b64_tr_b16 a[14:15], v24 offset:608
  buffer_load_dwordx4 v30, s[36:39], s62 offen offset:2112 lds
  v_mfma_f32_16x16x32_bf16 a[220:223], a[36:39], a[48:51], a[220:223]
  buffer_load_dwordx4 v31, s[36:39], s62 offen offset:3168 lds
  v_permlane16_swap_b32 v200, v202
  v_mfma_f32_16x16x32_bf16 a[224:227], a[36:39], a[52:55], a[224:227]
  v_permlane16_swap_b32 v201, v203
  v_mfma_f32_16x16x32_bf16 a[228:231], a[40:43], a[44:47], a[228:231]
  s_add_u32 s62, s62, 589824
  v_permlane16_swap_b32 v216, v218
  v_mfma_f32_16x16x32_bf16 a[232:235], a[40:43], a[48:51], a[232:235]
  v_permlane16_swap_b32 v217, v219
  v_mfma_f32_16x16x32_bf16 a[236:239], a[40:43], a[52:55], a[236:239]
  s_waitcnt lgkmcnt(0)
  v_mfma_f32_16x16x32_bf16 a[192:195], a[0:3], a[16:19], a[192:195]
  s_add_u32 m0, s61, s93
  ds_read_b128 a[44:47], v25 offset:6144
  ds_read_b128 a[48:51], v25 offset:7168
  v_mfma_f32_16x16x32_bf16 a[196:199], a[0:3], a[20:23], a[196:199]
  ds_read_b128 a[52:55], v25 offset:8192
  ds_read_b64_tr_b16 a[28:29], v24 offset:8448
  v_mfma_f32_16x16x32_bf16 a[200:203], a[0:3], a[24:27], a[200:203]
  ds_read_b64_tr_b16 a[30:31], v24 offset:8960
  buffer_load_dwordx4 v32, s[12:15], s63 offen offset:0 sc1 lds
  v_mfma_f32_16x16x32_bf16 a[204:207], a[4:7], a[16:19], a[204:207]
  ds_read_b64_tr_b16 a[32:33], v24 offset:8480
  ds_read_b64_tr_b16 a[34:35], v24 offset:8992
  v_mfma_f32_16x16x32_bf16 a[208:211], a[4:7], a[20:23], a[208:211]
  ds_read_b64_tr_b16 a[36:37], v24 offset:8512
  buffer_load_dwordx4 v32, s[12:15], s63 offen offset:1024 sc1 lds
  v_mfma_f32_16x16x32_bf16 a[212:215], a[4:7], a[24:27], a[212:215]
  ds_read_b64_tr_b16 a[38:39], v24 offset:9024
  ds_read_b64_tr_b16 a[40:41], v24 offset:8544
  v_mfma_f32_16x16x32_bf16 a[216:219], a[8:11], a[16:19], a[216:219]
  ds_read_b64_tr_b16 a[42:43], v24 offset:9056
  buffer_load_dwordx4 v32, s[12:15], s63 offen offset:2048 sc1 lds
  v_mfma_f32_16x16x32_bf16 a[220:223], a[8:11], a[20:23], a[220:223]
  s_mov_b32 s93, s92
  s_add_u32 s92, s92, 29184
  v_mfma_f32_16x16x32_bf16 a[224:227], a[8:11], a[24:27], a[224:227]
  s_add_u32 s63, s63, 73728
  s_cmp_eq_u32 s92, 145920
  s_cselect_b32 s92, 0, s92
  v_mfma_f32_16x16x32_bf16 a[228:231], a[12:15], a[16:19], a[228:231]
  v_add_u32 v24, s92, v26
  v_mfma_f32_16x16x32_bf16 a[232:235], a[12:15], a[20:23], a[232:235]
  v_add_u32 v25, s92, v27
  v_mfma_f32_16x16x32_bf16 a[236:239], a[12:15], a[24:27], a[236:239]
  s_waitcnt vmcnt(21) lgkmcnt(0)
  s_barrier
  v_mfma_f32_16x16x32_bf16 a[192:195], a[28:31], a[44:47], a[192:195]
  s_add_u32 m0, s60, s93
  ds_read_b128 a[16:19], v25 offset:0
  ds_read_b128 a[20:23], v25 offset:1024
  v_mfma_f32_16x16x32_bf16 a[196:199], a[28:31], a[48:51], a[196:199]
  ds_read_b128 a[24:27], v25 offset:2048
  ds_read_b64_tr_b16 a[0:1], v24 offset:0
  v_mfma_f32_16x16x32_bf16 a[200:203], a[28:31], a[52:55], a[200:203]
  ds_read_b64_tr_b16 a[2:3], v24 offset:512
  buffer_load_dwordx4 v28, s[36:39], s62 offen offset:0 lds
  v_mfma_f32_16x16x32_bf16 a[204:207], a[32:35], a[44:47], a[204:207]
  ds_read_b64_tr_b16 a[4:5], v24 offset:32
  ds_read_b64_tr_b16 a[6:7], v24 offset:544
  v_mfma_f32_16x16x32_bf16 a[208:211], a[32:35], a[48:51], a[208:211]
  ds_read_b64_tr_b16 a[8:9], v24 offset:64
  buffer_load_dwordx4 v29, s[36:39], s62 offen offset:1056 lds
  v_mfma_f32_16x16x32_bf16 a[212:215], a[32:35], a[52:55], a[212:215]
  ds_read_b64_tr_b16 a[10:11], v24 offset:576
  ds_read_b64_tr_b16 a[12:13], v24 offset:96
  v_mfma_f32_16x16x32_bf16 a[216:219], a[36:39], a[44:47], a[216:219]
  ds_read_b64_tr_b16 a[14:15], v24 offset:608
  buffer_load_dwordx4 v30, s[36:39], s62 offen offset:2112 lds
  v_mfma_f32_16x16x32_bf16 a[220:223], a[36:39], a[48:51], a[220:223]
  buffer_load_dwordx4 v31, s[36:39], s62 offen offset:3168 lds
  v_mfma_f32_16x16x32_bf16 a[224:227], a[36:39], a[52:55], a[224:227]
  v_permlane16_swap_b32 v232, v234
  v_mfma_f32_16x16x32_bf16 a[228:231], a[40:43], a[44:47], a[228:231]
  s_add_u32 s62, s62, 589824
  v_permlane16_swap_b32 v233, v235
  v_mfma_f32_16x16x32_bf16 a[232:235], a[40:43], a[48:51], a[232:235]
  v_permlane16_swap_b32 v248, v250
  v_mfma_f32_16x16x32_bf16 a[236:239], a[40:43], a[52:55], a[236:239]
  s_waitcnt lgkmcnt(0)
  v_mfma_f32_16x16x32_bf16 a[192:195], a[0:3], a[16:19], a[192:195]
  s_add_u32 m0, s61, s93
  ds_read_b128 a[44:47], v25 offset:6144
  ds_read_b128 a[48:51], v25 offset:7168
  v_mfma_f32_16x16x32_bf16 a[196:199], a[0:3], a[20:23], a[196:199]
  ds_read_b128 a[52:55], v25 offset:8192
  ds_read_b64_tr_b16 a[28:29], v24 offset:8448
  v_mfma_f32_16x16x32_bf16 a[200:203], a[0:3], a[24:27], a[200:203]
  ds_read_b64_tr_b16 a[30:31], v24 offset:8960
  buffer_load_dwordx4 v32, s[12:15], s63 offen offset:0 sc1 lds
  v_mfma_f32_16x16x32_bf16 a[204:207], a[4:7], a[16:19], a[204:207]
  ds_read_b64_tr_b16 a[32:33], v24 offset:8480
  ds_read_b64_tr_b16 a[34:35], v24 offset:8992
  v_mfma_f32_16x16x32_bf16 a[208:211], a[4:7], a[20:23], a[208:211]
  ds_read_b64_tr_b16 a[36:37], v24 offset:8512
  buffer_load_dwordx4 v32, s[12:15], s63 offen offset:1024 sc1 lds
  v_mfma_f32_16x16x32_bf16 a[212:215], a[4:7], a[24:27], a[212:215]
  ds_read_b64_tr_b16 a[38:39], v24 offset:9024
  ds_read_b64_tr_b16 a[40:41], v24 offset:8544
  v_mfma_f32_16x16x32_bf16 a[216:219], a[8:11], a[16:19], a[216:219]
  ds_read_b64_tr_b16 a[42:43], v24 offset:9056
  buffer_load_dwordx4 v32, s[12:15], s63 offen offset:2048 sc1 lds
  v_mfma_f32_16x16x32_bf16 a[220:223], a[8:11], a[20:23], a[220:223]
  s_mov_b32 s93, s92
  s_add_u32 s92, s92, 29184
  v_mfma_f32_16x16x32_bf16 a[224:227], a[8:11], a[24:27], a[224:227]
  s_add_u32 s63, s63, 73728
  s_cmp_eq_u32 s92, 145920
  s_cselect_b32 s92, 0, s92
  v_mfma_f32_16x16x32_bf16 a[228:231], a[12:15], a[16:19], a[228:231]
  v_add_u32 v24, s92, v26
  v_mfma_f32_16x16x32_bf16 a[232:235], a[12:15], a[20:23], a[232:235]
  v_add_u32 v25, s92, v27
  v_mfma_f32_16x16x32_bf16 a[236:239], a[12:15], a[24:27], a[236:239]
  s_waitcnt vmcnt(21) lgkmcnt(0)
  s_barrier
  v_mfma_f32_16x16x32_bf16 a[192:195], a[28:31], a[44:47], a[192:195]
  s_add_u32 m0, s60, s93
  ds_read_b128 a[16:19], v25 offset:0
  ds_read_b128 a[20:23], v25 offset:1024
  v_mfma_f32_16x16x32_bf16 a[196:199], a[28:31], a[48:51], a[196:199]
  ds_read_b128 a[24:27], v25 offset:2048
  ds_read_b64_tr_b16 a[0:1], v24 offset:0
  v_mfma_f32_16x16x32_bf16 a[200:203], a[28:31], a[52:55], a[200:203]
  ds_read_b64_tr_b16 a[2:3], v24 offset:512
  buffer_load_dwordx4 v28, s[36:39], s62 offen offset:0 lds
  v_mfma_f32_16x16x32_bf16 a[204:207], a[32:35], a[44:47], a[204:207]
  ds_read_b64_tr_b16 a[4:5], v24 offset:32
  ds_read_b64_tr_b16 a[6:7], v24 offset:544
  v_mfma_f32_16x16x32_bf16 a[208:211], a[32:35], a[48:51], a[208:211]
  ds_read_b64_tr_b16 a[8:9], v24 offset:64
  buffer_load_dwordx4 v29, s[36:39], s62 offen offset:1056 lds
  v_mfma_f32_16x16x32_bf16 a[212:215], a[32:35], a[52:55], a[212:215]
  ds_read_b64_tr_b16 a[10:11], v24 offset:576
  ds_read_b64_tr_b16 a[12:13], v24 offset:96
  v_mfma_f32_16x16x32_bf16 a[216:219], a[36:39], a[44:47], a[216:219]
  ds_read_b64_tr_b16 a[14:15], v24 offset:608
  buffer_load_dwordx4 v30, s[36:39], s62 offen offset:2112 lds
  v_mfma_f32_16x16x32_bf16 a[220:223], a[36:39], a[48:51], a[220:223]
  buffer_load_dwordx4 v31, s[36:39], s62 offen offset:3168 lds
  v_permlane16_swap_b32 v249, v251
  v_mfma_f32_16x16x32_bf16 a[224:227], a[36:39], a[52:55], a[224:227]
  v_fmac_f32 v160, v56, v48
  v_fmac_f32 v161, v57, v48
  v_fmac_f32 v162, v58, v48
  v_mfma_f32_16x16x32_bf16 a[228:231], a[40:43], a[44:47], a[228:231]
  s_add_u32 s62, s62, 589824
  v_fmac_f32 v163, v59, v48
  v_fmac_f32 v176, v60, v48
  v_fmac_f32 v177, v61, v48
  v_mfma_f32_16x16x32_bf16 a[232:235], a[40:43], a[48:51], a[232:235]
  v_fmac_f32 v178, v62, v48
  v_fmac_f32 v179, v63, v48
  v_mul_f32 v160, v160, v49
  v_mfma_f32_16x16x32_bf16 a[236:239], a[40:43], a[52:55], a[236:239]
  s_waitcnt lgkmcnt(0)
  v_mfma_f32_16x16x32_bf16 a[192:195], a[0:3], a[16:19], a[192:195]
  s_add_u32 m0, s61, s93
  ds_read_b128 a[44:47], v25 offset:6144
  ds_read_b128 a[48:51], v25 offset:7168
  v_mfma_f32_16x16x32_bf16 a[196:199], a[0:3], a[20:23], a[196:199]
  ds_read_b128 a[52:55], v25 offset:8192
  ds_read_b64_tr_b16 a[28:29], v24 offset:8448
  v_mfma_f32_16x16x32_bf16 a[200:203], a[0:3], a[24:27], a[200:203]
  ds_read_b64_tr_b16 a[30:31], v24 offset:8960
  buffer_load_dwordx4 v32, s[12:15], s63 offen offset:0 sc1 lds
  v_mfma_f32_16x16x32_bf16 a[204:207], a[4:7], a[16:19], a[204:207]
  ds_read_b64_tr_b16 a[32:33], v24 offset:8480
  ds_read_b64_tr_b16 a[34:35], v24 offset:8992
  v_mfma_f32_16x16x32_bf16 a[208:211], a[4:7], a[20:23], a[208:211]
  ds_read_b64_tr_b16 a[36:37], v24 offset:8512
  buffer_load_dwordx4 v32, s[12:15], s63 offen offset:1024 sc1 lds
  v_mfma_f32_16x16x32_bf16 a[212:215], a[4:7], a[24:27], a[212:215]
  ds_read_b64_tr_b16 a[38:39], v24 offset:9024
  ds_read_b64_tr_b16 a[40:41], v24 offset:8544
  v_mfma_f32_16x16x32_bf16 a[216:219], a[8:11], a[16:19], a[216:219]
  ds_read_b64_tr_b16 a[42:43], v24 offset:9056
  buffer_load_dwordx4 v32, s[12:15], s63 offen offset:2048 sc1 lds
  v_mfma_f32_16x16x32_bf16 a[220:223], a[8:11], a[20:23], a[220:223]
  s_mov_b32 s93, s92
  s_add_u32 s92, s92, 29184
  v_mul_f32 v161, v161, v49
  v_mfma_f32_16x16x32_bf16 a[224:227], a[8:11], a[24:27], a[224:227]
  s_add_u32 s63, s63, 73728
  s_cmp_eq_u32 s92, 145920
  s_cselect_b32 s92, 0, s92
  v_mfma_f32_16x16x32_bf16 a[228:231], a[12:15], a[16:19], a[228:231]
  v_add_u32 v24, s92, v26
  v_mul_f32 v162, v162, v49
  v_mfma_f32_16x16x32_bf16 a[232:235], a[12:15], a[20:23], a[232:235]
  v_add_u32 v25, s92, v27
  v_mul_f32 v163, v163, v49
  v_mfma_f32_16x16x32_bf16 a[236:239], a[12:15], a[24:27], a[236:239]
  s_waitcnt vmcnt(21) lgkmcnt(0)
  s_barrier
  v_mfma_f32_16x16x32_bf16 a[192:195], a[28:31], a[44:47], a[192:195]
  s_add_u32 m0, s60, s93
  ds_read_b128 a[16:19], v25 offset:0
  ds_read_b128 a[20:23], v25 offset:1024
  v_mfma_f32_16x16x32_bf16 a[196:199], a[28:31], a[48:51], a[196:199]
  ds_read_b128 a[24:27], v25 offset:2048
  ds_read_b64_tr_b16 a[0:1], v24 offset:0
  v_mfma_f32_16x16x32_bf16 a[200:203], a[28:31], a[52:55], a[200:203]
  ds_read_b64_tr_b16 a[2:3], v24 offset:512
  buffer_load_dwordx4 v28, s[36:39], s62 offen offset:0 lds
  v_mfma_f32_16x16x32_bf16 a[204:207], a[32:35], a[44:47], a[204:207]
  ds_read_b64_tr_b16 a[4:5], v24 offset:32
  ds_read_b64_tr_b16 a[6:7], v24 offset:544
  v_mfma_f32_16x16x32_bf16 a[208:211], a[32:35], a[48:51], a[208:211]
  ds_read_b64_tr_b16 a[8:9], v24 offset:64
  buffer_load_dwordx4 v29, s[36:39], s62 offen offset:1056 lds
  v_mfma_f32_16x16x32_bf16 a[212:215], a[32:35], a[52:55], a[212:215]
  ds_read_b64_tr_b16 a[10:11], v24 offset:576
  ds_read_b64_tr_b16 a[12:13], v24 offset:96
  v_mfma_f32_16x16x32_bf16 a[216:219], a[36:39], a[44:47], a[216:219]
  ds_read_b64_tr_b16 a[14:15], v24 offset:608
  buffer_load_dwordx4 v30, s[36:39], s62 offen offset:2112 lds
  v_mfma_f32_16x16x32_bf16 a[220:223], a[36:39], a[48:51], a[220:223]
  buffer_load_dwordx4 v31, s[36:39], s62 offen offset:3168 lds
  v_mul_f32 v176, v176, v49
  v_mfma_f32_16x16x32_bf16 a[224:227], a[36:39], a[52:55], a[224:227]
  v_mul_f32 v177, v177, v49
  v_mul_f32 v178, v178, v49
  v_mfma_f32_16x16x32_bf16 a[228:231], a[40:43], a[44:47], a[228:231]
  s_add_u32 s62, s62, 589824
  v_mul_f32 v179, v179, v49
  v_cvt_pk_bf16_f32 v204, v160, v161
  v_mfma_f32_16x16x32_bf16 a[232:235], a[40:43], a[48:51], a[232:235]
  v_cvt_pk_bf16_f32 v205, v162, v163
  v_cvt_pk_bf16_f32 v206, v176, v177
  v_mfma_f32_16x16x32_bf16 a[236:239], a[40:43], a[52:55], a[236:239]
  s_waitcnt lgkmcnt(0)
  v_mfma_f32_16x16x32_bf16 a[192:195], a[0:3], a[16:19], a[192:195]
  s_add_u32 m0, s61, s93
  ds_read_b128 a[44:47], v25 offset:6144
  ds_read_b128 a[48:51], v25 offset:7168
  v_mfma_f32_16x16x32_bf16 a[196:199], a[0:3], a[20:23], a[196:199]
  ds_read_b128 a[52:55], v25 offset:8192
  ds_read_b64_tr_b16 a[28:29], v24 offset:8448
  v_mfma_f32_16x16x32_bf16 a[200:203], a[0:3], a[24:27], a[200:203]
  ds_read_b64_tr_b16 a[30:31], v24 offset:8960
  buffer_load_dwordx4 v32, s[12:15], s63 offen offset:0 sc1 lds
  v_mfma_f32_16x16x32_bf16 a[204:207], a[4:7], a[16:19], a[204:207]
  ds_read_b64_tr_b16 a[32:33], v24 offset:8480
  ds_read_b64_tr_b16 a[34:35], v24 offset:8992
  v_mfma_f32_16x16x32_bf16 a[208:211], a[4:7], a[20:23], a[208:211]
  ds_read_b64_tr_b16 a[36:37], v24 offset:8512
  buffer_load_dwordx4 v32, s[12:15], s63 offen offset:1024 sc1 lds
  v_mfma_f32_16x16x32_bf16 a[212:215], a[4:7], a[24:27], a[212:215]
  ds_read_b64_tr_b16 a[38:39], v24 offset:9024
  ds_read_b64_tr_b16 a[40:41], v24 offset:8544
  v_mfma_f32_16x16x32_bf16 a[216:219], a[8:11], a[16:19], a[216:219]
  ds_read_b64_tr_b16 a[42:43], v24 offset:9056
  buffer_load_dwordx4 v32, s[12:15], s63 offen offset:2048 sc1 lds
  v_mfma_f32_16x16x32_bf16 a[220:223], a[8:11], a[20:23], a[220:223]
  s_mov_b32 s93, s92
  s_add_u32 s92, s92, 29184
  v_cvt_pk_bf16_f32 v207, v178, v179
  v_mfma_f32_16x16x32_bf16 a[224:227], a[8:11], a[24:27], a[224:227]
  s_add_u32 s63, s63, 73728
  s_cmp_eq_u32 s92, 145920
  s_cselect_b32 s92, 0, s92
  v_mfma_f32_16x16x32_bf16 a[228:231], a[12:15], a[16:19], a[228:231]
  v_add_u32 v24, s92, v26
  v_fmac_f32 v164, v56, v50
  v_mfma_f32_16x16x32_bf16 a[232:235], a[12:15], a[20:23], a[232:235]
  v_add_u32 v25, s92, v27
  v_fmac_f32 v165, v57, v50
  v_mfma_f32_16x16x32_bf16 a[236:239], a[12:15], a[24:27], a[236:239]
  s_waitcnt vmcnt(21) lgkmcnt(0)
  s_barrier
  v_mfma_f32_16x16x32_bf16 a[192:195], a[28:31], a[44:47], a[192:195]
  s_add_u32 m0, s60, s93
  ds_read_b128 a[16:19], v25 offset:0
  ds_read_b128 a[20:23], v25 offset:1024
  v_fmac_f32 v166, v58, v50
  v_mfma_f32_16x16x32_bf16 a[196:199], a[28:31], a[48:51], a[196:199]
  ds_read_b128 a[24:27], v25 offset:2048
  ds_read_b64_tr_b16 a[0:1], v24 offset:0
  v_fmac_f32 v167, v59, v50
  v_mfma_f32_16x16x32_bf16 a[200:203], a[28:31], a[52:55], a[200:203]
  ds_read_b64_tr_b16 a[2:3], v24 offset:512
  buffer_load_dwordx4 v28, s[36:39], s62 offen offset:0 lds
  v_fmac_f32 v180, v60, v50
  v_mfma_f32_16x16x32_bf16 a[204:207], a[32:35], a[44:47], a[204:207]
  ds_read_b64_tr_b16 a[4:5], v24 offset:32
  ds_read_b64_tr_b16 a[6:7], v24 offset:544
  v_fmac_f32 v181, v61, v50
  v_mfma_f32_16x16x32_bf16 a[208:211], a[32:35], a[48:51], a[208:211]
  ds_read_b64_tr_b16 a[8:9], v24 offset:64
  buffer_load_dwordx4 v29, s[36:39], s62 offen offset:1056 lds
  v_fmac_f32 v182, v62, v50
  v_mfma_f32_16x16x32_bf16 a[212:215], a[32:35], a[52:55], a[212:215]
  ds_read_b64_tr_b16 a[10:11], v24 offset:576
  ds_read_b64_tr_b16 a[12:13], v24 offset:96
  v_fmac_f32 v183, v63, v50
  v_mfma_f32_16x16x32_bf16 a[216:219], a[36:39], a[44:47], a[216:219]
  ds_read_b64_tr_b16 a[14:15], v24 offset:608
  buffer_load_dwordx4 v30, s[36:39], s62 offen offset:2112 lds
  v_mul_f32 v164, v164, v51
  v_mfma_f32_16x16x32_bf16 a[220:223], a[36:39], a[48:51], a[220:223]
  buffer_load_dwordx4 v31, s[36:39], s62 offen offset:3168 lds
  v_mul_f32 v165, v165, v51
  v_mul_f32 v166, v166, v51
  v_mfma_f32_16x16x32_bf16 a[224:227], a[36:39], a[52:55], a[224:227]
  v_mul_f32 v167, v167, v51
  v_mul_f32 v180, v180, v51
  v_mul_f32 v181, v181, v51
  v_mfma_f32_16x16x32_bf16 a[228:231], a[40:43], a[44:47], a[228:231]
  s_add_u32 s62, s62, 589824
  v_mul_f32 v182, v182, v51
  v_mul_f32 v183, v183, v51
  v_cvt_pk_bf16_f32 v220, v164, v165
  v_mfma_f32_16x16x32_bf16 a[232:235], a[40:43], a[48:51], a[232:235]
  v_cvt_pk_bf16_f32 v221, v166, v167
  v_cvt_pk_bf16_f32 v222, v180, v181
  v_cvt_pk_bf16_f32 v223, v182, v183
  v_mfma_f32_16x16x32_bf16 a[236:239], a[40:43], a[52:55], a[236:239]
  s_waitcnt lgkmcnt(0)
  v_mfma_f32_16x16x32_bf16 a[192:195], a[0:3], a[16:19], a[192:195]
  s_add_u32 m0, s61, s93
  ds_read_b128 a[44:47], v25 offset:6144
  ds_read_b128 a[48:51], v25 offset:7168
  v_mfma_f32_16x16x32_bf16 a[196:199], a[0:3], a[20:23], a[196:199]
  ds_read_b128 a[52:55], v25 offset:8192
  ds_read_b64_tr_b16 a[28:29], v24 offset:8448
  v_mfma_f32_16x16x32_bf16 a[200:203], a[0:3], a[24:27], a[200:203]
  ds_read_b64_tr_b16 a[30:31], v24 offset:8960
  buffer_load_dwordx4 v32, s[12:15], s63 offen offset:0 sc1 lds
  v_mfma_f32_16x16x32_bf16 a[204:207], a[4:7], a[16:19], a[204:207]
  ds_read_b64_tr_b16 a[32:33], v24 offset:8480
  ds_read_b64_tr_b16 a[34:35], v24 offset:8992
  v_mfma_f32_16x16x32_bf16 a[208:211], a[4:7], a[20:23], a[208:211]
  ds_read_b64_tr_b16 a[36:37], v24 offset:8512
  buffer_load_dwordx4 v32, s[12:15], s63 offen offset:1024 sc1 lds
  v_mfma_f32_16x16x32_bf16 a[212:215], a[4:7], a[24:27], a[212:215]
TP_6:
  s_cbranch_execz TR_1
  ds_read_b64_tr_b16 a[38:39], v24 offset:9024
  ds_read_b64_tr_b16 a[40:41], v24 offset:8544
  v_mfma_f32_16x16x32_bf16 a[216:219], a[8:11], a[16:19], a[216:219]
  ds_read_b64_tr_b16 a[42:43], v24 offset:9056
  buffer_load_dwordx4 v32, s[12:15], s63 offen offset:2048 sc1 lds
  v_mfma_f32_16x16x32_bf16 a[220:223], a[8:11], a[20:23], a[220:223]
  s_mov_b32 s93, s92
  s_add_u32 s92, s92, 29184
  v_fmac_f32 v168, v56, v52
  v_mfma_f32_16x16x32_bf16 a[224:227], a[8:11], a[24:27], a[224:227]
  s_add_u32 s63, s63, 73728
  s_cmp_eq_u32 s92, 145920
  s_cselect_b32 s92, 0, s92
  v_mfma_f32_16x16x32_bf16 a[228:231], a[12:15], a[16:19], a[228:231]
  v_add_u32 v24, s92, v26
  v_fmac_f32 v169, v57, v52
  v_mfma_f32_16x16x32_bf16 a[232:235], a[12:15], a[20:23], a[232:235]
  v_add_u32 v25, s92, v27
  v_fmac_f32 v170, v58, v52
  v_mfma_f32_16x16x32_bf16 a[236:239], a[12:15], a[24:27], a[236:239]
  s_waitcnt vmcnt(21) lgkmcnt(0)
  s_barrier
  v_mfma_f32_16x16x32_bf16 a[192:195], a[28:31], a[44:47], a[192:195]
  s_add_u32 m0, s60, s93
  ds_read_b128 a[16:19], v25 offset:0
  ds_read_b128 a[20:23], v25 offset:1024
  v_mfma_f32_16x16x32_bf16 a[196:199], a[28:31], a[48:51], a[196:199]
  ds_read_b128 a[24:27], v25 offset:2048
  ds_read_b64_tr_b16 a[0:1], v24 offset:0
  v_mfma_f32_16x16x32_bf16 a[200:203], a[28:31], a[52:55], a[200:203]
  ds_read_b64_tr_b16 a[2:3], v24 offset:512
  buffer_load_dwordx4 v28, s[36:39], s62 offen offset:0 lds
  v_mfma_f32_16x16x32_bf16 a[204:207], a[32:35], a[44:47], a[204:207]
  ds_read_b64_tr_b16 a[4:5], v24 offset:32
  ds_read_b64_tr_b16 a[6:7], v24 offset:544
  v_mfma_f32_16x16x32_bf16 a[208:211], a[32:35], a[48:51], a[208:211]
  ds_read_b64_tr_b16 a[8:9], v24 offset:64
  buffer_load_dwordx4 v29, s[36:39], s62 offen offset:1056 lds
  v_mfma_f32_16x16x32_bf16 a[212:215], a[32:35], a[52:55], a[212:215]
  ds_read_b64_tr_b16 a[10:11], v24 offset:576
  ds_read_b64_tr_b16 a[12:13], v24 offset:96
  v_mfma_f32_16x16x32_bf16 a[216:219], a[36:39], a[44:47], a[216:219]
  ds_read_b64_tr_b16 a[14:15], v24 offset:608
  buffer_load_dwordx4 v30, s[36:39], s62 offen offset:2112 lds
  v_mfma_f32_16x16x32_bf16 a[220:223], a[36:39], a[48:51], a[220:223]
  buffer_load_dwordx4 v31, s[36:39], s62 offen offset:3168 lds
  v_fmac_f32 v171, v59, v52
  v_mfma_f32_16x16x32_bf16 a[224:227], a[36:39], a[52:55], a[224:227]
  v_fmac_f32 v184, v60, v52
  v_fmac_f32 v185, v61, v52
  v_mfma_f32_16x16x32_bf16 a[228:231], a[40:43], a[44:47], a[228:231]
  s_add_u32 s62, s62, 589824
  v_fmac_f32 v186, v62, v52
  v_fmac_f32 v187, v63, v52
  v_mfma_f32_16x16x32_bf16 a[232:235], a[40:43], a[48:51], a[232:235]
  v_mul_f32 v168, v168, v53
  v_mul_f32 v169, v169, v53
  v_mfma_f32_16x16x32_bf16 a[236:239], a[40:43], a[52:55], a[236:239]
  s_waitcnt lgkmcnt(0)
  v_mfma_f32_16x16x32_bf16 a[192:195], a[0:3], a[16:19], a[192:195]
  s_add_u32 m0, s61, s93
  ds_read_b128 a[44:47], v25 offset:6144
  ds_read_b128 a[48:51], v25 offset:7168
  v_mfma_f32_16x16x32_bf16 a[196:199], a[0:3], a[20:23], a[196:199]
  ds_read_b128 a[52:55], v25 offset:8192
  ds_read_b64_tr_b16 a[28:29], v24 offset:8448
  v_mfma_f32_16x16x32_bf16 a[200:203], a[0:3], a[24:27], a[200:203]
  ds_read_b64_tr_b16 a[30:31], v24 offset:8960
  buffer_load_dwordx4 v32, s[12:15], s63 offen offset:0 sc1 lds
  v_mfma_f32_16x16x32_bf16 a[204:207], a[4:7], a[16:19], a[204:207]
  ds_read_b64_tr_b16 a[32:33], v24 offset:8480
  ds_read_b64_tr_b16 a[34:35], v24 offset:8992
  v_mfma_f32_16x16x32_bf16 a[208:211], a[4:7], a[20:23], a[208:211]
  ds_read_b64_tr_b16 a[36:37], v24 offset:8512
  buffer_load_dwordx4 v32, s[12:15], s63 offen offset:1024 sc1 lds
  v_mfma_f32_16x16x32_bf16 a[212:215], a[4:7], a[24:27], a[212:215]
  ds_read_b64_tr_b16 a[38:39], v24 offset:9024
  ds_read_b64_tr_b16 a[40:41], v24 offset:8544
  v_mfma_f32_16x16x32_bf16 a[216:219], a[8:11], a[16:19], a[216:219]
  ds_read_b64_tr_b16 a[42:43], v24 offset:9056
  buffer_load_dwordx4 v32, s[12:15], s63 offen offset:2048 sc1 lds
  v_mfma_f32_16x16x32_bf16 a[220:223], a[8:11], a[20:23], a[220:223]
  s_mov_b32 s93, s92
  s_add_u32 s92, s92, 29184
  v_mul_f32 v170, v170, v53
  v_mfma_f32_16x16x32_bf16 a[224:227], a[8:11], a[24:27], a[224:227]
  s_add_u32 s63, s63, 73728
  s_cmp_eq_u32 s92, 145920
  s_cselect_b32 s92, 0, s92
  v_mfma_f32_16x16x32_bf16 a[228:231], a[12:15], a[16:19], a[228:231]
  v_add_u32 v24, s92, v26
  v_mul_f32 v171, v171, v53
  v_mfma_f32_16x16x32_bf16 a[232:235], a[12:15], a[20:23], a[232:235]
  v_add_u32 v25, s92, v27
  v_mul_f32 v184, v184, v53
  v_mfma_f32_16x16x32_bf16 a[236:239], a[12:15], a[24:27], a[236:239]
  s_waitcnt vmcnt(21) lgkmcnt(0)
  s_barrier
  v_mfma_f32_16x16x32_bf16 a[192:195], a[28:31], a[44:47], a[192:195]
  s_add_u32 m0, s60, s93
  ds_read_b128 a[16:19], v25 offset:0
  ds_read_b128 a[20:23], v25 offset:1024
  v_mul_f32 v185, v185, v53
  v_mfma_f32_16x16x32_bf16 a[196:199], a[28:31], a[48:51], a[196:199]
  ds_read_b128 a[24:27], v25 offset:2048
  ds_read_b64_tr_b16 a[0:1], v24 offset:0
  v_mul_f32 v186, v186, v53
  v_mfma_f32_16x16x32_bf16 a[200:203], a[28:31], a[52:55], a[200:203]
  ds_read_b64_tr_b16 a[2:3], v24 offset:512
  buffer_load_dwordx4 v28, s[36:39], s62 offen offset:0 lds
  v_mul_f32 v187, v187, v53
  v_mfma_f32_16x16x32_bf16 a[204:207], a[32:35], a[44:47], a[204:207]
  ds_read_b64_tr_b16 a[4:5], v24 offset:32
  ds_read_b64_tr_b16 a[6:7], v24 offset:544
  v_cvt_pk_bf16_f32 v236, v168, v169
  v_mfma_f32_16x16x32_bf16 a[208:211], a[32:35], a[48:51], a[208:211]
  ds_read_b64_tr_b16 a[8:9], v24 offset:64
  buffer_load_dwordx4 v29, s[36:39], s62 offen offset:1056 lds
  v_cvt_pk_bf16_f32 v237, v170, v171
  v_mfma_f32_16x16x32_bf16 a[212:215], a[32:35], a[52:55], a[212:215]
  ds_read_b64_tr_b16 a[10:11], v24 offset:576
  ds_read_b64_tr_b16 a[12:13], v24 offset:96
  v_cvt_pk_bf16_f32 v238, v184, v185
  v_mfma_f32_16x16x32_bf16 a[216:219], a[36:39], a[44:47], a[216:219]
  ds_read_b64_tr_b16 a[14:15], v24 offset:608
  buffer_load_dwordx4 v30, s[36:39], s62 offen offset:2112 lds
  v_cvt_pk_bf16_f32 v239, v186, v187
  v_mfma_f32_16x16x32_bf16 a[220:223], a[36:39], a[48:51], a[220:223]
  buffer_load_dwordx4 v31, s[36:39], s62 offen offset:3168 lds
  v_fmac_f32 v172, v56, v54
  v_fmac_f32 v173, v57, v54
  v_mfma_f32_16x16x32_bf16 a[224:227], a[36:39], a[52:55], a[224:227]
  v_fmac_f32 v174, v58, v54
  v_fmac_f32 v175, v59, v54
  v_fmac_f32 v188, v60, v54
  v_mfma_f32_16x16x32_bf16 a[228:231], a[40:43], a[44:47], a[228:231]
  s_add_u32 s62, s62, 589824
  v_fmac_f32 v189, v61, v54
  v_fmac_f32 v190, v62, v54
  v_fmac_f32 v191, v63, v54
  v_mfma_f32_16x16x32_bf16 a[232:235], a[40:43], a[48:51], a[232:235]
  v_mul_f32 v172, v172, v55
  v_mul_f32 v173, v173, v55
  v_mul_f32 v174, v174, v55
  v_mfma_f32_16x16x32_bf16 a[236:239], a[40:43], a[52:55], a[236:239]
  s_waitcnt lgkmcnt(0)
  v_mfma_f32_16x16x32_bf16 a[192:195], a[0:3], a[16:19], a[192:195]
  s_add_u32 m0, s61, s93
  ds_read_b128 a[44:47], v25 offset:6144
  ds_read_b128 a[48:51], v25 offset:7168
  v_mfma_f32_16x16x32_bf16 a[196:199], a[0:3], a[20:23], a[196:199]
  ds_read_b128 a[52:55], v25 offset:8192
  ds_read_b64_tr_b16 a[28:29], v24 offset:8448
  v_mfma_f32_16x16x32_bf16 a[200:203], a[0:3], a[24:27], a[200:203]
  ds_read_b64_tr_b16 a[30:31], v24 offset:8960
  buffer_load_dwordx4 v32, s[12:15], s63 offen offset:0 sc1 lds
  v_mfma_f32_16x16x32_bf16 a[204:207], a[4:7], a[16:19], a[204:207]
  ds_read_b64_tr_b16 a[32:33], v24 offset:8480
  ds_read_b64_tr_b16 a[34:35], v24 offset:8992
  v_mfma_f32_16x16x32_bf16 a[208:211], a[4:7], a[20:23], a[208:211]
  ds_read_b64_tr_b16 a[36:37], v24 offset:8512
  buffer_load_dwordx4 v32, s[12:15], s63 offen offset:1024 sc1 lds
  v_mfma_f32_16x16x32_bf16 a[212:215], a[4:7], a[24:27], a[212:215]
  ds_read_b64_tr_b16 a[38:39], v24 offset:9024
  ds_read_b64_tr_b16 a[40:41], v24 offset:8544
  v_mfma_f32_16x16x32_bf16 a[216:219], a[8:11], a[16:19], a[216:219]
  ds_read_b64_tr_b16 a[42:43], v24 offset:9056
  buffer_load_dwordx4 v32, s[12:15], s63 offen offset:2048 sc1 lds
  v_mfma_f32_16x16x32_bf16 a[220:223], a[8:11], a[20:23], a[220:223]
  s_mov_b32 s93, s92
  s_add_u32 s92, s92, 29184
  v_mul_f32 v175, v175, v55
  v_mfma_f32_16x16x32_bf16 a[224:227], a[8:11], a[24:27], a[224:227]
  s_add_u32 s63, s63, 73728
  s_cmp_eq_u32 s92, 145920
  s_cselect_b32 s92, 0, s92
  v_mfma_f32_16x16x32_bf16 a[228:231], a[12:15], a[16:19], a[228:231]
  v_add_u32 v24, s92, v26
  v_mul_f32 v188, v188, v55
  v_mfma_f32_16x16x32_bf16 a[232:235], a[12:15], a[20:23], a[232:235]
  v_add_u32 v25, s92, v27
  v_mul_f32 v189, v189, v55
  v_mfma_f32_16x16x32_bf16 a[236:239], a[12:15], a[24:27], a[236:239]
  s_waitcnt vmcnt(21) lgkmcnt(0)
  s_barrier
  v_mfma_f32_16x16x32_bf16 a[192:195], a[28:31], a[44:47], a[192:195]
  s_add_u32 m0, s56, 75008
  ds_read_b128 a[16:19], v25 offset:0
  ds_read_b128 a[20:23], v25 offset:1024
  v_mfma_f32_16x16x32_bf16 a[196:199], a[28:31], a[48:51], a[196:199]
  ds_read_b128 a[24:27], v25 offset:2048
  ds_read_b64_tr_b16 a[0:1], v24 offset:0
  v_mfma_f32_16x16x32_bf16 a[200:203], a[28:31], a[52:55], a[200:203]
  ds_read_b64_tr_b16 a[2:3], v24 offset:512
  buffer_load_dwordx4 v10, s[28:31], s58 offen lds
  v_mfma_f32_16x16x32_bf16 a[204:207], a[32:35], a[44:47], a[204:207]
  ds_read_b64_tr_b16 a[4:5], v24 offset:32
  ds_read_b64_tr_b16 a[6:7], v24 offset:544
  v_mfma_f32_16x16x32_bf16 a[208:211], a[32:35], a[48:51], a[208:211]
  ds_read_b64_tr_b16 a[8:9], v24 offset:64
  v_mul_f32 v190, v190, v55
  v_mfma_f32_16x16x32_bf16 a[212:215], a[32:35], a[52:55], a[212:215]
  ds_read_b64_tr_b16 a[10:11], v24 offset:576
  ds_read_b64_tr_b16 a[12:13], v24 offset:96
  v_mfma_f32_16x16x32_bf16 a[216:219], a[36:39], a[44:47], a[216:219]
  ds_read_b64_tr_b16 a[14:15], v24 offset:608
  buffer_load_dwordx4 v11, s[28:31], s58 offen offset:1024 lds
  v_mfma_f32_16x16x32_bf16 a[220:223], a[36:39], a[48:51], a[220:223]
  v_mul_f32 v191, v191, v55
  v_cvt_pk_bf16_f32 v252, v172, v173
  v_mfma_f32_16x16x32_bf16 a[224:227], a[36:39], a[52:55], a[224:227]
  s_add_u32 s58, s58, 8192
  v_cvt_pk_bf16_f32 v253, v174, v175
  v_cvt_pk_bf16_f32 v254, v188, v189
  v_mfma_f32_16x16x32_bf16 a[228:231], a[40:43], a[44:47], a[228:231]
  v_cvt_pk_bf16_f32 v255, v190, v191
  v_mfma_f32_16x16x32_bf16 a[232:235], a[40:43], a[48:51], a[232:235]
  v_permlane16_swap_b32 v204, v206
  v_mfma_f32_16x16x32_bf16 a[236:239], a[40:43], a[52:55], a[236:239]
  s_waitcnt lgkmcnt(0)
  v_mfma_f32_16x16x32_bf16 a[192:195], a[0:3], a[16:19], a[192:195]
  ds_read_b128 a[44:47], v25 offset:6144
  ds_read_b128 a[48:51], v25 offset:7168
  v_mfma_f32_16x16x32_bf16 a[196:199], a[0:3], a[20:23], a[196:199]
  ds_read_b128 a[52:55], v25 offset:8192
  ds_read_b64_tr_b16 a[28:29], v24 offset:8448
  v_mfma_f32_16x16x32_bf16 a[200:203], a[0:3], a[24:27], a[200:203]
  ds_read_b64_tr_b16 a[30:31], v24 offset:8960
  v_mfma_f32_16x16x32_bf16 a[204:207], a[4:7], a[16:19], a[204:207]
  ds_read_b64_tr_b16 a[32:33], v24 offset:8480
  ds_read_b64_tr_b16 a[34:35], v24 offset:8992
  v_mfma_f32_16x16x32_bf16 a[208:211], a[4:7], a[20:23], a[208:211]
  ds_read_b64_tr_b16 a[36:37], v24 offset:8512
  v_mfma_f32_16x16x32_bf16 a[212:215], a[4:7], a[24:27], a[212:215]
  ds_read_b64_tr_b16 a[38:39], v24 offset:9024
  ds_read_b64_tr_b16 a[40:41], v24 offset:8544
  v_mfma_f32_16x16x32_bf16 a[216:219], a[8:11], a[16:19], a[216:219]
  ds_read_b64_tr_b16 a[42:43], v24 offset:9056
  v_mfma_f32_16x16x32_bf16 a[220:223], a[8:11], a[20:23], a[220:223]
  s_mov_b32 s93, s92
  s_add_u32 s92, s92, 29184
  v_mfma_f32_16x16x32_bf16 a[224:227], a[8:11], a[24:27], a[224:227]
  s_cmp_eq_u32 s92, 145920
  s_cselect_b32 s92, 0, s92
  v_mfma_f32_16x16x32_bf16 a[228:231], a[12:15], a[16:19], a[228:231]
  v_add_u32 v24, s92, v26
  v_mfma_f32_16x16x32_bf16 a[232:235], a[12:15], a[20:23], a[232:235]
  v_add_u32 v25, s92, v27
  v_mfma_f32_16x16x32_bf16 a[236:239], a[12:15], a[24:27], a[236:239]
  s_waitcnt vmcnt(16) lgkmcnt(0)
  s_barrier
  v_mfma_f32_16x16x32_bf16 a[192:195], a[28:31], a[44:47], a[192:195]
  s_add_u32 m0, s56, 91648
  ds_read_b128 a[16:19], v25 offset:0
  ds_read_b128 a[20:23], v25 offset:1024
  v_mfma_f32_16x16x32_bf16 a[196:199], a[28:31], a[48:51], a[196:199]
  ds_read_b128 a[24:27], v25 offset:2048
  ds_read_b64_tr_b16 a[0:1], v24 offset:0
  v_mfma_f32_16x16x32_bf16 a[200:203], a[28:31], a[52:55], a[200:203]
  ds_read_b64_tr_b16 a[2:3], v24 offset:512
  buffer_load_dwordx4 v10, s[28:31], s58 offen lds
  v_mfma_f32_16x16x32_bf16 a[204:207], a[32:35], a[44:47], a[204:207]
  ds_read_b64_tr_b16 a[4:5], v24 offset:32
  ds_read_b64_tr_b16 a[6:7], v24 offset:544
  v_mfma_f32_16x16x32_bf16 a[208:211], a[32:35], a[48:51], a[208:211]
  ds_read_b64_tr_b16 a[8:9], v24 offset:64
  buffer_load_dwordx4 v11, s[28:31], s58 offen offset:1024 lds
  v_mfma_f32_16x16x32_bf16 a[212:215], a[32:35], a[52:55], a[212:215]
  s_add_u32 s58, s58, 8192
  ds_read_b64_tr_b16 a[10:11], v24 offset:576
  ds_read_b64_tr_b16 a[12:13], v24 offset:96
  v_mfma_f32_16x16x32_bf16 a[216:219], a[36:39], a[44:47], a[216:219]
  s_add_u32 m0, s57, 99840
  ds_read_b64_tr_b16 a[14:15], v24 offset:608
  v_permlane16_swap_b32 v205, v207
  v_mfma_f32_16x16x32_bf16 a[220:223], a[36:39], a[48:51], a[220:223]
  buffer_load_dwordx4 v12, s[32:35], s59 offen lds
  v_permlane16_swap_b32 v220, v222
  v_mfma_f32_16x16x32_bf16 a[224:227], a[36:39], a[52:55], a[224:227]
  buffer_load_dwordx4 v13, s[32:35], s59 offen offset:1056 lds
  v_permlane16_swap_b32 v221, v223
  v_mfma_f32_16x16x32_bf16 a[228:231], a[40:43], a[44:47], a[228:231]
  s_add_u32 s59, s59, 8192
  v_permlane16_swap_b32 v236, v238
  v_mfma_f32_16x16x32_bf16 a[232:235], a[40:43], a[48:51], a[232:235]
  v_permlane16_swap_b32 v237, v239
  v_mfma_f32_16x16x32_bf16 a[236:239], a[40:43], a[52:55], a[236:239]
  s_waitcnt lgkmcnt(0)
  v_mfma_f32_16x16x32_bf16 a[192:195], a[0:3], a[16:19], a[192:195]
  ds_read_b128 a[44:47], v25 offset:6144
  ds_read_b128 a[48:51], v25 offset:7168
  v_mfma_f32_16x16x32_bf16 a[196:199], a[0:3], a[20:23], a[196:199]
  ds_read_b128 a[52:55], v25 offset:8192
  ds_read_b64_tr_b16 a[28:29], v24 offset:8448
  v_mfma_f32_16x16x32_bf16 a[200:203], a[0:3], a[24:27], a[200:203]
  ds_read_b64_tr_b16 a[30:31], v24 offset:8960
  v_mfma_f32_16x16x32_bf16 a[204:207], a[4:7], a[16:19], a[204:207]
  ds_read_b64_tr_b16 a[32:33], v24 offset:8480
  ds_read_b64_tr_b16 a[34:35], v24 offset:8992
  v_mfma_f32_16x16x32_bf16 a[208:211], a[4:7], a[20:23], a[208:211]
  ds_read_b64_tr_b16 a[36:37], v24 offset:8512
  v_mfma_f32_16x16x32_bf16 a[212:215], a[4:7], a[24:27], a[212:215]
  ds_read_b64_tr_b16 a[38:39], v24 offset:9024
  ds_read_b64_tr_b16 a[40:41], v24 offset:8544
  v_mfma_f32_16x16x32_bf16 a[216:219], a[8:11], a[16:19], a[216:219]
  ds_read_b64_tr_b16 a[42:43], v24 offset:9056
  v_mfma_f32_16x16x32_bf16 a[220:223], a[8:11], a[20:23], a[220:223]
  s_mov_b32 s93, s92
  s_add_u32 s92, s92, 29184
  v_mfma_f32_16x16x32_bf16 a[224:227], a[8:11], a[24:27], a[224:227]
  s_cmp_eq_u32 s92, 145920
  s_cselect_b32 s92, 0, s92
  v_mfma_f32_16x16x32_bf16 a[228:231], a[12:15], a[16:19], a[228:231]
  v_add_u32 v24, s92, v26
  v_mfma_f32_16x16x32_bf16 a[232:235], a[12:15], a[20:23], a[232:235]
  v_add_u32 v25, s92, v27
  v_mfma_f32_16x16x32_bf16 a[236:239], a[12:15], a[24:27], a[236:239]
  s_waitcnt vmcnt(13) lgkmcnt(0)
  s_barrier
  v_mfma_f32_16x16x32_bf16 a[192:195], a[28:31], a[44:47], a[192:195]
  s_add_u32 m0, s56, 108288
  ds_read_b128 a[16:19], v25 offset:0
  ds_read_b128 a[20:23], v25 offset:1024
  v_mfma_f32_16x16x32_bf16 a[196:199], a[28:31], a[48:51], a[196:199]
  ds_read_b128 a[24:27], v25 offset:2048
  ds_read_b64_tr_b16 a[0:1], v24 offset:0
  v_mfma_f32_16x16x32_bf16 a[200:203], a[28:31], a[52:55], a[200:203]
  ds_read_b64_tr_b16 a[2:3], v24 offset:512
  buffer_load_dwordx4 v10, s[28:31], s58 offen lds
  v_mfma_f32_16x16x32_bf16 a[204:207], a[32:35], a[44:47], a[204:207]
  ds_read_b64_tr_b16 a[4:5], v24 offset:32
  ds_read_b64_tr_b16 a[6:7], v24 offset:544
  v_mfma_f32_16x16x32_bf16 a[208:211], a[32:35], a[48:51], a[208:211]
  ds_read_b64_tr_b16 a[8:9], v24 offset:64
  buffer_load_dwordx4 v11, s[28:31], s58 offen offset:1024 lds
  v_mfma_f32_16x16x32_bf16 a[212:215], a[32:35], a[52:55], a[212:215]
  s_add_u32 s58, s58, 8192
  ds_read_b64_tr_b16 a[10:11], v24 offset:576
  ds_read_b64_tr_b16 a[12:13], v24 offset:96
  v_mfma_f32_16x16x32_bf16 a[216:219], a[36:39], a[44:47], a[216:219]
  s_add_u32 m0, s57, 116480
  ds_read_b64_tr_b16 a[14:15], v24 offset:608
  v_mfma_f32_16x16x32_bf16 a[220:223], a[36:39], a[48:51], a[220:223]
  buffer_load_dwordx4 v12, s[32:35], s59 offen lds
  v_mfma_f32_16x16x32_bf16 a[224:227], a[36:39], a[52:55], a[224:227]
  buffer_load_dwordx4 v13, s[32:35], s59 offen offset:1056 lds
  v_mfma_f32_16x16x32_bf16 a[228:231], a[40:43], a[44:47], a[228:231]
  s_add_u32 s59, s59, 8192
  v_permlane16_swap_b32 v252, v254
  v_mfma_f32_16x16x32_bf16 a[232:235], a[40:43], a[48:51], a[232:235]
  v_permlane16_swap_b32 v253, v255
  v_mfma_f32_16x16x32_bf16 a[236:239], a[40:43], a[52:55], a[236:239]
  s_waitcnt lgkmcnt(0)
  v_mfma_f32_16x16x32_bf16 a[192:195], a[0:3], a[16:19], a[192:195]
  s_add_u32 m0, s56, 124928
  ds_read_b128 a[44:47], v25 offset:6144
  ds_read_b128 a[48:51], v25 offset:7168
  v_mfma_f32_16x16x32_bf16 a[196:199], a[0:3], a[20:23], a[196:199]
  ds_read_b128 a[52:55], v25 offset:8192
  ds_read_b64_tr_b16 a[28:29], v24 offset:8448
  v_mfma_f32_16x16x32_bf16 a[200:203], a[0:3], a[24:27], a[200:203]
  ds_read_b64_tr_b16 a[30:31], v24 offset:8960
  buffer_load_dwordx4 v10, s[28:31], s58 offen lds
  v_mfma_f32_16x16x32_bf16 a[204:207], a[4:7], a[16:19], a[204:207]
  ds_read_b64_tr_b16 a[32:33], v24 offset:8480
  ds_read_b64_tr_b16 a[34:35], v24 offset:8992
  v_mfma_f32_16x16x32_bf16 a[208:211], a[4:7], a[20:23], a[208:211]
  ds_read_b64_tr_b16 a[36:37], v24 offset:8512
  buffer_load_dwordx4 v11, s[28:31], s58 offen offset:1024 lds
  v_mfma_f32_16x16x32_bf16 a[212:215], a[4:7], a[24:27], a[212:215]
  s_add_u32 s58, s58, 8192
  ds_read_b64_tr_b16 a[38:39], v24 offset:9024
  ds_read_b64_tr_b16 a[40:41], v24 offset:8544
  v_mfma_f32_16x16x32_bf16 a[216:219], a[8:11], a[16:19], a[216:219]
  s_add_u32 m0, s57, 133120
  ds_read_b64_tr_b16 a[42:43], v24 offset:9056
  v_add_u32 v48, 49920, v14
  v_mfma_f32_16x16x32_bf16 a[220:223], a[8:11], a[20:23], a[220:223]
  s_mov_b32 s93, s92
  s_add_u32 s92, s92, 29184
  buffer_load_dwordx4 v12, s[32:35], s59 offen lds
  v_mfma_f32_16x16x32_bf16 a[224:227], a[8:11], a[24:27], a[224:227]
  s_cmp_eq_u32 s92, 145920
  s_cselect_b32 s92, 0, s92
  buffer_load_dwordx4 v13, s[32:35], s59 offen offset:1056 lds
  v_mfma_f32_16x16x32_bf16 a[228:231], a[12:15], a[16:19], a[228:231]
  s_add_u32 s59, s59, 8192
  v_add_u32 v24, s92, v26
  v_add_u32 v49, 49920, v15
  v_mfma_f32_16x16x32_bf16 a[232:235], a[12:15], a[20:23], a[232:235]
  v_add_u32 v25, s92, v27
  v_add_u32 v50, 49920, v16
  v_mfma_f32_16x16x32_bf16 a[236:239], a[12:15], a[24:27], a[236:239]
  s_waitcnt vmcnt(14) lgkmcnt(0)
  s_barrier
  v_mfma_f32_16x16x32_bf16 a[192:195], a[28:31], a[44:47], a[192:195]
  s_add_u32 m0, s56, 141568
  ds_read_b128 a[16:19], v25 offset:0
  ds_read_b128 a[20:23], v25 offset:1024
  v_add_u32 v51, 49920, v17
  v_mfma_f32_16x16x32_bf16 a[196:199], a[28:31], a[48:51], a[196:199]
  ds_read_b128 a[24:27], v25 offset:2048
  ds_read_b64_tr_b16 a[0:1], v24 offset:0
  v_add_u32 v52, 49920, v18
  v_mfma_f32_16x16x32_bf16 a[200:203], a[28:31], a[52:55], a[200:203]
  s_lshl_b32 s3, s8, 2
  s_and_b32 s4, s18, 1
  ds_read_b64_tr_b16 a[2:3], v24 offset:512
  buffer_load_dwordx4 v10, s[28:31], s58 offen lds
  v_mfma_f32_16x16x32_bf16 a[204:207], a[32:35], a[44:47], a[204:207]
  s_lshl_b32 s4, s4, 1
  s_add_u32 s3, s3, s4
  ds_read_b64_tr_b16 a[4:5], v24 offset:32
  ds_read_b64_tr_b16 a[6:7], v24 offset:544
  v_mfma_f32_16x16x32_bf16 a[208:211], a[32:35], a[48:51], a[208:211]
  s_mul_i32 s3, s3, 36
  s_mul_i32 s4, s9, 6
  ds_read_b64_tr_b16 a[8:9], v24 offset:64
  buffer_load_dwordx4 v11, s[28:31], s58 offen offset:1024 lds
  v_mfma_f32_16x16x32_bf16 a[212:215], a[32:35], a[52:55], a[212:215]
  s_add_u32 s58, s58, 8192
  s_add_u32 s3, s3, s4
  ds_read_b64_tr_b16 a[10:11], v24 offset:576
  ds_read_b64_tr_b16 a[12:13], v24 offset:96
  v_mfma_f32_16x16x32_bf16 a[216:219], a[36:39], a[44:47], a[216:219]
  s_add_u32 m0, s57, 149760
  s_lshr_b32 s4, s18, 1
  s_mul_i32 s4, s4, 3
  ds_read_b64_tr_b16 a[14:15], v24 offset:608
  v_mfma_f32_16x16x32_bf16 a[220:223], a[36:39], a[48:51], a[220:223]
  s_add_u32 s3, s3, s4
  s_lshl_b32 s3, s3, 10
  s_add_u32 s3, s3, 16777216
  buffer_load_dwordx4 v12, s[32:35], s59 offen lds
  v_mfma_f32_16x16x32_bf16 a[224:227], a[36:39], a[52:55], a[224:227]
  buffer_load_dwordx4 v13, s[32:35], s59 offen offset:1056 lds
  v_add_u32 v20, s3, v3
  v_add_u32 v21, 36864, v20
  v_mfma_f32_16x16x32_bf16 a[228:231], a[40:43], a[44:47], a[228:231]
  s_add_u32 s59, s59, 8192
  v_mov_b32 v56, 0xbdd2d3e8
  v_mov_b32 v57, 0xc0135761
  v_mov_b32 v58, 1.0
  v_mfma_f32_16x16x32_bf16 a[232:235], a[40:43], a[48:51], a[232:235]
  v_mfma_f32_16x16x32_bf16 a[236:239], a[40:43], a[52:55], a[236:239]
  s_waitcnt lgkmcnt(0)
  v_mfma_f32_16x16x32_bf16 a[192:195], a[0:3], a[16:19], a[192:195]
  ds_read_b128 a[44:47], v25 offset:6144
  ds_read_b128 a[48:51], v25 offset:7168
  v_mfma_f32_16x16x32_bf16 a[196:199], a[0:3], a[20:23], a[196:199]
  ds_read_b128 a[52:55], v25 offset:8192
  ds_read_b64_tr_b16 a[28:29], v24 offset:8448
  v_mfma_f32_16x16x32_bf16 a[200:203], a[0:3], a[24:27], a[200:203]
  ds_read_b64_tr_b16 a[30:31], v24 offset:8960
  v_mfma_f32_16x16x32_bf16 a[204:207], a[4:7], a[16:19], a[204:207]
  ds_read_b64_tr_b16 a[32:33], v24 offset:8480
  ds_read_b64_tr_b16 a[34:35], v24 offset:8992
  v_mfma_f32_16x16x32_bf16 a[208:211], a[4:7], a[20:23], a[208:211]
  ds_read_b64_tr_b16 a[36:37], v24 offset:8512
  v_mfma_f32_16x16x32_bf16 a[212:215], a[4:7], a[24:27], a[212:215]
  ds_read_b64_tr_b16 a[38:39], v24 offset:9024
  ds_read_b64_tr_b16 a[40:41], v24 offset:8544
  v_mfma_f32_16x16x32_bf16 a[216:219], a[8:11], a[16:19], a[216:219]
  ds_read_b64_tr_b16 a[42:43], v24 offset:9056
  v_mfma_f32_16x16x32_bf16 a[220:223], a[8:11], a[20:23], a[220:223]
  s_mov_b32 s93, s92
  s_add_u32 s92, s92, 29184
  v_mfma_f32_16x16x32_bf16 a[224:227], a[8:11], a[24:27], a[224:227]
  s_cmp_eq_u32 s92, 145920
  s_cselect_b32 s92, 0, s92
  v_mfma_f32_16x16x32_bf16 a[228:231], a[12:15], a[16:19], a[228:231]
  v_add_u32 v24, s92, v26
  v_mfma_f32_16x16x32_bf16 a[232:235], a[12:15], a[20:23], a[232:235]
  v_add_u32 v25, s92, v27
  v_mfma_f32_16x16x32_bf16 a[236:239], a[12:15], a[24:27], a[236:239]
  s_waitcnt lgkmcnt(0)
  s_barrier
  v_mfma_f32_16x16x32_bf16 a[192:195], a[28:31], a[44:47], a[192:195]
  v_mfma_f32_16x16x32_bf16 a[196:199], a[28:31], a[48:51], a[196:199]
  v_mfma_f32_16x16x32_bf16 a[200:203], a[28:31], a[52:55], a[200:203]
  v_mfma_f32_16x16x32_bf16 a[204:207], a[32:35], a[44:47], a[204:207]
  v_mfma_f32_16x16x32_bf16 a[208:211], a[32:35], a[48:51], a[208:211]
  v_mfma_f32_16x16x32_bf16 a[212:215], a[32:35], a[52:55], a[212:215]
  v_mfma_f32_16x16x32_bf16 a[216:219], a[36:39], a[44:47], a[216:219]
  v_mfma_f32_16x16x32_bf16 a[220:223], a[36:39], a[48:51], a[220:223]
  v_mfma_f32_16x16x32_bf16 a[224:227], a[36:39], a[52:55], a[224:227]
  v_mfma_f32_16x16x32_bf16 a[228:231], a[40:43], a[44:47], a[228:231]
  v_mfma_f32_16x16x32_bf16 a[232:235], a[40:43], a[48:51], a[232:235]
  v_mfma_f32_16x16x32_bf16 a[236:239], a[40:43], a[52:55], a[236:239]
  s_nop 4
  v_accvgpr_read_b32 v96, a192
  v_accvgpr_read_b32 v97, a193
  v_accvgpr_read_b32 v98, a194
  v_accvgpr_read_b32 v99, a195
  v_accvgpr_read_b32 v100, a204
  v_accvgpr_read_b32 v101, a205
  v_accvgpr_read_b32 v102, a206
  v_accvgpr_read_b32 v103, a207
  v_pk_mul_f32 v[104:105], v[96:97], v[96:97]
  v_pk_mul_f32 v[106:107], v[98:99], v[98:99]
  v_pk_mul_f32 v[108:109], v[100:101], v[100:101]
  v_pk_mul_f32 v[110:111], v[102:103], v[102:103]
  v_pk_fma_f32 v[104:105], v[104:105], v[56:57], v[56:57] op_sel:[0,0,1] op_sel_hi:[1,0,1]
  v_pk_fma_f32 v[106:107], v[106:107], v[56:57], v[56:57] op_sel:[0,0,1] op_sel_hi:[1,0,1]
  v_pk_fma_f32 v[108:109], v[108:109], v[56:57], v[56:57] op_sel:[0,0,1] op_sel_hi:[1,0,1]
  v_pk_fma_f32 v[110:111], v[110:111], v[56:57], v[56:57] op_sel:[0,0,1] op_sel_hi:[1,0,1]
  v_pk_mul_f32 v[104:105], v[104:105], v[96:97]
  v_pk_mul_f32 v[106:107], v[106:107], v[98:99]
  v_pk_mul_f32 v[108:109], v[108:109], v[100:101]
  v_pk_mul_f32 v[110:111], v[110:111], v[102:103]
  v_exp_f32 v104, v104
  v_exp_f32 v105, v105
  v_exp_f32 v106, v106
  v_exp_f32 v107, v107
  v_exp_f32 v108, v108
  v_exp_f32 v109, v109
  v_exp_f32 v110, v110
  v_exp_f32 v111, v111
  v_pk_add_f32 v[104:105], v[104:105], v[58:59] op_sel_hi:[1,0]
  v_pk_add_f32 v[106:107], v[106:107], v[58:59] op_sel_hi:[1,0]
  v_pk_add_f32 v[108:109], v[108:109], v[58:59] op_sel_hi:[1,0]
  v_pk_add_f32 v[110:111], v[110:111], v[58:59] op_sel_hi:[1,0]
  v_rcp_f32 v104, v104
  v_rcp_f32 v105, v105
  v_rcp_f32 v106, v106
  v_rcp_f32 v107, v107
  v_rcp_f32 v108, v108
  v_rcp_f32 v109, v109
  v_rcp_f32 v110, v110
  v_rcp_f32 v111, v111
  v_pk_mul_f32 v[104:105], v[104:105], v[96:97]
  v_pk_mul_f32 v[106:107], v[106:107], v[98:99]
  v_pk_mul_f32 v[108:109], v[108:109], v[100:101]
  v_pk_mul_f32 v[110:111], v[110:111], v[102:103]
  v_cvt_pk_bf16_f32 v112, v104, v105
  v_cvt_pk_bf16_f32 v113, v106, v107
  v_cvt_pk_bf16_f32 v114, v108, v109
  v_cvt_pk_bf16_f32 v115, v110, v111
  buffer_store_dwordx4 v[112:115], v20, s[12:15], 0 offen offset:0 sc1
  v_accvgpr_read_b32 v96, a196
  v_accvgpr_read_b32 v97, a197
  v_accvgpr_read_b32 v98, a198
  v_accvgpr_read_b32 v99, a199
  v_accvgpr_read_b32 v100, a208
  v_accvgpr_read_b32 v101, a209
  v_accvgpr_read_b32 v102, a210
  v_accvgpr_read_b32 v103, a211
  v_pk_mul_f32 v[104:105], v[96:97], v[96:97]
  v_pk_mul_f32 v[106:107], v[98:99], v[98:99]
  v_pk_mul_f32 v[108:109], v[100:101], v[100:101]
  v_pk_mul_f32 v[110:111], v[102:103], v[102:103]
  v_pk_fma_f32 v[104:105], v[104:105], v[56:57], v[56:57] op_sel:[0,0,1] op_sel_hi:[1,0,1]
  v_pk_fma_f32 v[106:107], v[106:107], v[56:57], v[56:57] op_sel:[0,0,1] op_sel_hi:[1,0,1]
  v_pk_fma_f32 v[108:109], v[108:109], v[56:57], v[56:57] op_sel:[0,0,1] op_sel_hi:[1,0,1]
  v_pk_fma_f32 v[110:111], v[110:111], v[56:57], v[56:57] op_sel:[0,0,1] op_sel_hi:[1,0,1]
  v_pk_mul_f32 v[104:105], v[104:105], v[96:97]
  v_pk_mul_f32 v[106:107], v[106:107], v[98:99]
  v_pk_mul_f32 v[108:109], v[108:109], v[100:101]
  v_pk_mul_f32 v[110:111], v[110:111], v[102:103]
  v_exp_f32 v104, v104
  v_exp_f32 v105, v105
  v_exp_f32 v106, v106
  v_exp_f32 v107, v107
  v_exp_f32 v108, v108
  v_exp_f32 v109, v109
  v_exp_f32 v110, v110
  v_exp_f32 v111, v111
  v_pk_add_f32 v[104:105], v[104:105], v[58:59] op_sel_hi:[1,0]
  v_pk_add_f32 v[106:107], v[106:107], v[58:59] op_sel_hi:[1,0]
  v_pk_add_f32 v[108:109], v[108:109], v[58:59] op_sel_hi:[1,0]
  v_pk_add_f32 v[110:111], v[110:111], v[58:59] op_sel_hi:[1,0]
  v_rcp_f32 v104, v104
  v_rcp_f32 v105, v105
  v_rcp_f32 v106, v106
  v_rcp_f32 v107, v107
  v_rcp_f32 v108, v108
  v_rcp_f32 v109, v109
  v_rcp_f32 v110, v110
  v_rcp_f32 v111, v111
  v_pk_mul_f32 v[104:105], v[104:105], v[96:97]
  v_pk_mul_f32 v[106:107], v[106:107], v[98:99]
  v_pk_mul_f32 v[108:109], v[108:109], v[100:101]
  v_pk_mul_f32 v[110:111], v[110:111], v[102:103]
  v_cvt_pk_bf16_f32 v112, v104, v105
TP_7:
  s_cbranch_execz TR_1
  v_cvt_pk_bf16_f32 v113, v106, v107
  v_cvt_pk_bf16_f32 v114, v108, v109
  v_cvt_pk_bf16_f32 v115, v110, v111
  buffer_store_dwordx4 v[112:115], v20, s[12:15], 0 offen offset:1024 sc1
  v_accvgpr_read_b32 v96, a200
  v_accvgpr_read_b32 v97, a201
  v_accvgpr_read_b32 v98, a202
  v_accvgpr_read_b32 v99, a203
  v_accvgpr_read_b32 v100, a212
  v_accvgpr_read_b32 v101, a213
  v_accvgpr_read_b32 v102, a214
  v_accvgpr_read_b32 v103, a215
  v_pk_mul_f32 v[104:105], v[96:97], v[96:97]
  v_pk_mul_f32 v[106:107], v[98:99], v[98:99]
  v_pk_mul_f32 v[108:109], v[100:101], v[100:101]
  v_pk_mul_f32 v[110:111], v[102:103], v[102:103]
  v_pk_fma_f32 v[104:105], v[104:105], v[56:57], v[56:57] op_sel:[0,0,1] op_sel_hi:[1,0,1]
  v_pk_fma_f32 v[106:107], v[106:107], v[56:57], v[56:57] op_sel:[0,0,1] op_sel_hi:[1,0,1]
  v_pk_fma_f32 v[108:109], v[108:109], v[56:57], v[56:57] op_sel:[0,0,1] op_sel_hi:[1,0,1]
  v_pk_fma_f32 v[110:111], v[110:111], v[56:57], v[56:57] op_sel:[0,0,1] op_sel_hi:[1,0,1]
  v_pk_mul_f32 v[104:105], v[104:105], v[96:97]
  v_pk_mul_f32 v[106:107], v[106:107], v[98:99]
  v_pk_mul_f32 v[108:109], v[108:109], v[100:101]
  v_pk_mul_f32 v[110:111], v[110:111], v[102:103]
  v_exp_f32 v104, v104
  v_exp_f32 v105, v105
  v_exp_f32 v106, v106
  v_exp_f32 v107, v107
  v_exp_f32 v108, v108
  v_exp_f32 v109, v109
  v_exp_f32 v110, v110
  v_exp_f32 v111, v111
  v_pk_add_f32 v[104:105], v[104:105], v[58:59] op_sel_hi:[1,0]
  v_pk_add_f32 v[106:107], v[106:107], v[58:59] op_sel_hi:[1,0]
  v_pk_add_f32 v[108:109], v[108:109], v[58:59] op_sel_hi:[1,0]
  v_pk_add_f32 v[110:111], v[110:111], v[58:59] op_sel_hi:[1,0]
  v_rcp_f32 v104, v104
  v_rcp_f32 v105, v105
  v_rcp_f32 v106, v106
  v_rcp_f32 v107, v107
  v_rcp_f32 v108, v108
  v_rcp_f32 v109, v109
  v_rcp_f32 v110, v110
  v_rcp_f32 v111, v111
  v_pk_mul_f32 v[104:105], v[104:105], v[96:97]
  v_pk_mul_f32 v[106:107], v[106:107], v[98:99]
  v_pk_mul_f32 v[108:109], v[108:109], v[100:101]
  v_pk_mul_f32 v[110:111], v[110:111], v[102:103]
  v_cvt_pk_bf16_f32 v112, v104, v105
  v_cvt_pk_bf16_f32 v113, v106, v107
  v_cvt_pk_bf16_f32 v114, v108, v109
  v_cvt_pk_bf16_f32 v115, v110, v111
  buffer_store_dwordx4 v[112:115], v20, s[12:15], 0 offen offset:2048 sc1
  v_accvgpr_read_b32 v96, a216
  v_accvgpr_read_b32 v97, a217
  v_accvgpr_read_b32 v98, a218
  v_accvgpr_read_b32 v99, a219
  v_accvgpr_read_b32 v100, a228
  v_accvgpr_read_b32 v101, a229
  v_accvgpr_read_b32 v102, a230
  v_accvgpr_read_b32 v103, a231
  v_pk_mul_f32 v[104:105], v[96:97], v[96:97]
  v_pk_mul_f32 v[106:107], v[98:99], v[98:99]
  v_pk_mul_f32 v[108:109], v[100:101], v[100:101]
  v_pk_mul_f32 v[110:111], v[102:103], v[102:103]
  v_pk_fma_f32 v[104:105], v[104:105], v[56:57], v[56:57] op_sel:[0,0,1] op_sel_hi:[1,0,1]
  v_pk_fma_f32 v[106:107], v[106:107], v[56:57], v[56:57] op_sel:[0,0,1] op_sel_hi:[1,0,1]
  v_pk_fma_f32 v[108:109], v[108:109], v[56:57], v[56:57] op_sel:[0,0,1] op_sel_hi:[1,0,1]
  v_pk_fma_f32 v[110:111], v[110:111], v[56:57], v[56:57] op_sel:[0,0,1] op_sel_hi:[1,0,1]
  v_pk_mul_f32 v[104:105], v[104:105], v[96:97]
  v_pk_mul_f32 v[106:107], v[106:107], v[98:99]
  v_pk_mul_f32 v[108:109], v[108:109], v[100:101]
  v_pk_mul_f32 v[110:111], v[110:111], v[102:103]
  v_exp_f32 v104, v104
  v_exp_f32 v105, v105
  v_exp_f32 v106, v106
  v_exp_f32 v107, v107
  v_exp_f32 v108, v108
  v_exp_f32 v109, v109
  v_exp_f32 v110, v110
  v_exp_f32 v111, v111
  v_pk_add_f32 v[104:105], v[104:105], v[58:59] op_sel_hi:[1,0]
  v_pk_add_f32 v[106:107], v[106:107], v[58:59] op_sel_hi:[1,0]
  v_pk_add_f32 v[108:109], v[108:109], v[58:59] op_sel_hi:[1,0]
  v_pk_add_f32 v[110:111], v[110:111], v[58:59] op_sel_hi:[1,0]
  v_rcp_f32 v104, v104
  v_rcp_f32 v105, v105
  v_rcp_f32 v106, v106
  v_rcp_f32 v107, v107
  v_rcp_f32 v108, v108
  v_rcp_f32 v109, v109
  v_rcp_f32 v110, v110
  v_rcp_f32 v111, v111
  v_pk_mul_f32 v[104:105], v[104:105], v[96:97]
  v_pk_mul_f32 v[106:107], v[106:107], v[98:99]
  v_pk_mul_f32 v[108:109], v[108:109], v[100:101]
  v_pk_mul_f32 v[110:111], v[110:111], v[102:103]
  v_cvt_pk_bf16_f32 v112, v104, v105
  v_cvt_pk_bf16_f32 v113, v106, v107
  v_cvt_pk_bf16_f32 v114, v108, v109
  v_cvt_pk_bf16_f32 v115, v110, v111
  buffer_store_dwordx4 v[112:115], v21, s[12:15], 0 offen offset:0 sc1
  v_accvgpr_read_b32 v96, a220
  v_accvgpr_read_b32 v97, a221
  v_accvgpr_read_b32 v98, a222
  v_accvgpr_read_b32 v99, a223
  v_accvgpr_read_b32 v100, a232
  v_accvgpr_read_b32 v101, a233
  v_accvgpr_read_b32 v102, a234
  v_accvgpr_read_b32 v103, a235
  v_pk_mul_f32 v[104:105], v[96:97], v[96:97]
  v_pk_mul_f32 v[106:107], v[98:99], v[98:99]
  v_pk_mul_f32 v[108:109], v[100:101], v[100:101]
  v_pk_mul_f32 v[110:111], v[102:103], v[102:103]
  v_pk_fma_f32 v[104:105], v[104:105], v[56:57], v[56:57] op_sel:[0,0,1] op_sel_hi:[1,0,1]
  v_pk_fma_f32 v[106:107], v[106:107], v[56:57], v[56:57] op_sel:[0,0,1] op_sel_hi:[1,0,1]
  v_pk_fma_f32 v[108:109], v[108:109], v[56:57], v[56:57] op_sel:[0,0,1] op_sel_hi:[1,0,1]
  v_pk_fma_f32 v[110:111], v[110:111], v[56:57], v[56:57] op_sel:[0,0,1] op_sel_hi:[1,0,1]
  v_pk_mul_f32 v[104:105], v[104:105], v[96:97]
  v_pk_mul_f32 v[106:107], v[106:107], v[98:99]
  v_pk_mul_f32 v[108:109], v[108:109], v[100:101]
  v_pk_mul_f32 v[110:111], v[110:111], v[102:103]
  v_exp_f32 v104, v104
  v_exp_f32 v105, v105
  v_exp_f32 v106, v106
  v_exp_f32 v107, v107
  v_exp_f32 v108, v108
  v_exp_f32 v109, v109
  v_exp_f32 v110, v110
  v_exp_f32 v111, v111
  v_pk_add_f32 v[104:105], v[104:105], v[58:59] op_sel_hi:[1,0]
  v_pk_add_f32 v[106:107], v[106:107], v[58:59] op_sel_hi:[1,0]
  v_pk_add_f32 v[108:109], v[108:109], v[58:59] op_sel_hi:[1,0]
  v_pk_add_f32 v[110:111], v[110:111], v[58:59] op_sel_hi:[1,0]
  v_rcp_f32 v104, v104
  v_rcp_f32 v105, v105
  v_rcp_f32 v106, v106
  v_rcp_f32 v107, v107
  v_rcp_f32 v108, v108
  v_rcp_f32 v109, v109
  v_rcp_f32 v110, v110
  v_rcp_f32 v111, v111
  v_pk_mul_f32 v[104:105], v[104:105], v[96:97]
  v_pk_mul_f32 v[106:107], v[106:107], v[98:99]
  v_pk_mul_f32 v[108:109], v[108:109], v[100:101]
  v_pk_mul_f32 v[110:111], v[110:111], v[102:103]
  v_cvt_pk_bf16_f32 v112, v104, v105
  v_cvt_pk_bf16_f32 v113, v106, v107
  v_cvt_pk_bf16_f32 v114, v108, v109
  v_cvt_pk_bf16_f32 v115, v110, v111
  buffer_store_dwordx4 v[112:115], v21, s[12:15], 0 offen offset:1024 sc1
  v_accvgpr_read_b32 v96, a224
  v_accvgpr_read_b32 v97, a225
  v_accvgpr_read_b32 v98, a226
  v_accvgpr_read_b32 v99, a227
  v_accvgpr_read_b32 v100, a236
  v_accvgpr_read_b32 v101, a237
  v_accvgpr_read_b32 v102, a238
  v_accvgpr_read_b32 v103, a239
  v_pk_mul_f32 v[104:105], v[96:97], v[96:97]
  v_pk_mul_f32 v[106:107], v[98:99], v[98:99]
  v_pk_mul_f32 v[108:109], v[100:101], v[100:101]
  v_pk_mul_f32 v[110:111], v[102:103], v[102:103]
  v_pk_fma_f32 v[104:105], v[104:105], v[56:57], v[56:57] op_sel:[0,0,1] op_sel_hi:[1,0,1]
  v_pk_fma_f32 v[106:107], v[106:107], v[56:57], v[56:57] op_sel:[0,0,1] op_sel_hi:[1,0,1]
  v_pk_fma_f32 v[108:109], v[108:109], v[56:57], v[56:57] op_sel:[0,0,1] op_sel_hi:[1,0,1]
  v_pk_fma_f32 v[110:111], v[110:111], v[56:57], v[56:57] op_sel:[0,0,1] op_sel_hi:[1,0,1]
  v_pk_mul_f32 v[104:105], v[104:105], v[96:97]
  v_pk_mul_f32 v[106:107], v[106:107], v[98:99]
  v_pk_mul_f32 v[108:109], v[108:109], v[100:101]
  v_pk_mul_f32 v[110:111], v[110:111], v[102:103]
  v_exp_f32 v104, v104
  v_exp_f32 v105, v105
  v_exp_f32 v106, v106
  v_exp_f32 v107, v107
  v_exp_f32 v108, v108
  v_exp_f32 v109, v109
  v_exp_f32 v110, v110
  v_exp_f32 v111, v111
  v_pk_add_f32 v[104:105], v[104:105], v[58:59] op_sel_hi:[1,0]
  v_pk_add_f32 v[106:107], v[106:107], v[58:59] op_sel_hi:[1,0]
  v_pk_add_f32 v[108:109], v[108:109], v[58:59] op_sel_hi:[1,0]
  v_pk_add_f32 v[110:111], v[110:111], v[58:59] op_sel_hi:[1,0]
  v_rcp_f32 v104, v104
  v_rcp_f32 v105, v105
  v_rcp_f32 v106, v106
  v_rcp_f32 v107, v107
  v_rcp_f32 v108, v108
  v_rcp_f32 v109, v109
  v_rcp_f32 v110, v110
  v_rcp_f32 v111, v111
  v_pk_mul_f32 v[104:105], v[104:105], v[96:97]
  v_pk_mul_f32 v[106:107], v[106:107], v[98:99]
  v_pk_mul_f32 v[108:109], v[108:109], v[100:101]
  v_pk_mul_f32 v[110:111], v[110:111], v[102:103]
  v_cvt_pk_bf16_f32 v112, v104, v105
  v_cvt_pk_bf16_f32 v113, v106, v107
  v_cvt_pk_bf16_f32 v114, v108, v109
  v_cvt_pk_bf16_f32 v115, v110, v111
  buffer_store_dwordx4 v[112:115], v21, s[12:15], 0 offen offset:2048 sc1
K_core:
  s_waitcnt vmcnt(12)
  s_barrier
  v_add_u32 v4, 16640, v14
  v_add_u32 v5, 16640, v15
  v_add_u32 v6, 16640, v16
  v_add_u32 v7, 16640, v17
  ds_read_b128 a[160:163], v4 offset:0
  ds_read_b128 a[164:167], v5 offset:0
  ds_read_b128 a[168:171], v6 offset:0
  ds_read_b128 a[172:175], v7 offset:0
  ds_read_b128 a[176:179], v4 offset:4096
  ds_read_b128 a[180:183], v5 offset:4096
  ds_read_b128 a[184:187], v6 offset:4096
  ds_read_b128 a[188:191], v7 offset:4096
  v_mov_b32 v60, 0
  v_mov_b32 v61, 0
  v_mov_b32 v62, 0
  v_mov_b32 v63, 0
  s_mov_b64 exec, 0
  s_cmp_eq_u32 s18, 0
  s_cbranch_scc1 TP_8
  s_cmp_eq_u32 s18, 1
  s_cbranch_scc1 TP_9
  s_cmp_eq_u32 s18, 2
  s_cbranch_scc1 TP_10
  s_branch TP_11
TR_2:
  s_mov_b64 exec, -1
  s_waitcnt lgkmcnt(0)
  v_mfma_f32_16x16x32_bf16 v[64:67], a[160:163], v[192:195], 0
  s_add_u32 m0, s56, 58368
  ds_read_b128 a[128:131], v14 offset:33280
  v_mfma_f32_16x16x32_bf16 v[68:71], a[160:163], v[208:211], 0
  v_mfma_f32_16x16x32_bf16 v[72:75], a[160:163], v[224:227], 0
  v_mfma_f32_16x16x32_bf16 v[76:79], a[160:163], v[240:243], 0
  ds_read_b128 a[132:135], v15 offset:33280
  buffer_load_dwordx4 v10, s[28:31], s58 offen lds
  v_mfma_f32_16x16x32_bf16 v[64:67], a[164:167], v[196:199], v[64:67]
  v_mfma_f32_16x16x32_bf16 v[68:71], a[164:167], v[212:215], v[68:71]
  v_mfma_f32_16x16x32_bf16 v[72:75], a[164:167], v[228:231], v[72:75]
  ds_read_b128 a[136:139], v16 offset:33280
  v_mfma_f32_16x16x32_bf16 v[76:79], a[164:167], v[244:247], v[76:79]
  buffer_load_dwordx4 v11, s[28:31], s58 offen offset:1024 lds
  v_mfma_f32_16x16x32_bf16 v[64:67], a[168:171], v[200:203], v[64:67]
  v_mfma_f32_16x16x32_bf16 v[68:71], a[168:171], v[216:219], v[68:71]
  ds_read_b128 a[140:143], v17 offset:33280
  v_mfma_f32_16x16x32_bf16 v[72:75], a[168:171], v[232:235], v[72:75]
  s_add_u32 s58, s58, 8192
  v_mfma_f32_16x16x32_bf16 v[76:79], a[168:171], v[248:251], v[76:79]
  v_mfma_f32_16x16x32_bf16 v[64:67], a[172:175], v[204:207], v[64:67]
  ds_read_b128 a[144:147], v14 offset:37376
  v_mfma_f32_16x16x32_bf16 v[68:71], a[172:175], v[220:223], v[68:71]
  v_mfma_f32_16x16x32_bf16 v[72:75], a[172:175], v[236:239], v[72:75]
  s_add_u32 m0, s57, 66560
  v_mfma_f32_16x16x32_bf16 v[76:79], a[172:175], v[252:255], v[76:79]
  ds_read_b128 a[148:151], v15 offset:37376
  v_mfma_f32_16x16x32_bf16 v[80:83], a[176:179], v[192:195], 0
  v_mfma_f32_16x16x32_bf16 v[84:87], a[176:179], v[208:211], 0
  v_mfma_f32_16x16x32_bf16 v[88:91], a[176:179], v[224:227], 0
  ds_read_b128 a[152:155], v16 offset:37376
  buffer_load_dwordx4 v12, s[32:35], s59 offen lds
  v_mfma_f32_16x16x32_bf16 v[92:95], a[176:179], v[240:243], 0
  v_mfma_f32_16x16x32_bf16 v[80:83], a[180:183], v[196:199], v[80:83]
  v_mfma_f32_16x16x32_bf16 v[84:87], a[180:183], v[212:215], v[84:87]
  ds_read_b128 a[156:159], v17 offset:37376
  buffer_load_dwordx4 v13, s[32:35], s59 offen offset:1056 lds
  v_mfma_f32_16x16x32_bf16 v[88:91], a[180:183], v[228:231], v[88:91]
  v_mfma_f32_16x16x32_bf16 v[92:95], a[180:183], v[244:247], v[92:95]
  v_mfma_f32_16x16x32_bf16 v[80:83], a[184:187], v[200:203], v[80:83]
  v_mfma_f32_16x16x32_bf16 v[84:87], a[184:187], v[216:219], v[84:87]
  s_add_u32 s59, s59, 8192
  v_mfma_f32_16x16x32_bf16 v[88:91], a[184:187], v[232:235], v[88:91]
  v_mfma_f32_16x16x32_bf16 v[92:95], a[184:187], v[248:251], v[92:95]
  v_mfma_f32_16x16x32_bf16 v[80:83], a[188:191], v[204:207], v[80:83]
  v_mfma_f32_16x16x32_bf16 v[84:87], a[188:191], v[220:223], v[84:87]
  v_mfma_f32_16x16x32_bf16 v[88:91], a[188:191], v[236:239], v[88:91]
  v_mfma_f32_16x16x32_bf16 v[92:95], a[188:191], v[252:255], v[92:95]
  s_waitcnt lgkmcnt(0)
  s_nop 6
  v_max3_f32 v40, v64, v65, v66
  v_max3_f32 v40, v40, v67, v80
  v_max3_f32 v40, v40, v81, v82
  v_max_f32 v40, v40, v83
  v_max3_f32 v41, v68, v69, v70
  v_max3_f32 v41, v41, v71, v84
  v_max3_f32 v41, v41, v85, v86
  v_max_f32 v41, v41, v87
  v_max3_f32 v42, v72, v73, v74
  v_max3_f32 v42, v42, v75, v88
  v_max3_f32 v42, v42, v89, v90
  v_max_f32 v42, v42, v91
  v_max3_f32 v43, v76, v77, v78
  v_max3_f32 v43, v43, v79, v92
  v_max3_f32 v43, v43, v93, v94
  v_max_f32 v43, v43, v95
  v_mov_b32 v44, v40
  v_mov_b32 v45, v41
  v_mov_b32 v46, v42
  v_mov_b32 v47, v43
  s_nop 0
  v_permlane16_swap_b32 v40, v44
  v_permlane16_swap_b32 v41, v45
  v_permlane16_swap_b32 v42, v46
  v_permlane16_swap_b32 v43, v47
  v_max_f32 v40, v40, v44
  v_max_f32 v41, v41, v45
  v_max_f32 v42, v42, v46
  v_max_f32 v43, v43, v47
  v_mov_b32 v44, v40
  v_mov_b32 v45, v41
  v_mov_b32 v46, v42
  v_mov_b32 v47, v43
  s_nop 0
  v_permlane32_swap_b32 v40, v44
  v_permlane32_swap_b32 v41, v45
  v_permlane32_swap_b32 v42, v46
  v_permlane32_swap_b32 v43, v47
  v_max_f32 v40, v40, v44
  v_max_f32 v41, v41, v45
  v_max_f32 v42, v42, v46
  v_max_f32 v43, v43, v47
  v_sub_f32 v160, 0xc2000000, v40
  v_sub_f32 v161, 0xc2000000, v40
  v_sub_f32 v162, 0xc2000000, v40
  v_sub_f32 v163, 0xc2000000, v40
  v_sub_f32 v164, 0xc2000000, v41
  v_sub_f32 v165, 0xc2000000, v41
  v_sub_f32 v166, 0xc2000000, v41
  v_sub_f32 v167, 0xc2000000, v41
  v_sub_f32 v168, 0xc2000000, v42
  v_sub_f32 v169, 0xc2000000, v42
  v_sub_f32 v170, 0xc2000000, v42
  v_sub_f32 v171, 0xc2000000, v42
  v_sub_f32 v172, 0xc2000000, v43
  v_sub_f32 v173, 0xc2000000, v43
  v_sub_f32 v174, 0xc2000000, v43
  v_sub_f32 v175, 0xc2000000, v43
  s_nop 0
  v_mfma_f32_16x16x32_bf16 v[96:99], a[128:131], v[192:195], v[160:163]
  ds_read_b64_tr_b16 a[160:161], v18 offset:41472
  v_add_f32 v64, v160, v64
  v_add_f32 v65, v160, v65
  v_add_f32 v66, v160, v66
  v_add_f32 v67, v160, v67
  v_mfma_f32_16x16x32_bf16 v[100:103], a[128:131], v[208:211], v[164:167]
  ds_read_b64_tr_b16 a[162:163], v18 offset:41984
  v_add_f32 v68, v164, v68
  v_add_f32 v69, v164, v69
  v_add_f32 v70, v164, v70
  v_add_f32 v71, v164, v71
  v_mfma_f32_16x16x32_bf16 v[104:107], a[128:131], v[224:227], v[168:171]
  v_add_f32 v72, v168, v72
  v_add_f32 v73, v168, v73
  v_add_f32 v74, v168, v74
  v_add_f32 v75, v168, v75
  v_add_f32 v76, v172, v76
  v_mfma_f32_16x16x32_bf16 v[108:111], a[128:131], v[240:243], v[172:175]
  ds_read_b64_tr_b16 a[164:165], v18 offset:41504
  v_add_f32 v77, v172, v77
  v_add_f32 v78, v172, v78
  v_add_f32 v79, v172, v79
  v_mfma_f32_16x16x32_bf16 v[96:99], a[132:135], v[196:199], v[96:99]
  ds_read_b64_tr_b16 a[166:167], v18 offset:42016
  v_exp_f32 v64, v64
  v_exp_f32 v65, v65
  v_mfma_f32_16x16x32_bf16 v[100:103], a[132:135], v[212:215], v[100:103]
  v_exp_f32 v66, v66
  v_exp_f32 v67, v67
  v_mfma_f32_16x16x32_bf16 v[104:107], a[132:135], v[228:231], v[104:107]
  ds_read_b64_tr_b16 a[168:169], v18 offset:41536
  v_exp_f32 v68, v68
  v_exp_f32 v69, v69
  v_mfma_f32_16x16x32_bf16 v[108:111], a[132:135], v[244:247], v[108:111]
  ds_read_b64_tr_b16 a[170:171], v18 offset:42048
  v_exp_f32 v70, v70
  v_exp_f32 v71, v71
  v_mfma_f32_16x16x32_bf16 v[96:99], a[136:139], v[200:203], v[96:99]
  v_exp_f32 v72, v72
  v_exp_f32 v73, v73
  v_mfma_f32_16x16x32_bf16 v[100:103], a[136:139], v[216:219], v[100:103]
  ds_read_b64_tr_b16 a[172:173], v18 offset:41568
  v_exp_f32 v74, v74
  v_exp_f32 v75, v75
  v_mfma_f32_16x16x32_bf16 v[104:107], a[136:139], v[232:235], v[104:107]
  ds_read_b64_tr_b16 a[174:175], v18 offset:42080
  v_exp_f32 v76, v76
  v_exp_f32 v77, v77
  v_mfma_f32_16x16x32_bf16 v[108:111], a[136:139], v[248:251], v[108:111]
  v_exp_f32 v78, v78
  v_exp_f32 v79, v79
  v_cvt_pk_bf16_f32 v128, v64, v65
  v_mfma_f32_16x16x32_bf16 v[96:99], a[140:143], v[204:207], v[96:99]
  ds_read_b64_tr_b16 a[176:177], v18 offset:41600
  v_cvt_pk_bf16_f32 v129, v66, v67
  v_cvt_pk_bf16_f32 v132, v68, v69
  v_cvt_pk_bf16_f32 v133, v70, v71
  v_cvt_pk_bf16_f32 v136, v72, v73
  v_mfma_f32_16x16x32_bf16 v[100:103], a[140:143], v[220:223], v[100:103]
  v_cvt_pk_bf16_f32 v137, v74, v75
  v_cvt_pk_bf16_f32 v140, v76, v77
  v_cvt_pk_bf16_f32 v141, v78, v79
  v_add_f32 v62, v62, v72
  v_add_f32 v62, v62, v73
  v_mfma_f32_16x16x32_bf16 v[104:107], a[140:143], v[236:239], v[104:107]
  ds_read_b64_tr_b16 a[178:179], v18 offset:42112
  v_add_f32 v62, v62, v74
  v_add_f32 v62, v62, v75
  v_add_f32 v63, v63, v76
  v_add_f32 v63, v63, v77
  v_mfma_f32_16x16x32_bf16 v[108:111], a[140:143], v[252:255], v[108:111]
  ds_read_b64_tr_b16 a[180:181], v18 offset:41632
  v_add_f32 v63, v63, v78
  v_add_f32 v63, v63, v79
  v_add_f32 v80, v160, v80
  v_add_f32 v81, v160, v81
  v_mfma_f32_16x16x32_bf16 v[112:115], a[144:147], v[192:195], v[160:163]
  v_add_f32 v82, v160, v82
  v_add_f32 v83, v160, v83
  v_add_f32 v84, v164, v84
  v_add_f32 v85, v164, v85
  v_add_f32 v86, v164, v86
  v_mfma_f32_16x16x32_bf16 v[116:119], a[144:147], v[208:211], v[164:167]
  ds_read_b64_tr_b16 a[182:183], v18 offset:42144
  v_add_f32 v87, v164, v87
  v_add_f32 v88, v168, v88
  v_add_f32 v89, v168, v89
  v_add_f32 v90, v168, v90
  v_mfma_f32_16x16x32_bf16 v[120:123], a[144:147], v[224:227], v[168:171]
  ds_read_b64_tr_b16 a[184:185], v18 offset:41664
  v_add_f32 v91, v168, v91
  v_add_f32 v92, v172, v92
  v_add_f32 v93, v172, v93
  v_add_f32 v94, v172, v94
  v_mfma_f32_16x16x32_bf16 v[124:127], a[144:147], v[240:243], v[172:175]
  v_add_f32 v95, v172, v95
  v_exp_f32 v80, v80
  v_exp_f32 v81, v81
  v_mfma_f32_16x16x32_bf16 v[112:115], a[148:151], v[196:199], v[112:115]
  ds_read_b64_tr_b16 a[186:187], v18 offset:42176
  v_exp_f32 v82, v82
  v_exp_f32 v83, v83
  v_mfma_f32_16x16x32_bf16 v[116:119], a[148:151], v[212:215], v[116:119]
  ds_read_b64_tr_b16 a[188:189], v18 offset:41696
  v_exp_f32 v84, v84
  v_exp_f32 v85, v85
  v_mfma_f32_16x16x32_bf16 v[120:123], a[148:151], v[228:231], v[120:123]
  v_exp_f32 v86, v86
  v_exp_f32 v87, v87
  v_mfma_f32_16x16x32_bf16 v[124:127], a[148:151], v[244:247], v[124:127]
  ds_read_b64_tr_b16 a[190:191], v18 offset:42208
  v_exp_f32 v88, v88
  v_exp_f32 v89, v89
  v_mfma_f32_16x16x32_bf16 v[112:115], a[152:155], v[200:203], v[112:115]
  v_exp_f32 v90, v90
  v_exp_f32 v91, v91
  v_mfma_f32_16x16x32_bf16 v[116:119], a[152:155], v[216:219], v[116:119]
  v_exp_f32 v92, v92
  v_exp_f32 v93, v93
  v_mfma_f32_16x16x32_bf16 v[120:123], a[152:155], v[232:235], v[120:123]
  v_exp_f32 v94, v94
  v_exp_f32 v95, v95
  v_cvt_pk_bf16_f32 v130, v80, v81
  v_mfma_f32_16x16x32_bf16 v[124:127], a[152:155], v[248:251], v[124:127]
  v_cvt_pk_bf16_f32 v131, v82, v83
  v_cvt_pk_bf16_f32 v134, v84, v85
  v_cvt_pk_bf16_f32 v135, v86, v87
  v_cvt_pk_bf16_f32 v138, v88, v89
  v_cvt_pk_bf16_f32 v139, v90, v91
  v_mfma_f32_16x16x32_bf16 v[112:115], a[156:159], v[204:207], v[112:115]
  v_cvt_pk_bf16_f32 v142, v92, v93
  v_cvt_pk_bf16_f32 v143, v94, v95
  v_add_f32 v62, v62, v88
  v_add_f32 v62, v62, v89
  v_add_f32 v62, v62, v90
  v_mfma_f32_16x16x32_bf16 v[116:119], a[156:159], v[220:223], v[116:119]
  v_add_f32 v62, v62, v91
  v_add_f32 v63, v63, v92
  v_add_f32 v63, v63, v93
  v_add_f32 v63, v63, v94
  v_add_f32 v63, v63, v95
  v_mfma_f32_16x16x32_bf16 v[120:123], a[156:159], v[236:239], v[120:123]
  v_mfma_f32_16x16x32_bf16 v[124:127], a[156:159], v[252:255], v[124:127]
  s_waitcnt vmcnt(12) lgkmcnt(0)
  s_barrier
  v_mfma_f32_16x16x32_bf16 v[176:179], v[36:39], v[128:131], 0
  s_add_u32 m0, s56, 75008
  v_exp_f32 v96, v96
  v_mfma_f32_16x16x32_bf16 v[180:183], v[36:39], v[132:135], 0
  ds_read_b128 a[128:131], v48 offset:0
  v_mfma_f32_16x16x32_bf16 a[0:3], a[160:163], v[128:131], 0
  v_exp_f32 v97, v97
  v_mfma_f32_16x16x32_bf16 a[4:7], a[160:163], v[132:135], 0
  ds_read_b128 a[132:135], v49 offset:0
  v_cvt_pk_bf16_f32 v144, v96, v97
  v_mfma_f32_16x16x32_bf16 a[8:11], a[160:163], v[136:139], 0
  v_exp_f32 v98, v98
  v_mfma_f32_16x16x32_bf16 a[12:15], a[160:163], v[140:143], 0
  buffer_load_dwordx4 v10, s[28:31], s58 offen lds
  v_mfma_f32_16x16x32_bf16 a[16:19], a[164:167], v[128:131], 0
  v_exp_f32 v99, v99
  v_mfma_f32_16x16x32_bf16 a[20:23], a[164:167], v[132:135], 0
  ds_read_b128 a[136:139], v50 offset:0
  v_cvt_pk_bf16_f32 v145, v98, v99
  v_mfma_f32_16x16x32_bf16 a[24:27], a[164:167], v[136:139], 0
  v_exp_f32 v100, v100
  v_mfma_f32_16x16x32_bf16 a[28:31], a[164:167], v[140:143], 0
  buffer_load_dwordx4 v11, s[28:31], s58 offen offset:1024 lds
  v_mfma_f32_16x16x32_bf16 a[32:35], a[168:171], v[128:131], 0
  s_add_u32 s58, s58, 8192
  v_exp_f32 v101, v101
  v_mfma_f32_16x16x32_bf16 a[36:39], a[168:171], v[132:135], 0
  ds_read_b128 a[140:143], v51 offset:0
  v_cvt_pk_bf16_f32 v148, v100, v101
  v_mfma_f32_16x16x32_bf16 a[40:43], a[168:171], v[136:139], 0
  s_add_u32 m0, s57, 83200
  v_exp_f32 v102, v102
  v_mfma_f32_16x16x32_bf16 a[44:47], a[168:171], v[140:143], 0
  v_mfma_f32_16x16x32_bf16 a[48:51], a[172:175], v[128:131], 0
  v_exp_f32 v103, v103
  v_mfma_f32_16x16x32_bf16 a[52:55], a[172:175], v[132:135], 0
  ds_read_b128 a[144:147], v48 offset:4096
  v_cvt_pk_bf16_f32 v149, v102, v103
  v_mfma_f32_16x16x32_bf16 a[56:59], a[172:175], v[136:139], 0
  v_exp_f32 v104, v104
  v_mfma_f32_16x16x32_bf16 a[60:63], a[172:175], v[140:143], 0
  ds_read_b128 a[148:151], v49 offset:4096
  buffer_load_dwordx4 v12, s[32:35], s59 offen lds
  v_mfma_f32_16x16x32_bf16 a[64:67], a[176:179], v[128:131], 0
  v_exp_f32 v105, v105
  v_mfma_f32_16x16x32_bf16 a[68:71], a[176:179], v[132:135], 0
  buffer_load_dwordx4 v13, s[32:35], s59 offen offset:1056 lds
  v_cvt_pk_bf16_f32 v152, v104, v105
  v_mfma_f32_16x16x32_bf16 a[72:75], a[176:179], v[136:139], 0
  v_exp_f32 v106, v106
  v_mfma_f32_16x16x32_bf16 a[76:79], a[176:179], v[140:143], 0
  ds_read_b128 a[152:155], v50 offset:4096
  v_add_f32 v62, v62, v104
  v_mfma_f32_16x16x32_bf16 a[80:83], a[180:183], v[128:131], 0
  s_add_u32 s59, s59, 8192
  v_exp_f32 v107, v107
  v_mfma_f32_16x16x32_bf16 a[84:87], a[180:183], v[132:135], 0
  v_cvt_pk_bf16_f32 v153, v106, v107
  v_add_f32 v62, v62, v105
  v_mfma_f32_16x16x32_bf16 a[88:91], a[180:183], v[136:139], 0
  v_exp_f32 v108, v108
  v_mfma_f32_16x16x32_bf16 a[92:95], a[180:183], v[140:143], 0
  ds_read_b128 a[156:159], v51 offset:4096
  buffer_load_dword v35, v34, s[24:27], s100 offen
  v_mfma_f32_16x16x32_bf16 a[96:99], a[184:187], v[128:131], 0
  v_exp_f32 v109, v109
  v_mfma_f32_16x16x32_bf16 a[100:103], a[184:187], v[132:135], 0
  v_cvt_pk_bf16_f32 v156, v108, v109
  v_add_f32 v62, v62, v106
  v_mfma_f32_16x16x32_bf16 a[104:107], a[184:187], v[136:139], 0
  s_add_u32 s100, s100, 393216
  v_exp_f32 v110, v110
  v_mfma_f32_16x16x32_bf16 a[108:111], a[184:187], v[140:143], 0
  v_add_f32 v62, v62, v107
  v_add_f32 v63, v63, v108
  v_mfma_f32_16x16x32_bf16 a[112:115], a[188:191], v[128:131], 0
  v_exp_f32 v111, v111
  v_mfma_f32_16x16x32_bf16 a[116:119], a[188:191], v[132:135], 0
  v_cvt_pk_bf16_f32 v157, v110, v111
  v_add_f32 v63, v63, v109
  v_mfma_f32_16x16x32_bf16 a[120:123], a[188:191], v[136:139], 0
  v_add_f32 v63, v63, v110
  v_add_f32 v63, v63, v111
  v_mfma_f32_16x16x32_bf16 a[124:127], a[188:191], v[140:143], 0
  s_waitcnt lgkmcnt(0)
  v_mfma_f32_16x16x32_bf16 v[64:67], a[128:131], v[192:195], v[160:163]
  v_exp_f32 v112, v112
  v_mfma_f32_16x16x32_bf16 v[68:71], a[128:131], v[208:211], v[164:167]
  v_exp_f32 v113, v113
  v_mfma_f32_16x16x32_bf16 v[72:75], a[128:131], v[224:227], v[168:171]
  ds_read_b64_tr_b16 a[160:161], v52 offset:8192
  v_cvt_pk_bf16_f32 v146, v112, v113
  v_mfma_f32_16x16x32_bf16 v[76:79], a[128:131], v[240:243], v[172:175]
  v_exp_f32 v114, v114
  v_mfma_f32_16x16x32_bf16 v[64:67], a[132:135], v[196:199], v[64:67]
  ds_read_b64_tr_b16 a[162:163], v52 offset:8704
  ds_read_b64_tr_b16 a[164:165], v52 offset:8224
  v_mfma_f32_16x16x32_bf16 v[68:71], a[132:135], v[212:215], v[68:71]
  v_exp_f32 v115, v115
  v_mfma_f32_16x16x32_bf16 v[72:75], a[132:135], v[228:231], v[72:75]
  ds_read_b64_tr_b16 a[166:167], v52 offset:8736
  v_cvt_pk_bf16_f32 v147, v114, v115
  v_mfma_f32_16x16x32_bf16 v[76:79], a[132:135], v[244:247], v[76:79]
  v_exp_f32 v116, v116
  v_mfma_f32_16x16x32_bf16 v[64:67], a[136:139], v[200:203], v[64:67]
  ds_read_b64_tr_b16 a[168:169], v52 offset:8256
  ds_read_b64_tr_b16 a[170:171], v52 offset:8768
  v_mfma_f32_16x16x32_bf16 v[68:71], a[136:139], v[216:219], v[68:71]
  v_exp_f32 v117, v117
  v_mfma_f32_16x16x32_bf16 v[72:75], a[136:139], v[232:235], v[72:75]
  ds_read_b64_tr_b16 a[172:173], v52 offset:8288
  v_cvt_pk_bf16_f32 v150, v116, v117
  v_mfma_f32_16x16x32_bf16 v[76:79], a[136:139], v[248:251], v[76:79]
  v_exp_f32 v118, v118
  v_mfma_f32_16x16x32_bf16 v[64:67], a[140:143], v[204:207], v[64:67]
  ds_read_b64_tr_b16 a[174:175], v52 offset:8800
  v_mfma_f32_16x16x32_bf16 v[68:71], a[140:143], v[220:223], v[68:71]
  v_exp_f32 v119, v119
  v_mfma_f32_16x16x32_bf16 v[72:75], a[140:143], v[236:239], v[72:75]
  ds_read_b64_tr_b16 a[176:177], v52 offset:8320
  v_cvt_pk_bf16_f32 v151, v118, v119
  v_mfma_f32_16x16x32_bf16 v[76:79], a[140:143], v[252:255], v[76:79]
  v_exp_f32 v120, v120
  v_mfma_f32_16x16x32_bf16 v[80:83], a[144:147], v[192:195], v[160:163]
  v_exp_f32 v121, v121
  v_mfma_f32_16x16x32_bf16 v[84:87], a[144:147], v[208:211], v[164:167]
  ds_read_b64_tr_b16 a[178:179], v52 offset:8832
  ds_read_b64_tr_b16 a[180:181], v52 offset:8352
  v_cvt_pk_bf16_f32 v154, v120, v121
  v_mfma_f32_16x16x32_bf16 v[88:91], a[144:147], v[224:227], v[168:171]
  v_exp_f32 v122, v122
  v_mfma_f32_16x16x32_bf16 v[92:95], a[144:147], v[240:243], v[172:175]
  ds_read_b64_tr_b16 a[182:183], v52 offset:8864
  ds_read_b64_tr_b16 a[184:185], v52 offset:8384
  v_mfma_f32_16x16x32_bf16 v[80:83], a[148:151], v[196:199], v[80:83]
  v_exp_f32 v123, v123
  v_mfma_f32_16x16x32_bf16 v[84:87], a[148:151], v[212:215], v[84:87]
  ds_read_b64_tr_b16 a[186:187], v52 offset:8896
  v_cvt_pk_bf16_f32 v155, v122, v123
  v_mfma_f32_16x16x32_bf16 v[88:91], a[148:151], v[228:231], v[88:91]
TP_8:
  s_cbranch_execz TR_2
  v_exp_f32 v124, v124
  v_mfma_f32_16x16x32_bf16 v[92:95], a[148:151], v[244:247], v[92:95]
  ds_read_b64_tr_b16 a[188:189], v52 offset:8416
  v_add_f32 v62, v62, v120
  v_mfma_f32_16x16x32_bf16 v[80:83], a[152:155], v[200:203], v[80:83]
  v_exp_f32 v125, v125
  v_mfma_f32_16x16x32_bf16 v[84:87], a[152:155], v[216:219], v[84:87]
  ds_read_b64_tr_b16 a[190:191], v52 offset:8928
  v_cvt_pk_bf16_f32 v158, v124, v125
  v_mfma_f32_16x16x32_bf16 v[88:91], a[152:155], v[232:235], v[88:91]
  v_exp_f32 v126, v126
  v_mfma_f32_16x16x32_bf16 v[92:95], a[152:155], v[248:251], v[92:95]
  v_add_f32 v62, v62, v121
  v_add_f32 v62, v62, v122
  v_mfma_f32_16x16x32_bf16 v[80:83], a[156:159], v[204:207], v[80:83]
  v_exp_f32 v127, v127
  v_mfma_f32_16x16x32_bf16 v[84:87], a[156:159], v[220:223], v[84:87]
  v_cvt_pk_bf16_f32 v159, v126, v127
  v_add_f32 v62, v62, v123
  v_mfma_f32_16x16x32_bf16 v[88:91], a[156:159], v[236:239], v[88:91]
  v_add_f32 v63, v63, v124
  v_add_f32 v63, v63, v125
  v_mfma_f32_16x16x32_bf16 v[92:95], a[156:159], v[252:255], v[92:95]
  s_waitcnt vmcnt(13) lgkmcnt(0)
  s_barrier
  v_mfma_f32_16x16x32_bf16 v[176:179], v[36:39], v[144:147], v[176:179]
  s_add_u32 m0, s56, 91648
  v_exp_f32 v64, v64
  v_mfma_f32_16x16x32_bf16 v[180:183], v[36:39], v[148:151], v[180:183]
  ds_read_b128 a[128:131], v48 offset:16640
  v_add_f32 v63, v63, v126
  v_mfma_f32_16x16x32_bf16 a[0:3], a[160:163], v[144:147], a[0:3]
  v_exp_f32 v65, v65
  v_mfma_f32_16x16x32_bf16 a[4:7], a[160:163], v[148:151], a[4:7]
  ds_read_b128 a[132:135], v49 offset:16640
  v_cvt_pk_bf16_f32 v128, v64, v65
  v_mfma_f32_16x16x32_bf16 a[8:11], a[160:163], v[152:155], a[8:11]
  v_exp_f32 v66, v66
  v_mfma_f32_16x16x32_bf16 a[12:15], a[160:163], v[156:159], a[12:15]
  buffer_load_dwordx4 v10, s[28:31], s58 offen lds
  v_add_f32 v63, v63, v127
  v_mfma_f32_16x16x32_bf16 a[16:19], a[164:167], v[144:147], a[16:19]
  v_exp_f32 v67, v67
  v_mfma_f32_16x16x32_bf16 a[20:23], a[164:167], v[148:151], a[20:23]
  ds_read_b128 a[136:139], v50 offset:16640
  v_cvt_pk_bf16_f32 v129, v66, v67
  v_mfma_f32_16x16x32_bf16 a[24:27], a[164:167], v[152:155], a[24:27]
  v_exp_f32 v68, v68
  v_mfma_f32_16x16x32_bf16 a[28:31], a[164:167], v[156:159], a[28:31]
  buffer_load_dwordx4 v11, s[28:31], s58 offen offset:1024 lds
  v_mfma_f32_16x16x32_bf16 a[32:35], a[168:171], v[144:147], a[32:35]
  s_add_u32 s58, s58, 8192
  v_exp_f32 v69, v69
  v_mfma_f32_16x16x32_bf16 a[36:39], a[168:171], v[148:151], a[36:39]
  ds_read_b128 a[140:143], v51 offset:16640
  v_cvt_pk_bf16_f32 v132, v68, v69
  v_mfma_f32_16x16x32_bf16 a[40:43], a[168:171], v[152:155], a[40:43]
  s_add_u32 m0, s57, 99840
  v_exp_f32 v70, v70
  v_mfma_f32_16x16x32_bf16 a[44:47], a[168:171], v[156:159], a[44:47]
  v_mfma_f32_16x16x32_bf16 a[48:51], a[172:175], v[144:147], a[48:51]
  v_exp_f32 v71, v71
  v_mfma_f32_16x16x32_bf16 a[52:55], a[172:175], v[148:151], a[52:55]
  ds_read_b128 a[144:147], v48 offset:20736
  v_cvt_pk_bf16_f32 v133, v70, v71
  v_mfma_f32_16x16x32_bf16 a[56:59], a[172:175], v[152:155], a[56:59]
  v_exp_f32 v72, v72
  v_mfma_f32_16x16x32_bf16 a[60:63], a[172:175], v[156:159], a[60:63]
  ds_read_b128 a[148:151], v49 offset:20736
  buffer_load_dwordx4 v12, s[32:35], s59 offen lds
  v_mfma_f32_16x16x32_bf16 a[64:67], a[176:179], v[144:147], a[64:67]
  v_exp_f32 v73, v73
  v_mfma_f32_16x16x32_bf16 a[68:71], a[176:179], v[148:151], a[68:71]
  buffer_load_dwordx4 v13, s[32:35], s59 offen offset:1056 lds
  v_cvt_pk_bf16_f32 v136, v72, v73
  v_mfma_f32_16x16x32_bf16 a[72:75], a[176:179], v[152:155], a[72:75]
  v_exp_f32 v74, v74
  v_mfma_f32_16x16x32_bf16 a[76:79], a[176:179], v[156:159], a[76:79]
  ds_read_b128 a[152:155], v50 offset:20736
  v_add_f32 v62, v62, v72
  v_mfma_f32_16x16x32_bf16 a[80:83], a[180:183], v[144:147], a[80:83]
  s_add_u32 s59, s59, 8192
  v_exp_f32 v75, v75
  v_mfma_f32_16x16x32_bf16 a[84:87], a[180:183], v[148:151], a[84:87]
  v_cvt_pk_bf16_f32 v137, v74, v75
  v_add_f32 v62, v62, v73
  v_mfma_f32_16x16x32_bf16 a[88:91], a[180:183], v[152:155], a[88:91]
  v_exp_f32 v76, v76
  v_mfma_f32_16x16x32_bf16 a[92:95], a[180:183], v[156:159], a[92:95]
  ds_read_b128 a[156:159], v51 offset:20736
  buffer_load_dword v35, v34, s[24:27], s100 offen
  v_mfma_f32_16x16x32_bf16 a[96:99], a[184:187], v[144:147], a[96:99]
  v_exp_f32 v77, v77
  v_mfma_f32_16x16x32_bf16 a[100:103], a[184:187], v[148:151], a[100:103]
  v_cvt_pk_bf16_f32 v140, v76, v77
  v_add_f32 v62, v62, v74
  v_mfma_f32_16x16x32_bf16 a[104:107], a[184:187], v[152:155], a[104:107]
  s_add_u32 s100, s100, 393216
  v_exp_f32 v78, v78
  v_mfma_f32_16x16x32_bf16 a[108:111], a[184:187], v[156:159], a[108:111]
  v_add_f32 v62, v62, v75
  v_add_f32 v63, v63, v76
  v_mfma_f32_16x16x32_bf16 a[112:115], a[188:191], v[144:147], a[112:115]
  v_exp_f32 v79, v79
  v_mfma_f32_16x16x32_bf16 a[116:119], a[188:191], v[148:151], a[116:119]
  v_cvt_pk_bf16_f32 v141, v78, v79
  v_add_f32 v63, v63, v77
  v_mfma_f32_16x16x32_bf16 a[120:123], a[188:191], v[152:155], a[120:123]
  v_add_f32 v63, v63, v78
  v_add_f32 v63, v63, v79
  v_mfma_f32_16x16x32_bf16 a[124:127], a[188:191], v[156:159], a[124:127]
  s_waitcnt lgkmcnt(0)
  v_mfma_f32_16x16x32_bf16 v[96:99], a[128:131], v[192:195], v[160:163]
  v_exp_f32 v80, v80
  v_mfma_f32_16x16x32_bf16 v[100:103], a[128:131], v[208:211], v[164:167]
  v_exp_f32 v81, v81
  v_mfma_f32_16x16x32_bf16 v[104:107], a[128:131], v[224:227], v[168:171]
  ds_read_b64_tr_b16 a[160:161], v52 offset:24832
  v_cvt_pk_bf16_f32 v130, v80, v81
  v_mfma_f32_16x16x32_bf16 v[108:111], a[128:131], v[240:243], v[172:175]
  v_exp_f32 v82, v82
  v_mfma_f32_16x16x32_bf16 v[96:99], a[132:135], v[196:199], v[96:99]
  ds_read_b64_tr_b16 a[162:163], v52 offset:25344
  ds_read_b64_tr_b16 a[164:165], v52 offset:24864
  v_mfma_f32_16x16x32_bf16 v[100:103], a[132:135], v[212:215], v[100:103]
  v_exp_f32 v83, v83
  v_mfma_f32_16x16x32_bf16 v[104:107], a[132:135], v[228:231], v[104:107]
  ds_read_b64_tr_b16 a[166:167], v52 offset:25376
  v_cvt_pk_bf16_f32 v131, v82, v83
  v_mfma_f32_16x16x32_bf16 v[108:111], a[132:135], v[244:247], v[108:111]
  v_exp_f32 v84, v84
  v_mfma_f32_16x16x32_bf16 v[96:99], a[136:139], v[200:203], v[96:99]
  ds_read_b64_tr_b16 a[168:169], v52 offset:24896
  ds_read_b64_tr_b16 a[170:171], v52 offset:25408
  v_mfma_f32_16x16x32_bf16 v[100:103], a[136:139], v[216:219], v[100:103]
  v_exp_f32 v85, v85
  v_mfma_f32_16x16x32_bf16 v[104:107], a[136:139], v[232:235], v[104:107]
  ds_read_b64_tr_b16 a[172:173], v52 offset:24928
  v_cvt_pk_bf16_f32 v134, v84, v85
  v_mfma_f32_16x16x32_bf16 v[108:111], a[136:139], v[248:251], v[108:111]
  v_exp_f32 v86, v86
  v_mfma_f32_16x16x32_bf16 v[96:99], a[140:143], v[204:207], v[96:99]
  ds_read_b64_tr_b16 a[174:175], v52 offset:25440
  v_mfma_f32_16x16x32_bf16 v[100:103], a[140:143], v[220:223], v[100:103]
  v_exp_f32 v87, v87
  v_mfma_f32_16x16x32_bf16 v[104:107], a[140:143], v[236:239], v[104:107]
  ds_read_b64_tr_b16 a[176:177], v52 offset:24960
  v_cvt_pk_bf16_f32 v135, v86, v87
  v_mfma_f32_16x16x32_bf16 v[108:111], a[140:143], v[252:255], v[108:111]
  v_exp_f32 v88, v88
  v_mfma_f32_16x16x32_bf16 v[112:115], a[144:147], v[192:195], v[160:163]
  v_exp_f32 v89, v89
  v_mfma_f32_16x16x32_bf16 v[116:119], a[144:147], v[208:211], v[164:167]
  ds_read_b64_tr_b16 a[178:179], v52 offset:25472
  ds_read_b64_tr_b16 a[180:181], v52 offset:24992
  v_cvt_pk_bf16_f32 v138, v88, v89
  v_mfma_f32_16x16x32_bf16 v[120:123], a[144:147], v[224:227], v[168:171]
  v_exp_f32 v90, v90
  v_mfma_f32_16x16x32_bf16 v[124:127], a[144:147], v[240:243], v[172:175]
  ds_read_b64_tr_b16 a[182:183], v52 offset:25504
  ds_read_b64_tr_b16 a[184:185], v52 offset:25024
  v_mfma_f32_16x16x32_bf16 v[112:115], a[148:151], v[196:199], v[112:115]
  v_exp_f32 v91, v91
  v_mfma_f32_16x16x32_bf16 v[116:119], a[148:151], v[212:215], v[116:119]
  ds_read_b64_tr_b16 a[186:187], v52 offset:25536
  v_cvt_pk_bf16_f32 v139, v90, v91
  v_mfma_f32_16x16x32_bf16 v[120:123], a[148:151], v[228:231], v[120:123]
  v_exp_f32 v92, v92
  v_mfma_f32_16x16x32_bf16 v[124:127], a[148:151], v[244:247], v[124:127]
  ds_read_b64_tr_b16 a[188:189], v52 offset:25056
  v_add_f32 v62, v62, v88
  v_mfma_f32_16x16x32_bf16 v[112:115], a[152:155], v[200:203], v[112:115]
  v_exp_f32 v93, v93
  v_mfma_f32_16x16x32_bf16 v[116:119], a[152:155], v[216:219], v[116:119]
  ds_read_b64_tr_b16 a[190:191], v52 offset:25568
  v_cvt_pk_bf16_f32 v142, v92, v93
  v_mfma_f32_16x16x32_bf16 v[120:123], a[152:155], v[232:235], v[120:123]
  v_exp_f32 v94, v94
  v_mfma_f32_16x16x32_bf16 v[124:127], a[152:155], v[248:251], v[124:127]
  v_add_f32 v62, v62, v89
  v_add_f32 v62, v62, v90
  v_mfma_f32_16x16x32_bf16 v[112:115], a[156:159], v[204:207], v[112:115]
  v_exp_f32 v95, v95
  v_mfma_f32_16x16x32_bf16 v[116:119], a[156:159], v[220:223], v[116:119]
  v_cvt_pk_bf16_f32 v143, v94, v95
  v_add_f32 v62, v62, v91
  v_mfma_f32_16x16x32_bf16 v[120:123], a[156:159], v[236:239], v[120:123]
  v_add_f32 v63, v63, v92
  v_add_f32 v63, v63, v93
  v_mfma_f32_16x16x32_bf16 v[124:127], a[156:159], v[252:255], v[124:127]
  s_waitcnt vmcnt(14) lgkmcnt(0)
  s_barrier
  v_mfma_f32_16x16x32_bf16 v[176:179], v[36:39], v[128:131], v[176:179]
  s_add_u32 m0, s56, 108288
  v_exp_f32 v96, v96
  v_mfma_f32_16x16x32_bf16 v[180:183], v[36:39], v[132:135], v[180:183]
  ds_read_b128 a[128:131], v48 offset:33280
  v_add_f32 v63, v63, v94
  v_mfma_f32_16x16x32_bf16 a[0:3], a[160:163], v[128:131], a[0:3]
  v_exp_f32 v97, v97
  v_mfma_f32_16x16x32_bf16 a[4:7], a[160:163], v[132:135], a[4:7]
  ds_read_b128 a[132:135], v49 offset:33280
  v_cvt_pk_bf16_f32 v144, v96, v97
  v_mfma_f32_16x16x32_bf16 a[8:11], a[160:163], v[136:139], a[8:11]
  v_exp_f32 v98, v98
  v_mfma_f32_16x16x32_bf16 a[12:15], a[160:163], v[140:143], a[12:15]
  buffer_load_dwordx4 v10, s[28:31], s58 offen lds
  v_add_f32 v63, v63, v95
  v_mfma_f32_16x16x32_bf16 a[16:19], a[164:167], v[128:131], a[16:19]
  v_exp_f32 v99, v99
  v_mfma_f32_16x16x32_bf16 a[20:23], a[164:167], v[132:135], a[20:23]
  ds_read_b128 a[136:139], v50 offset:33280
  v_cvt_pk_bf16_f32 v145, v98, v99
  v_mfma_f32_16x16x32_bf16 a[24:27], a[164:167], v[136:139], a[24:27]
  v_exp_f32 v100, v100
  v_mfma_f32_16x16x32_bf16 a[28:31], a[164:167], v[140:143], a[28:31]
  buffer_load_dwordx4 v11, s[28:31], s58 offen offset:1024 lds
  v_mfma_f32_16x16x32_bf16 a[32:35], a[168:171], v[128:131], a[32:35]
  s_add_u32 s58, s58, 8192
  v_exp_f32 v101, v101
  v_mfma_f32_16x16x32_bf16 a[36:39], a[168:171], v[132:135], a[36:39]
  ds_read_b128 a[140:143], v51 offset:33280
  v_cvt_pk_bf16_f32 v148, v100, v101
  v_mfma_f32_16x16x32_bf16 a[40:43], a[168:171], v[136:139], a[40:43]
  s_add_u32 m0, s57, 116480
  v_exp_f32 v102, v102
  v_mfma_f32_16x16x32_bf16 a[44:47], a[168:171], v[140:143], a[44:47]
  v_mfma_f32_16x16x32_bf16 a[48:51], a[172:175], v[128:131], a[48:51]
  v_exp_f32 v103, v103
  v_mfma_f32_16x16x32_bf16 a[52:55], a[172:175], v[132:135], a[52:55]
  ds_read_b128 a[144:147], v48 offset:37376
  v_cvt_pk_bf16_f32 v149, v102, v103
  v_mfma_f32_16x16x32_bf16 a[56:59], a[172:175], v[136:139], a[56:59]
  v_exp_f32 v104, v104
  v_mfma_f32_16x16x32_bf16 a[60:63], a[172:175], v[140:143], a[60:63]
  ds_read_b128 a[148:151], v49 offset:37376
  buffer_load_dwordx4 v12, s[32:35], s59 offen lds
  v_mfma_f32_16x16x32_bf16 a[64:67], a[176:179], v[128:131], a[64:67]
  v_exp_f32 v105, v105
  v_mfma_f32_16x16x32_bf16 a[68:71], a[176:179], v[132:135], a[68:71]
  buffer_load_dwordx4 v13, s[32:35], s59 offen offset:1056 lds
  v_cvt_pk_bf16_f32 v152, v104, v105
  v_mfma_f32_16x16x32_bf16 a[72:75], a[176:179], v[136:139], a[72:75]
  v_exp_f32 v106, v106
  v_mfma_f32_16x16x32_bf16 a[76:79], a[176:179], v[140:143], a[76:79]
  ds_read_b128 a[152:155], v50 offset:37376
  v_add_f32 v62, v62, v104
  v_mfma_f32_16x16x32_bf16 a[80:83], a[180:183], v[128:131], a[80:83]
  s_add_u32 s59, s59, 8192
  v_exp_f32 v107, v107
  v_mfma_f32_16x16x32_bf16 a[84:87], a[180:183], v[132:135], a[84:87]
  v_cvt_pk_bf16_f32 v153, v106, v107
  v_add_f32 v62, v62, v105
  v_mfma_f32_16x16x32_bf16 a[88:91], a[180:183], v[136:139], a[88:91]
  v_exp_f32 v108, v108
  v_mfma_f32_16x16x32_bf16 a[92:95], a[180:183], v[140:143], a[92:95]
  ds_read_b128 a[156:159], v51 offset:37376
  buffer_load_dword v35, v34, s[24:27], s100 offen
  v_mfma_f32_16x16x32_bf16 a[96:99], a[184:187], v[128:131], a[96:99]
  v_exp_f32 v109, v109
  v_mfma_f32_16x16x32_bf16 a[100:103], a[184:187], v[132:135], a[100:103]
  v_cvt_pk_bf16_f32 v156, v108, v109
  v_add_f32 v62, v62, v106
  v_mfma_f32_16x16x32_bf16 a[104:107], a[184:187], v[136:139], a[104:107]
  s_add_u32 s100, s100, 393216
  v_exp_f32 v110, v110
  v_mfma_f32_16x16x32_bf16 a[108:111], a[184:187], v[140:143], a[108:111]
  v_add_f32 v62, v62, v107
  v_add_f32 v63, v63, v108
  v_mfma_f32_16x16x32_bf16 a[112:115], a[188:191], v[128:131], a[112:115]
  v_exp_f32 v111, v111
  v_mfma_f32_16x16x32_bf16 a[116:119], a[188:191], v[132:135], a[116:119]
  v_cvt_pk_bf16_f32 v157, v110, v111
  v_add_f32 v63, v63, v109
  v_mfma_f32_16x16x32_bf16 a[120:123], a[188:191], v[136:139], a[120:123]
  v_add_f32 v63, v63, v110
  v_add_f32 v63, v63, v111
  v_mfma_f32_16x16x32_bf16 a[124:127], a[188:191], v[140:143], a[124:127]
  s_waitcnt lgkmcnt(0)
  v_mfma_f32_16x16x32_bf16 v[64:67], a[128:131], v[192:195], v[160:163]
  v_exp_f32 v112, v112
  v_mfma_f32_16x16x32_bf16 v[68:71], a[128:131], v[208:211], v[164:167]
  v_exp_f32 v113, v113
  v_mfma_f32_16x16x32_bf16 v[72:75], a[128:131], v[224:227], v[168:171]
  ds_read_b64_tr_b16 a[160:161], v52 offset:41472
  v_cvt_pk_bf16_f32 v146, v112, v113
  v_mfma_f32_16x16x32_bf16 v[76:79], a[128:131], v[240:243], v[172:175]
  v_exp_f32 v114, v114
  v_mfma_f32_16x16x32_bf16 v[64:67], a[132:135], v[196:199], v[64:67]
  ds_read_b64_tr_b16 a[162:163], v52 offset:41984
  ds_read_b64_tr_b16 a[164:165], v52 offset:41504
  v_mfma_f32_16x16x32_bf16 v[68:71], a[132:135], v[212:215], v[68:71]
  v_exp_f32 v115, v115
  v_mfma_f32_16x16x32_bf16 v[72:75], a[132:135], v[228:231], v[72:75]
  ds_read_b64_tr_b16 a[166:167], v52 offset:42016
  v_cvt_pk_bf16_f32 v147, v114, v115
  v_mfma_f32_16x16x32_bf16 v[76:79], a[132:135], v[244:247], v[76:79]
  v_exp_f32 v116, v116
  v_mfma_f32_16x16x32_bf16 v[64:67], a[136:139], v[200:203], v[64:67]
  ds_read_b64_tr_b16 a[168:169], v52 offset:41536
  ds_read_b64_tr_b16 a[170:171], v52 offset:42048
  v_mfma_f32_16x16x32_bf16 v[68:71], a[136:139], v[216:219], v[68:71]
  v_exp_f32 v117, v117
  v_mfma_f32_16x16x32_bf16 v[72:75], a[136:139], v[232:235], v[72:75]
  ds_read_b64_tr_b16 a[172:173], v52 offset:41568
  v_cvt_pk_bf16_f32 v150, v116, v117
  v_mfma_f32_16x16x32_bf16 v[76:79], a[136:139], v[248:251], v[76:79]
  v_exp_f32 v118, v118
  v_mfma_f32_16x16x32_bf16 v[64:67], a[140:143], v[204:207], v[64:67]
  ds_read_b64_tr_b16 a[174:175], v52 offset:42080
  v_mfma_f32_16x16x32_bf16 v[68:71], a[140:143], v[220:223], v[68:71]
  v_exp_f32 v119, v119
  v_mfma_f32_16x16x32_bf16 v[72:75], a[140:143], v[236:239], v[72:75]
  ds_read_b64_tr_b16 a[176:177], v52 offset:41600
  v_cvt_pk_bf16_f32 v151, v118, v119
  v_mfma_f32_16x16x32_bf16 v[76:79], a[140:143], v[252:255], v[76:79]
  v_exp_f32 v120, v120
  v_mfma_f32_16x16x32_bf16 v[80:83], a[144:147], v[192:195], v[160:163]
  v_exp_f32 v121, v121
  v_mfma_f32_16x16x32_bf16 v[84:87], a[144:147], v[208:211], v[164:167]
  ds_read_b64_tr_b16 a[178:179], v52 offset:42112
  ds_read_b64_tr_b16 a[180:181], v52 offset:41632
  v_cvt_pk_bf16_f32 v154, v120, v121
  v_mfma_f32_16x16x32_bf16 v[88:91], a[144:147], v[224:227], v[168:171]
  v_exp_f32 v122, v122
  v_mfma_f32_16x16x32_bf16 v[92:95], a[144:147], v[240:243], v[172:175]
  ds_read_b64_tr_b16 a[182:183], v52 offset:42144
  ds_read_b64_tr_b16 a[184:185], v52 offset:41664
  v_mfma_f32_16x16x32_bf16 v[80:83], a[148:151], v[196:199], v[80:83]
  v_exp_f32 v123, v123
  v_mfma_f32_16x16x32_bf16 v[84:87], a[148:151], v[212:215], v[84:87]
  ds_read_b64_tr_b16 a[186:187], v52 offset:42176
  v_cvt_pk_bf16_f32 v155, v122, v123
  v_mfma_f32_16x16x32_bf16 v[88:91], a[148:151], v[228:231], v[88:91]
  v_exp_f32 v124, v124
  v_mfma_f32_16x16x32_bf16 v[92:95], a[148:151], v[244:247], v[92:95]
  ds_read_b64_tr_b16 a[188:189], v52 offset:41696
  v_add_f32 v62, v62, v120
  v_mfma_f32_16x16x32_bf16 v[80:83], a[152:155], v[200:203], v[80:83]
  v_exp_f32 v125, v125
  v_mfma_f32_16x16x32_bf16 v[84:87], a[152:155], v[216:219], v[84:87]
  ds_read_b64_tr_b16 a[190:191], v52 offset:42208
  v_cvt_pk_bf16_f32 v158, v124, v125
  v_mfma_f32_16x16x32_bf16 v[88:91], a[152:155], v[232:235], v[88:91]
  v_exp_f32 v126, v126
  v_mfma_f32_16x16x32_bf16 v[92:95], a[152:155], v[248:251], v[92:95]
  v_add_f32 v62, v62, v121
  v_add_f32 v62, v62, v122
  v_mfma_f32_16x16x32_bf16 v[80:83], a[156:159], v[204:207], v[80:83]
  v_exp_f32 v127, v127
  v_mfma_f32_16x16x32_bf16 v[84:87], a[156:159], v[220:223], v[84:87]
  v_cvt_pk_bf16_f32 v159, v126, v127
  v_add_f32 v62, v62, v123
  v_mfma_f32_16x16x32_bf16 v[88:91], a[156:159], v[236:239], v[88:91]
  v_add_f32 v63, v63, v124
  v_add_f32 v63, v63, v125
  v_mfma_f32_16x16x32_bf16 v[92:95], a[156:159], v[252:255], v[92:95]
  s_waitcnt vmcnt(15) lgkmcnt(0)
  s_barrier
  v_mfma_f32_16x16x32_bf16 v[176:179], v[36:39], v[144:147], v[176:179]
  v_exp_f32 v64, v64
  v_mfma_f32_16x16x32_bf16 v[180:183], v[36:39], v[148:151], v[180:183]
  ds_read_b128 a[128:131], v14 offset:0
  buffer_store_dword v9, v8, s[12:15], s45 offen sc1
  v_mfma_f32_16x16x32_bf16 a[0:3], a[160:163], v[144:147], a[0:3]
  s_add_u32 m0, s56, 124928
  v_exp_f32 v65, v65
  v_mfma_f32_16x16x32_bf16 a[4:7], a[160:163], v[148:151], a[4:7]
  ds_read_b128 a[132:135], v15 offset:0
  v_cvt_pk_bf16_f32 v128, v64, v65
  v_mfma_f32_16x16x32_bf16 a[8:11], a[160:163], v[152:155], a[8:11]
  v_exp_f32 v66, v66
  v_mfma_f32_16x16x32_bf16 a[12:15], a[160:163], v[156:159], a[12:15]
  buffer_load_dwordx4 v10, s[28:31], s58 offen lds
  v_add_f32 v63, v63, v126
  v_mfma_f32_16x16x32_bf16 a[16:19], a[164:167], v[144:147], a[16:19]
  v_exp_f32 v67, v67
  v_mfma_f32_16x16x32_bf16 a[20:23], a[164:167], v[148:151], a[20:23]
  ds_read_b128 a[136:139], v16 offset:0
  v_cvt_pk_bf16_f32 v129, v66, v67
  v_mfma_f32_16x16x32_bf16 a[24:27], a[164:167], v[152:155], a[24:27]
  v_exp_f32 v68, v68
  v_mfma_f32_16x16x32_bf16 a[28:31], a[164:167], v[156:159], a[28:31]
  buffer_load_dwordx4 v11, s[28:31], s58 offen offset:1024 lds
  v_add_f32 v63, v63, v127
  v_mfma_f32_16x16x32_bf16 a[32:35], a[168:171], v[144:147], a[32:35]
  v_exp_f32 v69, v69
  v_mfma_f32_16x16x32_bf16 a[36:39], a[168:171], v[148:151], a[36:39]
  s_add_u32 s58, s58, 8192
  ds_read_b128 a[140:143], v17 offset:0
  v_cvt_pk_bf16_f32 v132, v68, v69
  v_mfma_f32_16x16x32_bf16 a[40:43], a[168:171], v[152:155], a[40:43]
  v_exp_f32 v70, v70
  v_mfma_f32_16x16x32_bf16 a[44:47], a[168:171], v[156:159], a[44:47]
  v_mfma_f32_16x16x32_bf16 a[48:51], a[172:175], v[144:147], a[48:51]
  s_add_u32 m0, s57, 133120
  v_exp_f32 v71, v71
  v_mfma_f32_16x16x32_bf16 a[52:55], a[172:175], v[148:151], a[52:55]
  ds_read_b128 a[144:147], v14 offset:4096
  v_cvt_pk_bf16_f32 v133, v70, v71
  v_mfma_f32_16x16x32_bf16 a[56:59], a[172:175], v[152:155], a[56:59]
  v_exp_f32 v72, v72
  v_mfma_f32_16x16x32_bf16 a[60:63], a[172:175], v[156:159], a[60:63]
  ds_read_b128 a[148:151], v15 offset:4096
  buffer_load_dwordx4 v12, s[32:35], s59 offen lds
  v_mfma_f32_16x16x32_bf16 a[64:67], a[176:179], v[144:147], a[64:67]
  v_exp_f32 v73, v73
  v_mfma_f32_16x16x32_bf16 a[68:71], a[176:179], v[148:151], a[68:71]
  v_cvt_pk_bf16_f32 v136, v72, v73
  v_add_f32 v62, v62, v72
  v_mfma_f32_16x16x32_bf16 a[72:75], a[176:179], v[152:155], a[72:75]
  v_exp_f32 v74, v74
  v_mfma_f32_16x16x32_bf16 a[76:79], a[176:179], v[156:159], a[76:79]
  ds_read_b128 a[152:155], v16 offset:4096
  buffer_load_dwordx4 v13, s[32:35], s59 offen offset:1056 lds
  v_mfma_f32_16x16x32_bf16 a[80:83], a[180:183], v[144:147], a[80:83]
  v_exp_f32 v75, v75
  v_mfma_f32_16x16x32_bf16 a[84:87], a[180:183], v[148:151], a[84:87]
  s_add_u32 s59, s59, 8192
  v_cvt_pk_bf16_f32 v137, v74, v75
  v_add_f32 v62, v62, v73
  v_mfma_f32_16x16x32_bf16 a[88:91], a[180:183], v[152:155], a[88:91]
  v_exp_f32 v76, v76
  v_mfma_f32_16x16x32_bf16 a[92:95], a[180:183], v[156:159], a[92:95]
  ds_read_b128 a[156:159], v17 offset:4096
  v_add_f32 v62, v62, v74
  v_mfma_f32_16x16x32_bf16 a[96:99], a[184:187], v[144:147], a[96:99]
  v_exp_f32 v77, v77
  v_mfma_f32_16x16x32_bf16 a[100:103], a[184:187], v[148:151], a[100:103]
  buffer_load_dword v35, v34, s[24:27], s100 offen
  v_cvt_pk_bf16_f32 v140, v76, v77
  v_mfma_f32_16x16x32_bf16 a[104:107], a[184:187], v[152:155], a[104:107]
  v_exp_f32 v78, v78
  v_mfma_f32_16x16x32_bf16 a[108:111], a[184:187], v[156:159], a[108:111]
  s_add_u32 s100, s100, 393216
  v_add_f32 v62, v62, v75
  v_add_f32 v63, v63, v76
  v_mfma_f32_16x16x32_bf16 a[112:115], a[188:191], v[144:147], a[112:115]
  v_exp_f32 v79, v79
  v_mfma_f32_16x16x32_bf16 a[116:119], a[188:191], v[148:151], a[116:119]
  v_cvt_pk_bf16_f32 v141, v78, v79
  v_add_f32 v63, v63, v77
  v_mfma_f32_16x16x32_bf16 a[120:123], a[188:191], v[152:155], a[120:123]
  v_add_f32 v63, v63, v78
  v_add_f32 v63, v63, v79
  v_mfma_f32_16x16x32_bf16 a[124:127], a[188:191], v[156:159], a[124:127]
  s_waitcnt lgkmcnt(0)
  v_mfma_f32_16x16x32_bf16 v[96:99], a[128:131], v[192:195], v[160:163]
  v_exp_f32 v80, v80
  v_mfma_f32_16x16x32_bf16 v[100:103], a[128:131], v[208:211], v[164:167]
  v_exp_f32 v81, v81
  v_mfma_f32_16x16x32_bf16 v[104:107], a[128:131], v[224:227], v[168:171]
  ds_read_b64_tr_b16 a[160:161], v18 offset:8192
  v_cvt_pk_bf16_f32 v130, v80, v81
  v_mfma_f32_16x16x32_bf16 v[108:111], a[128:131], v[240:243], v[172:175]
  v_exp_f32 v82, v82
  v_mfma_f32_16x16x32_bf16 v[96:99], a[132:135], v[196:199], v[96:99]
  ds_read_b64_tr_b16 a[162:163], v18 offset:8704
  ds_read_b64_tr_b16 a[164:165], v18 offset:8224
  v_mfma_f32_16x16x32_bf16 v[100:103], a[132:135], v[212:215], v[100:103]
  v_exp_f32 v83, v83
  v_mfma_f32_16x16x32_bf16 v[104:107], a[132:135], v[228:231], v[104:107]
  ds_read_b64_tr_b16 a[166:167], v18 offset:8736
  v_cvt_pk_bf16_f32 v131, v82, v83
  v_mfma_f32_16x16x32_bf16 v[108:111], a[132:135], v[244:247], v[108:111]
  v_exp_f32 v84, v84
  v_mfma_f32_16x16x32_bf16 v[96:99], a[136:139], v[200:203], v[96:99]
  ds_read_b64_tr_b16 a[168:169], v18 offset:8256
  ds_read_b64_tr_b16 a[170:171], v18 offset:8768
  v_mfma_f32_16x16x32_bf16 v[100:103], a[136:139], v[216:219], v[100:103]
  v_exp_f32 v85, v85
  v_mfma_f32_16x16x32_bf16 v[104:107], a[136:139], v[232:235], v[104:107]
  ds_read_b64_tr_b16 a[172:173], v18 offset:8288
  v_cvt_pk_bf16_f32 v134, v84, v85
  v_mfma_f32_16x16x32_bf16 v[108:111], a[136:139], v[248:251], v[108:111]
  v_exp_f32 v86, v86
  v_mfma_f32_16x16x32_bf16 v[96:99], a[140:143], v[204:207], v[96:99]
  ds_read_b64_tr_b16 a[174:175], v18 offset:8800
  v_mfma_f32_16x16x32_bf16 v[100:103], a[140:143], v[220:223], v[100:103]
  v_exp_f32 v87, v87
  v_mfma_f32_16x16x32_bf16 v[104:107], a[140:143], v[236:239], v[104:107]
  ds_read_b64_tr_b16 a[176:177], v18 offset:8320
  v_cvt_pk_bf16_f32 v135, v86, v87
  v_mfma_f32_16x16x32_bf16 v[108:111], a[140:143], v[252:255], v[108:111]
  v_exp_f32 v88, v88
  v_mfma_f32_16x16x32_bf16 v[112:115], a[144:147], v[192:195], v[160:163]
  v_exp_f32 v89, v89
  v_mfma_f32_16x16x32_bf16 v[116:119], a[144:147], v[208:211], v[164:167]
  ds_read_b64_tr_b16 a[178:179], v18 offset:8832
  ds_read_b64_tr_b16 a[180:181], v18 offset:8352
  v_cvt_pk_bf16_f32 v138, v88, v89
  v_mfma_f32_16x16x32_bf16 v[120:123], a[144:147], v[224:227], v[168:171]
  v_exp_f32 v90, v90
  v_mfma_f32_16x16x32_bf16 v[124:127], a[144:147], v[240:243], v[172:175]
  ds_read_b64_tr_b16 a[182:183], v18 offset:8864
  ds_read_b64_tr_b16 a[184:185], v18 offset:8384
  v_mfma_f32_16x16x32_bf16 v[112:115], a[148:151], v[196:199], v[112:115]
  v_exp_f32 v91, v91
  v_mfma_f32_16x16x32_bf16 v[116:119], a[148:151], v[212:215], v[116:119]
  ds_read_b64_tr_b16 a[186:187], v18 offset:8896
  v_cvt_pk_bf16_f32 v139, v90, v91
  v_mfma_f32_16x16x32_bf16 v[120:123], a[148:151], v[228:231], v[120:123]
  v_exp_f32 v92, v92
  v_mfma_f32_16x16x32_bf16 v[124:127], a[148:151], v[244:247], v[124:127]
  ds_read_b64_tr_b16 a[188:189], v18 offset:8416
  v_add_f32 v62, v62, v88
  v_mfma_f32_16x16x32_bf16 v[112:115], a[152:155], v[200:203], v[112:115]
  v_exp_f32 v93, v93
  v_mfma_f32_16x16x32_bf16 v[116:119], a[152:155], v[216:219], v[116:119]
  ds_read_b64_tr_b16 a[190:191], v18 offset:8928
  v_cvt_pk_bf16_f32 v142, v92, v93
  v_mfma_f32_16x16x32_bf16 v[120:123], a[152:155], v[232:235], v[120:123]
  v_exp_f32 v94, v94
  v_mfma_f32_16x16x32_bf16 v[124:127], a[152:155], v[248:251], v[124:127]
  v_add_f32 v62, v62, v89
  v_add_f32 v62, v62, v90
  v_mfma_f32_16x16x32_bf16 v[112:115], a[156:159], v[204:207], v[112:115]
  v_exp_f32 v95, v95
  v_mfma_f32_16x16x32_bf16 v[116:119], a[156:159], v[220:223], v[116:119]
  v_cvt_pk_bf16_f32 v143, v94, v95
  v_add_f32 v62, v62, v91
  v_mfma_f32_16x16x32_bf16 v[120:123], a[156:159], v[236:239], v[120:123]
  v_add_f32 v63, v63, v92
  v_add_f32 v63, v63, v93
  v_mfma_f32_16x16x32_bf16 v[124:127], a[156:159], v[252:255], v[124:127]
  s_waitcnt vmcnt(17) lgkmcnt(0)
  s_barrier
  v_mfma_f32_16x16x32_bf16 v[176:179], v[36:39], v[128:131], v[176:179]
  s_add_u32 m0, s56, 141568
  v_exp_f32 v96, v96
  v_mfma_f32_16x16x32_bf16 v[180:183], v[36:39], v[132:135], v[180:183]
  ds_read_b128 a[128:131], v14 offset:16640
  v_add_f32 v63, v63, v94
  v_mfma_f32_16x16x32_bf16 a[0:3], a[160:163], v[128:131], a[0:3]
  v_exp_f32 v97, v97
  v_mfma_f32_16x16x32_bf16 a[4:7], a[160:163], v[132:135], a[4:7]
  ds_read_b128 a[132:135], v15 offset:16640
  v_cvt_pk_bf16_f32 v144, v96, v97
  v_mfma_f32_16x16x32_bf16 a[8:11], a[160:163], v[136:139], a[8:11]
  v_exp_f32 v98, v98
  v_mfma_f32_16x16x32_bf16 a[12:15], a[160:163], v[140:143], a[12:15]
  buffer_load_dwordx4 v10, s[28:31], s58 offen lds
  v_add_f32 v63, v63, v95
  v_mfma_f32_16x16x32_bf16 a[16:19], a[164:167], v[128:131], a[16:19]
  v_exp_f32 v99, v99
  v_mfma_f32_16x16x32_bf16 a[20:23], a[164:167], v[132:135], a[20:23]
  ds_read_b128 a[136:139], v16 offset:16640
  v_cvt_pk_bf16_f32 v145, v98, v99
  v_mfma_f32_16x16x32_bf16 a[24:27], a[164:167], v[136:139], a[24:27]
  v_exp_f32 v100, v100
  v_mfma_f32_16x16x32_bf16 a[28:31], a[164:167], v[140:143], a[28:31]
  buffer_load_dwordx4 v11, s[28:31], s58 offen offset:1024 lds
  v_mfma_f32_16x16x32_bf16 a[32:35], a[168:171], v[128:131], a[32:35]
  s_add_u32 s58, s58, 8192
  v_exp_f32 v101, v101
  v_mfma_f32_16x16x32_bf16 a[36:39], a[168:171], v[132:135], a[36:39]
  ds_read_b128 a[140:143], v17 offset:16640
  v_cvt_pk_bf16_f32 v148, v100, v101
  v_mfma_f32_16x16x32_bf16 a[40:43], a[168:171], v[136:139], a[40:43]
  s_add_u32 m0, s57, 149760
  v_exp_f32 v102, v102
  v_mfma_f32_16x16x32_bf16 a[44:47], a[168:171], v[140:143], a[44:47]
  v_mfma_f32_16x16x32_bf16 a[48:51], a[172:175], v[128:131], a[48:51]
  v_exp_f32 v103, v103
  v_mfma_f32_16x16x32_bf16 a[52:55], a[172:175], v[132:135], a[52:55]
  ds_read_b128 a[144:147], v14 offset:20736
  v_cvt_pk_bf16_f32 v149, v102, v103
  v_mfma_f32_16x16x32_bf16 a[56:59], a[172:175], v[136:139], a[56:59]
  v_exp_f32 v104, v104
  v_mfma_f32_16x16x32_bf16 a[60:63], a[172:175], v[140:143], a[60:63]
  ds_read_b128 a[148:151], v15 offset:20736
  buffer_load_dwordx4 v12, s[32:35], s59 offen lds
  v_mfma_f32_16x16x32_bf16 a[64:67], a[176:179], v[128:131], a[64:67]
  v_exp_f32 v105, v105
  v_mfma_f32_16x16x32_bf16 a[68:71], a[176:179], v[132:135], a[68:71]
  buffer_load_dwordx4 v13, s[32:35], s59 offen offset:1056 lds
  v_cvt_pk_bf16_f32 v152, v104, v105
  v_mfma_f32_16x16x32_bf16 a[72:75], a[176:179], v[136:139], a[72:75]
  v_exp_f32 v106, v106
  v_mfma_f32_16x16x32_bf16 a[76:79], a[176:179], v[140:143], a[76:79]
  ds_read_b128 a[152:155], v16 offset:20736
  v_add_f32 v62, v62, v104
  v_mfma_f32_16x16x32_bf16 a[80:83], a[180:183], v[128:131], a[80:83]
  s_add_u32 s59, s59, 8192
  v_exp_f32 v107, v107
  v_mfma_f32_16x16x32_bf16 a[84:87], a[180:183], v[132:135], a[84:87]
  v_cvt_pk_bf16_f32 v153, v106, v107
  v_add_f32 v62, v62, v105
  v_mfma_f32_16x16x32_bf16 a[88:91], a[180:183], v[136:139], a[88:91]
  v_exp_f32 v108, v108
  v_mfma_f32_16x16x32_bf16 a[92:95], a[180:183], v[140:143], a[92:95]
  ds_read_b128 a[156:159], v17 offset:20736
  buffer_load_dword v35, v34, s[24:27], s100 offen
  v_mfma_f32_16x16x32_bf16 a[96:99], a[184:187], v[128:131], a[96:99]
  v_exp_f32 v109, v109
  v_mfma_f32_16x16x32_bf16 a[100:103], a[184:187], v[132:135], a[100:103]
  v_cvt_pk_bf16_f32 v156, v108, v109
  v_add_f32 v62, v62, v106
  v_mfma_f32_16x16x32_bf16 a[104:107], a[184:187], v[136:139], a[104:107]
  s_add_u32 s100, s100, 393216
  v_exp_f32 v110, v110
  v_mfma_f32_16x16x32_bf16 a[108:111], a[184:187], v[140:143], a[108:111]
  v_add_f32 v62, v62, v107
  v_add_f32 v63, v63, v108
  v_mfma_f32_16x16x32_bf16 a[112:115], a[188:191], v[128:131], a[112:115]
TP_9:
  s_cbranch_execz TR_2
  v_exp_f32 v111, v111
  v_mfma_f32_16x16x32_bf16 a[116:119], a[188:191], v[132:135], a[116:119]
  v_cvt_pk_bf16_f32 v157, v110, v111
  v_add_f32 v63, v63, v109
  v_mfma_f32_16x16x32_bf16 a[120:123], a[188:191], v[136:139], a[120:123]
  v_add_f32 v63, v63, v110
  v_add_f32 v63, v63, v111
  v_mfma_f32_16x16x32_bf16 a[124:127], a[188:191], v[140:143], a[124:127]
  s_waitcnt lgkmcnt(0)
  v_mfma_f32_16x16x32_bf16 v[64:67], a[128:131], v[192:195], v[160:163]
  v_exp_f32 v112, v112
  v_mfma_f32_16x16x32_bf16 v[68:71], a[128:131], v[208:211], v[164:167]
  v_exp_f32 v113, v113
  v_mfma_f32_16x16x32_bf16 v[72:75], a[128:131], v[224:227], v[168:171]
  ds_read_b64_tr_b16 a[160:161], v18 offset:24832
  v_cvt_pk_bf16_f32 v146, v112, v113
  v_mfma_f32_16x16x32_bf16 v[76:79], a[128:131], v[240:243], v[172:175]
  v_exp_f32 v114, v114
  v_mfma_f32_16x16x32_bf16 v[64:67], a[132:135], v[196:199], v[64:67]
  ds_read_b64_tr_b16 a[162:163], v18 offset:25344
  ds_read_b64_tr_b16 a[164:165], v18 offset:24864
  v_mfma_f32_16x16x32_bf16 v[68:71], a[132:135], v[212:215], v[68:71]
  v_exp_f32 v115, v115
  v_mfma_f32_16x16x32_bf16 v[72:75], a[132:135], v[228:231], v[72:75]
  ds_read_b64_tr_b16 a[166:167], v18 offset:25376
  v_cvt_pk_bf16_f32 v147, v114, v115
  v_mfma_f32_16x16x32_bf16 v[76:79], a[132:135], v[244:247], v[76:79]
  v_exp_f32 v116, v116
  v_mfma_f32_16x16x32_bf16 v[64:67], a[136:139], v[200:203], v[64:67]
  ds_read_b64_tr_b16 a[168:169], v18 offset:24896
  ds_read_b64_tr_b16 a[170:171], v18 offset:25408
  v_mfma_f32_16x16x32_bf16 v[68:71], a[136:139], v[216:219], v[68:71]
  v_exp_f32 v117, v117
  v_mfma_f32_16x16x32_bf16 v[72:75], a[136:139], v[232:235], v[72:75]
  ds_read_b64_tr_b16 a[172:173], v18 offset:24928
  v_cvt_pk_bf16_f32 v150, v116, v117
  v_mfma_f32_16x16x32_bf16 v[76:79], a[136:139], v[248:251], v[76:79]
  v_exp_f32 v118, v118
  v_mfma_f32_16x16x32_bf16 v[64:67], a[140:143], v[204:207], v[64:67]
  ds_read_b64_tr_b16 a[174:175], v18 offset:25440
  v_mfma_f32_16x16x32_bf16 v[68:71], a[140:143], v[220:223], v[68:71]
  v_exp_f32 v119, v119
  v_mfma_f32_16x16x32_bf16 v[72:75], a[140:143], v[236:239], v[72:75]
  ds_read_b64_tr_b16 a[176:177], v18 offset:24960
  v_cvt_pk_bf16_f32 v151, v118, v119
  v_mfma_f32_16x16x32_bf16 v[76:79], a[140:143], v[252:255], v[76:79]
  v_exp_f32 v120, v120
  v_mfma_f32_16x16x32_bf16 v[80:83], a[144:147], v[192:195], v[160:163]
  v_exp_f32 v121, v121
  v_mfma_f32_16x16x32_bf16 v[84:87], a[144:147], v[208:211], v[164:167]
  ds_read_b64_tr_b16 a[178:179], v18 offset:25472
  ds_read_b64_tr_b16 a[180:181], v18 offset:24992
  v_cvt_pk_bf16_f32 v154, v120, v121
  v_mfma_f32_16x16x32_bf16 v[88:91], a[144:147], v[224:227], v[168:171]
  v_exp_f32 v122, v122
  v_mfma_f32_16x16x32_bf16 v[92:95], a[144:147], v[240:243], v[172:175]
  ds_read_b64_tr_b16 a[182:183], v18 offset:25504
  ds_read_b64_tr_b16 a[184:185], v18 offset:25024
  v_mfma_f32_16x16x32_bf16 v[80:83], a[148:151], v[196:199], v[80:83]
  v_exp_f32 v123, v123
  v_mfma_f32_16x16x32_bf16 v[84:87], a[148:151], v[212:215], v[84:87]
  ds_read_b64_tr_b16 a[186:187], v18 offset:25536
  v_cvt_pk_bf16_f32 v155, v122, v123
  v_mfma_f32_16x16x32_bf16 v[88:91], a[148:151], v[228:231], v[88:91]
  v_exp_f32 v124, v124
  v_mfma_f32_16x16x32_bf16 v[92:95], a[148:151], v[244:247], v[92:95]
  ds_read_b64_tr_b16 a[188:189], v18 offset:25056
  v_add_f32 v62, v62, v120
  v_mfma_f32_16x16x32_bf16 v[80:83], a[152:155], v[200:203], v[80:83]
  v_exp_f32 v125, v125
  v_mfma_f32_16x16x32_bf16 v[84:87], a[152:155], v[216:219], v[84:87]
  ds_read_b64_tr_b16 a[190:191], v18 offset:25568
  v_cvt_pk_bf16_f32 v158, v124, v125
  v_mfma_f32_16x16x32_bf16 v[88:91], a[152:155], v[232:235], v[88:91]
  v_exp_f32 v126, v126
  v_mfma_f32_16x16x32_bf16 v[92:95], a[152:155], v[248:251], v[92:95]
  v_add_f32 v62, v62, v121
  v_add_f32 v62, v62, v122
  v_mfma_f32_16x16x32_bf16 v[80:83], a[156:159], v[204:207], v[80:83]
  v_exp_f32 v127, v127
  v_mfma_f32_16x16x32_bf16 v[84:87], a[156:159], v[220:223], v[84:87]
  v_cvt_pk_bf16_f32 v159, v126, v127
  v_add_f32 v62, v62, v123
  v_mfma_f32_16x16x32_bf16 v[88:91], a[156:159], v[236:239], v[88:91]
  v_add_f32 v63, v63, v124
  v_add_f32 v63, v63, v125
  v_mfma_f32_16x16x32_bf16 v[92:95], a[156:159], v[252:255], v[92:95]
  s_waitcnt vmcnt(17) lgkmcnt(0)
  s_barrier
  v_mfma_f32_16x16x32_bf16 v[176:179], v[36:39], v[144:147], v[176:179]
  s_add_u32 m0, s56, 58368
  v_exp_f32 v64, v64
  v_mfma_f32_16x16x32_bf16 v[180:183], v[36:39], v[148:151], v[180:183]
  ds_read_b128 a[128:131], v14 offset:33280
  v_add_f32 v63, v63, v126
  v_mfma_f32_16x16x32_bf16 a[0:3], a[160:163], v[144:147], a[0:3]
  v_exp_f32 v65, v65
  v_mfma_f32_16x16x32_bf16 a[4:7], a[160:163], v[148:151], a[4:7]
  ds_read_b128 a[132:135], v15 offset:33280
  v_cvt_pk_bf16_f32 v128, v64, v65
  v_mfma_f32_16x16x32_bf16 a[8:11], a[160:163], v[152:155], a[8:11]
  v_exp_f32 v66, v66
  v_mfma_f32_16x16x32_bf16 a[12:15], a[160:163], v[156:159], a[12:15]
  buffer_load_dwordx4 v10, s[28:31], s58 offen lds
  v_add_f32 v63, v63, v127
  v_mfma_f32_16x16x32_bf16 a[16:19], a[164:167], v[144:147], a[16:19]
  v_exp_f32 v67, v67
  v_mfma_f32_16x16x32_bf16 a[20:23], a[164:167], v[148:151], a[20:23]
  ds_read_b128 a[136:139], v16 offset:33280
  v_cvt_pk_bf16_f32 v129, v66, v67
  v_mfma_f32_16x16x32_bf16 a[24:27], a[164:167], v[152:155], a[24:27]
  v_exp_f32 v68, v68
  v_mfma_f32_16x16x32_bf16 a[28:31], a[164:167], v[156:159], a[28:31]
  buffer_load_dwordx4 v11, s[28:31], s58 offen offset:1024 lds
  v_mfma_f32_16x16x32_bf16 a[32:35], a[168:171], v[144:147], a[32:35]
  s_add_u32 s58, s58, 8192
  v_exp_f32 v69, v69
  v_mfma_f32_16x16x32_bf16 a[36:39], a[168:171], v[148:151], a[36:39]
  ds_read_b128 a[140:143], v17 offset:33280
  v_cvt_pk_bf16_f32 v132, v68, v69
  v_mfma_f32_16x16x32_bf16 a[40:43], a[168:171], v[152:155], a[40:43]
  s_add_u32 m0, s57, 66560
  v_exp_f32 v70, v70
  v_mfma_f32_16x16x32_bf16 a[44:47], a[168:171], v[156:159], a[44:47]
  v_mfma_f32_16x16x32_bf16 a[48:51], a[172:175], v[144:147], a[48:51]
  v_exp_f32 v71, v71
  v_mfma_f32_16x16x32_bf16 a[52:55], a[172:175], v[148:151], a[52:55]
  ds_read_b128 a[144:147], v14 offset:37376
  v_cvt_pk_bf16_f32 v133, v70, v71
  v_mfma_f32_16x16x32_bf16 a[56:59], a[172:175], v[152:155], a[56:59]
  v_exp_f32 v72, v72
  v_mfma_f32_16x16x32_bf16 a[60:63], a[172:175], v[156:159], a[60:63]
  ds_read_b128 a[148:151], v15 offset:37376
  buffer_load_dwordx4 v12, s[32:35], s59 offen lds
  v_mfma_f32_16x16x32_bf16 a[64:67], a[176:179], v[144:147], a[64:67]
  v_exp_f32 v73, v73
  v_mfma_f32_16x16x32_bf16 a[68:71], a[176:179], v[148:151], a[68:71]
  buffer_load_dwordx4 v13, s[32:35], s59 offen offset:1056 lds
  v_cvt_pk_bf16_f32 v136, v72, v73
  v_mfma_f32_16x16x32_bf16 a[72:75], a[176:179], v[152:155], a[72:75]
  v_exp_f32 v74, v74
  v_mfma_f32_16x16x32_bf16 a[76:79], a[176:179], v[156:159], a[76:79]
  ds_read_b128 a[152:155], v16 offset:37376
  v_add_f32 v62, v62, v72
  v_mfma_f32_16x16x32_bf16 a[80:83], a[180:183], v[144:147], a[80:83]
  s_add_u32 s59, s59, 8192
  v_exp_f32 v75, v75
  v_mfma_f32_16x16x32_bf16 a[84:87], a[180:183], v[148:151], a[84:87]
  v_cvt_pk_bf16_f32 v137, v74, v75
  v_add_f32 v62, v62, v73
  v_mfma_f32_16x16x32_bf16 a[88:91], a[180:183], v[152:155], a[88:91]
  v_exp_f32 v76, v76
  v_mfma_f32_16x16x32_bf16 a[92:95], a[180:183], v[156:159], a[92:95]
  ds_read_b128 a[156:159], v17 offset:37376
  buffer_load_dword v35, v34, s[24:27], s100 offen
  v_mfma_f32_16x16x32_bf16 a[96:99], a[184:187], v[144:147], a[96:99]
  v_exp_f32 v77, v77
  v_mfma_f32_16x16x32_bf16 a[100:103], a[184:187], v[148:151], a[100:103]
  v_cvt_pk_bf16_f32 v140, v76, v77
  v_add_f32 v62, v62, v74
  v_mfma_f32_16x16x32_bf16 a[104:107], a[184:187], v[152:155], a[104:107]
  s_add_u32 s100, s100, 393216
  v_exp_f32 v78, v78
  v_mfma_f32_16x16x32_bf16 a[108:111], a[184:187], v[156:159], a[108:111]
  v_add_f32 v62, v62, v75
  v_add_f32 v63, v63, v76
  v_mfma_f32_16x16x32_bf16 a[112:115], a[188:191], v[144:147], a[112:115]
  v_exp_f32 v79, v79
  v_mfma_f32_16x16x32_bf16 a[116:119], a[188:191], v[148:151], a[116:119]
  v_cvt_pk_bf16_f32 v141, v78, v79
  v_add_f32 v63, v63, v77
  v_mfma_f32_16x16x32_bf16 a[120:123], a[188:191], v[152:155], a[120:123]
  v_add_f32 v63, v63, v78
  v_add_f32 v63, v63, v79
  v_mfma_f32_16x16x32_bf16 a[124:127], a[188:191], v[156:159], a[124:127]
  s_waitcnt lgkmcnt(0)
  v_mfma_f32_16x16x32_bf16 v[96:99], a[128:131], v[192:195], v[160:163]
  v_exp_f32 v80, v80
  v_mfma_f32_16x16x32_bf16 v[100:103], a[128:131], v[208:211], v[164:167]
  v_exp_f32 v81, v81
  v_mfma_f32_16x16x32_bf16 v[104:107], a[128:131], v[224:227], v[168:171]
  ds_read_b64_tr_b16 a[160:161], v18 offset:41472
  v_cvt_pk_bf16_f32 v130, v80, v81
  v_mfma_f32_16x16x32_bf16 v[108:111], a[128:131], v[240:243], v[172:175]
  v_exp_f32 v82, v82
  v_mfma_f32_16x16x32_bf16 v[96:99], a[132:135], v[196:199], v[96:99]
  ds_read_b64_tr_b16 a[162:163], v18 offset:41984
  ds_read_b64_tr_b16 a[164:165], v18 offset:41504
  v_mfma_f32_16x16x32_bf16 v[100:103], a[132:135], v[212:215], v[100:103]
  v_exp_f32 v83, v83
  v_mfma_f32_16x16x32_bf16 v[104:107], a[132:135], v[228:231], v[104:107]
  ds_read_b64_tr_b16 a[166:167], v18 offset:42016
  v_cvt_pk_bf16_f32 v131, v82, v83
  v_mfma_f32_16x16x32_bf16 v[108:111], a[132:135], v[244:247], v[108:111]
  v_exp_f32 v84, v84
  v_mfma_f32_16x16x32_bf16 v[96:99], a[136:139], v[200:203], v[96:99]
  ds_read_b64_tr_b16 a[168:169], v18 offset:41536
  ds_read_b64_tr_b16 a[170:171], v18 offset:42048
  v_mfma_f32_16x16x32_bf16 v[100:103], a[136:139], v[216:219], v[100:103]
  v_exp_f32 v85, v85
  v_mfma_f32_16x16x32_bf16 v[104:107], a[136:139], v[232:235], v[104:107]
  ds_read_b64_tr_b16 a[172:173], v18 offset:41568
  v_cvt_pk_bf16_f32 v134, v84, v85
  v_mfma_f32_16x16x32_bf16 v[108:111], a[136:139], v[248:251], v[108:111]
  v_exp_f32 v86, v86
  v_mfma_f32_16x16x32_bf16 v[96:99], a[140:143], v[204:207], v[96:99]
  ds_read_b64_tr_b16 a[174:175], v18 offset:42080
  v_mfma_f32_16x16x32_bf16 v[100:103], a[140:143], v[220:223], v[100:103]
  v_exp_f32 v87, v87
  v_mfma_f32_16x16x32_bf16 v[104:107], a[140:143], v[236:239], v[104:107]
  ds_read_b64_tr_b16 a[176:177], v18 offset:41600
  v_cvt_pk_bf16_f32 v135, v86, v87
  v_mfma_f32_16x16x32_bf16 v[108:111], a[140:143], v[252:255], v[108:111]
  v_exp_f32 v88, v88
  v_mfma_f32_16x16x32_bf16 v[112:115], a[144:147], v[192:195], v[160:163]
  v_exp_f32 v89, v89
  v_mfma_f32_16x16x32_bf16 v[116:119], a[144:147], v[208:211], v[164:167]
  ds_read_b64_tr_b16 a[178:179], v18 offset:42112
  ds_read_b64_tr_b16 a[180:181], v18 offset:41632
  v_cvt_pk_bf16_f32 v138, v88, v89
  v_mfma_f32_16x16x32_bf16 v[120:123], a[144:147], v[224:227], v[168:171]
  v_exp_f32 v90, v90
  v_mfma_f32_16x16x32_bf16 v[124:127], a[144:147], v[240:243], v[172:175]
  ds_read_b64_tr_b16 a[182:183], v18 offset:42144
  ds_read_b64_tr_b16 a[184:185], v18 offset:41664
  v_mfma_f32_16x16x32_bf16 v[112:115], a[148:151], v[196:199], v[112:115]
  v_exp_f32 v91, v91
  v_mfma_f32_16x16x32_bf16 v[116:119], a[148:151], v[212:215], v[116:119]
  ds_read_b64_tr_b16 a[186:187], v18 offset:42176
  v_cvt_pk_bf16_f32 v139, v90, v91
  v_mfma_f32_16x16x32_bf16 v[120:123], a[148:151], v[228:231], v[120:123]
  v_exp_f32 v92, v92
  v_mfma_f32_16x16x32_bf16 v[124:127], a[148:151], v[244:247], v[124:127]
  ds_read_b64_tr_b16 a[188:189], v18 offset:41696
  v_add_f32 v62, v62, v88
  v_mfma_f32_16x16x32_bf16 v[112:115], a[152:155], v[200:203], v[112:115]
  v_exp_f32 v93, v93
  v_mfma_f32_16x16x32_bf16 v[116:119], a[152:155], v[216:219], v[116:119]
  ds_read_b64_tr_b16 a[190:191], v18 offset:42208
  v_cvt_pk_bf16_f32 v142, v92, v93
  v_mfma_f32_16x16x32_bf16 v[120:123], a[152:155], v[232:235], v[120:123]
  v_exp_f32 v94, v94
  v_mfma_f32_16x16x32_bf16 v[124:127], a[152:155], v[248:251], v[124:127]
  v_add_f32 v62, v62, v89
  v_add_f32 v62, v62, v90
  v_mfma_f32_16x16x32_bf16 v[112:115], a[156:159], v[204:207], v[112:115]
  v_exp_f32 v95, v95
  v_mfma_f32_16x16x32_bf16 v[116:119], a[156:159], v[220:223], v[116:119]
  v_cvt_pk_bf16_f32 v143, v94, v95
  v_add_f32 v62, v62, v91
  v_mfma_f32_16x16x32_bf16 v[120:123], a[156:159], v[236:239], v[120:123]
  v_add_f32 v63, v63, v92
  v_add_f32 v63, v63, v93
  v_mfma_f32_16x16x32_bf16 v[124:127], a[156:159], v[252:255], v[124:127]
  s_waitcnt vmcnt(17) lgkmcnt(0)
  s_barrier
  v_mfma_f32_16x16x32_bf16 v[176:179], v[36:39], v[128:131], v[176:179]
  s_add_u32 m0, s56, 75008
  v_exp_f32 v96, v96
  v_mfma_f32_16x16x32_bf16 v[180:183], v[36:39], v[132:135], v[180:183]
  ds_read_b128 a[128:131], v48 offset:0
  v_add_f32 v63, v63, v94
  v_mfma_f32_16x16x32_bf16 a[0:3], a[160:163], v[128:131], a[0:3]
  v_exp_f32 v97, v97
  v_mfma_f32_16x16x32_bf16 a[4:7], a[160:163], v[132:135], a[4:7]
  ds_read_b128 a[132:135], v49 offset:0
  v_cvt_pk_bf16_f32 v144, v96, v97
  v_mfma_f32_16x16x32_bf16 a[8:11], a[160:163], v[136:139], a[8:11]
  v_exp_f32 v98, v98
  v_mfma_f32_16x16x32_bf16 a[12:15], a[160:163], v[140:143], a[12:15]
  buffer_load_dwordx4 v10, s[28:31], s58 offen lds
  v_add_f32 v63, v63, v95
  v_mfma_f32_16x16x32_bf16 a[16:19], a[164:167], v[128:131], a[16:19]
  v_exp_f32 v99, v99
  v_mfma_f32_16x16x32_bf16 a[20:23], a[164:167], v[132:135], a[20:23]
  ds_read_b128 a[136:139], v50 offset:0
  v_cvt_pk_bf16_f32 v145, v98, v99
  v_mfma_f32_16x16x32_bf16 a[24:27], a[164:167], v[136:139], a[24:27]
  v_exp_f32 v100, v100
  v_mfma_f32_16x16x32_bf16 a[28:31], a[164:167], v[140:143], a[28:31]
  buffer_load_dwordx4 v11, s[28:31], s58 offen offset:1024 lds
  v_mfma_f32_16x16x32_bf16 a[32:35], a[168:171], v[128:131], a[32:35]
  s_add_u32 s58, s58, 8192
  v_exp_f32 v101, v101
  v_mfma_f32_16x16x32_bf16 a[36:39], a[168:171], v[132:135], a[36:39]
  ds_read_b128 a[140:143], v51 offset:0
  v_cvt_pk_bf16_f32 v148, v100, v101
  v_mfma_f32_16x16x32_bf16 a[40:43], a[168:171], v[136:139], a[40:43]
  s_add_u32 m0, s57, 83200
  v_exp_f32 v102, v102
  v_mfma_f32_16x16x32_bf16 a[44:47], a[168:171], v[140:143], a[44:47]
  v_mfma_f32_16x16x32_bf16 a[48:51], a[172:175], v[128:131], a[48:51]
  v_exp_f32 v103, v103
  v_mfma_f32_16x16x32_bf16 a[52:55], a[172:175], v[132:135], a[52:55]
  ds_read_b128 a[144:147], v48 offset:4096
  v_cvt_pk_bf16_f32 v149, v102, v103
  v_mfma_f32_16x16x32_bf16 a[56:59], a[172:175], v[136:139], a[56:59]
  v_exp_f32 v104, v104
  v_mfma_f32_16x16x32_bf16 a[60:63], a[172:175], v[140:143], a[60:63]
  ds_read_b128 a[148:151], v49 offset:4096
  buffer_load_dwordx4 v12, s[32:35], s59 offen lds
  v_mfma_f32_16x16x32_bf16 a[64:67], a[176:179], v[128:131], a[64:67]
  v_exp_f32 v105, v105
  v_mfma_f32_16x16x32_bf16 a[68:71], a[176:179], v[132:135], a[68:71]
  buffer_load_dwordx4 v13, s[32:35], s59 offen offset:1056 lds
  v_cvt_pk_bf16_f32 v152, v104, v105
  v_mfma_f32_16x16x32_bf16 a[72:75], a[176:179], v[136:139], a[72:75]
  v_exp_f32 v106, v106
  v_mfma_f32_16x16x32_bf16 a[76:79], a[176:179], v[140:143], a[76:79]
  ds_read_b128 a[152:155], v50 offset:4096
  v_add_f32 v62, v62, v104
  v_mfma_f32_16x16x32_bf16 a[80:83], a[180:183], v[128:131], a[80:83]
  s_add_u32 s59, s59, 8192
  v_exp_f32 v107, v107
  v_mfma_f32_16x16x32_bf16 a[84:87], a[180:183], v[132:135], a[84:87]
  v_cvt_pk_bf16_f32 v153, v106, v107
  v_add_f32 v62, v62, v105
  v_mfma_f32_16x16x32_bf16 a[88:91], a[180:183], v[136:139], a[88:91]
  v_exp_f32 v108, v108
  v_mfma_f32_16x16x32_bf16 a[92:95], a[180:183], v[140:143], a[92:95]
  ds_read_b128 a[156:159], v51 offset:4096
  buffer_load_dword v35, v34, s[24:27], s100 offen
  v_mfma_f32_16x16x32_bf16 a[96:99], a[184:187], v[128:131], a[96:99]
  v_exp_f32 v109, v109
  v_mfma_f32_16x16x32_bf16 a[100:103], a[184:187], v[132:135], a[100:103]
  v_cvt_pk_bf16_f32 v156, v108, v109
  v_add_f32 v62, v62, v106
  v_mfma_f32_16x16x32_bf16 a[104:107], a[184:187], v[136:139], a[104:107]
  s_add_u32 s100, s100, 393216
  v_exp_f32 v110, v110
  v_mfma_f32_16x16x32_bf16 a[108:111], a[184:187], v[140:143], a[108:111]
  v_add_f32 v62, v62, v107
  v_add_f32 v63, v63, v108
  v_mfma_f32_16x16x32_bf16 a[112:115], a[188:191], v[128:131], a[112:115]
  v_exp_f32 v111, v111
  v_mfma_f32_16x16x32_bf16 a[116:119], a[188:191], v[132:135], a[116:119]
  v_cvt_pk_bf16_f32 v157, v110, v111
  v_add_f32 v63, v63, v109
  v_mfma_f32_16x16x32_bf16 a[120:123], a[188:191], v[136:139], a[120:123]
  v_add_f32 v63, v63, v110
  v_add_f32 v63, v63, v111
  v_mfma_f32_16x16x32_bf16 a[124:127], a[188:191], v[140:143], a[124:127]
  s_waitcnt lgkmcnt(0)
  v_mfma_f32_16x16x32_bf16 v[64:67], a[128:131], v[192:195], v[160:163]
  v_exp_f32 v112, v112
  v_mfma_f32_16x16x32_bf16 v[68:71], a[128:131], v[208:211], v[164:167]
  v_exp_f32 v113, v113
  v_mfma_f32_16x16x32_bf16 v[72:75], a[128:131], v[224:227], v[168:171]
  ds_read_b64_tr_b16 a[160:161], v52 offset:8192
  v_cvt_pk_bf16_f32 v146, v112, v113
  v_mfma_f32_16x16x32_bf16 v[76:79], a[128:131], v[240:243], v[172:175]
  v_exp_f32 v114, v114
  v_mfma_f32_16x16x32_bf16 v[64:67], a[132:135], v[196:199], v[64:67]
  ds_read_b64_tr_b16 a[162:163], v52 offset:8704
  ds_read_b64_tr_b16 a[164:165], v52 offset:8224
  v_mfma_f32_16x16x32_bf16 v[68:71], a[132:135], v[212:215], v[68:71]
  v_exp_f32 v115, v115
  v_mfma_f32_16x16x32_bf16 v[72:75], a[132:135], v[228:231], v[72:75]
  ds_read_b64_tr_b16 a[166:167], v52 offset:8736
  v_cvt_pk_bf16_f32 v147, v114, v115
  v_mfma_f32_16x16x32_bf16 v[76:79], a[132:135], v[244:247], v[76:79]
  v_exp_f32 v116, v116
  v_mfma_f32_16x16x32_bf16 v[64:67], a[136:139], v[200:203], v[64:67]
  ds_read_b64_tr_b16 a[168:169], v52 offset:8256
  ds_read_b64_tr_b16 a[170:171], v52 offset:8768
  v_mfma_f32_16x16x32_bf16 v[68:71], a[136:139], v[216:219], v[68:71]
  v_exp_f32 v117, v117
  v_mfma_f32_16x16x32_bf16 v[72:75], a[136:139], v[232:235], v[72:75]
  ds_read_b64_tr_b16 a[172:173], v52 offset:8288
  v_cvt_pk_bf16_f32 v150, v116, v117
  v_mfma_f32_16x16x32_bf16 v[76:79], a[136:139], v[248:251], v[76:79]
  v_exp_f32 v118, v118
  v_mfma_f32_16x16x32_bf16 v[64:67], a[140:143], v[204:207], v[64:67]
  ds_read_b64_tr_b16 a[174:175], v52 offset:8800
  v_mfma_f32_16x16x32_bf16 v[68:71], a[140:143], v[220:223], v[68:71]
  v_exp_f32 v119, v119
  v_mfma_f32_16x16x32_bf16 v[72:75], a[140:143], v[236:239], v[72:75]
  ds_read_b64_tr_b16 a[176:177], v52 offset:8320
  v_cvt_pk_bf16_f32 v151, v118, v119
  v_mfma_f32_16x16x32_bf16 v[76:79], a[140:143], v[252:255], v[76:79]
  v_exp_f32 v120, v120
  v_mfma_f32_16x16x32_bf16 v[80:83], a[144:147], v[192:195], v[160:163]
  v_exp_f32 v121, v121
  v_mfma_f32_16x16x32_bf16 v[84:87], a[144:147], v[208:211], v[164:167]
  ds_read_b64_tr_b16 a[178:179], v52 offset:8832
  ds_read_b64_tr_b16 a[180:181], v52 offset:8352
  v_cvt_pk_bf16_f32 v154, v120, v121
  v_mfma_f32_16x16x32_bf16 v[88:91], a[144:147], v[224:227], v[168:171]
  v_exp_f32 v122, v122
  v_mfma_f32_16x16x32_bf16 v[92:95], a[144:147], v[240:243], v[172:175]
  ds_read_b64_tr_b16 a[182:183], v52 offset:8864
  ds_read_b64_tr_b16 a[184:185], v52 offset:8384
  v_mfma_f32_16x16x32_bf16 v[80:83], a[148:151], v[196:199], v[80:83]
  v_exp_f32 v123, v123
  v_mfma_f32_16x16x32_bf16 v[84:87], a[148:151], v[212:215], v[84:87]
  ds_read_b64_tr_b16 a[186:187], v52 offset:8896
  v_cvt_pk_bf16_f32 v155, v122, v123
  v_mfma_f32_16x16x32_bf16 v[88:91], a[148:151], v[228:231], v[88:91]
  v_exp_f32 v124, v124
  v_mfma_f32_16x16x32_bf16 v[92:95], a[148:151], v[244:247], v[92:95]
  ds_read_b64_tr_b16 a[188:189], v52 offset:8416
  v_add_f32 v62, v62, v120
  v_mfma_f32_16x16x32_bf16 v[80:83], a[152:155], v[200:203], v[80:83]
  v_exp_f32 v125, v125
  v_mfma_f32_16x16x32_bf16 v[84:87], a[152:155], v[216:219], v[84:87]
  ds_read_b64_tr_b16 a[190:191], v52 offset:8928
  v_cvt_pk_bf16_f32 v158, v124, v125
  v_mfma_f32_16x16x32_bf16 v[88:91], a[152:155], v[232:235], v[88:91]
  v_exp_f32 v126, v126
  v_mfma_f32_16x16x32_bf16 v[92:95], a[152:155], v[248:251], v[92:95]
  v_add_f32 v62, v62, v121
  v_add_f32 v62, v62, v122
  v_mfma_f32_16x16x32_bf16 v[80:83], a[156:159], v[204:207], v[80:83]
  v_exp_f32 v127, v127
  v_mfma_f32_16x16x32_bf16 v[84:87], a[156:159], v[220:223], v[84:87]
  v_cvt_pk_bf16_f32 v159, v126, v127
  v_add_f32 v62, v62, v123
  v_mfma_f32_16x16x32_bf16 v[88:91], a[156:159], v[236:239], v[88:91]
  v_add_f32 v63, v63, v124
  v_add_f32 v63, v63, v125
  v_mfma_f32_16x16x32_bf16 v[92:95], a[156:159], v[252:255], v[92:95]
  s_waitcnt vmcnt(16) lgkmcnt(0)
  s_barrier
  v_mfma_f32_16x16x32_bf16 v[176:179], v[36:39], v[144:147], v[176:179]
  s_add_u32 m0, s56, 91648
  v_exp_f32 v64, v64
  v_mfma_f32_16x16x32_bf16 v[180:183], v[36:39], v[148:151], v[180:183]
  ds_read_b128 a[128:131], v48 offset:16640
  v_add_f32 v63, v63, v126
  v_mfma_f32_16x16x32_bf16 a[0:3], a[160:163], v[144:147], a[0:3]
  v_exp_f32 v65, v65
  v_mfma_f32_16x16x32_bf16 a[4:7], a[160:163], v[148:151], a[4:7]
  ds_read_b128 a[132:135], v49 offset:16640
  v_cvt_pk_bf16_f32 v128, v64, v65
  v_mfma_f32_16x16x32_bf16 a[8:11], a[160:163], v[152:155], a[8:11]
  v_exp_f32 v66, v66
  v_mfma_f32_16x16x32_bf16 a[12:15], a[160:163], v[156:159], a[12:15]
  buffer_load_dwordx4 v10, s[28:31], s58 offen lds
  v_add_f32 v63, v63, v127
  v_mfma_f32_16x16x32_bf16 a[16:19], a[164:167], v[144:147], a[16:19]
  v_exp_f32 v67, v67
  v_mfma_f32_16x16x32_bf16 a[20:23], a[164:167], v[148:151], a[20:23]
  ds_read_b128 a[136:139], v50 offset:16640
  v_cvt_pk_bf16_f32 v129, v66, v67
  v_mfma_f32_16x16x32_bf16 a[24:27], a[164:167], v[152:155], a[24:27]
  v_exp_f32 v68, v68
  v_mfma_f32_16x16x32_bf16 a[28:31], a[164:167], v[156:159], a[28:31]
  buffer_load_dwordx4 v11, s[28:31], s58 offen offset:1024 lds
  v_mfma_f32_16x16x32_bf16 a[32:35], a[168:171], v[144:147], a[32:35]
  s_add_u32 s58, s58, 8192
  v_exp_f32 v69, v69
  v_mfma_f32_16x16x32_bf16 a[36:39], a[168:171], v[148:151], a[36:39]
  ds_read_b128 a[140:143], v51 offset:16640
  v_cvt_pk_bf16_f32 v132, v68, v69
  v_mfma_f32_16x16x32_bf16 a[40:43], a[168:171], v[152:155], a[40:43]
  s_add_u32 m0, s57, 99840
  v_exp_f32 v70, v70
  v_mfma_f32_16x16x32_bf16 a[44:47], a[168:171], v[156:159], a[44:47]
  v_mfma_f32_16x16x32_bf16 a[48:51], a[172:175], v[144:147], a[48:51]
  v_exp_f32 v71, v71
  v_mfma_f32_16x16x32_bf16 a[52:55], a[172:175], v[148:151], a[52:55]
  ds_read_b128 a[144:147], v48 offset:20736
  v_cvt_pk_bf16_f32 v133, v70, v71
  v_mfma_f32_16x16x32_bf16 a[56:59], a[172:175], v[152:155], a[56:59]
  v_exp_f32 v72, v72
  v_mfma_f32_16x16x32_bf16 a[60:63], a[172:175], v[156:159], a[60:63]
  ds_read_b128 a[148:151], v49 offset:20736
  buffer_load_dwordx4 v12, s[32:35], s59 offen lds
  v_mfma_f32_16x16x32_bf16 a[64:67], a[176:179], v[144:147], a[64:67]
  v_exp_f32 v73, v73
  v_mfma_f32_16x16x32_bf16 a[68:71], a[176:179], v[148:151], a[68:71]
  buffer_load_dwordx4 v13, s[32:35], s59 offen offset:1056 lds
  v_cvt_pk_bf16_f32 v136, v72, v73
  v_mfma_f32_16x16x32_bf16 a[72:75], a[176:179], v[152:155], a[72:75]
  v_exp_f32 v74, v74
  v_mfma_f32_16x16x32_bf16 a[76:79], a[176:179], v[156:159], a[76:79]
  ds_read_b128 a[152:155], v50 offset:20736
  v_add_f32 v62, v62, v72
  v_mfma_f32_16x16x32_bf16 a[80:83], a[180:183], v[144:147], a[80:83]
  s_add_u32 s59, s59, 8192
  v_exp_f32 v75, v75
  v_mfma_f32_16x16x32_bf16 a[84:87], a[180:183], v[148:151], a[84:87]
  v_cvt_pk_bf16_f32 v137, v74, v75
  v_add_f32 v62, v62, v73
  v_mfma_f32_16x16x32_bf16 a[88:91], a[180:183], v[152:155], a[88:91]
  v_exp_f32 v76, v76
  v_mfma_f32_16x16x32_bf16 a[92:95], a[180:183], v[156:159], a[92:95]
  ds_read_b128 a[156:159], v51 offset:20736
  buffer_load_dword v35, v34, s[24:27], s100 offen
  v_mfma_f32_16x16x32_bf16 a[96:99], a[184:187], v[144:147], a[96:99]
  v_exp_f32 v77, v77
  v_mfma_f32_16x16x32_bf16 a[100:103], a[184:187], v[148:151], a[100:103]
  v_cvt_pk_bf16_f32 v140, v76, v77
  v_add_f32 v62, v62, v74
  v_mfma_f32_16x16x32_bf16 a[104:107], a[184:187], v[152:155], a[104:107]
  s_add_u32 s100, s100, 393216
  v_exp_f32 v78, v78
  v_mfma_f32_16x16x32_bf16 a[108:111], a[184:187], v[156:159], a[108:111]
  v_add_f32 v62, v62, v75
  v_add_f32 v63, v63, v76
  v_mfma_f32_16x16x32_bf16 a[112:115], a[188:191], v[144:147], a[112:115]
  v_exp_f32 v79, v79
  v_mfma_f32_16x16x32_bf16 a[116:119], a[188:191], v[148:151], a[116:119]
  v_cvt_pk_bf16_f32 v141, v78, v79
  v_add_f32 v63, v63, v77
  v_mfma_f32_16x16x32_bf16 a[120:123], a[188:191], v[152:155], a[120:123]
  v_add_f32 v63, v63, v78
  v_add_f32 v63, v63, v79
  v_mfma_f32_16x16x32_bf16 a[124:127], a[188:191], v[156:159], a[124:127]
  s_waitcnt lgkmcnt(0)
  v_mfma_f32_16x16x32_bf16 v[96:99], a[128:131], v[192:195], v[160:163]
  s_getpc_b64 s[6:7]
K_pc2:
  v_exp_f32 v80, v80
  v_mfma_f32_16x16x32_bf16 v[100:103], a[128:131], v[208:211], v[164:167]
  v_exp_f32 v81, v81
  v_mfma_f32_16x16x32_bf16 v[104:107], a[128:131], v[224:227], v[168:171]
  ds_read_b64_tr_b16 a[160:161], v52 offset:24832
  v_cvt_pk_bf16_f32 v130, v80, v81
  v_mfma_f32_16x16x32_bf16 v[108:111], a[128:131], v[240:243], v[172:175]
  v_exp_f32 v82, v82
  v_mfma_f32_16x16x32_bf16 v[96:99], a[132:135], v[196:199], v[96:99]
  ds_read_b64_tr_b16 a[162:163], v52 offset:25344
  ds_read_b64_tr_b16 a[164:165], v52 offset:24864
  v_mfma_f32_16x16x32_bf16 v[100:103], a[132:135], v[212:215], v[100:103]
  s_lshr_b32 s3, s2, 3
  v_exp_f32 v83, v83
  v_mfma_f32_16x16x32_bf16 v[104:107], a[132:135], v[228:231], v[104:107]
  ds_read_b64_tr_b16 a[166:167], v52 offset:25376
  v_cvt_pk_bf16_f32 v131, v82, v83
  v_mfma_f32_16x16x32_bf16 v[108:111], a[132:135], v[244:247], v[108:111]
  v_exp_f32 v84, v84
  v_mfma_f32_16x16x32_bf16 v[96:99], a[136:139], v[200:203], v[96:99]
  ds_read_b64_tr_b16 a[168:169], v52 offset:24896
  ds_read_b64_tr_b16 a[170:171], v52 offset:25408
  v_mfma_f32_16x16x32_bf16 v[100:103], a[136:139], v[216:219], v[100:103]
  v_exp_f32 v85, v85
  v_mfma_f32_16x16x32_bf16 v[104:107], a[136:139], v[232:235], v[104:107]
  s_lshl_b32 s3, s3, 11
  ds_read_b64_tr_b16 a[172:173], v52 offset:24928
  v_cvt_pk_bf16_f32 v134, v84, v85
  v_mfma_f32_16x16x32_bf16 v[108:111], a[136:139], v[248:251], v[108:111]
  v_exp_f32 v86, v86
  v_mfma_f32_16x16x32_bf16 v[96:99], a[140:143], v[204:207], v[96:99]
  ds_read_b64_tr_b16 a[174:175], v52 offset:25440
  v_mfma_f32_16x16x32_bf16 v[100:103], a[140:143], v[220:223], v[100:103]
  v_exp_f32 v87, v87
  v_mfma_f32_16x16x32_bf16 v[104:107], a[140:143], v[236:239], v[104:107]
  ds_read_b64_tr_b16 a[176:177], v52 offset:24960
  v_cvt_pk_bf16_f32 v135, v86, v87
  v_mfma_f32_16x16x32_bf16 v[108:111], a[140:143], v[252:255], v[108:111]
  v_exp_f32 v88, v88
  v_lshl_add_u32 v4, v0, 3, s3
  v_mfma_f32_16x16x32_bf16 v[112:115], a[144:147], v[192:195], v[160:163]
  v_exp_f32 v89, v89
  v_mfma_f32_16x16x32_bf16 v[116:119], a[144:147], v[208:211], v[164:167]
  ds_read_b64_tr_b16 a[178:179], v52 offset:25472
  ds_read_b64_tr_b16 a[180:181], v52 offset:24992
  v_cvt_pk_bf16_f32 v138, v88, v89
  v_mfma_f32_16x16x32_bf16 v[120:123], a[144:147], v[224:227], v[168:171]
  v_exp_f32 v90, v90
  v_mfma_f32_16x16x32_bf16 v[124:127], a[144:147], v[240:243], v[172:175]
  ds_read_b64_tr_b16 a[182:183], v52 offset:25504
  ds_read_b64_tr_b16 a[184:185], v52 offset:25024
  v_mfma_f32_16x16x32_bf16 v[112:115], a[148:151], v[196:199], v[112:115]
  v_exp_f32 v91, v91
  v_mfma_f32_16x16x32_bf16 v[116:119], a[148:151], v[212:215], v[116:119]
  ds_read_b64_tr_b16 a[186:187], v52 offset:25536
  v_cvt_pk_bf16_f32 v139, v90, v91
  v_mfma_f32_16x16x32_bf16 v[120:123], a[148:151], v[228:231], v[120:123]
  v_exp_f32 v92, v92
  v_mfma_f32_16x16x32_bf16 v[124:127], a[148:151], v[244:247], v[124:127]
  ds_read_b64_tr_b16 a[188:189], v52 offset:25056
  v_min_u32 v4, K_end - K_pc2 - 16, v4
  v_mfma_f32_16x16x32_bf16 v[112:115], a[152:155], v[200:203], v[112:115]
  v_exp_f32 v93, v93
  v_mfma_f32_16x16x32_bf16 v[116:119], a[152:155], v[216:219], v[116:119]
  ds_read_b64_tr_b16 a[190:191], v52 offset:25568
  v_cvt_pk_bf16_f32 v142, v92, v93
  v_mfma_f32_16x16x32_bf16 v[120:123], a[152:155], v[232:235], v[120:123]
  v_exp_f32 v94, v94
  v_mfma_f32_16x16x32_bf16 v[124:127], a[152:155], v[248:251], v[124:127]
  global_load_dwordx2 v[54:55], v4, s[6:7]
  v_add_f32 v62, v62, v88
  v_mfma_f32_16x16x32_bf16 v[112:115], a[156:159], v[204:207], v[112:115]
  v_exp_f32 v95, v95
  v_mfma_f32_16x16x32_bf16 v[116:119], a[156:159], v[220:223], v[116:119]
  v_cvt_pk_bf16_f32 v143, v94, v95
  v_add_f32 v62, v62, v89
  v_mfma_f32_16x16x32_bf16 v[120:123], a[156:159], v[236:239], v[120:123]
  v_add_f32 v62, v62, v90
  v_add_f32 v62, v62, v91
  v_mfma_f32_16x16x32_bf16 v[124:127], a[156:159], v[252:255], v[124:127]
  s_waitcnt vmcnt(17) lgkmcnt(0)
  s_barrier
  v_mfma_f32_16x16x32_bf16 v[176:179], v[36:39], v[128:131], v[176:179]
  s_add_u32 m0, s56, 108288
  v_exp_f32 v96, v96
  v_mfma_f32_16x16x32_bf16 v[180:183], v[36:39], v[132:135], v[180:183]
  ds_read_b128 a[128:131], v48 offset:33280
  v_add_f32 v63, v63, v92
  v_mfma_f32_16x16x32_bf16 a[0:3], a[160:163], v[128:131], a[0:3]
  v_exp_f32 v97, v97
  v_mfma_f32_16x16x32_bf16 a[4:7], a[160:163], v[132:135], a[4:7]
  ds_read_b128 a[132:135], v49 offset:33280
  v_cvt_pk_bf16_f32 v144, v96, v97
  v_mfma_f32_16x16x32_bf16 a[8:11], a[160:163], v[136:139], a[8:11]
TP_10:
  s_cbranch_execz TR_2
  v_exp_f32 v98, v98
  v_mfma_f32_16x16x32_bf16 a[12:15], a[160:163], v[140:143], a[12:15]
  buffer_load_dwordx4 v10, s[28:31], s58 offen lds
  v_add_f32 v63, v63, v93
  v_mfma_f32_16x16x32_bf16 a[16:19], a[164:167], v[128:131], a[16:19]
  v_exp_f32 v99, v99
  v_mfma_f32_16x16x32_bf16 a[20:23], a[164:167], v[132:135], a[20:23]
  ds_read_b128 a[136:139], v50 offset:33280
  v_cvt_pk_bf16_f32 v145, v98, v99
  v_mfma_f32_16x16x32_bf16 a[24:27], a[164:167], v[136:139], a[24:27]
  v_exp_f32 v100, v100
  v_mfma_f32_16x16x32_bf16 a[28:31], a[164:167], v[140:143], a[28:31]
  buffer_load_dwordx4 v11, s[28:31], s58 offen offset:1024 lds
  v_add_f32 v63, v63, v94
  v_mfma_f32_16x16x32_bf16 a[32:35], a[168:171], v[128:131], a[32:35]
  s_add_u32 s58, s58, 8192
  v_exp_f32 v101, v101
  v_mfma_f32_16x16x32_bf16 a[36:39], a[168:171], v[132:135], a[36:39]
  ds_read_b128 a[140:143], v51 offset:33280
  v_cvt_pk_bf16_f32 v148, v100, v101
  v_mfma_f32_16x16x32_bf16 a[40:43], a[168:171], v[136:139], a[40:43]
  s_add_u32 m0, s57, 116480
  v_exp_f32 v102, v102
  v_mfma_f32_16x16x32_bf16 a[44:47], a[168:171], v[140:143], a[44:47]
  v_add_f32 v63, v63, v95
  v_mfma_f32_16x16x32_bf16 a[48:51], a[172:175], v[128:131], a[48:51]
  v_exp_f32 v103, v103
  v_mfma_f32_16x16x32_bf16 a[52:55], a[172:175], v[132:135], a[52:55]
  ds_read_b128 a[144:147], v48 offset:37376
  v_cvt_pk_bf16_f32 v149, v102, v103
  v_mfma_f32_16x16x32_bf16 a[56:59], a[172:175], v[136:139], a[56:59]
  v_exp_f32 v104, v104
  v_mfma_f32_16x16x32_bf16 a[60:63], a[172:175], v[140:143], a[60:63]
  ds_read_b128 a[148:151], v49 offset:37376
  buffer_load_dwordx4 v12, s[32:35], s59 offen lds
  v_mfma_f32_16x16x32_bf16 a[64:67], a[176:179], v[128:131], a[64:67]
  v_exp_f32 v105, v105
  v_mfma_f32_16x16x32_bf16 a[68:71], a[176:179], v[132:135], a[68:71]
  buffer_load_dwordx4 v13, s[32:35], s59 offen offset:1056 lds
  v_cvt_pk_bf16_f32 v152, v104, v105
  v_mfma_f32_16x16x32_bf16 a[72:75], a[176:179], v[136:139], a[72:75]
  v_exp_f32 v106, v106
  v_mfma_f32_16x16x32_bf16 a[76:79], a[176:179], v[140:143], a[76:79]
  ds_read_b128 a[152:155], v50 offset:37376
  v_add_f32 v62, v62, v104
  v_mfma_f32_16x16x32_bf16 a[80:83], a[180:183], v[128:131], a[80:83]
  s_add_u32 s59, s59, 8192
  v_exp_f32 v107, v107
  v_mfma_f32_16x16x32_bf16 a[84:87], a[180:183], v[132:135], a[84:87]
  v_cvt_pk_bf16_f32 v153, v106, v107
  v_add_f32 v62, v62, v105
  v_mfma_f32_16x16x32_bf16 a[88:91], a[180:183], v[136:139], a[88:91]
  v_exp_f32 v108, v108
  v_mfma_f32_16x16x32_bf16 a[92:95], a[180:183], v[140:143], a[92:95]
  ds_read_b128 a[156:159], v51 offset:37376
  buffer_load_dword v35, v34, s[24:27], s100 offen
  v_mfma_f32_16x16x32_bf16 a[96:99], a[184:187], v[128:131], a[96:99]
  v_exp_f32 v109, v109
  v_mfma_f32_16x16x32_bf16 a[100:103], a[184:187], v[132:135], a[100:103]
  v_cvt_pk_bf16_f32 v156, v108, v109
  v_add_f32 v62, v62, v106
  v_mfma_f32_16x16x32_bf16 a[104:107], a[184:187], v[136:139], a[104:107]
  s_add_u32 s100, s100, 393216
  v_exp_f32 v110, v110
  v_mfma_f32_16x16x32_bf16 a[108:111], a[184:187], v[140:143], a[108:111]
  v_add_f32 v62, v62, v107
  v_add_f32 v63, v63, v108
  v_mfma_f32_16x16x32_bf16 a[112:115], a[188:191], v[128:131], a[112:115]
  v_exp_f32 v111, v111
  v_mfma_f32_16x16x32_bf16 a[116:119], a[188:191], v[132:135], a[116:119]
  v_cvt_pk_bf16_f32 v157, v110, v111
  v_add_f32 v63, v63, v109
  v_mfma_f32_16x16x32_bf16 a[120:123], a[188:191], v[136:139], a[120:123]
  v_add_f32 v63, v63, v110
  v_add_f32 v63, v63, v111
  v_mfma_f32_16x16x32_bf16 a[124:127], a[188:191], v[140:143], a[124:127]
  s_waitcnt lgkmcnt(0)
  v_mfma_f32_16x16x32_bf16 v[64:67], a[128:131], v[192:195], v[160:163]
  v_exp_f32 v112, v112
  v_mfma_f32_16x16x32_bf16 v[68:71], a[128:131], v[208:211], v[164:167]
  v_exp_f32 v113, v113
  v_mfma_f32_16x16x32_bf16 v[72:75], a[128:131], v[224:227], v[168:171]
  ds_read_b64_tr_b16 a[160:161], v52 offset:41472
  v_cvt_pk_bf16_f32 v146, v112, v113
  v_mfma_f32_16x16x32_bf16 v[76:79], a[128:131], v[240:243], v[172:175]
  v_exp_f32 v114, v114
  v_mfma_f32_16x16x32_bf16 v[64:67], a[132:135], v[196:199], v[64:67]
  ds_read_b64_tr_b16 a[162:163], v52 offset:41984
  ds_read_b64_tr_b16 a[164:165], v52 offset:41504
  v_mfma_f32_16x16x32_bf16 v[68:71], a[132:135], v[212:215], v[68:71]
  v_exp_f32 v115, v115
  v_mfma_f32_16x16x32_bf16 v[72:75], a[132:135], v[228:231], v[72:75]
  ds_read_b64_tr_b16 a[166:167], v52 offset:42016
  v_cvt_pk_bf16_f32 v147, v114, v115
  v_mfma_f32_16x16x32_bf16 v[76:79], a[132:135], v[244:247], v[76:79]
  v_exp_f32 v116, v116
  v_mfma_f32_16x16x32_bf16 v[64:67], a[136:139], v[200:203], v[64:67]
  ds_read_b64_tr_b16 a[168:169], v52 offset:41536
  ds_read_b64_tr_b16 a[170:171], v52 offset:42048
  v_mfma_f32_16x16x32_bf16 v[68:71], a[136:139], v[216:219], v[68:71]
  v_exp_f32 v117, v117
  v_mfma_f32_16x16x32_bf16 v[72:75], a[136:139], v[232:235], v[72:75]
  ds_read_b64_tr_b16 a[172:173], v52 offset:41568
  v_cvt_pk_bf16_f32 v150, v116, v117
  v_mfma_f32_16x16x32_bf16 v[76:79], a[136:139], v[248:251], v[76:79]
  v_exp_f32 v118, v118
  v_mfma_f32_16x16x32_bf16 v[64:67], a[140:143], v[204:207], v[64:67]
  ds_read_b64_tr_b16 a[174:175], v52 offset:42080
  v_mfma_f32_16x16x32_bf16 v[68:71], a[140:143], v[220:223], v[68:71]
  v_exp_f32 v119, v119
  v_mfma_f32_16x16x32_bf16 v[72:75], a[140:143], v[236:239], v[72:75]
  ds_read_b64_tr_b16 a[176:177], v52 offset:41600
  v_cvt_pk_bf16_f32 v151, v118, v119
  v_mfma_f32_16x16x32_bf16 v[76:79], a[140:143], v[252:255], v[76:79]
  v_exp_f32 v120, v120
  v_mfma_f32_16x16x32_bf16 v[80:83], a[144:147], v[192:195], v[160:163]
  v_exp_f32 v121, v121
  v_mfma_f32_16x16x32_bf16 v[84:87], a[144:147], v[208:211], v[164:167]
  ds_read_b64_tr_b16 a[178:179], v52 offset:42112
  ds_read_b64_tr_b16 a[180:181], v52 offset:41632
  v_cvt_pk_bf16_f32 v154, v120, v121
  v_mfma_f32_16x16x32_bf16 v[88:91], a[144:147], v[224:227], v[168:171]
  v_exp_f32 v122, v122
  v_mfma_f32_16x16x32_bf16 v[92:95], a[144:147], v[240:243], v[172:175]
  ds_read_b64_tr_b16 a[182:183], v52 offset:42144
  ds_read_b64_tr_b16 a[184:185], v52 offset:41664
  v_mfma_f32_16x16x32_bf16 v[80:83], a[148:151], v[196:199], v[80:83]
  v_exp_f32 v123, v123
  v_mfma_f32_16x16x32_bf16 v[84:87], a[148:151], v[212:215], v[84:87]
  ds_read_b64_tr_b16 a[186:187], v52 offset:42176
  v_cvt_pk_bf16_f32 v155, v122, v123
  v_mfma_f32_16x16x32_bf16 v[88:91], a[148:151], v[228:231], v[88:91]
  v_exp_f32 v124, v124
  v_mfma_f32_16x16x32_bf16 v[92:95], a[148:151], v[244:247], v[92:95]
  ds_read_b64_tr_b16 a[188:189], v52 offset:41696
  v_add_f32 v62, v62, v120
  v_mfma_f32_16x16x32_bf16 v[80:83], a[152:155], v[200:203], v[80:83]
  v_exp_f32 v125, v125
  v_mfma_f32_16x16x32_bf16 v[84:87], a[152:155], v[216:219], v[84:87]
  ds_read_b64_tr_b16 a[190:191], v52 offset:42208
  v_cvt_pk_bf16_f32 v158, v124, v125
  v_mfma_f32_16x16x32_bf16 v[88:91], a[152:155], v[232:235], v[88:91]
  v_exp_f32 v126, v126
  v_mfma_f32_16x16x32_bf16 v[92:95], a[152:155], v[248:251], v[92:95]
  v_add_f32 v62, v62, v121
  v_add_f32 v62, v62, v122
  v_mfma_f32_16x16x32_bf16 v[80:83], a[156:159], v[204:207], v[80:83]
  v_exp_f32 v127, v127
  v_mfma_f32_16x16x32_bf16 v[84:87], a[156:159], v[220:223], v[84:87]
  v_cvt_pk_bf16_f32 v159, v126, v127
  v_add_f32 v62, v62, v123
  v_mfma_f32_16x16x32_bf16 v[88:91], a[156:159], v[236:239], v[88:91]
  v_add_f32 v63, v63, v124
  v_add_f32 v63, v63, v125
  v_mfma_f32_16x16x32_bf16 v[92:95], a[156:159], v[252:255], v[92:95]
  s_waitcnt vmcnt(17) lgkmcnt(0)
  s_barrier
  v_mfma_f32_16x16x32_bf16 v[176:179], v[36:39], v[144:147], v[176:179]
  s_add_u32 m0, s56, 124928
  v_exp_f32 v64, v64
  v_mfma_f32_16x16x32_bf16 v[180:183], v[36:39], v[148:151], v[180:183]
  ds_read_b128 a[128:131], v14 offset:0
  v_add_f32 v63, v63, v126
  v_mfma_f32_16x16x32_bf16 a[0:3], a[160:163], v[144:147], a[0:3]
  v_exp_f32 v65, v65
  v_mfma_f32_16x16x32_bf16 a[4:7], a[160:163], v[148:151], a[4:7]
  ds_read_b128 a[132:135], v15 offset:0
  v_cvt_pk_bf16_f32 v128, v64, v65
  v_mfma_f32_16x16x32_bf16 a[8:11], a[160:163], v[152:155], a[8:11]
  v_exp_f32 v66, v66
  v_mfma_f32_16x16x32_bf16 a[12:15], a[160:163], v[156:159], a[12:15]
  buffer_load_dwordx4 v10, s[28:31], s58 offen lds
  v_add_f32 v63, v63, v127
  v_mfma_f32_16x16x32_bf16 a[16:19], a[164:167], v[144:147], a[16:19]
  v_exp_f32 v67, v67
  v_mfma_f32_16x16x32_bf16 a[20:23], a[164:167], v[148:151], a[20:23]
  ds_read_b128 a[136:139], v16 offset:0
  v_cvt_pk_bf16_f32 v129, v66, v67
  v_mfma_f32_16x16x32_bf16 a[24:27], a[164:167], v[152:155], a[24:27]
  v_exp_f32 v68, v68
  v_mfma_f32_16x16x32_bf16 a[28:31], a[164:167], v[156:159], a[28:31]
  buffer_load_dwordx4 v11, s[28:31], s58 offen offset:1024 lds
  v_mfma_f32_16x16x32_bf16 a[32:35], a[168:171], v[144:147], a[32:35]
  s_add_u32 s58, s58, 8192
  v_exp_f32 v69, v69
  v_mfma_f32_16x16x32_bf16 a[36:39], a[168:171], v[148:151], a[36:39]
  ds_read_b128 a[140:143], v17 offset:0
  v_cvt_pk_bf16_f32 v132, v68, v69
  v_mfma_f32_16x16x32_bf16 a[40:43], a[168:171], v[152:155], a[40:43]
  s_add_u32 m0, s57, 133120
  v_exp_f32 v70, v70
  v_mfma_f32_16x16x32_bf16 a[44:47], a[168:171], v[156:159], a[44:47]
  v_mfma_f32_16x16x32_bf16 a[48:51], a[172:175], v[144:147], a[48:51]
  v_exp_f32 v71, v71
  v_mfma_f32_16x16x32_bf16 a[52:55], a[172:175], v[148:151], a[52:55]
  ds_read_b128 a[144:147], v14 offset:4096
  v_cvt_pk_bf16_f32 v133, v70, v71
  v_mfma_f32_16x16x32_bf16 a[56:59], a[172:175], v[152:155], a[56:59]
  v_exp_f32 v72, v72
  v_mfma_f32_16x16x32_bf16 a[60:63], a[172:175], v[156:159], a[60:63]
  ds_read_b128 a[148:151], v15 offset:4096
  buffer_load_dwordx4 v12, s[32:35], s59 offen lds
  v_mfma_f32_16x16x32_bf16 a[64:67], a[176:179], v[144:147], a[64:67]
  v_exp_f32 v73, v73
  v_mfma_f32_16x16x32_bf16 a[68:71], a[176:179], v[148:151], a[68:71]
  buffer_load_dwordx4 v13, s[32:35], s59 offen offset:1056 lds
  v_cvt_pk_bf16_f32 v136, v72, v73
  v_mfma_f32_16x16x32_bf16 a[72:75], a[176:179], v[152:155], a[72:75]
  v_exp_f32 v74, v74
  v_mfma_f32_16x16x32_bf16 a[76:79], a[176:179], v[156:159], a[76:79]
  ds_read_b128 a[152:155], v16 offset:4096
  v_add_f32 v62, v62, v72
  v_mfma_f32_16x16x32_bf16 a[80:83], a[180:183], v[144:147], a[80:83]
  s_add_u32 s59, s59, 8192
  v_exp_f32 v75, v75
  v_mfma_f32_16x16x32_bf16 a[84:87], a[180:183], v[148:151], a[84:87]
  v_cvt_pk_bf16_f32 v137, v74, v75
  v_add_f32 v62, v62, v73
  v_mfma_f32_16x16x32_bf16 a[88:91], a[180:183], v[152:155], a[88:91]
  v_exp_f32 v76, v76
  v_mfma_f32_16x16x32_bf16 a[92:95], a[180:183], v[156:159], a[92:95]
  ds_read_b128 a[156:159], v17 offset:4096
  buffer_load_dword v35, v34, s[24:27], s100 offen
  v_mfma_f32_16x16x32_bf16 a[96:99], a[184:187], v[144:147], a[96:99]
  v_exp_f32 v77, v77
  v_mfma_f32_16x16x32_bf16 a[100:103], a[184:187], v[148:151], a[100:103]
  v_cvt_pk_bf16_f32 v140, v76, v77
  v_add_f32 v62, v62, v74
  v_mfma_f32_16x16x32_bf16 a[104:107], a[184:187], v[152:155], a[104:107]
  s_add_u32 s100, s100, 393216
  v_exp_f32 v78, v78
  v_mfma_f32_16x16x32_bf16 a[108:111], a[184:187], v[156:159], a[108:111]
  v_add_f32 v62, v62, v75
  v_add_f32 v63, v63, v76
  v_mfma_f32_16x16x32_bf16 a[112:115], a[188:191], v[144:147], a[112:115]
  v_exp_f32 v79, v79
  v_mfma_f32_16x16x32_bf16 a[116:119], a[188:191], v[148:151], a[116:119]
  v_cvt_pk_bf16_f32 v141, v78, v79
  v_add_f32 v63, v63, v77
  v_mfma_f32_16x16x32_bf16 a[120:123], a[188:191], v[152:155], a[120:123]
  v_add_f32 v63, v63, v78
  v_add_f32 v63, v63, v79
  v_mfma_f32_16x16x32_bf16 a[124:127], a[188:191], v[156:159], a[124:127]
  s_waitcnt lgkmcnt(0)
  v_mfma_f32_16x16x32_bf16 v[96:99], a[128:131], v[192:195], v[160:163]
  v_exp_f32 v80, v80
  v_mfma_f32_16x16x32_bf16 v[100:103], a[128:131], v[208:211], v[164:167]
  v_exp_f32 v81, v81
  v_mfma_f32_16x16x32_bf16 v[104:107], a[128:131], v[224:227], v[168:171]
  ds_read_b64_tr_b16 a[160:161], v18 offset:8192
  v_cvt_pk_bf16_f32 v130, v80, v81
  v_mfma_f32_16x16x32_bf16 v[108:111], a[128:131], v[240:243], v[172:175]
  v_exp_f32 v82, v82
  v_mfma_f32_16x16x32_bf16 v[96:99], a[132:135], v[196:199], v[96:99]
  ds_read_b64_tr_b16 a[162:163], v18 offset:8704
  ds_read_b64_tr_b16 a[164:165], v18 offset:8224
  v_mfma_f32_16x16x32_bf16 v[100:103], a[132:135], v[212:215], v[100:103]
  v_exp_f32 v83, v83
  v_mfma_f32_16x16x32_bf16 v[104:107], a[132:135], v[228:231], v[104:107]
  ds_read_b64_tr_b16 a[166:167], v18 offset:8736
  v_cvt_pk_bf16_f32 v131, v82, v83
  v_mfma_f32_16x16x32_bf16 v[108:111], a[132:135], v[244:247], v[108:111]
  v_exp_f32 v84, v84
  v_mfma_f32_16x16x32_bf16 v[96:99], a[136:139], v[200:203], v[96:99]
  ds_read_b64_tr_b16 a[168:169], v18 offset:8256
  ds_read_b64_tr_b16 a[170:171], v18 offset:8768
  v_mfma_f32_16x16x32_bf16 v[100:103], a[136:139], v[216:219], v[100:103]
  v_exp_f32 v85, v85
  v_mfma_f32_16x16x32_bf16 v[104:107], a[136:139], v[232:235], v[104:107]
  ds_read_b64_tr_b16 a[172:173], v18 offset:8288
  v_cvt_pk_bf16_f32 v134, v84, v85
  v_mfma_f32_16x16x32_bf16 v[108:111], a[136:139], v[248:251], v[108:111]
  v_exp_f32 v86, v86
  v_mfma_f32_16x16x32_bf16 v[96:99], a[140:143], v[204:207], v[96:99]
  ds_read_b64_tr_b16 a[174:175], v18 offset:8800
  v_mfma_f32_16x16x32_bf16 v[100:103], a[140:143], v[220:223], v[100:103]
  v_exp_f32 v87, v87
  v_mfma_f32_16x16x32_bf16 v[104:107], a[140:143], v[236:239], v[104:107]
  ds_read_b64_tr_b16 a[176:177], v18 offset:8320
  v_cvt_pk_bf16_f32 v135, v86, v87
  v_mfma_f32_16x16x32_bf16 v[108:111], a[140:143], v[252:255], v[108:111]
  v_exp_f32 v88, v88
  v_mfma_f32_16x16x32_bf16 v[112:115], a[144:147], v[192:195], v[160:163]
  v_exp_f32 v89, v89
  v_mfma_f32_16x16x32_bf16 v[116:119], a[144:147], v[208:211], v[164:167]
  ds_read_b64_tr_b16 a[178:179], v18 offset:8832
  ds_read_b64_tr_b16 a[180:181], v18 offset:8352
  v_cvt_pk_bf16_f32 v138, v88, v89
  v_mfma_f32_16x16x32_bf16 v[120:123], a[144:147], v[224:227], v[168:171]
  v_exp_f32 v90, v90
  v_mfma_f32_16x16x32_bf16 v[124:127], a[144:147], v[240:243], v[172:175]
  ds_read_b64_tr_b16 a[182:183], v18 offset:8864
  ds_read_b64_tr_b16 a[184:185], v18 offset:8384
  v_mfma_f32_16x16x32_bf16 v[112:115], a[148:151], v[196:199], v[112:115]
  v_exp_f32 v91, v91
  v_mfma_f32_16x16x32_bf16 v[116:119], a[148:151], v[212:215], v[116:119]
  ds_read_b64_tr_b16 a[186:187], v18 offset:8896
  v_cvt_pk_bf16_f32 v139, v90, v91
  v_mfma_f32_16x16x32_bf16 v[120:123], a[148:151], v[228:231], v[120:123]
  v_exp_f32 v92, v92
  v_mfma_f32_16x16x32_bf16 v[124:127], a[148:151], v[244:247], v[124:127]
  ds_read_b64_tr_b16 a[188:189], v18 offset:8416
  v_add_f32 v62, v62, v88
  v_mfma_f32_16x16x32_bf16 v[112:115], a[152:155], v[200:203], v[112:115]
  v_exp_f32 v93, v93
  v_mfma_f32_16x16x32_bf16 v[116:119], a[152:155], v[216:219], v[116:119]
  ds_read_b64_tr_b16 a[190:191], v18 offset:8928
  v_cvt_pk_bf16_f32 v142, v92, v93
  v_mfma_f32_16x16x32_bf16 v[120:123], a[152:155], v[232:235], v[120:123]
  v_exp_f32 v94, v94
  v_mfma_f32_16x16x32_bf16 v[124:127], a[152:155], v[248:251], v[124:127]
  v_add_f32 v62, v62, v89
  v_add_f32 v62, v62, v90
  v_mfma_f32_16x16x32_bf16 v[112:115], a[156:159], v[204:207], v[112:115]
  v_exp_f32 v95, v95
  v_mfma_f32_16x16x32_bf16 v[116:119], a[156:159], v[220:223], v[116:119]
  v_cvt_pk_bf16_f32 v143, v94, v95
  v_add_f32 v62, v62, v91
  v_mfma_f32_16x16x32_bf16 v[120:123], a[156:159], v[236:239], v[120:123]
  v_add_f32 v63, v63, v92
  v_add_f32 v63, v63, v93
  v_mfma_f32_16x16x32_bf16 v[124:127], a[156:159], v[252:255], v[124:127]
  s_waitcnt vmcnt(17) lgkmcnt(0)
  s_barrier
  v_mfma_f32_16x16x32_bf16 v[176:179], v[36:39], v[128:131], v[176:179]
  s_add_u32 m0, s57, 149760
  v_exp_f32 v96, v96
  v_mfma_f32_16x16x32_bf16 v[180:183], v[36:39], v[132:135], v[180:183]
  ds_read_b128 a[128:131], v14 offset:16640
  v_add_f32 v63, v63, v94
  v_mfma_f32_16x16x32_bf16 a[0:3], a[160:163], v[128:131], a[0:3]
  v_exp_f32 v97, v97
  v_mfma_f32_16x16x32_bf16 a[4:7], a[160:163], v[132:135], a[4:7]
  ds_read_b128 a[132:135], v15 offset:16640
  v_cvt_pk_bf16_f32 v144, v96, v97
  v_mfma_f32_16x16x32_bf16 a[8:11], a[160:163], v[136:139], a[8:11]
  v_exp_f32 v98, v98
  v_mfma_f32_16x16x32_bf16 a[12:15], a[160:163], v[140:143], a[12:15]
  buffer_load_dwordx4 v12, s[32:35], s59 offen lds
  v_add_f32 v63, v63, v95
  v_mfma_f32_16x16x32_bf16 a[16:19], a[164:167], v[128:131], a[16:19]
  v_exp_f32 v99, v99
  v_mfma_f32_16x16x32_bf16 a[20:23], a[164:167], v[132:135], a[20:23]
  ds_read_b128 a[136:139], v16 offset:16640
  v_cvt_pk_bf16_f32 v145, v98, v99
  v_mfma_f32_16x16x32_bf16 a[24:27], a[164:167], v[136:139], a[24:27]
  v_exp_f32 v100, v100
  v_mfma_f32_16x16x32_bf16 a[28:31], a[164:167], v[140:143], a[28:31]
  v_mfma_f32_16x16x32_bf16 a[32:35], a[168:171], v[128:131], a[32:35]
  v_exp_f32 v101, v101
  v_mfma_f32_16x16x32_bf16 a[36:39], a[168:171], v[132:135], a[36:39]
  ds_read_b128 a[140:143], v17 offset:16640
  v_cvt_pk_bf16_f32 v148, v100, v101
  v_mfma_f32_16x16x32_bf16 a[40:43], a[168:171], v[136:139], a[40:43]
  v_exp_f32 v102, v102
  v_mfma_f32_16x16x32_bf16 a[44:47], a[168:171], v[140:143], a[44:47]
  buffer_load_dwordx4 v13, s[32:35], s59 offen offset:1056 lds
  v_mfma_f32_16x16x32_bf16 a[48:51], a[172:175], v[128:131], a[48:51]
  v_exp_f32 v103, v103
  v_mfma_f32_16x16x32_bf16 a[52:55], a[172:175], v[132:135], a[52:55]
  ds_read_b128 a[144:147], v14 offset:20736
  v_cvt_pk_bf16_f32 v149, v102, v103
  v_mfma_f32_16x16x32_bf16 a[56:59], a[172:175], v[136:139], a[56:59]
  s_add_u32 s59, s59, 8192
  v_exp_f32 v104, v104
  v_mfma_f32_16x16x32_bf16 a[60:63], a[172:175], v[140:143], a[60:63]
  ds_read_b128 a[148:151], v15 offset:20736
  v_add_f32 v62, v62, v104
  v_mfma_f32_16x16x32_bf16 a[64:67], a[176:179], v[128:131], a[64:67]
  v_exp_f32 v105, v105
  v_mfma_f32_16x16x32_bf16 a[68:71], a[176:179], v[132:135], a[68:71]
  v_cvt_pk_bf16_f32 v152, v104, v105
  v_add_f32 v62, v62, v105
  v_mfma_f32_16x16x32_bf16 a[72:75], a[176:179], v[136:139], a[72:75]
  v_exp_f32 v106, v106
  v_mfma_f32_16x16x32_bf16 a[76:79], a[176:179], v[140:143], a[76:79]
  ds_read_b128 a[152:155], v16 offset:20736
  buffer_load_dword v35, v34, s[24:27], s100 offen
  v_mfma_f32_16x16x32_bf16 a[80:83], a[180:183], v[128:131], a[80:83]
  v_exp_f32 v107, v107
  v_mfma_f32_16x16x32_bf16 a[84:87], a[180:183], v[132:135], a[84:87]
  v_cvt_pk_bf16_f32 v153, v106, v107
  v_add_f32 v62, v62, v106
  v_mfma_f32_16x16x32_bf16 a[88:91], a[180:183], v[136:139], a[88:91]
  v_exp_f32 v108, v108
  v_mfma_f32_16x16x32_bf16 a[92:95], a[180:183], v[140:143], a[92:95]
  ds_read_b128 a[156:159], v17 offset:20736
  v_add_f32 v62, v62, v107
  v_mfma_f32_16x16x32_bf16 a[96:99], a[184:187], v[128:131], a[96:99]
  s_add_u32 s100, s100, 393216
  v_exp_f32 v109, v109
  v_mfma_f32_16x16x32_bf16 a[100:103], a[184:187], v[132:135], a[100:103]
  v_cvt_pk_bf16_f32 v156, v108, v109
  v_add_f32 v63, v63, v108
  v_mfma_f32_16x16x32_bf16 a[104:107], a[184:187], v[136:139], a[104:107]
  v_exp_f32 v110, v110
  v_mfma_f32_16x16x32_bf16 a[108:111], a[184:187], v[140:143], a[108:111]
  v_add_f32 v63, v63, v109
  v_add_f32 v63, v63, v110
  v_mfma_f32_16x16x32_bf16 a[112:115], a[188:191], v[128:131], a[112:115]
  v_exp_f32 v111, v111
  v_mfma_f32_16x16x32_bf16 a[116:119], a[188:191], v[132:135], a[116:119]
  v_cvt_pk_bf16_f32 v157, v110, v111
  v_add_f32 v63, v63, v111
  v_mfma_f32_16x16x32_bf16 a[120:123], a[188:191], v[136:139], a[120:123]
  v_mfma_f32_16x16x32_bf16 a[124:127], a[188:191], v[140:143], a[124:127]
  s_waitcnt lgkmcnt(0)
  v_mfma_f32_16x16x32_bf16 v[64:67], a[128:131], v[192:195], v[160:163]
  v_exp_f32 v112, v112
  v_mfma_f32_16x16x32_bf16 v[68:71], a[128:131], v[208:211], v[164:167]
  v_exp_f32 v113, v113
  v_mfma_f32_16x16x32_bf16 v[72:75], a[128:131], v[224:227], v[168:171]
  ds_read_b64_tr_b16 a[160:161], v18 offset:24832
  v_cvt_pk_bf16_f32 v146, v112, v113
  v_mfma_f32_16x16x32_bf16 v[76:79], a[128:131], v[240:243], v[172:175]
  v_exp_f32 v114, v114
  v_mfma_f32_16x16x32_bf16 v[64:67], a[132:135], v[196:199], v[64:67]
  ds_read_b64_tr_b16 a[162:163], v18 offset:25344
  ds_read_b64_tr_b16 a[164:165], v18 offset:24864
  v_mfma_f32_16x16x32_bf16 v[68:71], a[132:135], v[212:215], v[68:71]
  v_exp_f32 v115, v115
  v_mfma_f32_16x16x32_bf16 v[72:75], a[132:135], v[228:231], v[72:75]
  ds_read_b64_tr_b16 a[166:167], v18 offset:25376
  v_cvt_pk_bf16_f32 v147, v114, v115
  v_mfma_f32_16x16x32_bf16 v[76:79], a[132:135], v[244:247], v[76:79]
  v_exp_f32 v116, v116
  v_mfma_f32_16x16x32_bf16 v[64:67], a[136:139], v[200:203], v[64:67]
  ds_read_b64_tr_b16 a[168:169], v18 offset:24896
  ds_read_b64_tr_b16 a[170:171], v18 offset:25408
  v_mfma_f32_16x16x32_bf16 v[68:71], a[136:139], v[216:219], v[68:71]
  v_exp_f32 v117, v117
  v_mfma_f32_16x16x32_bf16 v[72:75], a[136:139], v[232:235], v[72:75]
  ds_read_b64_tr_b16 a[172:173], v18 offset:24928
  v_cvt_pk_bf16_f32 v150, v116, v117
  v_mfma_f32_16x16x32_bf16 v[76:79], a[136:139], v[248:251], v[76:79]
  v_exp_f32 v118, v118
  v_mfma_f32_16x16x32_bf16 v[64:67], a[140:143], v[204:207], v[64:67]
  ds_read_b64_tr_b16 a[174:175], v18 offset:25440
  v_mfma_f32_16x16x32_bf16 v[68:71], a[140:143], v[220:223], v[68:71]
  v_exp_f32 v119, v119
  v_mfma_f32_16x16x32_bf16 v[72:75], a[140:143], v[236:239], v[72:75]
  ds_read_b64_tr_b16 a[176:177], v18 offset:24960
  v_cvt_pk_bf16_f32 v151, v118, v119
  v_mfma_f32_16x16x32_bf16 v[76:79], a[140:143], v[252:255], v[76:79]
  v_exp_f32 v120, v120
  v_mfma_f32_16x16x32_bf16 v[80:83], a[144:147], v[192:195], v[160:163]
  v_exp_f32 v121, v121
  v_mfma_f32_16x16x32_bf16 v[84:87], a[144:147], v[208:211], v[164:167]
  ds_read_b64_tr_b16 a[178:179], v18 offset:25472
  ds_read_b64_tr_b16 a[180:181], v18 offset:24992
  v_cvt_pk_bf16_f32 v154, v120, v121
  v_mfma_f32_16x16x32_bf16 v[88:91], a[144:147], v[224:227], v[168:171]
  v_exp_f32 v122, v122
  v_mfma_f32_16x16x32_bf16 v[92:95], a[144:147], v[240:243], v[172:175]
  ds_read_b64_tr_b16 a[182:183], v18 offset:25504
  ds_read_b64_tr_b16 a[184:185], v18 offset:25024
  v_mfma_f32_16x16x32_bf16 v[80:83], a[148:151], v[196:199], v[80:83]
  v_exp_f32 v123, v123
  v_mfma_f32_16x16x32_bf16 v[84:87], a[148:151], v[212:215], v[84:87]
  ds_read_b64_tr_b16 a[186:187], v18 offset:25536
  v_cvt_pk_bf16_f32 v155, v122, v123
  v_mfma_f32_16x16x32_bf16 v[88:91], a[148:151], v[228:231], v[88:91]
  v_exp_f32 v124, v124
  v_mfma_f32_16x16x32_bf16 v[92:95], a[148:151], v[244:247], v[92:95]
  ds_read_b64_tr_b16 a[188:189], v18 offset:25056
  v_add_f32 v62, v62, v120
  v_mfma_f32_16x16x32_bf16 v[80:83], a[152:155], v[200:203], v[80:83]
  v_exp_f32 v125, v125
  v_mfma_f32_16x16x32_bf16 v[84:87], a[152:155], v[216:219], v[84:87]
  ds_read_b64_tr_b16 a[190:191], v18 offset:25568
  v_cvt_pk_bf16_f32 v158, v124, v125
  v_mfma_f32_16x16x32_bf16 v[88:91], a[152:155], v[232:235], v[88:91]
  v_exp_f32 v126, v126
  v_mfma_f32_16x16x32_bf16 v[92:95], a[152:155], v[248:251], v[92:95]
  v_add_f32 v62, v62, v121
  v_add_f32 v62, v62, v122
  v_mfma_f32_16x16x32_bf16 v[80:83], a[156:159], v[204:207], v[80:83]
  v_exp_f32 v127, v127
  v_mfma_f32_16x16x32_bf16 v[84:87], a[156:159], v[220:223], v[84:87]
  v_cvt_pk_bf16_f32 v159, v126, v127
  v_add_f32 v62, v62, v123
  v_mfma_f32_16x16x32_bf16 v[88:91], a[156:159], v[236:239], v[88:91]
  v_add_f32 v63, v63, v124
  v_add_f32 v63, v63, v125
  v_mfma_f32_16x16x32_bf16 v[92:95], a[156:159], v[252:255], v[92:95]
  s_waitcnt vmcnt(15) lgkmcnt(0)
  s_barrier
  v_mfma_f32_16x16x32_bf16 v[176:179], v[36:39], v[144:147], v[176:179]
  v_exp_f32 v64, v64
  v_mfma_f32_16x16x32_bf16 v[180:183], v[36:39], v[148:151], v[180:183]
  ds_read_b128 a[128:131], v14 offset:33280
  buffer_load_dword v35, v34, s[24:27], s100 offen
  v_mfma_f32_16x16x32_bf16 a[0:3], a[160:163], v[144:147], a[0:3]
  v_exp_f32 v65, v65
  v_mfma_f32_16x16x32_bf16 a[4:7], a[160:163], v[148:151], a[4:7]
  ds_read_b128 a[132:135], v15 offset:33280
  v_cvt_pk_bf16_f32 v128, v64, v65
  v_mfma_f32_16x16x32_bf16 a[8:11], a[160:163], v[152:155], a[8:11]
  v_exp_f32 v66, v66
  v_mfma_f32_16x16x32_bf16 a[12:15], a[160:163], v[156:159], a[12:15]
  v_add_f32 v63, v63, v126
  v_add_f32 v63, v63, v127
  v_mfma_f32_16x16x32_bf16 a[16:19], a[164:167], v[144:147], a[16:19]
  v_exp_f32 v67, v67
  v_mfma_f32_16x16x32_bf16 a[20:23], a[164:167], v[148:151], a[20:23]
  ds_read_b128 a[136:139], v16 offset:33280
  v_cvt_pk_bf16_f32 v129, v66, v67
  v_mfma_f32_16x16x32_bf16 a[24:27], a[164:167], v[152:155], a[24:27]
  v_exp_f32 v68, v68
  v_mfma_f32_16x16x32_bf16 a[28:31], a[164:167], v[156:159], a[28:31]
  v_mfma_f32_16x16x32_bf16 a[32:35], a[168:171], v[144:147], a[32:35]
  v_exp_f32 v69, v69
  v_mfma_f32_16x16x32_bf16 a[36:39], a[168:171], v[148:151], a[36:39]
  ds_read_b128 a[140:143], v17 offset:33280
  v_cvt_pk_bf16_f32 v132, v68, v69
  v_mfma_f32_16x16x32_bf16 a[40:43], a[168:171], v[152:155], a[40:43]
  v_exp_f32 v70, v70
  v_mfma_f32_16x16x32_bf16 a[44:47], a[168:171], v[156:159], a[44:47]
  v_mfma_f32_16x16x32_bf16 a[48:51], a[172:175], v[144:147], a[48:51]
  v_exp_f32 v71, v71
  v_mfma_f32_16x16x32_bf16 a[52:55], a[172:175], v[148:151], a[52:55]
  ds_read_b128 a[144:147], v14 offset:37376
  v_cvt_pk_bf16_f32 v133, v70, v71
  v_mfma_f32_16x16x32_bf16 a[56:59], a[172:175], v[152:155], a[56:59]
  s_add_u32 s100, s100, 393216
  v_exp_f32 v72, v72
  v_mfma_f32_16x16x32_bf16 a[60:63], a[172:175], v[156:159], a[60:63]
  ds_read_b128 a[148:151], v15 offset:37376
  v_add_f32 v62, v62, v72
  v_mfma_f32_16x16x32_bf16 a[64:67], a[176:179], v[144:147], a[64:67]
  v_exp_f32 v73, v73
  v_mfma_f32_16x16x32_bf16 a[68:71], a[176:179], v[148:151], a[68:71]
  v_cvt_pk_bf16_f32 v136, v72, v73
  v_add_f32 v62, v62, v73
  v_mfma_f32_16x16x32_bf16 a[72:75], a[176:179], v[152:155], a[72:75]
  v_exp_f32 v74, v74
  v_mfma_f32_16x16x32_bf16 a[76:79], a[176:179], v[156:159], a[76:79]
  ds_read_b128 a[152:155], v16 offset:37376
  v_add_f32 v62, v62, v74
  v_mfma_f32_16x16x32_bf16 a[80:83], a[180:183], v[144:147], a[80:83]
  v_exp_f32 v75, v75
  v_mfma_f32_16x16x32_bf16 a[84:87], a[180:183], v[148:151], a[84:87]
  v_cvt_pk_bf16_f32 v137, v74, v75
  v_add_f32 v62, v62, v75
  v_mfma_f32_16x16x32_bf16 a[88:91], a[180:183], v[152:155], a[88:91]
  v_exp_f32 v76, v76
  v_mfma_f32_16x16x32_bf16 a[92:95], a[180:183], v[156:159], a[92:95]
  ds_read_b128 a[156:159], v17 offset:37376
  v_add_f32 v63, v63, v76
  v_mfma_f32_16x16x32_bf16 a[96:99], a[184:187], v[144:147], a[96:99]
  v_exp_f32 v77, v77
  v_mfma_f32_16x16x32_bf16 a[100:103], a[184:187], v[148:151], a[100:103]
  v_cvt_pk_bf16_f32 v140, v76, v77
  v_add_f32 v63, v63, v77
  v_mfma_f32_16x16x32_bf16 a[104:107], a[184:187], v[152:155], a[104:107]
  v_exp_f32 v78, v78
  v_mfma_f32_16x16x32_bf16 a[108:111], a[184:187], v[156:159], a[108:111]
  v_add_f32 v63, v63, v78
  v_mfma_f32_16x16x32_bf16 a[112:115], a[188:191], v[144:147], a[112:115]
  v_exp_f32 v79, v79
  v_mfma_f32_16x16x32_bf16 a[116:119], a[188:191], v[148:151], a[116:119]
  v_cvt_pk_bf16_f32 v141, v78, v79
  v_add_f32 v63, v63, v79
  v_mfma_f32_16x16x32_bf16 a[120:123], a[188:191], v[152:155], a[120:123]
  v_mfma_f32_16x16x32_bf16 a[124:127], a[188:191], v[156:159], a[124:127]
  s_waitcnt lgkmcnt(0)
  v_mfma_f32_16x16x32_bf16 v[96:99], a[128:131], v[192:195], v[160:163]
  v_exp_f32 v80, v80
  v_mfma_f32_16x16x32_bf16 v[100:103], a[128:131], v[208:211], v[164:167]
  v_exp_f32 v81, v81
  v_mfma_f32_16x16x32_bf16 v[104:107], a[128:131], v[224:227], v[168:171]
  ds_read_b64_tr_b16 a[160:161], v18 offset:41472
  v_cvt_pk_bf16_f32 v130, v80, v81
  v_mfma_f32_16x16x32_bf16 v[108:111], a[128:131], v[240:243], v[172:175]
  v_exp_f32 v82, v82
  v_mfma_f32_16x16x32_bf16 v[96:99], a[132:135], v[196:199], v[96:99]
  ds_read_b64_tr_b16 a[162:163], v18 offset:41984
  ds_read_b64_tr_b16 a[164:165], v18 offset:41504
  v_mfma_f32_16x16x32_bf16 v[100:103], a[132:135], v[212:215], v[100:103]
  v_exp_f32 v83, v83
  v_mfma_f32_16x16x32_bf16 v[104:107], a[132:135], v[228:231], v[104:107]
  ds_read_b64_tr_b16 a[166:167], v18 offset:42016
  v_cvt_pk_bf16_f32 v131, v82, v83
  v_mfma_f32_16x16x32_bf16 v[108:111], a[132:135], v[244:247], v[108:111]
  v_exp_f32 v84, v84
  v_mfma_f32_16x16x32_bf16 v[96:99], a[136:139], v[200:203], v[96:99]
  ds_read_b64_tr_b16 a[168:169], v18 offset:41536
  ds_read_b64_tr_b16 a[170:171], v18 offset:42048
  v_mfma_f32_16x16x32_bf16 v[100:103], a[136:139], v[216:219], v[100:103]
  v_exp_f32 v85, v85
  v_mfma_f32_16x16x32_bf16 v[104:107], a[136:139], v[232:235], v[104:107]
  ds_read_b64_tr_b16 a[172:173], v18 offset:41568
  v_cvt_pk_bf16_f32 v134, v84, v85
  v_mfma_f32_16x16x32_bf16 v[108:111], a[136:139], v[248:251], v[108:111]
  v_exp_f32 v86, v86
  v_mfma_f32_16x16x32_bf16 v[96:99], a[140:143], v[204:207], v[96:99]
  ds_read_b64_tr_b16 a[174:175], v18 offset:42080
  v_mfma_f32_16x16x32_bf16 v[100:103], a[140:143], v[220:223], v[100:103]
  v_exp_f32 v87, v87
  v_mfma_f32_16x16x32_bf16 v[104:107], a[140:143], v[236:239], v[104:107]
  ds_read_b64_tr_b16 a[176:177], v18 offset:41600
  v_cvt_pk_bf16_f32 v135, v86, v87
  v_mfma_f32_16x16x32_bf16 v[108:111], a[140:143], v[252:255], v[108:111]
TP_11:
  s_cbranch_execz TR_2
  v_exp_f32 v88, v88
  v_mfma_f32_16x16x32_bf16 v[112:115], a[144:147], v[192:195], v[160:163]
  v_exp_f32 v89, v89
  v_mfma_f32_16x16x32_bf16 v[116:119], a[144:147], v[208:211], v[164:167]
  ds_read_b64_tr_b16 a[178:179], v18 offset:42112
  ds_read_b64_tr_b16 a[180:181], v18 offset:41632
  v_cvt_pk_bf16_f32 v138, v88, v89
  v_mfma_f32_16x16x32_bf16 v[120:123], a[144:147], v[224:227], v[168:171]
  v_exp_f32 v90, v90
  v_mfma_f32_16x16x32_bf16 v[124:127], a[144:147], v[240:243], v[172:175]
  ds_read_b64_tr_b16 a[182:183], v18 offset:42144
  ds_read_b64_tr_b16 a[184:185], v18 offset:41664
  v_mfma_f32_16x16x32_bf16 v[112:115], a[148:151], v[196:199], v[112:115]
  v_exp_f32 v91, v91
  v_mfma_f32_16x16x32_bf16 v[116:119], a[148:151], v[212:215], v[116:119]
  ds_read_b64_tr_b16 a[186:187], v18 offset:42176
  v_cvt_pk_bf16_f32 v139, v90, v91
  v_mfma_f32_16x16x32_bf16 v[120:123], a[148:151], v[228:231], v[120:123]
  v_exp_f32 v92, v92
  v_mfma_f32_16x16x32_bf16 v[124:127], a[148:151], v[244:247], v[124:127]
  ds_read_b64_tr_b16 a[188:189], v18 offset:41696
  v_add_f32 v62, v62, v88
  v_mfma_f32_16x16x32_bf16 v[112:115], a[152:155], v[200:203], v[112:115]
  v_exp_f32 v93, v93
  v_mfma_f32_16x16x32_bf16 v[116:119], a[152:155], v[216:219], v[116:119]
  ds_read_b64_tr_b16 a[190:191], v18 offset:42208
  v_cvt_pk_bf16_f32 v142, v92, v93
  v_mfma_f32_16x16x32_bf16 v[120:123], a[152:155], v[232:235], v[120:123]
  v_exp_f32 v94, v94
  v_mfma_f32_16x16x32_bf16 v[124:127], a[152:155], v[248:251], v[124:127]
  v_add_f32 v62, v62, v89
  v_add_f32 v62, v62, v90
  v_mfma_f32_16x16x32_bf16 v[112:115], a[156:159], v[204:207], v[112:115]
  v_exp_f32 v95, v95
  v_mfma_f32_16x16x32_bf16 v[116:119], a[156:159], v[220:223], v[116:119]
  v_cvt_pk_bf16_f32 v143, v94, v95
  v_add_f32 v62, v62, v91
  v_mfma_f32_16x16x32_bf16 v[120:123], a[156:159], v[236:239], v[120:123]
  v_add_f32 v63, v63, v92
  v_add_f32 v63, v63, v93
  v_mfma_f32_16x16x32_bf16 v[124:127], a[156:159], v[252:255], v[124:127]
  s_waitcnt vmcnt(10) lgkmcnt(0)
  s_barrier
  v_mfma_f32_16x16x32_bf16 v[176:179], v[36:39], v[128:131], v[176:179]
  v_exp_f32 v96, v96
  v_mfma_f32_16x16x32_bf16 v[180:183], v[36:39], v[132:135], v[180:183]
  ds_read_b128 a[128:131], v48 offset:0
  v_add_f32 v63, v63, v94
  v_mfma_f32_16x16x32_bf16 a[0:3], a[160:163], v[128:131], a[0:3]
  v_exp_f32 v97, v97
  v_mfma_f32_16x16x32_bf16 a[4:7], a[160:163], v[132:135], a[4:7]
  ds_read_b128 a[132:135], v49 offset:0
  v_cvt_pk_bf16_f32 v144, v96, v97
  v_mfma_f32_16x16x32_bf16 a[8:11], a[160:163], v[136:139], a[8:11]
  v_exp_f32 v98, v98
  v_mfma_f32_16x16x32_bf16 a[12:15], a[160:163], v[140:143], a[12:15]
  v_add_f32 v63, v63, v95
  v_mfma_f32_16x16x32_bf16 a[16:19], a[164:167], v[128:131], a[16:19]
  v_exp_f32 v99, v99
  v_mfma_f32_16x16x32_bf16 a[20:23], a[164:167], v[132:135], a[20:23]
  ds_read_b128 a[136:139], v50 offset:0
  v_cvt_pk_bf16_f32 v145, v98, v99
  v_mfma_f32_16x16x32_bf16 a[24:27], a[164:167], v[136:139], a[24:27]
  v_exp_f32 v100, v100
  v_mfma_f32_16x16x32_bf16 a[28:31], a[164:167], v[140:143], a[28:31]
  v_mfma_f32_16x16x32_bf16 a[32:35], a[168:171], v[128:131], a[32:35]
  v_exp_f32 v101, v101
  v_mfma_f32_16x16x32_bf16 a[36:39], a[168:171], v[132:135], a[36:39]
  ds_read_b128 a[140:143], v51 offset:0
  v_cvt_pk_bf16_f32 v148, v100, v101
  v_mfma_f32_16x16x32_bf16 a[40:43], a[168:171], v[136:139], a[40:43]
  v_exp_f32 v102, v102
  v_mfma_f32_16x16x32_bf16 a[44:47], a[168:171], v[140:143], a[44:47]
  v_mfma_f32_16x16x32_bf16 a[48:51], a[172:175], v[128:131], a[48:51]
  v_exp_f32 v103, v103
  v_mfma_f32_16x16x32_bf16 a[52:55], a[172:175], v[132:135], a[52:55]
  ds_read_b128 a[144:147], v48 offset:4096
  v_cvt_pk_bf16_f32 v149, v102, v103
  v_mfma_f32_16x16x32_bf16 a[56:59], a[172:175], v[136:139], a[56:59]
  v_exp_f32 v104, v104
  v_mfma_f32_16x16x32_bf16 a[60:63], a[172:175], v[140:143], a[60:63]
  ds_read_b128 a[148:151], v49 offset:4096
  v_add_f32 v62, v62, v104
  v_mfma_f32_16x16x32_bf16 a[64:67], a[176:179], v[128:131], a[64:67]
  v_exp_f32 v105, v105
  v_mfma_f32_16x16x32_bf16 a[68:71], a[176:179], v[132:135], a[68:71]
  v_cvt_pk_bf16_f32 v152, v104, v105
  v_add_f32 v62, v62, v105
  v_mfma_f32_16x16x32_bf16 a[72:75], a[176:179], v[136:139], a[72:75]
  v_exp_f32 v106, v106
  v_mfma_f32_16x16x32_bf16 a[76:79], a[176:179], v[140:143], a[76:79]
  ds_read_b128 a[152:155], v50 offset:4096
  v_add_f32 v62, v62, v106
  v_mfma_f32_16x16x32_bf16 a[80:83], a[180:183], v[128:131], a[80:83]
  v_exp_f32 v107, v107
  v_mfma_f32_16x16x32_bf16 a[84:87], a[180:183], v[132:135], a[84:87]
  v_cvt_pk_bf16_f32 v153, v106, v107
  v_add_f32 v62, v62, v107
  v_mfma_f32_16x16x32_bf16 a[88:91], a[180:183], v[136:139], a[88:91]
  v_exp_f32 v108, v108
  v_mfma_f32_16x16x32_bf16 a[92:95], a[180:183], v[140:143], a[92:95]
  ds_read_b128 a[156:159], v51 offset:4096
  v_add_f32 v63, v63, v108
  v_mfma_f32_16x16x32_bf16 a[96:99], a[184:187], v[128:131], a[96:99]
  v_exp_f32 v109, v109
  v_mfma_f32_16x16x32_bf16 a[100:103], a[184:187], v[132:135], a[100:103]
  v_cvt_pk_bf16_f32 v156, v108, v109
  v_add_f32 v63, v63, v109
  v_mfma_f32_16x16x32_bf16 a[104:107], a[184:187], v[136:139], a[104:107]
  v_exp_f32 v110, v110
  v_mfma_f32_16x16x32_bf16 a[108:111], a[184:187], v[140:143], a[108:111]
  v_add_f32 v63, v63, v110
  v_mfma_f32_16x16x32_bf16 a[112:115], a[188:191], v[128:131], a[112:115]
  v_exp_f32 v111, v111
  v_mfma_f32_16x16x32_bf16 a[116:119], a[188:191], v[132:135], a[116:119]
  v_cvt_pk_bf16_f32 v157, v110, v111
  v_add_f32 v63, v63, v111
  v_mfma_f32_16x16x32_bf16 a[120:123], a[188:191], v[136:139], a[120:123]
  v_mfma_f32_16x16x32_bf16 a[124:127], a[188:191], v[140:143], a[124:127]
  s_waitcnt lgkmcnt(0)
  s_mov_b64 exec, 0
  s_cmp_ge_u32 s16, 4
  s_cbranch_scc1 TE_U
  s_cmp_eq_u32 s18, 0
  s_cbranch_scc1 TP_12
  s_cmp_eq_u32 s18, 1
  s_cbranch_scc1 TP_13
  s_cmp_eq_u32 s18, 2
  s_cbranch_scc1 TP_14
  s_branch TP_15
TE_U:
  s_cmp_eq_u32 s18, 0
  s_cbranch_scc1 TP_18
  s_cmp_eq_u32 s18, 1
  s_cbranch_scc1 TP_19
  s_cmp_eq_u32 s18, 2
  s_cbranch_scc1 TP_20
  s_branch TP_21
TR_3:
  s_mov_b64 exec, -1
  s_cmp_ge_u32 s16, 4
  s_cbranch_scc1 K_U
K_O:
  s_mul_i32 s3, s18, 144
  v_add_u32 v7, s3, v2
  s_and_b32 s4, s17, 3
  s_mul_i32 s4, s4, 288
  v_add_u32 v4, 0, v7
  v_mul_u32_u24 v5, 3641, v4
  v_lshrrev_b32 v5, 16, v5
  v_mul_u32_u24 v6, 18, v5
  v_sub_u32 v6, v4, v6
  v_mul_u32_u24 v5, 1152, v5
  v_lshl_add_u32 v6, v6, 4, v5
  v_add_u32 v20, s4, v6
  s_sub_u32 s4, s4, 1024
  v_add_u32 v4, 64, v7
  v_mul_u32_u24 v5, 3641, v4
  v_lshrrev_b32 v5, 16, v5
  v_mul_u32_u24 v6, 18, v5
  v_sub_u32 v6, v4, v6
  v_mul_u32_u24 v5, 1152, v5
  v_lshl_add_u32 v6, v6, 4, v5
  v_add_u32 v21, s4, v6
  s_sub_u32 s4, s4, 1024
  v_add_u32 v4, 128, v7
  v_mul_u32_u24 v5, 3641, v4
  v_lshrrev_b32 v5, 16, v5
  v_mul_u32_u24 v6, 18, v5
  v_sub_u32 v6, v4, v6
  v_mul_u32_u24 v5, 1152, v5
  v_lshl_add_u32 v6, v6, 4, v5
  v_add_u32 v22, s4, v6
  s_sub_u32 s4, s4, 1024
  v_lshrrev_b32 v4, 2, v2
  v_mul_u32_u24 v4, 288, v4
  v_and_b32 v5, 3, v2
  v_lshl_add_u32 v23, v5, 3, v4
  v_lshlrev_b32 v24, 2, v5
  s_mul_i32 s60, s18, 2304
  s_and_b32 s54, s44, 0xffffff80
  s_add_u32 s55, s54, 16
  s_and_b32 s99, s19, 0xf8
  v_mov_b32 v26, 2
  v_mov_b32 v27, 4
  s_lshl_b32 s63, s5, 12
  s_add_u32 s63, s63, 0
  v_mfma_f32_16x16x32_bf16 v[64:67], a[128:131], v[192:195], v[160:163]
  v_exp_f32 v112, v112
  v_mfma_f32_16x16x32_bf16 v[68:71], a[128:131], v[208:211], v[164:167]
  v_exp_f32 v113, v113
  v_mfma_f32_16x16x32_bf16 v[72:75], a[128:131], v[224:227], v[168:171]
  ds_read_b64_tr_b16 a[160:161], v52 offset:8192
  v_cvt_pk_bf16_f32 v146, v112, v113
  v_mfma_f32_16x16x32_bf16 v[76:79], a[128:131], v[240:243], v[172:175]
  v_exp_f32 v114, v114
  v_mfma_f32_16x16x32_bf16 v[64:67], a[132:135], v[196:199], v[64:67]
  ds_read_b64_tr_b16 a[162:163], v52 offset:8704
  ds_read_b64_tr_b16 a[164:165], v52 offset:8224
  v_mfma_f32_16x16x32_bf16 v[68:71], a[132:135], v[212:215], v[68:71]
  v_exp_f32 v115, v115
  v_mfma_f32_16x16x32_bf16 v[72:75], a[132:135], v[228:231], v[72:75]
  ds_read_b64_tr_b16 a[166:167], v52 offset:8736
  v_cvt_pk_bf16_f32 v147, v114, v115
  v_mfma_f32_16x16x32_bf16 v[76:79], a[132:135], v[244:247], v[76:79]
  v_exp_f32 v116, v116
  v_mfma_f32_16x16x32_bf16 v[64:67], a[136:139], v[200:203], v[64:67]
  ds_read_b64_tr_b16 a[168:169], v52 offset:8256
  ds_read_b64_tr_b16 a[170:171], v52 offset:8768
  v_mfma_f32_16x16x32_bf16 v[68:71], a[136:139], v[216:219], v[68:71]
  v_exp_f32 v117, v117
  v_mfma_f32_16x16x32_bf16 v[72:75], a[136:139], v[232:235], v[72:75]
  ds_read_b64_tr_b16 a[172:173], v52 offset:8288
  v_cvt_pk_bf16_f32 v150, v116, v117
  v_mfma_f32_16x16x32_bf16 v[76:79], a[136:139], v[248:251], v[76:79]
  v_exp_f32 v118, v118
  v_mfma_f32_16x16x32_bf16 v[64:67], a[140:143], v[204:207], v[64:67]
  ds_read_b64_tr_b16 a[174:175], v52 offset:8800
  v_mfma_f32_16x16x32_bf16 v[68:71], a[140:143], v[220:223], v[68:71]
  v_exp_f32 v119, v119
  v_mfma_f32_16x16x32_bf16 v[72:75], a[140:143], v[236:239], v[72:75]
  ds_read_b64_tr_b16 a[176:177], v52 offset:8320
  v_cvt_pk_bf16_f32 v151, v118, v119
  v_mfma_f32_16x16x32_bf16 v[76:79], a[140:143], v[252:255], v[76:79]
  v_exp_f32 v120, v120
  v_mfma_f32_16x16x32_bf16 v[80:83], a[144:147], v[192:195], v[160:163]
  v_exp_f32 v121, v121
  v_mfma_f32_16x16x32_bf16 v[84:87], a[144:147], v[208:211], v[164:167]
  ds_read_b64_tr_b16 a[178:179], v52 offset:8832
  ds_read_b64_tr_b16 a[180:181], v52 offset:8352
  v_cvt_pk_bf16_f32 v154, v120, v121
  v_mfma_f32_16x16x32_bf16 v[88:91], a[144:147], v[224:227], v[168:171]
  v_exp_f32 v122, v122
  v_mfma_f32_16x16x32_bf16 v[92:95], a[144:147], v[240:243], v[172:175]
  ds_read_b64_tr_b16 a[182:183], v52 offset:8864
  ds_read_b64_tr_b16 a[184:185], v52 offset:8384
  v_mfma_f32_16x16x32_bf16 v[80:83], a[148:151], v[196:199], v[80:83]
  v_exp_f32 v123, v123
  v_mfma_f32_16x16x32_bf16 v[84:87], a[148:151], v[212:215], v[84:87]
  ds_read_b64_tr_b16 a[186:187], v52 offset:8896
  v_cvt_pk_bf16_f32 v155, v122, v123
  v_mfma_f32_16x16x32_bf16 v[88:91], a[148:151], v[228:231], v[88:91]
  v_exp_f32 v124, v124
  v_mfma_f32_16x16x32_bf16 v[92:95], a[148:151], v[244:247], v[92:95]
  ds_read_b64_tr_b16 a[188:189], v52 offset:8416
  v_add_f32 v62, v62, v120
  v_mfma_f32_16x16x32_bf16 v[80:83], a[152:155], v[200:203], v[80:83]
  v_exp_f32 v125, v125
  v_mfma_f32_16x16x32_bf16 v[84:87], a[152:155], v[216:219], v[84:87]
  ds_read_b64_tr_b16 a[190:191], v52 offset:8928
  v_cvt_pk_bf16_f32 v158, v124, v125
  v_mfma_f32_16x16x32_bf16 v[88:91], a[152:155], v[232:235], v[88:91]
  v_exp_f32 v126, v126
  v_mfma_f32_16x16x32_bf16 v[92:95], a[152:155], v[248:251], v[92:95]
  v_add_f32 v62, v62, v121
  v_add_f32 v62, v62, v122
  v_mfma_f32_16x16x32_bf16 v[80:83], a[156:159], v[204:207], v[80:83]
  v_exp_f32 v127, v127
  v_mfma_f32_16x16x32_bf16 v[84:87], a[156:159], v[220:223], v[84:87]
  v_cvt_pk_bf16_f32 v159, v126, v127
  v_add_f32 v62, v62, v123
  v_mfma_f32_16x16x32_bf16 v[88:91], a[156:159], v[236:239], v[88:91]
  v_add_f32 v63, v63, v124
  v_add_f32 v63, v63, v125
  v_mfma_f32_16x16x32_bf16 v[92:95], a[156:159], v[252:255], v[92:95]
  s_waitcnt vmcnt(5) lgkmcnt(0)
  s_barrier
  v_mfma_f32_16x16x32_bf16 v[176:179], v[36:39], v[144:147], v[176:179]
  s_xor_b32 s3, s19, 0
  v_exp_f32 v64, v64
  v_mfma_f32_16x16x32_bf16 v[180:183], v[36:39], v[148:151], v[180:183]
  ds_read_b128 a[128:131], v48 offset:16640
  v_add_f32 v63, v63, v126
  v_mfma_f32_16x16x32_bf16 a[0:3], a[160:163], v[144:147], a[0:3]
  s_lshl2_add_u32 s3, s3, 0
  v_exp_f32 v65, v65
  v_mfma_f32_16x16x32_bf16 a[4:7], a[160:163], v[148:151], a[4:7]
  ds_read_b128 a[132:135], v49 offset:16640
  v_cvt_pk_bf16_f32 v128, v64, v65
  v_mfma_f32_16x16x32_bf16 a[8:11], a[160:163], v[152:155], a[8:11]
  s_mul_i32 s61, s3, 36864
  v_exp_f32 v66, v66
  v_mfma_f32_16x16x32_bf16 a[12:15], a[160:163], v[156:159], a[12:15]
  v_add_f32 v63, v63, v127
  v_mfma_f32_16x16x32_bf16 a[16:19], a[164:167], v[144:147], a[16:19]
  s_add_u32 m0, s60, 0
  v_exp_f32 v67, v67
  v_mfma_f32_16x16x32_bf16 a[20:23], a[164:167], v[148:151], a[20:23]
  ds_read_b128 a[136:139], v50 offset:16640
  v_cvt_pk_bf16_f32 v129, v66, v67
  v_mfma_f32_16x16x32_bf16 a[24:27], a[164:167], v[152:155], a[24:27]
  v_exp_f32 v68, v68
  v_mfma_f32_16x16x32_bf16 a[28:31], a[164:167], v[156:159], a[28:31]
  buffer_load_dwordx4 v20, s[40:43], s61 offen lds
  v_mfma_f32_16x16x32_bf16 a[32:35], a[168:171], v[144:147], a[32:35]
  v_exp_f32 v69, v69
  v_mfma_f32_16x16x32_bf16 a[36:39], a[168:171], v[148:151], a[36:39]
  ds_read_b128 a[140:143], v51 offset:16640
  v_cvt_pk_bf16_f32 v132, v68, v69
  v_mfma_f32_16x16x32_bf16 a[40:43], a[168:171], v[152:155], a[40:43]
  v_exp_f32 v70, v70
  v_mfma_f32_16x16x32_bf16 a[44:47], a[168:171], v[156:159], a[44:47]
  buffer_load_dwordx4 v21, s[40:43], s61 offen offset:1024 lds
  s_mov_b64 exec, 0xffff
  buffer_load_dwordx4 v22, s[40:43], s61 offen offset:2048 lds
  s_mov_b64 exec, -1
  v_mfma_f32_16x16x32_bf16 a[48:51], a[172:175], v[144:147], a[48:51]
  v_exp_f32 v71, v71
  v_mfma_f32_16x16x32_bf16 a[52:55], a[172:175], v[148:151], a[52:55]
  ds_read_b128 a[144:147], v48 offset:20736
  v_cvt_pk_bf16_f32 v133, v70, v71
  v_mfma_f32_16x16x32_bf16 a[56:59], a[172:175], v[152:155], a[56:59]
  s_xor_b32 s3, s19, 0
  v_exp_f32 v72, v72
  v_mfma_f32_16x16x32_bf16 a[60:63], a[172:175], v[156:159], a[60:63]
  ds_read_b128 a[148:151], v49 offset:20736
  v_add_f32 v62, v62, v72
  v_mfma_f32_16x16x32_bf16 a[64:67], a[176:179], v[144:147], a[64:67]
  s_lshl2_add_u32 s3, s3, 1
  v_exp_f32 v73, v73
  v_mfma_f32_16x16x32_bf16 a[68:71], a[176:179], v[148:151], a[68:71]
  v_cvt_pk_bf16_f32 v136, v72, v73
  v_add_f32 v62, v62, v73
  v_mfma_f32_16x16x32_bf16 a[72:75], a[176:179], v[152:155], a[72:75]
  s_mul_i32 s61, s3, 36864
  v_exp_f32 v74, v74
  v_mfma_f32_16x16x32_bf16 a[76:79], a[176:179], v[156:159], a[76:79]
  ds_read_b128 a[152:155], v50 offset:20736
  v_add_f32 v62, v62, v74
  v_mfma_f32_16x16x32_bf16 a[80:83], a[180:183], v[144:147], a[80:83]
  s_add_u32 m0, s60, 9216
  v_exp_f32 v75, v75
  v_mfma_f32_16x16x32_bf16 a[84:87], a[180:183], v[148:151], a[84:87]
  v_cvt_pk_bf16_f32 v137, v74, v75
  v_add_f32 v62, v62, v75
  v_mfma_f32_16x16x32_bf16 a[88:91], a[180:183], v[152:155], a[88:91]
  v_exp_f32 v76, v76
  v_mfma_f32_16x16x32_bf16 a[92:95], a[180:183], v[156:159], a[92:95]
  ds_read_b128 a[156:159], v51 offset:20736
  buffer_load_dwordx4 v20, s[40:43], s61 offen lds
  v_mfma_f32_16x16x32_bf16 a[96:99], a[184:187], v[144:147], a[96:99]
  v_exp_f32 v77, v77
  v_mfma_f32_16x16x32_bf16 a[100:103], a[184:187], v[148:151], a[100:103]
  buffer_load_dwordx4 v21, s[40:43], s61 offen offset:1024 lds
  v_cvt_pk_bf16_f32 v140, v76, v77
  v_mfma_f32_16x16x32_bf16 a[104:107], a[184:187], v[152:155], a[104:107]
  v_exp_f32 v78, v78
  v_mfma_f32_16x16x32_bf16 a[108:111], a[184:187], v[156:159], a[108:111]
  s_mov_b64 exec, 0xffff
  buffer_load_dwordx4 v22, s[40:43], s61 offen offset:2048 lds
  s_mov_b64 exec, -1
  v_mfma_f32_16x16x32_bf16 a[112:115], a[188:191], v[144:147], a[112:115]
  v_exp_f32 v79, v79
  v_mfma_f32_16x16x32_bf16 a[116:119], a[188:191], v[148:151], a[116:119]
  v_cvt_pk_bf16_f32 v141, v78, v79
  v_add_f32 v63, v63, v76
  v_add_f32 v63, v63, v79
  v_mfma_f32_16x16x32_bf16 a[120:123], a[188:191], v[152:155], a[120:123]
  v_add_f32 v63, v63, v77
  v_add_f32 v63, v63, v78
  v_mfma_f32_16x16x32_bf16 a[124:127], a[188:191], v[156:159], a[124:127]
  s_waitcnt lgkmcnt(0)
  v_mfma_f32_16x16x32_bf16 v[96:99], a[128:131], v[192:195], v[160:163]
  v_exp_f32 v80, v80
  v_mfma_f32_16x16x32_bf16 v[100:103], a[128:131], v[208:211], v[164:167]
  v_exp_f32 v81, v81
  v_mfma_f32_16x16x32_bf16 v[104:107], a[128:131], v[224:227], v[168:171]
  ds_read_b64_tr_b16 a[160:161], v52 offset:24832
  v_cvt_pk_bf16_f32 v130, v80, v81
  v_mfma_f32_16x16x32_bf16 v[108:111], a[128:131], v[240:243], v[172:175]
  v_exp_f32 v82, v82
  v_mfma_f32_16x16x32_bf16 v[96:99], a[132:135], v[196:199], v[96:99]
  ds_read_b64_tr_b16 a[162:163], v52 offset:25344
  ds_read_b64_tr_b16 a[164:165], v52 offset:24864
  v_mfma_f32_16x16x32_bf16 v[100:103], a[132:135], v[212:215], v[100:103]
  v_exp_f32 v83, v83
  v_mfma_f32_16x16x32_bf16 v[104:107], a[132:135], v[228:231], v[104:107]
  ds_read_b64_tr_b16 a[166:167], v52 offset:25376
  v_cvt_pk_bf16_f32 v131, v82, v83
  v_mfma_f32_16x16x32_bf16 v[108:111], a[132:135], v[244:247], v[108:111]
  v_exp_f32 v84, v84
  v_mfma_f32_16x16x32_bf16 v[96:99], a[136:139], v[200:203], v[96:99]
  ds_read_b64_tr_b16 a[168:169], v52 offset:24896
  ds_read_b64_tr_b16 a[170:171], v52 offset:25408
  v_mfma_f32_16x16x32_bf16 v[100:103], a[136:139], v[216:219], v[100:103]
  v_exp_f32 v85, v85
  v_mfma_f32_16x16x32_bf16 v[104:107], a[136:139], v[232:235], v[104:107]
  ds_read_b64_tr_b16 a[172:173], v52 offset:24928
  v_cvt_pk_bf16_f32 v134, v84, v85
  v_mfma_f32_16x16x32_bf16 v[108:111], a[136:139], v[248:251], v[108:111]
  v_exp_f32 v86, v86
  v_mfma_f32_16x16x32_bf16 v[96:99], a[140:143], v[204:207], v[96:99]
  ds_read_b64_tr_b16 a[174:175], v52 offset:25440
  v_mfma_f32_16x16x32_bf16 v[100:103], a[140:143], v[220:223], v[100:103]
  v_exp_f32 v87, v87
  v_mfma_f32_16x16x32_bf16 v[104:107], a[140:143], v[236:239], v[104:107]
  ds_read_b64_tr_b16 a[176:177], v52 offset:24960
  v_cvt_pk_bf16_f32 v135, v86, v87
  v_mfma_f32_16x16x32_bf16 v[108:111], a[140:143], v[252:255], v[108:111]
  v_exp_f32 v88, v88
  v_mfma_f32_16x16x32_bf16 v[112:115], a[144:147], v[192:195], v[160:163]
  v_exp_f32 v89, v89
  v_mfma_f32_16x16x32_bf16 v[116:119], a[144:147], v[208:211], v[164:167]
  ds_read_b64_tr_b16 a[178:179], v52 offset:25472
  ds_read_b64_tr_b16 a[180:181], v52 offset:24992
  v_cvt_pk_bf16_f32 v138, v88, v89
  v_mfma_f32_16x16x32_bf16 v[120:123], a[144:147], v[224:227], v[168:171]
  v_exp_f32 v90, v90
  v_mfma_f32_16x16x32_bf16 v[124:127], a[144:147], v[240:243], v[172:175]
  ds_read_b64_tr_b16 a[182:183], v52 offset:25504
  ds_read_b64_tr_b16 a[184:185], v52 offset:25024
  v_mfma_f32_16x16x32_bf16 v[112:115], a[148:151], v[196:199], v[112:115]
  v_exp_f32 v91, v91
  v_mfma_f32_16x16x32_bf16 v[116:119], a[148:151], v[212:215], v[116:119]
  ds_read_b64_tr_b16 a[186:187], v52 offset:25536
  v_cvt_pk_bf16_f32 v139, v90, v91
  v_mfma_f32_16x16x32_bf16 v[120:123], a[148:151], v[228:231], v[120:123]
  v_exp_f32 v92, v92
  v_mfma_f32_16x16x32_bf16 v[124:127], a[148:151], v[244:247], v[124:127]
  ds_read_b64_tr_b16 a[188:189], v52 offset:25056
  v_add_f32 v62, v62, v88
  v_mfma_f32_16x16x32_bf16 v[112:115], a[152:155], v[200:203], v[112:115]
  v_exp_f32 v93, v93
  v_mfma_f32_16x16x32_bf16 v[116:119], a[152:155], v[216:219], v[116:119]
  ds_read_b64_tr_b16 a[190:191], v52 offset:25568
  v_cvt_pk_bf16_f32 v142, v92, v93
  v_mfma_f32_16x16x32_bf16 v[120:123], a[152:155], v[232:235], v[120:123]
  v_exp_f32 v94, v94
  v_mfma_f32_16x16x32_bf16 v[124:127], a[152:155], v[248:251], v[124:127]
  v_add_f32 v62, v62, v89
  v_add_f32 v62, v62, v90
  v_mfma_f32_16x16x32_bf16 v[112:115], a[156:159], v[204:207], v[112:115]
  v_exp_f32 v95, v95
  v_mfma_f32_16x16x32_bf16 v[116:119], a[156:159], v[220:223], v[116:119]
  v_cvt_pk_bf16_f32 v143, v94, v95
  v_add_f32 v62, v62, v91
  v_mfma_f32_16x16x32_bf16 v[120:123], a[156:159], v[236:239], v[120:123]
  v_add_f32 v63, v63, v92
  v_add_f32 v63, v63, v93
  v_mfma_f32_16x16x32_bf16 v[124:127], a[156:159], v[252:255], v[124:127]
  s_waitcnt vmcnt(8) lgkmcnt(0)
  s_barrier
  v_mfma_f32_16x16x32_bf16 v[176:179], v[36:39], v[128:131], v[176:179]
  s_xor_b32 s3, s19, 0
  v_exp_f32 v96, v96
  v_mfma_f32_16x16x32_bf16 v[180:183], v[36:39], v[132:135], v[180:183]
  v_add_f32 v63, v63, v94
  v_add_f32 v63, v63, v95
  v_mfma_f32_16x16x32_bf16 a[0:3], a[160:163], v[128:131], a[0:3]
  s_lshl2_add_u32 s3, s3, 2
  v_exp_f32 v97, v97
  v_mfma_f32_16x16x32_bf16 a[4:7], a[160:163], v[132:135], a[4:7]
  v_cvt_pk_bf16_f32 v144, v96, v97
  v_mfma_f32_16x16x32_bf16 a[8:11], a[160:163], v[136:139], a[8:11]
  s_mul_i32 s61, s3, 36864
  v_exp_f32 v98, v98
  v_mfma_f32_16x16x32_bf16 a[12:15], a[160:163], v[140:143], a[12:15]
  v_mfma_f32_16x16x32_bf16 a[16:19], a[164:167], v[128:131], a[16:19]
  s_add_u32 m0, s60, 18432
  v_exp_f32 v99, v99
  v_mfma_f32_16x16x32_bf16 a[20:23], a[164:167], v[132:135], a[20:23]
  v_cvt_pk_bf16_f32 v145, v98, v99
  v_mfma_f32_16x16x32_bf16 a[24:27], a[164:167], v[136:139], a[24:27]
  v_exp_f32 v100, v100
  v_mfma_f32_16x16x32_bf16 a[28:31], a[164:167], v[140:143], a[28:31]
  buffer_load_dwordx4 v20, s[40:43], s61 offen lds
  v_mfma_f32_16x16x32_bf16 a[32:35], a[168:171], v[128:131], a[32:35]
  v_exp_f32 v101, v101
  v_mfma_f32_16x16x32_bf16 a[36:39], a[168:171], v[132:135], a[36:39]
  buffer_load_dwordx4 v21, s[40:43], s61 offen offset:1024 lds
  v_cvt_pk_bf16_f32 v148, v100, v101
  v_mfma_f32_16x16x32_bf16 a[40:43], a[168:171], v[136:139], a[40:43]
  v_exp_f32 v102, v102
  v_mfma_f32_16x16x32_bf16 a[44:47], a[168:171], v[140:143], a[44:47]
  s_mov_b64 exec, 0xffff
  buffer_load_dwordx4 v22, s[40:43], s61 offen offset:2048 lds
  s_mov_b64 exec, -1
  v_mfma_f32_16x16x32_bf16 a[48:51], a[172:175], v[128:131], a[48:51]
  v_exp_f32 v103, v103
  v_mfma_f32_16x16x32_bf16 a[52:55], a[172:175], v[132:135], a[52:55]
  v_cvt_pk_bf16_f32 v149, v102, v103
  v_mfma_f32_16x16x32_bf16 a[56:59], a[172:175], v[136:139], a[56:59]
  s_xor_b32 s3, s19, 0
  v_exp_f32 v104, v104
  v_mfma_f32_16x16x32_bf16 a[60:63], a[172:175], v[140:143], a[60:63]
  v_add_f32 v62, v62, v104
  v_mfma_f32_16x16x32_bf16 a[64:67], a[176:179], v[128:131], a[64:67]
  s_lshl2_add_u32 s3, s3, 3
  v_exp_f32 v105, v105
  v_mfma_f32_16x16x32_bf16 a[68:71], a[176:179], v[132:135], a[68:71]
  v_cvt_pk_bf16_f32 v152, v104, v105
  v_add_f32 v62, v62, v105
  v_mfma_f32_16x16x32_bf16 a[72:75], a[176:179], v[136:139], a[72:75]
  s_mul_i32 s61, s3, 36864
  v_exp_f32 v106, v106
  v_mfma_f32_16x16x32_bf16 a[76:79], a[176:179], v[140:143], a[76:79]
  v_add_f32 v62, v62, v106
  v_mfma_f32_16x16x32_bf16 a[80:83], a[180:183], v[128:131], a[80:83]
  s_add_u32 m0, s60, 27648
  v_exp_f32 v107, v107
  v_mfma_f32_16x16x32_bf16 a[84:87], a[180:183], v[132:135], a[84:87]
  v_cvt_pk_bf16_f32 v153, v106, v107
  v_add_f32 v62, v62, v107
  v_mfma_f32_16x16x32_bf16 a[88:91], a[180:183], v[136:139], a[88:91]
  v_exp_f32 v108, v108
  v_mfma_f32_16x16x32_bf16 a[92:95], a[180:183], v[140:143], a[92:95]
  buffer_load_dwordx4 v20, s[40:43], s61 offen lds
  v_add_f32 v63, v63, v108
  v_mfma_f32_16x16x32_bf16 a[96:99], a[184:187], v[128:131], a[96:99]
  v_exp_f32 v109, v109
  v_mfma_f32_16x16x32_bf16 a[100:103], a[184:187], v[132:135], a[100:103]
  buffer_load_dwordx4 v21, s[40:43], s61 offen offset:1024 lds
  v_cvt_pk_bf16_f32 v156, v108, v109
  v_mfma_f32_16x16x32_bf16 a[104:107], a[184:187], v[136:139], a[104:107]
  v_exp_f32 v110, v110
  v_mfma_f32_16x16x32_bf16 a[108:111], a[184:187], v[140:143], a[108:111]
  s_mov_b64 exec, 0xffff
  buffer_load_dwordx4 v22, s[40:43], s61 offen offset:2048 lds
  s_mov_b64 exec, -1
  v_mfma_f32_16x16x32_bf16 a[112:115], a[188:191], v[128:131], a[112:115]
  v_exp_f32 v111, v111
  v_mfma_f32_16x16x32_bf16 a[116:119], a[188:191], v[132:135], a[116:119]
  v_cvt_pk_bf16_f32 v157, v110, v111
  v_add_f32 v63, v63, v109
  v_mfma_f32_16x16x32_bf16 a[120:123], a[188:191], v[136:139], a[120:123]
  v_add_f32 v63, v63, v110
  v_add_f32 v63, v63, v111
  v_mfma_f32_16x16x32_bf16 a[124:127], a[188:191], v[140:143], a[124:127]
  s_waitcnt lgkmcnt(0)
  ds_read_b64_tr_b16 a[160:161], v52 offset:41472
  ds_read_b64_tr_b16 a[162:163], v52 offset:41984
  ds_read_b64_tr_b16 a[164:165], v52 offset:41504
  ds_read_b64_tr_b16 a[166:167], v52 offset:42016
  ds_read_b64_tr_b16 a[168:169], v52 offset:41536
  ds_read_b64_tr_b16 a[170:171], v52 offset:42048
  ds_read_b64_tr_b16 a[172:173], v52 offset:41568
  ds_read_b64_tr_b16 a[174:175], v52 offset:42080
  ds_read_b64_tr_b16 a[176:177], v52 offset:41600
  ds_read_b64_tr_b16 a[178:179], v52 offset:42112
  ds_read_b64_tr_b16 a[180:181], v52 offset:41632
  ds_read_b64_tr_b16 a[182:183], v52 offset:42144
  ds_read_b64_tr_b16 a[184:185], v52 offset:41664
  ds_read_b64_tr_b16 a[186:187], v52 offset:42176
  ds_read_b64_tr_b16 a[188:189], v52 offset:41696
  ds_read_b64_tr_b16 a[190:191], v52 offset:42208
  v_exp_f32 v112, v112
  v_exp_f32 v113, v113
  v_exp_f32 v114, v114
  v_exp_f32 v115, v115
  v_exp_f32 v116, v116
  v_exp_f32 v117, v117
  v_exp_f32 v118, v118
  v_exp_f32 v119, v119
  v_exp_f32 v120, v120
  v_exp_f32 v121, v121
  v_exp_f32 v122, v122
  v_exp_f32 v123, v123
  v_exp_f32 v124, v124
  v_exp_f32 v125, v125
  v_exp_f32 v126, v126
  v_exp_f32 v127, v127
  v_cvt_pk_bf16_f32 v146, v112, v113
  v_cvt_pk_bf16_f32 v147, v114, v115
  v_cvt_pk_bf16_f32 v150, v116, v117
  v_cvt_pk_bf16_f32 v151, v118, v119
  v_cvt_pk_bf16_f32 v154, v120, v121
  v_cvt_pk_bf16_f32 v155, v122, v123
  v_cvt_pk_bf16_f32 v158, v124, v125
  v_cvt_pk_bf16_f32 v159, v126, v127
  v_add_f32 v62, v62, v120
  v_add_f32 v62, v62, v121
  v_add_f32 v62, v62, v122
  v_add_f32 v62, v62, v123
  v_add_f32 v63, v63, v124
  v_add_f32 v63, v63, v125
  v_add_f32 v63, v63, v126
  v_add_f32 v63, v63, v127
  s_waitcnt vmcnt(6) lgkmcnt(0)
  s_barrier
  v_mfma_f32_16x16x32_bf16 v[176:179], v[36:39], v[144:147], v[176:179]
  s_xor_b32 s3, s19, 1
  v_mfma_f32_16x16x32_bf16 v[180:183], v[36:39], v[148:151], v[180:183]
  v_mfma_f32_16x16x32_bf16 a[0:3], a[160:163], v[144:147], a[0:3]
  s_lshl2_add_u32 s3, s3, 0
  ds_read_b64_tr_b16 v[64:65], v23 offset:0
  v_mfma_f32_16x16x32_bf16 a[4:7], a[160:163], v[148:151], a[4:7]
  ds_read_b64_tr_b16 v[66:67], v23 offset:4608
  v_mfma_f32_16x16x32_bf16 a[8:11], a[160:163], v[152:155], a[8:11]
  s_mul_i32 s61, s3, 36864
  v_mfma_f32_16x16x32_bf16 a[12:15], a[160:163], v[156:159], a[12:15]
  ds_read_b64_tr_b16 v[68:69], v23 offset:32
  v_mfma_f32_16x16x32_bf16 a[16:19], a[164:167], v[144:147], a[16:19]
  s_add_u32 m0, s60, 36864
  ds_read_b64_tr_b16 v[70:71], v23 offset:4640
  v_mfma_f32_16x16x32_bf16 a[20:23], a[164:167], v[148:151], a[20:23]
  v_mfma_f32_16x16x32_bf16 a[24:27], a[164:167], v[152:155], a[24:27]
  ds_read_b64_tr_b16 v[72:73], v23 offset:64
  v_mfma_f32_16x16x32_bf16 a[28:31], a[164:167], v[156:159], a[28:31]
  buffer_load_dwordx4 v20, s[40:43], s61 offen lds
  ds_read_b64_tr_b16 v[74:75], v23 offset:4672
  v_mfma_f32_16x16x32_bf16 a[32:35], a[168:171], v[144:147], a[32:35]
  v_mfma_f32_16x16x32_bf16 a[36:39], a[168:171], v[148:151], a[36:39]
  buffer_load_dwordx4 v21, s[40:43], s61 offen offset:1024 lds
  ds_read_b64_tr_b16 v[76:77], v23 offset:96
  v_mfma_f32_16x16x32_bf16 a[40:43], a[168:171], v[152:155], a[40:43]
  ds_read_b64_tr_b16 v[78:79], v23 offset:4704
  v_mfma_f32_16x16x32_bf16 a[44:47], a[168:171], v[156:159], a[44:47]
  s_mov_b64 exec, 0xffff
  buffer_load_dwordx4 v22, s[40:43], s61 offen offset:2048 lds
  s_mov_b64 exec, -1
  v_mfma_f32_16x16x32_bf16 a[48:51], a[172:175], v[144:147], a[48:51]
  ds_read_b64_tr_b16 v[80:81], v23 offset:128
  v_mfma_f32_16x16x32_bf16 a[52:55], a[172:175], v[148:151], a[52:55]
  ds_read_b64_tr_b16 v[82:83], v23 offset:4736
  v_mfma_f32_16x16x32_bf16 a[56:59], a[172:175], v[152:155], a[56:59]
  s_xor_b32 s3, s19, 2
  v_mfma_f32_16x16x32_bf16 a[60:63], a[172:175], v[156:159], a[60:63]
  ds_read_b64_tr_b16 v[84:85], v23 offset:160
  v_mfma_f32_16x16x32_bf16 a[64:67], a[176:179], v[144:147], a[64:67]
  s_lshl2_add_u32 s3, s3, 0
  ds_read_b64_tr_b16 v[86:87], v23 offset:4768
  v_mfma_f32_16x16x32_bf16 a[68:71], a[176:179], v[148:151], a[68:71]
  v_mfma_f32_16x16x32_bf16 a[72:75], a[176:179], v[152:155], a[72:75]
  s_mul_i32 s61, s3, 36864
  ds_read_b64_tr_b16 v[88:89], v23 offset:192
  v_mfma_f32_16x16x32_bf16 a[76:79], a[176:179], v[156:159], a[76:79]
  ds_read_b64_tr_b16 v[90:91], v23 offset:4800
  v_mfma_f32_16x16x32_bf16 a[80:83], a[180:183], v[144:147], a[80:83]
  s_add_u32 m0, s60, 46080
  v_mfma_f32_16x16x32_bf16 a[84:87], a[180:183], v[148:151], a[84:87]
  ds_read_b64_tr_b16 v[92:93], v23 offset:224
  v_mfma_f32_16x16x32_bf16 a[88:91], a[180:183], v[152:155], a[88:91]
TP_12:
  s_cbranch_execz TP_16
  ds_read_b64_tr_b16 v[94:95], v23 offset:4832
  v_mfma_f32_16x16x32_bf16 a[92:95], a[180:183], v[156:159], a[92:95]
  buffer_load_dwordx4 v20, s[40:43], s61 offen lds
  v_mfma_f32_16x16x32_bf16 a[96:99], a[184:187], v[144:147], a[96:99]
  ds_read_b64_tr_b16 v[96:97], v23 offset:256
  v_mfma_f32_16x16x32_bf16 a[100:103], a[184:187], v[148:151], a[100:103]
  buffer_load_dwordx4 v21, s[40:43], s61 offen offset:1024 lds
  ds_read_b64_tr_b16 v[98:99], v23 offset:4864
  v_mfma_f32_16x16x32_bf16 a[104:107], a[184:187], v[152:155], a[104:107]
  v_mfma_f32_16x16x32_bf16 a[108:111], a[184:187], v[156:159], a[108:111]
  s_mov_b64 exec, 0xffff
  buffer_load_dwordx4 v22, s[40:43], s61 offen offset:2048 lds
  s_mov_b64 exec, -1
  v_mfma_f32_16x16x32_bf16 a[112:115], a[188:191], v[144:147], a[112:115]
  v_mfma_f32_16x16x32_bf16 a[116:119], a[188:191], v[148:151], a[116:119]
  v_mfma_f32_16x16x32_bf16 a[120:123], a[188:191], v[152:155], a[120:123]
  v_mfma_f32_16x16x32_bf16 a[124:127], a[188:191], v[156:159], a[124:127]
  s_waitcnt lgkmcnt(0)
  s_lshl_b32 s11, s19, 19
  s_lshl_b32 s4, s5, 12
  s_add_u32 s11, s11, s4
  s_add_u32 s11, s11, 0
  s_nop 2
  v_mov_b32 v44, v60
  v_mov_b32 v45, v61
  v_mov_b32 v46, v62
  v_mov_b32 v47, v63
  s_nop 0
  v_permlane16_swap_b32 v60, v44
  v_permlane16_swap_b32 v61, v45
  v_permlane16_swap_b32 v62, v46
  v_permlane16_swap_b32 v63, v47
  v_add_f32 v60, v60, v44
  v_add_f32 v61, v61, v45
  v_add_f32 v62, v62, v46
  v_add_f32 v63, v63, v47
  v_mov_b32 v44, v60
  v_mov_b32 v45, v61
  v_mov_b32 v46, v62
  v_mov_b32 v47, v63
  s_nop 0
  v_permlane32_swap_b32 v60, v44
  v_permlane32_swap_b32 v61, v45
  v_permlane32_swap_b32 v62, v46
  v_permlane32_swap_b32 v63, v47
  v_add_f32 v60, v60, v44
  v_add_f32 v61, v61, v45
  v_add_f32 v62, v62, v46
  v_add_f32 v63, v63, v47
  v_add_f32 v60, v60, v176
  v_add_f32 v61, v61, v180
  v_add_f32 v45, v60, v61
  v_add_f32 v46, v62, v63
  v_add_f32 v44, v45, v46
  v_mov_b32 v45, 0x5f800000
  v_cmp_nlt_f32 s[6:7], v44, v45
  s_cmp_lg_u64 s[6:7], 0
  s_cbranch_scc0 FBR_O
  s_call_b64 s[6:7], K_fallback
FBR_O:
  v_rcp_f32 v40, v60
  v_rcp_f32 v41, v61
  v_rcp_f32 v42, v62
  v_rcp_f32 v43, v63
  v_accvgpr_read_b32 v136, a0
  v_accvgpr_read_b32 v137, a1
  v_accvgpr_read_b32 v138, a2
  v_accvgpr_read_b32 v139, a3
  v_accvgpr_read_b32 v140, a16
  v_accvgpr_read_b32 v141, a17
  v_accvgpr_read_b32 v142, a18
  v_accvgpr_read_b32 v143, a19
  v_pk_mul_f32 v[136:137], v[136:137], v[40:41] op_sel_hi:[1,0]
  v_pk_mul_f32 v[138:139], v[138:139], v[40:41] op_sel_hi:[1,0]
  v_pk_mul_f32 v[140:141], v[140:141], v[40:41] op_sel_hi:[1,0]
  v_pk_mul_f32 v[142:143], v[142:143], v[40:41] op_sel_hi:[1,0]
  v_cvt_pk_bf16_f32 v168, v136, v137
  v_cvt_pk_bf16_f32 v169, v138, v139
  v_cvt_pk_bf16_f32 v170, v140, v141
  v_cvt_pk_bf16_f32 v171, v142, v143
  buffer_store_dwordx4 v[168:171], v3, s[12:15], s11 offen offset:0 sc1
  v_accvgpr_read_b32 v144, a4
  v_accvgpr_read_b32 v145, a5
  v_accvgpr_read_b32 v146, a6
  v_accvgpr_read_b32 v147, a7
  v_accvgpr_read_b32 v148, a20
  v_accvgpr_read_b32 v149, a21
  v_accvgpr_read_b32 v150, a22
  v_accvgpr_read_b32 v151, a23
  v_pk_mul_f32 v[144:145], v[144:145], v[40:41] op_sel:[0,1] op_sel_hi:[1,1]
  v_pk_mul_f32 v[146:147], v[146:147], v[40:41] op_sel:[0,1] op_sel_hi:[1,1]
  v_pk_mul_f32 v[148:149], v[148:149], v[40:41] op_sel:[0,1] op_sel_hi:[1,1]
  v_pk_mul_f32 v[150:151], v[150:151], v[40:41] op_sel:[0,1] op_sel_hi:[1,1]
  v_cvt_pk_bf16_f32 v172, v144, v145
  v_cvt_pk_bf16_f32 v173, v146, v147
  v_cvt_pk_bf16_f32 v174, v148, v149
  v_cvt_pk_bf16_f32 v175, v150, v151
  buffer_store_dwordx4 v[172:175], v3, s[12:15], s11 offen offset:1024 sc1
  v_accvgpr_read_b32 v152, a8
  v_accvgpr_read_b32 v153, a9
  v_accvgpr_read_b32 v154, a10
  v_accvgpr_read_b32 v155, a11
  v_accvgpr_read_b32 v156, a24
  v_accvgpr_read_b32 v157, a25
  v_accvgpr_read_b32 v158, a26
  v_accvgpr_read_b32 v159, a27
  v_pk_mul_f32 v[152:153], v[152:153], v[42:43] op_sel_hi:[1,0]
  v_pk_mul_f32 v[154:155], v[154:155], v[42:43] op_sel_hi:[1,0]
  v_pk_mul_f32 v[156:157], v[156:157], v[42:43] op_sel_hi:[1,0]
  v_pk_mul_f32 v[158:159], v[158:159], v[42:43] op_sel_hi:[1,0]
  v_cvt_pk_bf16_f32 v176, v152, v153
  v_cvt_pk_bf16_f32 v177, v154, v155
  v_cvt_pk_bf16_f32 v178, v156, v157
  v_cvt_pk_bf16_f32 v179, v158, v159
  buffer_store_dwordx4 v[176:179], v3, s[12:15], s11 offen offset:2048 sc1
  v_accvgpr_read_b32 v160, a12
  v_accvgpr_read_b32 v161, a13
  v_accvgpr_read_b32 v162, a14
  v_accvgpr_read_b32 v163, a15
  v_accvgpr_read_b32 v164, a28
  v_accvgpr_read_b32 v165, a29
  v_accvgpr_read_b32 v166, a30
  v_accvgpr_read_b32 v167, a31
  v_pk_mul_f32 v[160:161], v[160:161], v[42:43] op_sel:[0,1] op_sel_hi:[1,1]
  v_pk_mul_f32 v[162:163], v[162:163], v[42:43] op_sel:[0,1] op_sel_hi:[1,1]
  v_pk_mul_f32 v[164:165], v[164:165], v[42:43] op_sel:[0,1] op_sel_hi:[1,1]
  v_pk_mul_f32 v[166:167], v[166:167], v[42:43] op_sel:[0,1] op_sel_hi:[1,1]
  v_cvt_pk_bf16_f32 v180, v160, v161
  v_cvt_pk_bf16_f32 v181, v162, v163
  v_cvt_pk_bf16_f32 v182, v164, v165
  v_cvt_pk_bf16_f32 v183, v166, v167
  buffer_store_dwordx4 v[180:183], v3, s[12:15], s11 offen offset:3072 sc1
  s_add_u32 s11, s11, 131072
  v_accvgpr_read_b32 v136, a32
  v_accvgpr_read_b32 v137, a33
  v_accvgpr_read_b32 v138, a34
  v_accvgpr_read_b32 v139, a35
  v_accvgpr_read_b32 v140, a48
  v_accvgpr_read_b32 v141, a49
  v_accvgpr_read_b32 v142, a50
  v_accvgpr_read_b32 v143, a51
  v_pk_mul_f32 v[136:137], v[136:137], v[40:41] op_sel_hi:[1,0]
  v_pk_mul_f32 v[138:139], v[138:139], v[40:41] op_sel_hi:[1,0]
  v_pk_mul_f32 v[140:141], v[140:141], v[40:41] op_sel_hi:[1,0]
  v_pk_mul_f32 v[142:143], v[142:143], v[40:41] op_sel_hi:[1,0]
  v_cvt_pk_bf16_f32 v184, v136, v137
  v_cvt_pk_bf16_f32 v185, v138, v139
  v_cvt_pk_bf16_f32 v186, v140, v141
  v_cvt_pk_bf16_f32 v187, v142, v143
  buffer_store_dwordx4 v[184:187], v3, s[12:15], s11 offen offset:0 sc1
  v_accvgpr_read_b32 v144, a36
  v_accvgpr_read_b32 v145, a37
  v_accvgpr_read_b32 v146, a38
  v_accvgpr_read_b32 v147, a39
  v_accvgpr_read_b32 v148, a52
  v_accvgpr_read_b32 v149, a53
  v_accvgpr_read_b32 v150, a54
  v_accvgpr_read_b32 v151, a55
  v_pk_mul_f32 v[144:145], v[144:145], v[40:41] op_sel:[0,1] op_sel_hi:[1,1]
  v_pk_mul_f32 v[146:147], v[146:147], v[40:41] op_sel:[0,1] op_sel_hi:[1,1]
  v_pk_mul_f32 v[148:149], v[148:149], v[40:41] op_sel:[0,1] op_sel_hi:[1,1]
  v_pk_mul_f32 v[150:151], v[150:151], v[40:41] op_sel:[0,1] op_sel_hi:[1,1]
  v_cvt_pk_bf16_f32 v188, v144, v145
  v_cvt_pk_bf16_f32 v189, v146, v147
  v_cvt_pk_bf16_f32 v190, v148, v149
  v_cvt_pk_bf16_f32 v191, v150, v151
  buffer_store_dwordx4 v[188:191], v3, s[12:15], s11 offen offset:1024 sc1
  v_accvgpr_read_b32 v152, a40
  v_accvgpr_read_b32 v153, a41
  v_accvgpr_read_b32 v154, a42
  v_accvgpr_read_b32 v155, a43
  v_accvgpr_read_b32 v156, a56
  v_accvgpr_read_b32 v157, a57
  v_accvgpr_read_b32 v158, a58
  v_accvgpr_read_b32 v159, a59
  v_pk_mul_f32 v[152:153], v[152:153], v[42:43] op_sel_hi:[1,0]
  v_pk_mul_f32 v[154:155], v[154:155], v[42:43] op_sel_hi:[1,0]
  v_pk_mul_f32 v[156:157], v[156:157], v[42:43] op_sel_hi:[1,0]
  v_pk_mul_f32 v[158:159], v[158:159], v[42:43] op_sel_hi:[1,0]
  v_cvt_pk_bf16_f32 v192, v152, v153
  v_cvt_pk_bf16_f32 v193, v154, v155
  v_cvt_pk_bf16_f32 v194, v156, v157
  v_cvt_pk_bf16_f32 v195, v158, v159
  buffer_store_dwordx4 v[192:195], v3, s[12:15], s11 offen offset:2048 sc1
  v_accvgpr_read_b32 v160, a44
  v_accvgpr_read_b32 v161, a45
  v_accvgpr_read_b32 v162, a46
  v_accvgpr_read_b32 v163, a47
  v_accvgpr_read_b32 v164, a60
  v_accvgpr_read_b32 v165, a61
  v_accvgpr_read_b32 v166, a62
  v_accvgpr_read_b32 v167, a63
  v_pk_mul_f32 v[160:161], v[160:161], v[42:43] op_sel:[0,1] op_sel_hi:[1,1]
  v_pk_mul_f32 v[162:163], v[162:163], v[42:43] op_sel:[0,1] op_sel_hi:[1,1]
  v_pk_mul_f32 v[164:165], v[164:165], v[42:43] op_sel:[0,1] op_sel_hi:[1,1]
  v_pk_mul_f32 v[166:167], v[166:167], v[42:43] op_sel:[0,1] op_sel_hi:[1,1]
  v_cvt_pk_bf16_f32 v196, v160, v161
  v_cvt_pk_bf16_f32 v197, v162, v163
  v_cvt_pk_bf16_f32 v198, v164, v165
  v_cvt_pk_bf16_f32 v199, v166, v167
  buffer_store_dwordx4 v[196:199], v3, s[12:15], s11 offen offset:3072 sc1
  s_add_u32 s11, s11, 131072
  v_accvgpr_read_b32 v136, a64
  v_accvgpr_read_b32 v137, a65
  v_accvgpr_read_b32 v138, a66
  v_accvgpr_read_b32 v139, a67
  v_accvgpr_read_b32 v140, a80
  v_accvgpr_read_b32 v141, a81
  v_accvgpr_read_b32 v142, a82
  v_accvgpr_read_b32 v143, a83
  v_pk_mul_f32 v[136:137], v[136:137], v[40:41] op_sel_hi:[1,0]
  v_pk_mul_f32 v[138:139], v[138:139], v[40:41] op_sel_hi:[1,0]
  v_pk_mul_f32 v[140:141], v[140:141], v[40:41] op_sel_hi:[1,0]
  v_pk_mul_f32 v[142:143], v[142:143], v[40:41] op_sel_hi:[1,0]
  v_cvt_pk_bf16_f32 v200, v136, v137
  v_cvt_pk_bf16_f32 v201, v138, v139
  v_cvt_pk_bf16_f32 v202, v140, v141
  v_cvt_pk_bf16_f32 v203, v142, v143
  v_accvgpr_read_b32 v144, a68
  v_accvgpr_read_b32 v145, a69
  v_accvgpr_read_b32 v146, a70
  v_accvgpr_read_b32 v147, a71
  v_accvgpr_read_b32 v148, a84
  v_accvgpr_read_b32 v149, a85
  v_accvgpr_read_b32 v150, a86
  v_accvgpr_read_b32 v151, a87
  v_pk_mul_f32 v[144:145], v[144:145], v[40:41] op_sel:[0,1] op_sel_hi:[1,1]
  v_pk_mul_f32 v[146:147], v[146:147], v[40:41] op_sel:[0,1] op_sel_hi:[1,1]
  v_pk_mul_f32 v[148:149], v[148:149], v[40:41] op_sel:[0,1] op_sel_hi:[1,1]
  v_pk_mul_f32 v[150:151], v[150:151], v[40:41] op_sel:[0,1] op_sel_hi:[1,1]
  v_cvt_pk_bf16_f32 v204, v144, v145
  v_cvt_pk_bf16_f32 v205, v146, v147
  v_cvt_pk_bf16_f32 v206, v148, v149
  v_cvt_pk_bf16_f32 v207, v150, v151
  v_accvgpr_read_b32 v152, a72
  v_accvgpr_read_b32 v153, a73
  v_accvgpr_read_b32 v154, a74
  v_accvgpr_read_b32 v155, a75
  v_accvgpr_read_b32 v156, a88
  v_accvgpr_read_b32 v157, a89
  v_accvgpr_read_b32 v158, a90
  v_accvgpr_read_b32 v159, a91
  v_pk_mul_f32 v[152:153], v[152:153], v[42:43] op_sel_hi:[1,0]
  v_pk_mul_f32 v[154:155], v[154:155], v[42:43] op_sel_hi:[1,0]
  v_pk_mul_f32 v[156:157], v[156:157], v[42:43] op_sel_hi:[1,0]
  v_pk_mul_f32 v[158:159], v[158:159], v[42:43] op_sel_hi:[1,0]
  v_cvt_pk_bf16_f32 v208, v152, v153
  v_cvt_pk_bf16_f32 v209, v154, v155
  v_cvt_pk_bf16_f32 v210, v156, v157
  v_cvt_pk_bf16_f32 v211, v158, v159
  v_accvgpr_read_b32 v160, a76
  v_accvgpr_read_b32 v161, a77
  v_accvgpr_read_b32 v162, a78
  v_accvgpr_read_b32 v163, a79
  v_accvgpr_read_b32 v164, a92
  v_accvgpr_read_b32 v165, a93
  v_accvgpr_read_b32 v166, a94
  v_accvgpr_read_b32 v167, a95
  v_pk_mul_f32 v[160:161], v[160:161], v[42:43] op_sel:[0,1] op_sel_hi:[1,1]
  v_pk_mul_f32 v[162:163], v[162:163], v[42:43] op_sel:[0,1] op_sel_hi:[1,1]
  v_pk_mul_f32 v[164:165], v[164:165], v[42:43] op_sel:[0,1] op_sel_hi:[1,1]
  v_pk_mul_f32 v[166:167], v[166:167], v[42:43] op_sel:[0,1] op_sel_hi:[1,1]
  v_cvt_pk_bf16_f32 v212, v160, v161
  v_cvt_pk_bf16_f32 v213, v162, v163
  v_cvt_pk_bf16_f32 v214, v164, v165
  v_cvt_pk_bf16_f32 v215, v166, v167
  v_accvgpr_read_b32 v136, a96
  v_accvgpr_read_b32 v137, a97
  v_accvgpr_read_b32 v138, a98
  v_accvgpr_read_b32 v139, a99
  v_accvgpr_read_b32 v140, a112
  v_accvgpr_read_b32 v141, a113
  v_accvgpr_read_b32 v142, a114
  v_accvgpr_read_b32 v143, a115
  v_pk_mul_f32 v[136:137], v[136:137], v[40:41] op_sel_hi:[1,0]
  v_pk_mul_f32 v[138:139], v[138:139], v[40:41] op_sel_hi:[1,0]
  v_pk_mul_f32 v[140:141], v[140:141], v[40:41] op_sel_hi:[1,0]
  v_pk_mul_f32 v[142:143], v[142:143], v[40:41] op_sel_hi:[1,0]
  v_cvt_pk_bf16_f32 v216, v136, v137
  v_cvt_pk_bf16_f32 v217, v138, v139
  v_cvt_pk_bf16_f32 v218, v140, v141
  v_cvt_pk_bf16_f32 v219, v142, v143
  v_accvgpr_read_b32 v144, a100
  v_accvgpr_read_b32 v145, a101
  v_accvgpr_read_b32 v146, a102
  v_accvgpr_read_b32 v147, a103
  v_accvgpr_read_b32 v148, a116
  v_accvgpr_read_b32 v149, a117
  v_accvgpr_read_b32 v150, a118
  v_accvgpr_read_b32 v151, a119
  v_pk_mul_f32 v[144:145], v[144:145], v[40:41] op_sel:[0,1] op_sel_hi:[1,1]
  v_pk_mul_f32 v[146:147], v[146:147], v[40:41] op_sel:[0,1] op_sel_hi:[1,1]
  v_pk_mul_f32 v[148:149], v[148:149], v[40:41] op_sel:[0,1] op_sel_hi:[1,1]
  v_pk_mul_f32 v[150:151], v[150:151], v[40:41] op_sel:[0,1] op_sel_hi:[1,1]
  v_cvt_pk_bf16_f32 v220, v144, v145
  v_cvt_pk_bf16_f32 v221, v146, v147
  v_cvt_pk_bf16_f32 v222, v148, v149
  v_cvt_pk_bf16_f32 v223, v150, v151
  v_accvgpr_read_b32 v152, a104
  v_accvgpr_read_b32 v153, a105
  v_accvgpr_read_b32 v154, a106
  v_accvgpr_read_b32 v155, a107
  v_accvgpr_read_b32 v156, a120
  v_accvgpr_read_b32 v157, a121
  v_accvgpr_read_b32 v158, a122
  v_accvgpr_read_b32 v159, a123
  v_pk_mul_f32 v[152:153], v[152:153], v[42:43] op_sel_hi:[1,0]
  v_pk_mul_f32 v[154:155], v[154:155], v[42:43] op_sel_hi:[1,0]
  v_pk_mul_f32 v[156:157], v[156:157], v[42:43] op_sel_hi:[1,0]
  v_pk_mul_f32 v[158:159], v[158:159], v[42:43] op_sel_hi:[1,0]
  v_cvt_pk_bf16_f32 v224, v152, v153
  v_cvt_pk_bf16_f32 v225, v154, v155
  v_cvt_pk_bf16_f32 v226, v156, v157
  v_cvt_pk_bf16_f32 v227, v158, v159
  v_accvgpr_read_b32 v160, a108
  v_accvgpr_read_b32 v161, a109
  v_accvgpr_read_b32 v162, a110
  v_accvgpr_read_b32 v163, a111
  v_accvgpr_read_b32 v164, a124
  v_accvgpr_read_b32 v165, a125
  v_accvgpr_read_b32 v166, a126
  v_accvgpr_read_b32 v167, a127
  v_pk_mul_f32 v[160:161], v[160:161], v[42:43] op_sel:[0,1] op_sel_hi:[1,1]
  v_pk_mul_f32 v[162:163], v[162:163], v[42:43] op_sel:[0,1] op_sel_hi:[1,1]
  v_pk_mul_f32 v[164:165], v[164:165], v[42:43] op_sel:[0,1] op_sel_hi:[1,1]
  v_pk_mul_f32 v[166:167], v[166:167], v[42:43] op_sel:[0,1] op_sel_hi:[1,1]
  v_cvt_pk_bf16_f32 v228, v160, v161
  v_cvt_pk_bf16_f32 v229, v162, v163
  v_cvt_pk_bf16_f32 v230, v164, v165
  v_cvt_pk_bf16_f32 v231, v166, v167
  s_barrier
  v_mfma_f32_16x16x32_bf16 a[128:131], v[64:67], v[168:171], 0
  s_xor_b32 s3, s19, 3
  ds_read_b64_tr_b16 v[100:101], v23 offset:9216
  v_mfma_f32_16x16x32_bf16 a[132:135], v[64:67], v[172:175], 0
  ds_read_b64_tr_b16 v[102:103], v23 offset:13824
  v_mfma_f32_16x16x32_bf16 a[136:139], v[64:67], v[176:179], 0
  v_mfma_f32_16x16x32_bf16 a[140:143], v[64:67], v[180:183], 0
  ds_read_b64_tr_b16 v[104:105], v23 offset:9248
  v_mfma_f32_16x16x32_bf16 a[144:147], v[68:71], v[168:171], 0
  s_lshl2_add_u32 s3, s3, 0
  ds_read_b64_tr_b16 v[106:107], v23 offset:13856
  v_mfma_f32_16x16x32_bf16 a[148:151], v[68:71], v[172:175], 0
  v_mfma_f32_16x16x32_bf16 a[152:155], v[68:71], v[176:179], 0
  ds_read_b64_tr_b16 v[108:109], v23 offset:9280
  v_mfma_f32_16x16x32_bf16 a[156:159], v[68:71], v[180:183], 0
  v_mfma_f32_16x16x32_bf16 a[160:163], v[72:75], v[168:171], 0
  ds_read_b64_tr_b16 v[110:111], v23 offset:13888
  v_mfma_f32_16x16x32_bf16 a[164:167], v[72:75], v[172:175], 0
  s_mul_i32 s61, s3, 36864
  ds_read_b64_tr_b16 v[112:113], v23 offset:9312
  v_mfma_f32_16x16x32_bf16 a[168:171], v[72:75], v[176:179], 0
  v_mfma_f32_16x16x32_bf16 a[172:175], v[72:75], v[180:183], 0
  ds_read_b64_tr_b16 v[114:115], v23 offset:13920
  v_mfma_f32_16x16x32_bf16 a[176:179], v[76:79], v[168:171], 0
  ds_read_b64_tr_b16 v[116:117], v23 offset:9344
  v_mfma_f32_16x16x32_bf16 a[180:183], v[76:79], v[172:175], 0
  v_mfma_f32_16x16x32_bf16 a[184:187], v[76:79], v[176:179], 0
  s_add_u32 m0, s60, 0
  ds_read_b64_tr_b16 v[118:119], v23 offset:13952
  v_mfma_f32_16x16x32_bf16 a[188:191], v[76:79], v[180:183], 0
  v_mfma_f32_16x16x32_bf16 a[192:195], v[80:83], v[168:171], 0
  ds_read_b64_tr_b16 v[120:121], v23 offset:9376
  v_mfma_f32_16x16x32_bf16 a[196:199], v[80:83], v[172:175], 0
  ds_read_b64_tr_b16 v[122:123], v23 offset:13984
  v_mfma_f32_16x16x32_bf16 a[200:203], v[80:83], v[176:179], 0
  v_mfma_f32_16x16x32_bf16 a[204:207], v[80:83], v[180:183], 0
  buffer_load_dwordx4 v20, s[40:43], s61 offen lds
  ds_read_b64_tr_b16 v[124:125], v23 offset:9408
  v_mfma_f32_16x16x32_bf16 a[208:211], v[84:87], v[168:171], 0
  ds_read_b64_tr_b16 v[126:127], v23 offset:14016
  v_mfma_f32_16x16x32_bf16 a[212:215], v[84:87], v[172:175], 0
  v_mfma_f32_16x16x32_bf16 a[216:219], v[84:87], v[176:179], 0
  ds_read_b64_tr_b16 v[128:129], v23 offset:9440
  v_mfma_f32_16x16x32_bf16 a[220:223], v[84:87], v[180:183], 0
  v_mfma_f32_16x16x32_bf16 a[224:227], v[88:91], v[168:171], 0
  buffer_load_dwordx4 v21, s[40:43], s61 offen offset:1024 lds
  ds_read_b64_tr_b16 v[130:131], v23 offset:14048
  v_mfma_f32_16x16x32_bf16 a[228:231], v[88:91], v[172:175], 0
  ds_read_b64_tr_b16 v[132:133], v23 offset:9472
  v_mfma_f32_16x16x32_bf16 a[232:235], v[88:91], v[176:179], 0
  v_mfma_f32_16x16x32_bf16 a[236:239], v[88:91], v[180:183], 0
  ds_read_b64_tr_b16 v[134:135], v23 offset:14080
  v_mfma_f32_16x16x32_bf16 a[240:243], v[92:95], v[168:171], 0
  v_mfma_f32_16x16x32_bf16 a[244:247], v[92:95], v[172:175], 0
  s_mov_b64 exec, 0xffff
  buffer_load_dwordx4 v22, s[40:43], s61 offen offset:2048 lds
  s_mov_b64 exec, -1
  v_mfma_f32_16x16x32_bf16 a[248:251], v[92:95], v[176:179], 0
  v_mfma_f32_16x16x32_bf16 a[252:255], v[92:95], v[180:183], 0
  v_mfma_f32_16x16x32_bf16 v[240:243], v[96:99], v[168:171], 0
  v_mfma_f32_16x16x32_bf16 v[244:247], v[96:99], v[172:175], 0
  v_mfma_f32_16x16x32_bf16 v[248:251], v[96:99], v[176:179], 0
  v_mfma_f32_16x16x32_bf16 v[252:255], v[96:99], v[180:183], 0
  s_waitcnt vmcnt(20) lgkmcnt(0)
  s_barrier
  v_mfma_f32_16x16x32_bf16 a[128:131], v[100:103], v[184:187], a[128:131]
  s_xor_b32 s3, s19, 1
  ds_read_b64_tr_b16 v[64:65], v23 offset:18432
  v_mfma_f32_16x16x32_bf16 a[132:135], v[100:103], v[188:191], a[132:135]
  ds_read_b64_tr_b16 v[66:67], v23 offset:23040
  v_mfma_f32_16x16x32_bf16 a[136:139], v[100:103], v[192:195], a[136:139]
  v_mfma_f32_16x16x32_bf16 a[140:143], v[100:103], v[196:199], a[140:143]
  ds_read_b64_tr_b16 v[68:69], v23 offset:18464
  v_mfma_f32_16x16x32_bf16 a[144:147], v[104:107], v[184:187], a[144:147]
  s_lshl2_add_u32 s3, s3, 1
  ds_read_b64_tr_b16 v[70:71], v23 offset:23072
  v_mfma_f32_16x16x32_bf16 a[148:151], v[104:107], v[188:191], a[148:151]
  v_mfma_f32_16x16x32_bf16 a[152:155], v[104:107], v[192:195], a[152:155]
  ds_read_b64_tr_b16 v[72:73], v23 offset:18496
  v_mfma_f32_16x16x32_bf16 a[156:159], v[104:107], v[196:199], a[156:159]
  v_mfma_f32_16x16x32_bf16 a[160:163], v[108:111], v[184:187], a[160:163]
  ds_read_b64_tr_b16 v[74:75], v23 offset:23104
  v_mfma_f32_16x16x32_bf16 a[164:167], v[108:111], v[188:191], a[164:167]
  s_mul_i32 s61, s3, 36864
  ds_read_b64_tr_b16 v[76:77], v23 offset:18528
  v_mfma_f32_16x16x32_bf16 a[168:171], v[108:111], v[192:195], a[168:171]
  v_mfma_f32_16x16x32_bf16 a[172:175], v[108:111], v[196:199], a[172:175]
  ds_read_b64_tr_b16 v[78:79], v23 offset:23136
  v_mfma_f32_16x16x32_bf16 a[176:179], v[112:115], v[184:187], a[176:179]
  ds_read_b64_tr_b16 v[80:81], v23 offset:18560
  v_mfma_f32_16x16x32_bf16 a[180:183], v[112:115], v[188:191], a[180:183]
  v_mfma_f32_16x16x32_bf16 a[184:187], v[112:115], v[192:195], a[184:187]
  s_add_u32 m0, s60, 9216
  ds_read_b64_tr_b16 v[82:83], v23 offset:23168
  v_mfma_f32_16x16x32_bf16 a[188:191], v[112:115], v[196:199], a[188:191]
  v_mfma_f32_16x16x32_bf16 a[192:195], v[116:119], v[184:187], a[192:195]
  ds_read_b64_tr_b16 v[84:85], v23 offset:18592
  v_mfma_f32_16x16x32_bf16 a[196:199], v[116:119], v[188:191], a[196:199]
  ds_read_b64_tr_b16 v[86:87], v23 offset:23200
  v_mfma_f32_16x16x32_bf16 a[200:203], v[116:119], v[192:195], a[200:203]
  v_mfma_f32_16x16x32_bf16 a[204:207], v[116:119], v[196:199], a[204:207]
  buffer_load_dwordx4 v20, s[40:43], s61 offen lds
  ds_read_b64_tr_b16 v[88:89], v23 offset:18624
  v_mfma_f32_16x16x32_bf16 a[208:211], v[120:123], v[184:187], a[208:211]
  ds_read_b64_tr_b16 v[90:91], v23 offset:23232
  v_mfma_f32_16x16x32_bf16 a[212:215], v[120:123], v[188:191], a[212:215]
  v_mfma_f32_16x16x32_bf16 a[216:219], v[120:123], v[192:195], a[216:219]
  ds_read_b64_tr_b16 v[92:93], v23 offset:18656
  v_mfma_f32_16x16x32_bf16 a[220:223], v[120:123], v[196:199], a[220:223]
  v_mfma_f32_16x16x32_bf16 a[224:227], v[124:127], v[184:187], a[224:227]
  buffer_load_dwordx4 v21, s[40:43], s61 offen offset:1024 lds
  ds_read_b64_tr_b16 v[94:95], v23 offset:23264
  v_mfma_f32_16x16x32_bf16 a[228:231], v[124:127], v[188:191], a[228:231]
  ds_read_b64_tr_b16 v[96:97], v23 offset:18688
  v_mfma_f32_16x16x32_bf16 a[232:235], v[124:127], v[192:195], a[232:235]
  v_mfma_f32_16x16x32_bf16 a[236:239], v[124:127], v[196:199], a[236:239]
  ds_read_b64_tr_b16 v[98:99], v23 offset:23296
  v_mfma_f32_16x16x32_bf16 a[240:243], v[128:131], v[184:187], a[240:243]
  v_mfma_f32_16x16x32_bf16 a[244:247], v[128:131], v[188:191], a[244:247]
  s_mov_b64 exec, 0xffff
  buffer_load_dwordx4 v22, s[40:43], s61 offen offset:2048 lds
  s_mov_b64 exec, -1
  v_mfma_f32_16x16x32_bf16 a[248:251], v[128:131], v[192:195], a[248:251]
  v_mfma_f32_16x16x32_bf16 a[252:255], v[128:131], v[196:199], a[252:255]
  v_mfma_f32_16x16x32_bf16 v[240:243], v[132:135], v[184:187], v[240:243]
  v_mfma_f32_16x16x32_bf16 v[244:247], v[132:135], v[188:191], v[244:247]
  v_mfma_f32_16x16x32_bf16 v[248:251], v[132:135], v[192:195], v[248:251]
  v_mfma_f32_16x16x32_bf16 v[252:255], v[132:135], v[196:199], v[252:255]
  s_waitcnt vmcnt(6) lgkmcnt(0)
  s_barrier
  v_mfma_f32_16x16x32_bf16 a[128:131], v[64:67], v[200:203], a[128:131]
  buffer_store_dword v26, v8, s[12:15], s44 offen sc1
  ds_read_b64_tr_b16 v[100:101], v23 offset:27648
  v_mfma_f32_16x16x32_bf16 a[132:135], v[64:67], v[204:207], a[132:135]
  ds_read_b64_tr_b16 v[102:103], v23 offset:32256
  v_mfma_f32_16x16x32_bf16 a[136:139], v[64:67], v[208:211], a[136:139]
  v_mfma_f32_16x16x32_bf16 a[140:143], v[64:67], v[212:215], a[140:143]
  s_xor_b32 s3, s19, 2
  ds_read_b64_tr_b16 v[104:105], v23 offset:27680
  v_mfma_f32_16x16x32_bf16 a[144:147], v[68:71], v[200:203], a[144:147]
  ds_read_b64_tr_b16 v[106:107], v23 offset:32288
  v_mfma_f32_16x16x32_bf16 a[148:151], v[68:71], v[204:207], a[148:151]
  v_mfma_f32_16x16x32_bf16 a[152:155], v[68:71], v[208:211], a[152:155]
  ds_read_b64_tr_b16 v[108:109], v23 offset:27712
  v_mfma_f32_16x16x32_bf16 a[156:159], v[68:71], v[212:215], a[156:159]
  s_lshl2_add_u32 s3, s3, 1
  v_mfma_f32_16x16x32_bf16 a[160:163], v[72:75], v[200:203], a[160:163]
  ds_read_b64_tr_b16 v[110:111], v23 offset:32320
  v_mfma_f32_16x16x32_bf16 a[164:167], v[72:75], v[204:207], a[164:167]
  ds_read_b64_tr_b16 v[112:113], v23 offset:27744
  v_mfma_f32_16x16x32_bf16 a[168:171], v[72:75], v[208:211], a[168:171]
  v_mfma_f32_16x16x32_bf16 a[172:175], v[72:75], v[212:215], a[172:175]
  s_mul_i32 s61, s3, 36864
  ds_read_b64_tr_b16 v[114:115], v23 offset:32352
  v_mfma_f32_16x16x32_bf16 a[176:179], v[76:79], v[200:203], a[176:179]
  ds_read_b64_tr_b16 v[116:117], v23 offset:27776
  v_mfma_f32_16x16x32_bf16 a[180:183], v[76:79], v[204:207], a[180:183]
  v_mfma_f32_16x16x32_bf16 a[184:187], v[76:79], v[208:211], a[184:187]
  ds_read_b64_tr_b16 v[118:119], v23 offset:32384
  v_mfma_f32_16x16x32_bf16 a[188:191], v[76:79], v[212:215], a[188:191]
  s_add_u32 m0, s60, 18432
  v_mfma_f32_16x16x32_bf16 a[192:195], v[80:83], v[200:203], a[192:195]
  ds_read_b64_tr_b16 v[120:121], v23 offset:27808
  v_mfma_f32_16x16x32_bf16 a[196:199], v[80:83], v[204:207], a[196:199]
  ds_read_b64_tr_b16 v[122:123], v23 offset:32416
  v_mfma_f32_16x16x32_bf16 a[200:203], v[80:83], v[208:211], a[200:203]
  buffer_load_dwordx4 v20, s[40:43], s61 offen lds
  v_mfma_f32_16x16x32_bf16 a[204:207], v[80:83], v[212:215], a[204:207]
  ds_read_b64_tr_b16 v[124:125], v23 offset:27840
  v_mfma_f32_16x16x32_bf16 a[208:211], v[84:87], v[200:203], a[208:211]
  ds_read_b64_tr_b16 v[126:127], v23 offset:32448
  v_mfma_f32_16x16x32_bf16 a[212:215], v[84:87], v[204:207], a[212:215]
  v_mfma_f32_16x16x32_bf16 a[216:219], v[84:87], v[208:211], a[216:219]
  buffer_load_dwordx4 v21, s[40:43], s61 offen offset:1024 lds
  ds_read_b64_tr_b16 v[128:129], v23 offset:27872
  v_mfma_f32_16x16x32_bf16 a[220:223], v[84:87], v[212:215], a[220:223]
  v_mfma_f32_16x16x32_bf16 a[224:227], v[88:91], v[200:203], a[224:227]
  ds_read_b64_tr_b16 v[130:131], v23 offset:32480
  v_mfma_f32_16x16x32_bf16 a[228:231], v[88:91], v[204:207], a[228:231]
  ds_read_b64_tr_b16 v[132:133], v23 offset:27904
  v_mfma_f32_16x16x32_bf16 a[232:235], v[88:91], v[208:211], a[232:235]
  s_mov_b64 exec, 0xffff
  buffer_load_dwordx4 v22, s[40:43], s61 offen offset:2048 lds
  s_mov_b64 exec, -1
  v_mfma_f32_16x16x32_bf16 a[236:239], v[88:91], v[212:215], a[236:239]
  ds_read_b64_tr_b16 v[134:135], v23 offset:32512
  v_mfma_f32_16x16x32_bf16 a[240:243], v[92:95], v[200:203], a[240:243]
  v_mfma_f32_16x16x32_bf16 a[244:247], v[92:95], v[204:207], a[244:247]
  v_mfma_f32_16x16x32_bf16 a[248:251], v[92:95], v[208:211], a[248:251]
  buffer_load_dword v25, v24, s[12:15], s54 offen sc1
  v_mfma_f32_16x16x32_bf16 a[252:255], v[92:95], v[212:215], a[252:255]
  v_mfma_f32_16x16x32_bf16 v[240:243], v[96:99], v[200:203], v[240:243]
  v_mfma_f32_16x16x32_bf16 v[244:247], v[96:99], v[204:207], v[244:247]
  v_mfma_f32_16x16x32_bf16 v[248:251], v[96:99], v[208:211], v[248:251]
  v_mfma_f32_16x16x32_bf16 v[252:255], v[96:99], v[212:215], v[252:255]
  s_waitcnt lgkmcnt(0)
  s_barrier
  v_mfma_f32_16x16x32_bf16 a[128:131], v[100:103], v[216:219], a[128:131]
  s_waitcnt vmcnt(0)
  v_cmp_gt_u32 s[6:7], 2, v25
  s_cmp_lg_u64 s[6:7], 0
  s_cbranch_scc1 SP_pO4
RT_pO4:
  v_mfma_f32_16x16x32_bf16 a[132:135], v[100:103], v[220:223], a[132:135]
  s_xor_b32 s4, s19, 1
  ds_read_b64_tr_b16 v[64:65], v23 offset:36864
  ds_read_b64_tr_b16 v[66:67], v23 offset:41472
  v_mfma_f32_16x16x32_bf16 a[136:139], v[100:103], v[224:227], a[136:139]
  s_lshl2_add_u32 s4, s4, 0
  v_mfma_f32_16x16x32_bf16 a[140:143], v[100:103], v[228:231], a[140:143]
  ds_read_b64_tr_b16 v[68:69], v23 offset:36896
  v_mfma_f32_16x16x32_bf16 a[144:147], v[104:107], v[216:219], a[144:147]
  s_lshl_b32 s4, s4, 17
  ds_read_b64_tr_b16 v[70:71], v23 offset:41504
  v_mfma_f32_16x16x32_bf16 a[148:151], v[104:107], v[220:223], a[148:151]
  s_add_u32 s62, s4, s63
  v_mfma_f32_16x16x32_bf16 a[152:155], v[104:107], v[224:227], a[152:155]
TP_13:
  s_cbranch_execz TP_17
  ds_read_b64_tr_b16 v[72:73], v23 offset:36928
  v_mfma_f32_16x16x32_bf16 a[156:159], v[104:107], v[228:231], a[156:159]
  buffer_load_dwordx4 a[0:3], v3, s[12:15], s62 offen offset:0 sc1
  v_mfma_f32_16x16x32_bf16 a[160:163], v[108:111], v[216:219], a[160:163]
  buffer_load_dwordx4 a[4:7], v3, s[12:15], s62 offen offset:1024 sc1
  ds_read_b64_tr_b16 v[74:75], v23 offset:41536
  v_mfma_f32_16x16x32_bf16 a[164:167], v[108:111], v[220:223], a[164:167]
  buffer_load_dwordx4 a[8:11], v3, s[12:15], s62 offen offset:2048 sc1
  ds_read_b64_tr_b16 v[76:77], v23 offset:36960
  v_mfma_f32_16x16x32_bf16 a[168:171], v[108:111], v[224:227], a[168:171]
  v_mfma_f32_16x16x32_bf16 a[172:175], v[108:111], v[228:231], a[172:175]
  buffer_load_dwordx4 a[12:15], v3, s[12:15], s62 offen offset:3072 sc1
  ds_read_b64_tr_b16 v[78:79], v23 offset:41568
  v_mfma_f32_16x16x32_bf16 a[176:179], v[112:115], v[216:219], a[176:179]
  s_xor_b32 s4, s19, 2
  ds_read_b64_tr_b16 v[80:81], v23 offset:36992
  v_mfma_f32_16x16x32_bf16 a[180:183], v[112:115], v[220:223], a[180:183]
  v_mfma_f32_16x16x32_bf16 a[184:187], v[112:115], v[224:227], a[184:187]
  s_lshl2_add_u32 s4, s4, 0
  ds_read_b64_tr_b16 v[82:83], v23 offset:41600
  v_mfma_f32_16x16x32_bf16 a[188:191], v[112:115], v[228:231], a[188:191]
  s_lshl_b32 s4, s4, 17
  v_mfma_f32_16x16x32_bf16 a[192:195], v[116:119], v[216:219], a[192:195]
  ds_read_b64_tr_b16 v[84:85], v23 offset:37024
  v_mfma_f32_16x16x32_bf16 a[196:199], v[116:119], v[220:223], a[196:199]
  s_add_u32 s62, s4, s63
  ds_read_b64_tr_b16 v[86:87], v23 offset:41632
  v_mfma_f32_16x16x32_bf16 a[200:203], v[116:119], v[224:227], a[200:203]
  buffer_load_dwordx4 a[16:19], v3, s[12:15], s62 offen offset:0 sc1
  v_mfma_f32_16x16x32_bf16 a[204:207], v[116:119], v[228:231], a[204:207]
  buffer_load_dwordx4 a[20:23], v3, s[12:15], s62 offen offset:1024 sc1
  ds_read_b64_tr_b16 v[88:89], v23 offset:37056
  v_mfma_f32_16x16x32_bf16 a[208:211], v[120:123], v[216:219], a[208:211]
  ds_read_b64_tr_b16 v[90:91], v23 offset:41664
  v_mfma_f32_16x16x32_bf16 a[212:215], v[120:123], v[220:223], a[212:215]
  buffer_load_dwordx4 a[24:27], v3, s[12:15], s62 offen offset:2048 sc1
  v_mfma_f32_16x16x32_bf16 a[216:219], v[120:123], v[224:227], a[216:219]
  buffer_load_dwordx4 a[28:31], v3, s[12:15], s62 offen offset:3072 sc1
  ds_read_b64_tr_b16 v[92:93], v23 offset:37088
  v_mfma_f32_16x16x32_bf16 a[220:223], v[120:123], v[228:231], a[220:223]
  v_mfma_f32_16x16x32_bf16 a[224:227], v[124:127], v[216:219], a[224:227]
  s_xor_b32 s3, s19, 3
  ds_read_b64_tr_b16 v[94:95], v23 offset:41696
  v_mfma_f32_16x16x32_bf16 a[228:231], v[124:127], v[220:223], a[228:231]
  s_lshl2_add_u32 s3, s3, 1
  ds_read_b64_tr_b16 v[96:97], v23 offset:37120
  v_mfma_f32_16x16x32_bf16 a[232:235], v[124:127], v[224:227], a[232:235]
  s_mul_i32 s61, s3, 36864
  v_mfma_f32_16x16x32_bf16 a[236:239], v[124:127], v[228:231], a[236:239]
  ds_read_b64_tr_b16 v[98:99], v23 offset:41728
  v_mfma_f32_16x16x32_bf16 a[240:243], v[128:131], v[216:219], a[240:243]
  s_add_u32 m0, s60, 27648
  v_mfma_f32_16x16x32_bf16 a[244:247], v[128:131], v[220:223], a[244:247]
  buffer_load_dwordx4 v20, s[40:43], s61 offen lds
  v_mfma_f32_16x16x32_bf16 a[248:251], v[128:131], v[224:227], a[248:251]
  v_mfma_f32_16x16x32_bf16 a[252:255], v[128:131], v[228:231], a[252:255]
  buffer_load_dwordx4 v21, s[40:43], s61 offen offset:1024 lds
  v_mfma_f32_16x16x32_bf16 v[240:243], v[132:135], v[216:219], v[240:243]
  s_mov_b64 exec, 0xffff
  buffer_load_dwordx4 v22, s[40:43], s61 offen offset:2048 lds
  s_mov_b64 exec, -1
  v_mfma_f32_16x16x32_bf16 v[244:247], v[132:135], v[220:223], v[244:247]
  v_mfma_f32_16x16x32_bf16 v[248:251], v[132:135], v[224:227], v[248:251]
  v_mfma_f32_16x16x32_bf16 v[252:255], v[132:135], v[228:231], v[252:255]
  s_waitcnt vmcnt(7) lgkmcnt(0)
  s_barrier
  v_mfma_f32_16x16x32_bf16 a[128:131], v[64:67], a[0:3], a[128:131]
  s_xor_b32 s4, s19, 3
  ds_read_b64_tr_b16 v[100:101], v23 offset:46080
  v_mfma_f32_16x16x32_bf16 a[132:135], v[64:67], a[4:7], a[132:135]
  s_lshl2_add_u32 s4, s4, 0
  ds_read_b64_tr_b16 v[102:103], v23 offset:50688
  v_mfma_f32_16x16x32_bf16 a[136:139], v[64:67], a[8:11], a[136:139]
  s_lshl_b32 s4, s4, 17
  v_mfma_f32_16x16x32_bf16 a[140:143], v[64:67], a[12:15], a[140:143]
  s_add_u32 s62, s4, s63
  ds_read_b64_tr_b16 v[104:105], v23 offset:46112
  v_mfma_f32_16x16x32_bf16 a[144:147], v[68:71], a[0:3], a[144:147]
  ds_read_b64_tr_b16 v[106:107], v23 offset:50720
  v_mfma_f32_16x16x32_bf16 a[148:151], v[68:71], a[4:7], a[148:151]
  buffer_load_dwordx4 a[32:35], v3, s[12:15], s62 offen offset:0 sc1
  v_mfma_f32_16x16x32_bf16 a[152:155], v[68:71], a[8:11], a[152:155]
  buffer_load_dwordx4 a[36:39], v3, s[12:15], s62 offen offset:1024 sc1
  ds_read_b64_tr_b16 v[108:109], v23 offset:46144
  v_mfma_f32_16x16x32_bf16 a[156:159], v[68:71], a[12:15], a[156:159]
  buffer_load_dwordx4 a[40:43], v3, s[12:15], s62 offen offset:2048 sc1
  v_mfma_f32_16x16x32_bf16 a[160:163], v[72:75], a[0:3], a[160:163]
  ds_read_b64_tr_b16 v[110:111], v23 offset:50752
  v_mfma_f32_16x16x32_bf16 a[164:167], v[72:75], a[4:7], a[164:167]
  buffer_load_dwordx4 a[44:47], v3, s[12:15], s62 offen offset:3072 sc1
  ds_read_b64_tr_b16 v[112:113], v23 offset:46176
  v_mfma_f32_16x16x32_bf16 a[168:171], v[72:75], a[8:11], a[168:171]
  s_xor_b32 s4, s19, 1
  v_mfma_f32_16x16x32_bf16 a[172:175], v[72:75], a[12:15], a[172:175]
  s_lshl2_add_u32 s4, s4, 1
  ds_read_b64_tr_b16 v[114:115], v23 offset:50784
  v_mfma_f32_16x16x32_bf16 a[176:179], v[76:79], a[0:3], a[176:179]
  ds_read_b64_tr_b16 v[116:117], v23 offset:46208
  v_mfma_f32_16x16x32_bf16 a[180:183], v[76:79], a[4:7], a[180:183]
  s_lshl_b32 s4, s4, 17
  v_mfma_f32_16x16x32_bf16 a[184:187], v[76:79], a[8:11], a[184:187]
  s_add_u32 s62, s4, s63
  ds_read_b64_tr_b16 v[118:119], v23 offset:50816
  v_mfma_f32_16x16x32_bf16 a[188:191], v[76:79], a[12:15], a[188:191]
  buffer_load_dwordx4 a[48:51], v3, s[12:15], s62 offen offset:0 sc1
  v_mfma_f32_16x16x32_bf16 a[192:195], v[80:83], a[0:3], a[192:195]
  ds_read_b64_tr_b16 v[120:121], v23 offset:46240
  v_mfma_f32_16x16x32_bf16 a[196:199], v[80:83], a[4:7], a[196:199]
  buffer_load_dwordx4 a[52:55], v3, s[12:15], s62 offen offset:1024 sc1
  ds_read_b64_tr_b16 v[122:123], v23 offset:50848
  v_mfma_f32_16x16x32_bf16 a[200:203], v[80:83], a[8:11], a[200:203]
  buffer_load_dwordx4 a[56:59], v3, s[12:15], s62 offen offset:2048 sc1
  v_mfma_f32_16x16x32_bf16 a[204:207], v[80:83], a[12:15], a[204:207]
  buffer_load_dwordx4 a[60:63], v3, s[12:15], s62 offen offset:3072 sc1
  ds_read_b64_tr_b16 v[124:125], v23 offset:46272
  v_mfma_f32_16x16x32_bf16 a[208:211], v[84:87], a[0:3], a[208:211]
  s_add_u32 s3, s99, 4
  ds_read_b64_tr_b16 v[126:127], v23 offset:50880
  v_mfma_f32_16x16x32_bf16 a[212:215], v[84:87], a[4:7], a[212:215]
  v_mfma_f32_16x16x32_bf16 a[216:219], v[84:87], a[8:11], a[216:219]
  s_lshl2_add_u32 s3, s3, 0
  ds_read_b64_tr_b16 v[128:129], v23 offset:46304
  v_mfma_f32_16x16x32_bf16 a[220:223], v[84:87], a[12:15], a[220:223]
  s_mul_i32 s61, s3, 36864
  v_mfma_f32_16x16x32_bf16 a[224:227], v[88:91], a[0:3], a[224:227]
  s_add_u32 m0, s60, 36864
  ds_read_b64_tr_b16 v[130:131], v23 offset:50912
  v_mfma_f32_16x16x32_bf16 a[228:231], v[88:91], a[4:7], a[228:231]
  ds_read_b64_tr_b16 v[132:133], v23 offset:46336
  v_mfma_f32_16x16x32_bf16 a[232:235], v[88:91], a[8:11], a[232:235]
  buffer_load_dwordx4 v20, s[40:43], s61 offen lds
  v_mfma_f32_16x16x32_bf16 a[236:239], v[88:91], a[12:15], a[236:239]
  buffer_load_dwordx4 v21, s[40:43], s61 offen offset:1024 lds
  ds_read_b64_tr_b16 v[134:135], v23 offset:50944
  v_mfma_f32_16x16x32_bf16 a[240:243], v[92:95], a[0:3], a[240:243]
  s_mov_b64 exec, 0xffff
  buffer_load_dwordx4 v22, s[40:43], s61 offen offset:2048 lds
  s_mov_b64 exec, -1
  v_mfma_f32_16x16x32_bf16 a[244:247], v[92:95], a[4:7], a[244:247]
  v_mfma_f32_16x16x32_bf16 a[248:251], v[92:95], a[8:11], a[248:251]
  buffer_store_dwordx4 v[200:203], v3, s[12:15], s11 offen offset:0 sc1
  v_mfma_f32_16x16x32_bf16 a[252:255], v[92:95], a[12:15], a[252:255]
  buffer_store_dwordx4 v[204:207], v3, s[12:15], s11 offen offset:1024 sc1
  v_mfma_f32_16x16x32_bf16 v[240:243], v[96:99], a[0:3], v[240:243]
  buffer_store_dwordx4 v[208:211], v3, s[12:15], s11 offen offset:2048 sc1
  v_mfma_f32_16x16x32_bf16 v[244:247], v[96:99], a[4:7], v[244:247]
  v_mfma_f32_16x16x32_bf16 v[248:251], v[96:99], a[8:11], v[248:251]
  v_mfma_f32_16x16x32_bf16 v[252:255], v[96:99], a[12:15], v[252:255]
  s_waitcnt vmcnt(17) lgkmcnt(0)
  s_barrier
  v_mfma_f32_16x16x32_bf16 a[128:131], v[100:103], a[16:19], a[128:131]
  buffer_load_dword v25, v24, s[12:15], s55 offen sc1
  ds_read_b64_tr_b16 v[64:65], v23 offset:0
  v_mfma_f32_16x16x32_bf16 a[132:135], v[100:103], a[20:23], a[132:135]
  s_xor_b32 s4, s19, 2
  ds_read_b64_tr_b16 v[66:67], v23 offset:4608
  v_mfma_f32_16x16x32_bf16 a[136:139], v[100:103], a[24:27], a[136:139]
  s_lshl2_add_u32 s4, s4, 1
  v_mfma_f32_16x16x32_bf16 a[140:143], v[100:103], a[28:31], a[140:143]
  s_lshl_b32 s4, s4, 17
  ds_read_b64_tr_b16 v[68:69], v23 offset:32
  v_mfma_f32_16x16x32_bf16 a[144:147], v[104:107], a[16:19], a[144:147]
  s_add_u32 s62, s4, s63
  ds_read_b64_tr_b16 v[70:71], v23 offset:4640
  v_mfma_f32_16x16x32_bf16 a[148:151], v[104:107], a[20:23], a[148:151]
  v_mfma_f32_16x16x32_bf16 a[152:155], v[104:107], a[24:27], a[152:155]
  buffer_load_dwordx4 a[64:67], v3, s[12:15], s62 offen offset:0 sc1
  ds_read_b64_tr_b16 v[72:73], v23 offset:64
  v_mfma_f32_16x16x32_bf16 a[156:159], v[104:107], a[28:31], a[156:159]
  buffer_load_dwordx4 a[68:71], v3, s[12:15], s62 offen offset:1024 sc1
  v_mfma_f32_16x16x32_bf16 a[160:163], v[108:111], a[16:19], a[160:163]
  buffer_load_dwordx4 a[72:75], v3, s[12:15], s62 offen offset:2048 sc1
  ds_read_b64_tr_b16 v[74:75], v23 offset:4672
  v_mfma_f32_16x16x32_bf16 a[164:167], v[108:111], a[20:23], a[164:167]
  buffer_load_dwordx4 a[76:79], v3, s[12:15], s62 offen offset:3072 sc1
  ds_read_b64_tr_b16 v[76:77], v23 offset:96
  v_mfma_f32_16x16x32_bf16 a[168:171], v[108:111], a[24:27], a[168:171]
  s_xor_b32 s4, s19, 3
  v_mfma_f32_16x16x32_bf16 a[172:175], v[108:111], a[28:31], a[172:175]
  ds_read_b64_tr_b16 v[78:79], v23 offset:4704
  v_mfma_f32_16x16x32_bf16 a[176:179], v[112:115], a[16:19], a[176:179]
  s_lshl2_add_u32 s4, s4, 1
  ds_read_b64_tr_b16 v[80:81], v23 offset:128
  v_mfma_f32_16x16x32_bf16 a[180:183], v[112:115], a[20:23], a[180:183]
  s_lshl_b32 s4, s4, 17
  v_mfma_f32_16x16x32_bf16 a[184:187], v[112:115], a[24:27], a[184:187]
  s_add_u32 s62, s4, s63
  ds_read_b64_tr_b16 v[82:83], v23 offset:4736
  v_mfma_f32_16x16x32_bf16 a[188:191], v[112:115], a[28:31], a[188:191]
  buffer_load_dwordx4 a[80:83], v3, s[12:15], s62 offen offset:0 sc1
  v_mfma_f32_16x16x32_bf16 a[192:195], v[116:119], a[16:19], a[192:195]
  ds_read_b64_tr_b16 v[84:85], v23 offset:160
  v_mfma_f32_16x16x32_bf16 a[196:199], v[116:119], a[20:23], a[196:199]
  buffer_load_dwordx4 a[84:87], v3, s[12:15], s62 offen offset:1024 sc1
  ds_read_b64_tr_b16 v[86:87], v23 offset:4768
  v_mfma_f32_16x16x32_bf16 a[200:203], v[116:119], a[24:27], a[200:203]
  buffer_load_dwordx4 a[88:91], v3, s[12:15], s62 offen offset:2048 sc1
  v_mfma_f32_16x16x32_bf16 a[204:207], v[116:119], a[28:31], a[204:207]
  buffer_load_dwordx4 a[92:95], v3, s[12:15], s62 offen offset:3072 sc1
  ds_read_b64_tr_b16 v[88:89], v23 offset:192
  v_mfma_f32_16x16x32_bf16 a[208:211], v[120:123], a[16:19], a[208:211]
  s_add_u32 s3, s99, 5
  ds_read_b64_tr_b16 v[90:91], v23 offset:4800
  v_mfma_f32_16x16x32_bf16 a[212:215], v[120:123], a[20:23], a[212:215]
  s_lshl2_add_u32 s3, s3, 0
  v_mfma_f32_16x16x32_bf16 a[216:219], v[120:123], a[24:27], a[216:219]
  ds_read_b64_tr_b16 v[92:93], v23 offset:224
  v_mfma_f32_16x16x32_bf16 a[220:223], v[120:123], a[28:31], a[220:223]
  s_mul_i32 s61, s3, 36864
  v_mfma_f32_16x16x32_bf16 a[224:227], v[124:127], a[16:19], a[224:227]
  s_add_u32 m0, s60, 46080
  ds_read_b64_tr_b16 v[94:95], v23 offset:4832
  v_mfma_f32_16x16x32_bf16 a[228:231], v[124:127], a[20:23], a[228:231]
  buffer_load_dwordx4 v20, s[40:43], s61 offen lds
  ds_read_b64_tr_b16 v[96:97], v23 offset:256
  v_mfma_f32_16x16x32_bf16 a[232:235], v[124:127], a[24:27], a[232:235]
  buffer_load_dwordx4 v21, s[40:43], s61 offen offset:1024 lds
  v_mfma_f32_16x16x32_bf16 a[236:239], v[124:127], a[28:31], a[236:239]
  s_mov_b64 exec, 0xffff
  buffer_load_dwordx4 v22, s[40:43], s61 offen offset:2048 lds
  s_mov_b64 exec, -1
  v_mfma_f32_16x16x32_bf16 a[240:243], v[128:131], a[16:19], a[240:243]
  ds_read_b64_tr_b16 v[98:99], v23 offset:4864
  v_mfma_f32_16x16x32_bf16 a[244:247], v[128:131], a[20:23], a[244:247]
  buffer_store_dwordx4 v[212:215], v3, s[12:15], s11 offen offset:3072 sc1
  v_mfma_f32_16x16x32_bf16 a[248:251], v[128:131], a[24:27], a[248:251]
  s_add_u32 s11, s11, 131072
  v_mfma_f32_16x16x32_bf16 a[252:255], v[128:131], a[28:31], a[252:255]
  buffer_store_dwordx4 v[216:219], v3, s[12:15], s11 offen offset:0 sc1
  v_mfma_f32_16x16x32_bf16 v[240:243], v[132:135], a[16:19], v[240:243]
  buffer_store_dwordx4 v[220:223], v3, s[12:15], s11 offen offset:1024 sc1
  v_mfma_f32_16x16x32_bf16 v[244:247], v[132:135], a[20:23], v[244:247]
  v_mfma_f32_16x16x32_bf16 v[248:251], v[132:135], a[24:27], v[248:251]
  v_mfma_f32_16x16x32_bf16 v[252:255], v[132:135], a[28:31], v[252:255]
  s_waitcnt vmcnt(25) lgkmcnt(0)
  s_barrier
  v_mfma_f32_16x16x32_bf16 a[128:131], v[64:67], a[32:35], a[128:131]
  s_waitcnt vmcnt(14)
  v_cmp_gt_u32 s[6:7], 1, v25
  s_cmp_lg_u64 s[6:7], 0
  s_cbranch_scc1 SP_pO10
RT_pO10:
  v_mfma_f32_16x16x32_bf16 a[132:135], v[64:67], a[36:39], a[132:135]
  s_add_u32 s4, s99, 4
  ds_read_b64_tr_b16 v[100:101], v23 offset:9216
  ds_read_b64_tr_b16 v[102:103], v23 offset:13824
  v_mfma_f32_16x16x32_bf16 a[136:139], v[64:67], a[40:43], a[136:139]
  v_mfma_f32_16x16x32_bf16 a[140:143], v[64:67], a[44:47], a[140:143]
  s_lshl2_add_u32 s4, s4, 0
  ds_read_b64_tr_b16 v[104:105], v23 offset:9248
  v_mfma_f32_16x16x32_bf16 a[144:147], v[68:71], a[32:35], a[144:147]
  ds_read_b64_tr_b16 v[106:107], v23 offset:13856
  v_mfma_f32_16x16x32_bf16 a[148:151], v[68:71], a[36:39], a[148:151]
  s_lshl_b32 s4, s4, 17
  v_mfma_f32_16x16x32_bf16 a[152:155], v[68:71], a[40:43], a[152:155]
  ds_read_b64_tr_b16 v[108:109], v23 offset:9280
  v_mfma_f32_16x16x32_bf16 a[156:159], v[68:71], a[44:47], a[156:159]
  s_add_u32 s62, s4, s63
  v_mfma_f32_16x16x32_bf16 a[160:163], v[72:75], a[32:35], a[160:163]
  buffer_load_dwordx4 a[96:99], v3, s[12:15], s62 offen offset:0 sc1
  ds_read_b64_tr_b16 v[110:111], v23 offset:13888
  v_mfma_f32_16x16x32_bf16 a[164:167], v[72:75], a[36:39], a[164:167]
  ds_read_b64_tr_b16 v[112:113], v23 offset:9312
  v_mfma_f32_16x16x32_bf16 a[168:171], v[72:75], a[40:43], a[168:171]
  buffer_load_dwordx4 a[100:103], v3, s[12:15], s62 offen offset:1024 sc1
  v_mfma_f32_16x16x32_bf16 a[172:175], v[72:75], a[44:47], a[172:175]
  ds_read_b64_tr_b16 v[114:115], v23 offset:13920
  v_mfma_f32_16x16x32_bf16 a[176:179], v[76:79], a[32:35], a[176:179]
  buffer_load_dwordx4 a[104:107], v3, s[12:15], s62 offen offset:2048 sc1
  ds_read_b64_tr_b16 v[116:117], v23 offset:9344
  v_mfma_f32_16x16x32_bf16 a[180:183], v[76:79], a[36:39], a[180:183]
  v_mfma_f32_16x16x32_bf16 a[184:187], v[76:79], a[40:43], a[184:187]
  buffer_load_dwordx4 a[108:111], v3, s[12:15], s62 offen offset:3072 sc1
  ds_read_b64_tr_b16 v[118:119], v23 offset:13952
  v_mfma_f32_16x16x32_bf16 a[188:191], v[76:79], a[44:47], a[188:191]
  v_mfma_f32_16x16x32_bf16 a[192:195], v[80:83], a[32:35], a[192:195]
  s_add_u32 s3, s99, 6
  ds_read_b64_tr_b16 v[120:121], v23 offset:9376
  v_mfma_f32_16x16x32_bf16 a[196:199], v[80:83], a[36:39], a[196:199]
  s_lshl2_add_u32 s3, s3, 0
  ds_read_b64_tr_b16 v[122:123], v23 offset:13984
  v_mfma_f32_16x16x32_bf16 a[200:203], v[80:83], a[40:43], a[200:203]
  v_mfma_f32_16x16x32_bf16 a[204:207], v[80:83], a[44:47], a[204:207]
  s_mul_i32 s61, s3, 36864
  ds_read_b64_tr_b16 v[124:125], v23 offset:9408
  v_mfma_f32_16x16x32_bf16 a[208:211], v[84:87], a[32:35], a[208:211]
  ds_read_b64_tr_b16 v[126:127], v23 offset:14016
  v_mfma_f32_16x16x32_bf16 a[212:215], v[84:87], a[36:39], a[212:215]
  s_add_u32 m0, s60, 0
  v_mfma_f32_16x16x32_bf16 a[216:219], v[84:87], a[40:43], a[216:219]
  ds_read_b64_tr_b16 v[128:129], v23 offset:9440
  v_mfma_f32_16x16x32_bf16 a[220:223], v[84:87], a[44:47], a[220:223]
  buffer_load_dwordx4 v20, s[40:43], s61 offen lds
  v_mfma_f32_16x16x32_bf16 a[224:227], v[88:91], a[32:35], a[224:227]
  ds_read_b64_tr_b16 v[130:131], v23 offset:14048
  v_mfma_f32_16x16x32_bf16 a[228:231], v[88:91], a[36:39], a[228:231]
  buffer_load_dwordx4 v21, s[40:43], s61 offen offset:1024 lds
  ds_read_b64_tr_b16 v[132:133], v23 offset:9472
  v_mfma_f32_16x16x32_bf16 a[232:235], v[88:91], a[40:43], a[232:235]
  s_mov_b64 exec, 0xffff
  buffer_load_dwordx4 v22, s[40:43], s61 offen offset:2048 lds
  s_mov_b64 exec, -1
  v_mfma_f32_16x16x32_bf16 a[236:239], v[88:91], a[44:47], a[236:239]
  ds_read_b64_tr_b16 v[134:135], v23 offset:14080
  v_mfma_f32_16x16x32_bf16 a[240:243], v[92:95], a[32:35], a[240:243]
  buffer_store_dwordx4 v[224:227], v3, s[12:15], s11 offen offset:2048 sc1
  v_mfma_f32_16x16x32_bf16 a[244:247], v[92:95], a[36:39], a[244:247]
  v_mfma_f32_16x16x32_bf16 a[248:251], v[92:95], a[40:43], a[248:251]
  buffer_store_dwordx4 v[228:231], v3, s[12:15], s11 offen offset:3072 sc1
  v_mfma_f32_16x16x32_bf16 a[252:255], v[92:95], a[44:47], a[252:255]
  v_mfma_f32_16x16x32_bf16 v[240:243], v[96:99], a[32:35], v[240:243]
  s_add_u32 s11, s11, 131072
  v_mfma_f32_16x16x32_bf16 v[244:247], v[96:99], a[36:39], v[244:247]
  v_mfma_f32_16x16x32_bf16 v[248:251], v[96:99], a[40:43], v[248:251]
  v_mfma_f32_16x16x32_bf16 v[252:255], v[96:99], a[44:47], v[252:255]
  s_waitcnt lgkmcnt(0)
  s_barrier
  v_mfma_f32_16x16x32_bf16 a[128:131], v[100:103], a[48:51], a[128:131]
  s_add_u32 s4, s99, 5
  ds_read_b64_tr_b16 v[64:65], v23 offset:18432
  v_mfma_f32_16x16x32_bf16 a[132:135], v[100:103], a[52:55], a[132:135]
  ds_read_b64_tr_b16 v[66:67], v23 offset:23040
  v_mfma_f32_16x16x32_bf16 a[136:139], v[100:103], a[56:59], a[136:139]
  s_lshl2_add_u32 s4, s4, 0
  v_mfma_f32_16x16x32_bf16 a[140:143], v[100:103], a[60:63], a[140:143]
  ds_read_b64_tr_b16 v[68:69], v23 offset:18464
  v_mfma_f32_16x16x32_bf16 a[144:147], v[104:107], a[48:51], a[144:147]
  s_lshl_b32 s4, s4, 17
  ds_read_b64_tr_b16 v[70:71], v23 offset:23072
  v_mfma_f32_16x16x32_bf16 a[148:151], v[104:107], a[52:55], a[148:151]
  v_mfma_f32_16x16x32_bf16 a[152:155], v[104:107], a[56:59], a[152:155]
  s_add_u32 s62, s4, s63
  ds_read_b64_tr_b16 v[72:73], v23 offset:18496
  v_mfma_f32_16x16x32_bf16 a[156:159], v[104:107], a[60:63], a[156:159]
  v_mfma_f32_16x16x32_bf16 a[160:163], v[108:111], a[48:51], a[160:163]
  ds_read_b64_tr_b16 v[74:75], v23 offset:23104
  v_mfma_f32_16x16x32_bf16 a[164:167], v[108:111], a[52:55], a[164:167]
  buffer_load_dwordx4 a[112:115], v3, s[12:15], s62 offen offset:0 sc1
  ds_read_b64_tr_b16 v[76:77], v23 offset:18528
  v_mfma_f32_16x16x32_bf16 a[168:171], v[108:111], a[56:59], a[168:171]
  v_mfma_f32_16x16x32_bf16 a[172:175], v[108:111], a[60:63], a[172:175]
  buffer_load_dwordx4 a[116:119], v3, s[12:15], s62 offen offset:1024 sc1
  ds_read_b64_tr_b16 v[78:79], v23 offset:23136
  v_mfma_f32_16x16x32_bf16 a[176:179], v[112:115], a[48:51], a[176:179]
  ds_read_b64_tr_b16 v[80:81], v23 offset:18560
  v_mfma_f32_16x16x32_bf16 a[180:183], v[112:115], a[52:55], a[180:183]
  buffer_load_dwordx4 a[120:123], v3, s[12:15], s62 offen offset:2048 sc1
  v_mfma_f32_16x16x32_bf16 a[184:187], v[112:115], a[56:59], a[184:187]
  ds_read_b64_tr_b16 v[82:83], v23 offset:23168
  v_mfma_f32_16x16x32_bf16 a[188:191], v[112:115], a[60:63], a[188:191]
  buffer_load_dwordx4 a[124:127], v3, s[12:15], s62 offen offset:3072 sc1
  v_mfma_f32_16x16x32_bf16 a[192:195], v[116:119], a[48:51], a[192:195]
  ds_read_b64_tr_b16 v[84:85], v23 offset:18592
  v_mfma_f32_16x16x32_bf16 a[196:199], v[116:119], a[52:55], a[196:199]
  ds_read_b64_tr_b16 v[86:87], v23 offset:23200
  v_mfma_f32_16x16x32_bf16 a[200:203], v[116:119], a[56:59], a[200:203]
  s_add_u32 s3, s99, 7
  v_mfma_f32_16x16x32_bf16 a[204:207], v[116:119], a[60:63], a[204:207]
  ds_read_b64_tr_b16 v[88:89], v23 offset:18624
  v_mfma_f32_16x16x32_bf16 a[208:211], v[120:123], a[48:51], a[208:211]
  s_lshl2_add_u32 s3, s3, 0
  ds_read_b64_tr_b16 v[90:91], v23 offset:23232
  v_mfma_f32_16x16x32_bf16 a[212:215], v[120:123], a[52:55], a[212:215]
  v_mfma_f32_16x16x32_bf16 a[216:219], v[120:123], a[56:59], a[216:219]
  s_mul_i32 s61, s3, 36864
  ds_read_b64_tr_b16 v[92:93], v23 offset:18656
  v_mfma_f32_16x16x32_bf16 a[220:223], v[120:123], a[60:63], a[220:223]
  v_mfma_f32_16x16x32_bf16 a[224:227], v[124:127], a[48:51], a[224:227]
  s_add_u32 m0, s60, 9216
  ds_read_b64_tr_b16 v[94:95], v23 offset:23264
  v_mfma_f32_16x16x32_bf16 a[228:231], v[124:127], a[52:55], a[228:231]
  ds_read_b64_tr_b16 v[96:97], v23 offset:18688
  v_mfma_f32_16x16x32_bf16 a[232:235], v[124:127], a[56:59], a[232:235]
  v_mfma_f32_16x16x32_bf16 a[236:239], v[124:127], a[60:63], a[236:239]
  buffer_load_dwordx4 v20, s[40:43], s61 offen lds
  ds_read_b64_tr_b16 v[98:99], v23 offset:23296
  v_mfma_f32_16x16x32_bf16 a[240:243], v[128:131], a[48:51], a[240:243]
  v_mfma_f32_16x16x32_bf16 a[244:247], v[128:131], a[52:55], a[244:247]
  buffer_load_dwordx4 v21, s[40:43], s61 offen offset:1024 lds
  v_mfma_f32_16x16x32_bf16 a[248:251], v[128:131], a[56:59], a[248:251]
  v_mfma_f32_16x16x32_bf16 a[252:255], v[128:131], a[60:63], a[252:255]
  s_mov_b64 exec, 0xffff
  buffer_load_dwordx4 v22, s[40:43], s61 offen offset:2048 lds
  s_mov_b64 exec, -1
  v_mfma_f32_16x16x32_bf16 v[240:243], v[132:135], a[48:51], v[240:243]
  v_mfma_f32_16x16x32_bf16 v[244:247], v[132:135], a[52:55], v[244:247]
  v_mfma_f32_16x16x32_bf16 v[248:251], v[132:135], a[56:59], v[248:251]
  v_mfma_f32_16x16x32_bf16 v[252:255], v[132:135], a[60:63], v[252:255]
  s_waitcnt vmcnt(7) lgkmcnt(0)
  s_barrier
  v_mfma_f32_16x16x32_bf16 a[128:131], v[64:67], a[64:67], a[128:131]
  buffer_store_dword v27, v8, s[12:15], s44 offen sc1
  ds_read_b64_tr_b16 v[100:101], v23 offset:27648
  v_mfma_f32_16x16x32_bf16 a[132:135], v[64:67], a[68:71], a[132:135]
  ds_read_b64_tr_b16 v[102:103], v23 offset:32256
  v_mfma_f32_16x16x32_bf16 a[136:139], v[64:67], a[72:75], a[136:139]
  s_add_u32 s4, s99, 6
  v_mfma_f32_16x16x32_bf16 a[140:143], v[64:67], a[76:79], a[140:143]
  ds_read_b64_tr_b16 v[104:105], v23 offset:27680
  v_mfma_f32_16x16x32_bf16 a[144:147], v[68:71], a[64:67], a[144:147]
  s_lshl2_add_u32 s4, s4, 0
  ds_read_b64_tr_b16 v[106:107], v23 offset:32288
  v_mfma_f32_16x16x32_bf16 a[148:151], v[68:71], a[68:71], a[148:151]
  v_mfma_f32_16x16x32_bf16 a[152:155], v[68:71], a[72:75], a[152:155]
  s_lshl_b32 s4, s4, 17
  ds_read_b64_tr_b16 v[108:109], v23 offset:27712
  v_mfma_f32_16x16x32_bf16 a[156:159], v[68:71], a[76:79], a[156:159]
  v_mfma_f32_16x16x32_bf16 a[160:163], v[72:75], a[64:67], a[160:163]
  s_add_u32 s62, s4, s63
  ds_read_b64_tr_b16 v[110:111], v23 offset:32320
  v_mfma_f32_16x16x32_bf16 a[164:167], v[72:75], a[68:71], a[164:167]
  ds_read_b64_tr_b16 v[112:113], v23 offset:27744
  v_mfma_f32_16x16x32_bf16 a[168:171], v[72:75], a[72:75], a[168:171]
  buffer_load_dwordx4 a[0:3], v3, s[12:15], s62 offen offset:0 sc1
  v_mfma_f32_16x16x32_bf16 a[172:175], v[72:75], a[76:79], a[172:175]
  ds_read_b64_tr_b16 v[114:115], v23 offset:32352
  v_mfma_f32_16x16x32_bf16 a[176:179], v[76:79], a[64:67], a[176:179]
  buffer_load_dwordx4 a[4:7], v3, s[12:15], s62 offen offset:1024 sc1
  ds_read_b64_tr_b16 v[116:117], v23 offset:27776
  v_mfma_f32_16x16x32_bf16 a[180:183], v[76:79], a[68:71], a[180:183]
  v_mfma_f32_16x16x32_bf16 a[184:187], v[76:79], a[72:75], a[184:187]
  buffer_load_dwordx4 a[8:11], v3, s[12:15], s62 offen offset:2048 sc1
  ds_read_b64_tr_b16 v[118:119], v23 offset:32384
  v_mfma_f32_16x16x32_bf16 a[188:191], v[76:79], a[76:79], a[188:191]
  v_mfma_f32_16x16x32_bf16 a[192:195], v[80:83], a[64:67], a[192:195]
  ds_read_b64_tr_b16 v[120:121], v23 offset:27808
  v_mfma_f32_16x16x32_bf16 a[196:199], v[80:83], a[68:71], a[196:199]
  buffer_load_dwordx4 a[12:15], v3, s[12:15], s62 offen offset:3072 sc1
  ds_read_b64_tr_b16 v[122:123], v23 offset:32416
  v_mfma_f32_16x16x32_bf16 a[200:203], v[80:83], a[72:75], a[200:203]
  v_mfma_f32_16x16x32_bf16 a[204:207], v[80:83], a[76:79], a[204:207]
  s_xor_b32 s3, s19, 1
  ds_read_b64_tr_b16 v[124:125], v23 offset:27840
  v_mfma_f32_16x16x32_bf16 a[208:211], v[84:87], a[64:67], a[208:211]
  ds_read_b64_tr_b16 v[126:127], v23 offset:32448
  v_mfma_f32_16x16x32_bf16 a[212:215], v[84:87], a[68:71], a[212:215]
  s_lshl2_add_u32 s3, s3, 2
  v_mfma_f32_16x16x32_bf16 a[216:219], v[84:87], a[72:75], a[216:219]
  ds_read_b64_tr_b16 v[128:129], v23 offset:27872
  v_mfma_f32_16x16x32_bf16 a[220:223], v[84:87], a[76:79], a[220:223]
  s_mul_i32 s61, s3, 36864
  v_mfma_f32_16x16x32_bf16 a[224:227], v[88:91], a[64:67], a[224:227]
  ds_read_b64_tr_b16 v[130:131], v23 offset:32480
  v_mfma_f32_16x16x32_bf16 a[228:231], v[88:91], a[68:71], a[228:231]
  s_add_u32 m0, s60, 18432
  ds_read_b64_tr_b16 v[132:133], v23 offset:27904
  v_mfma_f32_16x16x32_bf16 a[232:235], v[88:91], a[72:75], a[232:235]
  v_mfma_f32_16x16x32_bf16 a[236:239], v[88:91], a[76:79], a[236:239]
  buffer_load_dwordx4 v20, s[40:43], s61 offen lds
  ds_read_b64_tr_b16 v[134:135], v23 offset:32512
  v_mfma_f32_16x16x32_bf16 a[240:243], v[92:95], a[64:67], a[240:243]
  v_mfma_f32_16x16x32_bf16 a[244:247], v[92:95], a[68:71], a[244:247]
  buffer_load_dwordx4 v21, s[40:43], s61 offen offset:1024 lds
  v_mfma_f32_16x16x32_bf16 a[248:251], v[92:95], a[72:75], a[248:251]
  v_mfma_f32_16x16x32_bf16 a[252:255], v[92:95], a[76:79], a[252:255]
  s_mov_b64 exec, 0xffff
  buffer_load_dwordx4 v22, s[40:43], s61 offen offset:2048 lds
  s_mov_b64 exec, -1
  v_mfma_f32_16x16x32_bf16 v[240:243], v[96:99], a[64:67], v[240:243]
  v_mfma_f32_16x16x32_bf16 v[244:247], v[96:99], a[68:71], v[244:247]
  v_mfma_f32_16x16x32_bf16 v[248:251], v[96:99], a[72:75], v[248:251]
  v_mfma_f32_16x16x32_bf16 v[252:255], v[96:99], a[76:79], v[252:255]
  s_waitcnt lgkmcnt(0)
  s_barrier
  v_mfma_f32_16x16x32_bf16 a[128:131], v[100:103], a[80:83], a[128:131]
  buffer_load_dword v25, v24, s[12:15], s54 offen sc1
  ds_read_b64_tr_b16 v[64:65], v23 offset:36864
  v_mfma_f32_16x16x32_bf16 a[132:135], v[100:103], a[84:87], a[132:135]
  ds_read_b64_tr_b16 v[66:67], v23 offset:41472
  v_mfma_f32_16x16x32_bf16 a[136:139], v[100:103], a[88:91], a[136:139]
  s_add_u32 s4, s99, 7
  v_mfma_f32_16x16x32_bf16 a[140:143], v[100:103], a[92:95], a[140:143]
  ds_read_b64_tr_b16 v[68:69], v23 offset:36896
  v_mfma_f32_16x16x32_bf16 a[144:147], v[104:107], a[80:83], a[144:147]
  s_lshl2_add_u32 s4, s4, 0
  ds_read_b64_tr_b16 v[70:71], v23 offset:41504
  v_mfma_f32_16x16x32_bf16 a[148:151], v[104:107], a[84:87], a[148:151]
  v_mfma_f32_16x16x32_bf16 a[152:155], v[104:107], a[88:91], a[152:155]
  s_lshl_b32 s4, s4, 17
  ds_read_b64_tr_b16 v[72:73], v23 offset:36928
  v_mfma_f32_16x16x32_bf16 a[156:159], v[104:107], a[92:95], a[156:159]
  v_mfma_f32_16x16x32_bf16 a[160:163], v[108:111], a[80:83], a[160:163]
  s_add_u32 s62, s4, s63
  ds_read_b64_tr_b16 v[74:75], v23 offset:41536
  v_mfma_f32_16x16x32_bf16 a[164:167], v[108:111], a[84:87], a[164:167]
  ds_read_b64_tr_b16 v[76:77], v23 offset:36960
  v_mfma_f32_16x16x32_bf16 a[168:171], v[108:111], a[88:91], a[168:171]
  buffer_load_dwordx4 a[16:19], v3, s[12:15], s62 offen offset:0 sc1
  v_mfma_f32_16x16x32_bf16 a[172:175], v[108:111], a[92:95], a[172:175]
  ds_read_b64_tr_b16 v[78:79], v23 offset:41568
  v_mfma_f32_16x16x32_bf16 a[176:179], v[112:115], a[80:83], a[176:179]
  buffer_load_dwordx4 a[20:23], v3, s[12:15], s62 offen offset:1024 sc1
  ds_read_b64_tr_b16 v[80:81], v23 offset:36992
  v_mfma_f32_16x16x32_bf16 a[180:183], v[112:115], a[84:87], a[180:183]
  v_mfma_f32_16x16x32_bf16 a[184:187], v[112:115], a[88:91], a[184:187]
  buffer_load_dwordx4 a[24:27], v3, s[12:15], s62 offen offset:2048 sc1
  ds_read_b64_tr_b16 v[82:83], v23 offset:41600
  v_mfma_f32_16x16x32_bf16 a[188:191], v[112:115], a[92:95], a[188:191]
  v_mfma_f32_16x16x32_bf16 a[192:195], v[116:119], a[80:83], a[192:195]
  ds_read_b64_tr_b16 v[84:85], v23 offset:37024
  v_mfma_f32_16x16x32_bf16 a[196:199], v[116:119], a[84:87], a[196:199]
  buffer_load_dwordx4 a[28:31], v3, s[12:15], s62 offen offset:3072 sc1
  ds_read_b64_tr_b16 v[86:87], v23 offset:41632
  v_mfma_f32_16x16x32_bf16 a[200:203], v[116:119], a[88:91], a[200:203]
  v_mfma_f32_16x16x32_bf16 a[204:207], v[116:119], a[92:95], a[204:207]
  s_xor_b32 s3, s19, 2
  ds_read_b64_tr_b16 v[88:89], v23 offset:37056
  v_mfma_f32_16x16x32_bf16 a[208:211], v[120:123], a[80:83], a[208:211]
  ds_read_b64_tr_b16 v[90:91], v23 offset:41664
  v_mfma_f32_16x16x32_bf16 a[212:215], v[120:123], a[84:87], a[212:215]
  s_lshl2_add_u32 s3, s3, 2
  v_mfma_f32_16x16x32_bf16 a[216:219], v[120:123], a[88:91], a[216:219]
  ds_read_b64_tr_b16 v[92:93], v23 offset:37088
  v_mfma_f32_16x16x32_bf16 a[220:223], v[120:123], a[92:95], a[220:223]
  s_mul_i32 s61, s3, 36864
  v_mfma_f32_16x16x32_bf16 a[224:227], v[124:127], a[80:83], a[224:227]
  ds_read_b64_tr_b16 v[94:95], v23 offset:41696
  v_mfma_f32_16x16x32_bf16 a[228:231], v[124:127], a[84:87], a[228:231]
  s_add_u32 m0, s60, 27648
  ds_read_b64_tr_b16 v[96:97], v23 offset:37120
  v_mfma_f32_16x16x32_bf16 a[232:235], v[124:127], a[88:91], a[232:235]
  v_mfma_f32_16x16x32_bf16 a[236:239], v[124:127], a[92:95], a[236:239]
  buffer_load_dwordx4 v20, s[40:43], s61 offen lds
  ds_read_b64_tr_b16 v[98:99], v23 offset:41728
  v_mfma_f32_16x16x32_bf16 a[240:243], v[128:131], a[80:83], a[240:243]
  v_mfma_f32_16x16x32_bf16 a[244:247], v[128:131], a[84:87], a[244:247]
  buffer_load_dwordx4 v21, s[40:43], s61 offen offset:1024 lds
  v_mfma_f32_16x16x32_bf16 a[248:251], v[128:131], a[88:91], a[248:251]
  v_mfma_f32_16x16x32_bf16 a[252:255], v[128:131], a[92:95], a[252:255]
  s_mov_b64 exec, 0xffff
  buffer_load_dwordx4 v22, s[40:43], s61 offen offset:2048 lds
  s_mov_b64 exec, -1
  v_mfma_f32_16x16x32_bf16 v[240:243], v[132:135], a[80:83], v[240:243]
  v_mfma_f32_16x16x32_bf16 v[244:247], v[132:135], a[84:87], v[244:247]
  v_mfma_f32_16x16x32_bf16 v[248:251], v[132:135], a[88:91], v[248:251]
  v_mfma_f32_16x16x32_bf16 v[252:255], v[132:135], a[92:95], v[252:255]
  s_waitcnt lgkmcnt(0)
  s_barrier
  v_mfma_f32_16x16x32_bf16 a[128:131], v[64:67], a[96:99], a[128:131]
  s_waitcnt vmcnt(7)
  v_cmp_gt_u32 s[6:7], 4, v25
  s_cmp_lg_u64 s[6:7], 0
  s_cbranch_scc1 SP_pO14
RT_pO14:
  v_mfma_f32_16x16x32_bf16 a[132:135], v[64:67], a[100:103], a[132:135]
  ds_read_b64_tr_b16 v[100:101], v23 offset:46080
  ds_read_b64_tr_b16 v[102:103], v23 offset:50688
  v_mfma_f32_16x16x32_bf16 a[136:139], v[64:67], a[104:107], a[136:139]
  s_xor_b32 s4, s19, 1
  v_mfma_f32_16x16x32_bf16 a[140:143], v[64:67], a[108:111], a[140:143]
  ds_read_b64_tr_b16 v[104:105], v23 offset:46112
  v_mfma_f32_16x16x32_bf16 a[144:147], v[68:71], a[96:99], a[144:147]
TP_14:
  s_cbranch_execz TP_26
  s_lshl2_add_u32 s4, s4, 2
  ds_read_b64_tr_b16 v[106:107], v23 offset:50720
  v_mfma_f32_16x16x32_bf16 a[148:151], v[68:71], a[100:103], a[148:151]
  v_mfma_f32_16x16x32_bf16 a[152:155], v[68:71], a[104:107], a[152:155]
  s_lshl_b32 s4, s4, 17
  ds_read_b64_tr_b16 v[108:109], v23 offset:46144
  v_mfma_f32_16x16x32_bf16 a[156:159], v[68:71], a[108:111], a[156:159]
  v_mfma_f32_16x16x32_bf16 a[160:163], v[72:75], a[96:99], a[160:163]
  s_add_u32 s62, s4, s63
  ds_read_b64_tr_b16 v[110:111], v23 offset:50752
  v_mfma_f32_16x16x32_bf16 a[164:167], v[72:75], a[100:103], a[164:167]
  ds_read_b64_tr_b16 v[112:113], v23 offset:46176
  v_mfma_f32_16x16x32_bf16 a[168:171], v[72:75], a[104:107], a[168:171]
  buffer_load_dwordx4 a[32:35], v3, s[12:15], s62 offen offset:0 sc1
  v_mfma_f32_16x16x32_bf16 a[172:175], v[72:75], a[108:111], a[172:175]
  ds_read_b64_tr_b16 v[114:115], v23 offset:50784
  v_mfma_f32_16x16x32_bf16 a[176:179], v[76:79], a[96:99], a[176:179]
  buffer_load_dwordx4 a[36:39], v3, s[12:15], s62 offen offset:1024 sc1
  ds_read_b64_tr_b16 v[116:117], v23 offset:46208
  v_mfma_f32_16x16x32_bf16 a[180:183], v[76:79], a[100:103], a[180:183]
  v_mfma_f32_16x16x32_bf16 a[184:187], v[76:79], a[104:107], a[184:187]
  buffer_load_dwordx4 a[40:43], v3, s[12:15], s62 offen offset:2048 sc1
  ds_read_b64_tr_b16 v[118:119], v23 offset:50816
  v_mfma_f32_16x16x32_bf16 a[188:191], v[76:79], a[108:111], a[188:191]
  v_mfma_f32_16x16x32_bf16 a[192:195], v[80:83], a[96:99], a[192:195]
  ds_read_b64_tr_b16 v[120:121], v23 offset:46240
  v_mfma_f32_16x16x32_bf16 a[196:199], v[80:83], a[100:103], a[196:199]
  buffer_load_dwordx4 a[44:47], v3, s[12:15], s62 offen offset:3072 sc1
  ds_read_b64_tr_b16 v[122:123], v23 offset:50848
  v_mfma_f32_16x16x32_bf16 a[200:203], v[80:83], a[104:107], a[200:203]
  v_mfma_f32_16x16x32_bf16 a[204:207], v[80:83], a[108:111], a[204:207]
  s_xor_b32 s3, s19, 3
  ds_read_b64_tr_b16 v[124:125], v23 offset:46272
  v_mfma_f32_16x16x32_bf16 a[208:211], v[84:87], a[96:99], a[208:211]
  ds_read_b64_tr_b16 v[126:127], v23 offset:50880
  v_mfma_f32_16x16x32_bf16 a[212:215], v[84:87], a[100:103], a[212:215]
  s_lshl2_add_u32 s3, s3, 2
  v_mfma_f32_16x16x32_bf16 a[216:219], v[84:87], a[104:107], a[216:219]
  ds_read_b64_tr_b16 v[128:129], v23 offset:46304
  v_mfma_f32_16x16x32_bf16 a[220:223], v[84:87], a[108:111], a[220:223]
  s_mul_i32 s61, s3, 36864
  v_mfma_f32_16x16x32_bf16 a[224:227], v[88:91], a[96:99], a[224:227]
  ds_read_b64_tr_b16 v[130:131], v23 offset:50912
  v_mfma_f32_16x16x32_bf16 a[228:231], v[88:91], a[100:103], a[228:231]
  s_add_u32 m0, s60, 36864
  ds_read_b64_tr_b16 v[132:133], v23 offset:46336
  v_mfma_f32_16x16x32_bf16 a[232:235], v[88:91], a[104:107], a[232:235]
  v_mfma_f32_16x16x32_bf16 a[236:239], v[88:91], a[108:111], a[236:239]
  buffer_load_dwordx4 v20, s[40:43], s61 offen lds
  ds_read_b64_tr_b16 v[134:135], v23 offset:50944
  v_mfma_f32_16x16x32_bf16 a[240:243], v[92:95], a[96:99], a[240:243]
  v_mfma_f32_16x16x32_bf16 a[244:247], v[92:95], a[100:103], a[244:247]
  buffer_load_dwordx4 v21, s[40:43], s61 offen offset:1024 lds
  v_mfma_f32_16x16x32_bf16 a[248:251], v[92:95], a[104:107], a[248:251]
  v_mfma_f32_16x16x32_bf16 a[252:255], v[92:95], a[108:111], a[252:255]
  s_mov_b64 exec, 0xffff
  buffer_load_dwordx4 v22, s[40:43], s61 offen offset:2048 lds
  s_mov_b64 exec, -1
  v_mfma_f32_16x16x32_bf16 v[240:243], v[96:99], a[96:99], v[240:243]
  v_mfma_f32_16x16x32_bf16 v[244:247], v[96:99], a[100:103], v[244:247]
  v_mfma_f32_16x16x32_bf16 v[248:251], v[96:99], a[104:107], v[248:251]
  v_mfma_f32_16x16x32_bf16 v[252:255], v[96:99], a[108:111], v[252:255]
  s_waitcnt lgkmcnt(0)
  s_barrier
  v_mfma_f32_16x16x32_bf16 a[128:131], v[100:103], a[112:115], a[128:131]
  s_xor_b32 s4, s19, 2
  ds_read_b64_tr_b16 v[64:65], v23 offset:0
  v_mfma_f32_16x16x32_bf16 a[132:135], v[100:103], a[116:119], a[132:135]
  ds_read_b64_tr_b16 v[66:67], v23 offset:4608
  v_mfma_f32_16x16x32_bf16 a[136:139], v[100:103], a[120:123], a[136:139]
  s_lshl2_add_u32 s4, s4, 2
  v_mfma_f32_16x16x32_bf16 a[140:143], v[100:103], a[124:127], a[140:143]
  ds_read_b64_tr_b16 v[68:69], v23 offset:32
  v_mfma_f32_16x16x32_bf16 a[144:147], v[104:107], a[112:115], a[144:147]
  s_lshl_b32 s4, s4, 17
  ds_read_b64_tr_b16 v[70:71], v23 offset:4640
  v_mfma_f32_16x16x32_bf16 a[148:151], v[104:107], a[116:119], a[148:151]
  v_mfma_f32_16x16x32_bf16 a[152:155], v[104:107], a[120:123], a[152:155]
  s_add_u32 s62, s4, s63
  ds_read_b64_tr_b16 v[72:73], v23 offset:64
  v_mfma_f32_16x16x32_bf16 a[156:159], v[104:107], a[124:127], a[156:159]
  v_mfma_f32_16x16x32_bf16 a[160:163], v[108:111], a[112:115], a[160:163]
  ds_read_b64_tr_b16 v[74:75], v23 offset:4672
  v_mfma_f32_16x16x32_bf16 a[164:167], v[108:111], a[116:119], a[164:167]
  buffer_load_dwordx4 a[48:51], v3, s[12:15], s62 offen offset:0 sc1
  ds_read_b64_tr_b16 v[76:77], v23 offset:96
  v_mfma_f32_16x16x32_bf16 a[168:171], v[108:111], a[120:123], a[168:171]
  v_mfma_f32_16x16x32_bf16 a[172:175], v[108:111], a[124:127], a[172:175]
  buffer_load_dwordx4 a[52:55], v3, s[12:15], s62 offen offset:1024 sc1
  ds_read_b64_tr_b16 v[78:79], v23 offset:4704
  v_mfma_f32_16x16x32_bf16 a[176:179], v[112:115], a[112:115], a[176:179]
  ds_read_b64_tr_b16 v[80:81], v23 offset:128
  v_mfma_f32_16x16x32_bf16 a[180:183], v[112:115], a[116:119], a[180:183]
  buffer_load_dwordx4 a[56:59], v3, s[12:15], s62 offen offset:2048 sc1
  v_mfma_f32_16x16x32_bf16 a[184:187], v[112:115], a[120:123], a[184:187]
  ds_read_b64_tr_b16 v[82:83], v23 offset:4736
  v_mfma_f32_16x16x32_bf16 a[188:191], v[112:115], a[124:127], a[188:191]
  buffer_load_dwordx4 a[60:63], v3, s[12:15], s62 offen offset:3072 sc1
  v_mfma_f32_16x16x32_bf16 a[192:195], v[116:119], a[112:115], a[192:195]
  ds_read_b64_tr_b16 v[84:85], v23 offset:160
  v_mfma_f32_16x16x32_bf16 a[196:199], v[116:119], a[116:119], a[196:199]
  ds_read_b64_tr_b16 v[86:87], v23 offset:4768
  v_mfma_f32_16x16x32_bf16 a[200:203], v[116:119], a[120:123], a[200:203]
  s_xor_b32 s3, s19, 1
  v_mfma_f32_16x16x32_bf16 a[204:207], v[116:119], a[124:127], a[204:207]
  ds_read_b64_tr_b16 v[88:89], v23 offset:192
  v_mfma_f32_16x16x32_bf16 a[208:211], v[120:123], a[112:115], a[208:211]
  s_lshl2_add_u32 s3, s3, 3
  ds_read_b64_tr_b16 v[90:91], v23 offset:4800
  v_mfma_f32_16x16x32_bf16 a[212:215], v[120:123], a[116:119], a[212:215]
  v_mfma_f32_16x16x32_bf16 a[216:219], v[120:123], a[120:123], a[216:219]
  s_mul_i32 s61, s3, 36864
  ds_read_b64_tr_b16 v[92:93], v23 offset:224
  v_mfma_f32_16x16x32_bf16 a[220:223], v[120:123], a[124:127], a[220:223]
  v_mfma_f32_16x16x32_bf16 a[224:227], v[124:127], a[112:115], a[224:227]
  s_add_u32 m0, s60, 46080
  ds_read_b64_tr_b16 v[94:95], v23 offset:4832
  v_mfma_f32_16x16x32_bf16 a[228:231], v[124:127], a[116:119], a[228:231]
  ds_read_b64_tr_b16 v[96:97], v23 offset:256
  v_mfma_f32_16x16x32_bf16 a[232:235], v[124:127], a[120:123], a[232:235]
  v_mfma_f32_16x16x32_bf16 a[236:239], v[124:127], a[124:127], a[236:239]
  buffer_load_dwordx4 v20, s[40:43], s61 offen lds
  ds_read_b64_tr_b16 v[98:99], v23 offset:4864
  v_mfma_f32_16x16x32_bf16 a[240:243], v[128:131], a[112:115], a[240:243]
  v_mfma_f32_16x16x32_bf16 a[244:247], v[128:131], a[116:119], a[244:247]
  buffer_load_dwordx4 v21, s[40:43], s61 offen offset:1024 lds
  v_mfma_f32_16x16x32_bf16 a[248:251], v[128:131], a[120:123], a[248:251]
  v_mfma_f32_16x16x32_bf16 a[252:255], v[128:131], a[124:127], a[252:255]
  s_mov_b64 exec, 0xffff
  buffer_load_dwordx4 v22, s[40:43], s61 offen offset:2048 lds
  s_mov_b64 exec, -1
  v_mfma_f32_16x16x32_bf16 v[240:243], v[132:135], a[112:115], v[240:243]
  v_mfma_f32_16x16x32_bf16 v[244:247], v[132:135], a[116:119], v[244:247]
  v_mfma_f32_16x16x32_bf16 v[248:251], v[132:135], a[120:123], v[248:251]
  v_mfma_f32_16x16x32_bf16 v[252:255], v[132:135], a[124:127], v[252:255]
  s_waitcnt lgkmcnt(0)
  s_barrier
  v_mfma_f32_16x16x32_bf16 a[128:131], v[64:67], a[0:3], a[128:131]
  s_xor_b32 s4, s19, 3
  ds_read_b64_tr_b16 v[100:101], v23 offset:9216
  v_mfma_f32_16x16x32_bf16 a[132:135], v[64:67], a[4:7], a[132:135]
  ds_read_b64_tr_b16 v[102:103], v23 offset:13824
  v_mfma_f32_16x16x32_bf16 a[136:139], v[64:67], a[8:11], a[136:139]
  s_lshl2_add_u32 s4, s4, 2
  v_mfma_f32_16x16x32_bf16 a[140:143], v[64:67], a[12:15], a[140:143]
  ds_read_b64_tr_b16 v[104:105], v23 offset:9248
  v_mfma_f32_16x16x32_bf16 a[144:147], v[68:71], a[0:3], a[144:147]
  s_lshl_b32 s4, s4, 17
  ds_read_b64_tr_b16 v[106:107], v23 offset:13856
  v_mfma_f32_16x16x32_bf16 a[148:151], v[68:71], a[4:7], a[148:151]
  v_mfma_f32_16x16x32_bf16 a[152:155], v[68:71], a[8:11], a[152:155]
  s_add_u32 s62, s4, s63
  ds_read_b64_tr_b16 v[108:109], v23 offset:9280
  v_mfma_f32_16x16x32_bf16 a[156:159], v[68:71], a[12:15], a[156:159]
  v_mfma_f32_16x16x32_bf16 a[160:163], v[72:75], a[0:3], a[160:163]
  ds_read_b64_tr_b16 v[110:111], v23 offset:13888
  v_mfma_f32_16x16x32_bf16 a[164:167], v[72:75], a[4:7], a[164:167]
  buffer_load_dwordx4 a[64:67], v3, s[12:15], s62 offen offset:0 sc1
  ds_read_b64_tr_b16 v[112:113], v23 offset:9312
  v_mfma_f32_16x16x32_bf16 a[168:171], v[72:75], a[8:11], a[168:171]
  v_mfma_f32_16x16x32_bf16 a[172:175], v[72:75], a[12:15], a[172:175]
  buffer_load_dwordx4 a[68:71], v3, s[12:15], s62 offen offset:1024 sc1
  ds_read_b64_tr_b16 v[114:115], v23 offset:13920
  v_mfma_f32_16x16x32_bf16 a[176:179], v[76:79], a[0:3], a[176:179]
  ds_read_b64_tr_b16 v[116:117], v23 offset:9344
  v_mfma_f32_16x16x32_bf16 a[180:183], v[76:79], a[4:7], a[180:183]
  buffer_load_dwordx4 a[72:75], v3, s[12:15], s62 offen offset:2048 sc1
  v_mfma_f32_16x16x32_bf16 a[184:187], v[76:79], a[8:11], a[184:187]
  ds_read_b64_tr_b16 v[118:119], v23 offset:13952
  v_mfma_f32_16x16x32_bf16 a[188:191], v[76:79], a[12:15], a[188:191]
  buffer_load_dwordx4 a[76:79], v3, s[12:15], s62 offen offset:3072 sc1
  v_mfma_f32_16x16x32_bf16 a[192:195], v[80:83], a[0:3], a[192:195]
  ds_read_b64_tr_b16 v[120:121], v23 offset:9376
  v_mfma_f32_16x16x32_bf16 a[196:199], v[80:83], a[4:7], a[196:199]
  ds_read_b64_tr_b16 v[122:123], v23 offset:13984
  v_mfma_f32_16x16x32_bf16 a[200:203], v[80:83], a[8:11], a[200:203]
  s_xor_b32 s3, s19, 2
  v_mfma_f32_16x16x32_bf16 a[204:207], v[80:83], a[12:15], a[204:207]
  ds_read_b64_tr_b16 v[124:125], v23 offset:9408
  v_mfma_f32_16x16x32_bf16 a[208:211], v[84:87], a[0:3], a[208:211]
  s_lshl2_add_u32 s3, s3, 3
  ds_read_b64_tr_b16 v[126:127], v23 offset:14016
  v_mfma_f32_16x16x32_bf16 a[212:215], v[84:87], a[4:7], a[212:215]
  v_mfma_f32_16x16x32_bf16 a[216:219], v[84:87], a[8:11], a[216:219]
  s_mul_i32 s61, s3, 36864
  ds_read_b64_tr_b16 v[128:129], v23 offset:9440
  v_mfma_f32_16x16x32_bf16 a[220:223], v[84:87], a[12:15], a[220:223]
  v_mfma_f32_16x16x32_bf16 a[224:227], v[88:91], a[0:3], a[224:227]
  s_add_u32 m0, s60, 0
  ds_read_b64_tr_b16 v[130:131], v23 offset:14048
  v_mfma_f32_16x16x32_bf16 a[228:231], v[88:91], a[4:7], a[228:231]
  ds_read_b64_tr_b16 v[132:133], v23 offset:9472
  v_mfma_f32_16x16x32_bf16 a[232:235], v[88:91], a[8:11], a[232:235]
  v_mfma_f32_16x16x32_bf16 a[236:239], v[88:91], a[12:15], a[236:239]
  buffer_load_dwordx4 v20, s[40:43], s61 offen lds
  ds_read_b64_tr_b16 v[134:135], v23 offset:14080
  v_mfma_f32_16x16x32_bf16 a[240:243], v[92:95], a[0:3], a[240:243]
  v_mfma_f32_16x16x32_bf16 a[244:247], v[92:95], a[4:7], a[244:247]
  buffer_load_dwordx4 v21, s[40:43], s61 offen offset:1024 lds
  v_mfma_f32_16x16x32_bf16 a[248:251], v[92:95], a[8:11], a[248:251]
  v_mfma_f32_16x16x32_bf16 a[252:255], v[92:95], a[12:15], a[252:255]
  s_mov_b64 exec, 0xffff
  buffer_load_dwordx4 v22, s[40:43], s61 offen offset:2048 lds
  s_mov_b64 exec, -1
  v_mfma_f32_16x16x32_bf16 v[240:243], v[96:99], a[0:3], v[240:243]
  v_mfma_f32_16x16x32_bf16 v[244:247], v[96:99], a[4:7], v[244:247]
  v_mfma_f32_16x16x32_bf16 v[248:251], v[96:99], a[8:11], v[248:251]
  v_mfma_f32_16x16x32_bf16 v[252:255], v[96:99], a[12:15], v[252:255]
  s_waitcnt vmcnt(24) lgkmcnt(0)
  s_barrier
  v_mfma_f32_16x16x32_bf16 a[128:131], v[100:103], a[16:19], a[128:131]
  s_xor_b32 s4, s19, 1
  ds_read_b64_tr_b16 v[64:65], v23 offset:18432
  v_mfma_f32_16x16x32_bf16 a[132:135], v[100:103], a[20:23], a[132:135]
  ds_read_b64_tr_b16 v[66:67], v23 offset:23040
  v_mfma_f32_16x16x32_bf16 a[136:139], v[100:103], a[24:27], a[136:139]
  s_lshl2_add_u32 s4, s4, 3
  v_mfma_f32_16x16x32_bf16 a[140:143], v[100:103], a[28:31], a[140:143]
  ds_read_b64_tr_b16 v[68:69], v23 offset:18464
  v_mfma_f32_16x16x32_bf16 a[144:147], v[104:107], a[16:19], a[144:147]
  s_lshl_b32 s4, s4, 17
  ds_read_b64_tr_b16 v[70:71], v23 offset:23072
  v_mfma_f32_16x16x32_bf16 a[148:151], v[104:107], a[20:23], a[148:151]
  v_mfma_f32_16x16x32_bf16 a[152:155], v[104:107], a[24:27], a[152:155]
  s_add_u32 s62, s4, s63
  ds_read_b64_tr_b16 v[72:73], v23 offset:18496
  v_mfma_f32_16x16x32_bf16 a[156:159], v[104:107], a[28:31], a[156:159]
  v_mfma_f32_16x16x32_bf16 a[160:163], v[108:111], a[16:19], a[160:163]
  ds_read_b64_tr_b16 v[74:75], v23 offset:23104
  v_mfma_f32_16x16x32_bf16 a[164:167], v[108:111], a[20:23], a[164:167]
  buffer_load_dwordx4 a[80:83], v3, s[12:15], s62 offen offset:0 sc1
  ds_read_b64_tr_b16 v[76:77], v23 offset:18528
  v_mfma_f32_16x16x32_bf16 a[168:171], v[108:111], a[24:27], a[168:171]
  v_mfma_f32_16x16x32_bf16 a[172:175], v[108:111], a[28:31], a[172:175]
  buffer_load_dwordx4 a[84:87], v3, s[12:15], s62 offen offset:1024 sc1
  ds_read_b64_tr_b16 v[78:79], v23 offset:23136
  v_mfma_f32_16x16x32_bf16 a[176:179], v[112:115], a[16:19], a[176:179]
  ds_read_b64_tr_b16 v[80:81], v23 offset:18560
  v_mfma_f32_16x16x32_bf16 a[180:183], v[112:115], a[20:23], a[180:183]
  buffer_load_dwordx4 a[88:91], v3, s[12:15], s62 offen offset:2048 sc1
  v_mfma_f32_16x16x32_bf16 a[184:187], v[112:115], a[24:27], a[184:187]
  ds_read_b64_tr_b16 v[82:83], v23 offset:23168
  v_mfma_f32_16x16x32_bf16 a[188:191], v[112:115], a[28:31], a[188:191]
  buffer_load_dwordx4 a[92:95], v3, s[12:15], s62 offen offset:3072 sc1
  v_mfma_f32_16x16x32_bf16 a[192:195], v[116:119], a[16:19], a[192:195]
  ds_read_b64_tr_b16 v[84:85], v23 offset:18592
  v_mfma_f32_16x16x32_bf16 a[196:199], v[116:119], a[20:23], a[196:199]
  ds_read_b64_tr_b16 v[86:87], v23 offset:23200
  v_mfma_f32_16x16x32_bf16 a[200:203], v[116:119], a[24:27], a[200:203]
  s_xor_b32 s3, s19, 3
  v_mfma_f32_16x16x32_bf16 a[204:207], v[116:119], a[28:31], a[204:207]
  ds_read_b64_tr_b16 v[88:89], v23 offset:18624
  v_mfma_f32_16x16x32_bf16 a[208:211], v[120:123], a[16:19], a[208:211]
  s_lshl2_add_u32 s3, s3, 3
  ds_read_b64_tr_b16 v[90:91], v23 offset:23232
  v_mfma_f32_16x16x32_bf16 a[212:215], v[120:123], a[20:23], a[212:215]
  v_mfma_f32_16x16x32_bf16 a[216:219], v[120:123], a[24:27], a[216:219]
  s_mul_i32 s61, s3, 36864
  ds_read_b64_tr_b16 v[92:93], v23 offset:18656
  v_mfma_f32_16x16x32_bf16 a[220:223], v[120:123], a[28:31], a[220:223]
  v_mfma_f32_16x16x32_bf16 a[224:227], v[124:127], a[16:19], a[224:227]
  s_add_u32 m0, s60, 9216
  ds_read_b64_tr_b16 v[94:95], v23 offset:23264
  v_mfma_f32_16x16x32_bf16 a[228:231], v[124:127], a[20:23], a[228:231]
  ds_read_b64_tr_b16 v[96:97], v23 offset:18688
  v_mfma_f32_16x16x32_bf16 a[232:235], v[124:127], a[24:27], a[232:235]
  v_mfma_f32_16x16x32_bf16 a[236:239], v[124:127], a[28:31], a[236:239]
  buffer_load_dwordx4 v20, s[40:43], s61 offen lds
  ds_read_b64_tr_b16 v[98:99], v23 offset:23296
  v_mfma_f32_16x16x32_bf16 a[240:243], v[128:131], a[16:19], a[240:243]
  v_mfma_f32_16x16x32_bf16 a[244:247], v[128:131], a[20:23], a[244:247]
  buffer_load_dwordx4 v21, s[40:43], s61 offen offset:1024 lds
  v_mfma_f32_16x16x32_bf16 a[248:251], v[128:131], a[24:27], a[248:251]
  v_mfma_f32_16x16x32_bf16 a[252:255], v[128:131], a[28:31], a[252:255]
  s_mov_b64 exec, 0xffff
  buffer_load_dwordx4 v22, s[40:43], s61 offen offset:2048 lds
  s_mov_b64 exec, -1
  v_mfma_f32_16x16x32_bf16 v[240:243], v[132:135], a[16:19], v[240:243]
  v_mfma_f32_16x16x32_bf16 v[244:247], v[132:135], a[20:23], v[244:247]
  v_mfma_f32_16x16x32_bf16 v[248:251], v[132:135], a[24:27], v[248:251]
  v_mfma_f32_16x16x32_bf16 v[252:255], v[132:135], a[28:31], v[252:255]
  s_waitcnt vmcnt(24) lgkmcnt(0)
  s_barrier
  v_mfma_f32_16x16x32_bf16 a[128:131], v[64:67], a[32:35], a[128:131]
  s_xor_b32 s4, s19, 2
  ds_read_b64_tr_b16 v[100:101], v23 offset:27648
  v_mfma_f32_16x16x32_bf16 a[132:135], v[64:67], a[36:39], a[132:135]
  ds_read_b64_tr_b16 v[102:103], v23 offset:32256
  v_mfma_f32_16x16x32_bf16 a[136:139], v[64:67], a[40:43], a[136:139]
  s_lshl2_add_u32 s4, s4, 3
  v_mfma_f32_16x16x32_bf16 a[140:143], v[64:67], a[44:47], a[140:143]
  ds_read_b64_tr_b16 v[104:105], v23 offset:27680
  v_mfma_f32_16x16x32_bf16 a[144:147], v[68:71], a[32:35], a[144:147]
  s_lshl_b32 s4, s4, 17
  ds_read_b64_tr_b16 v[106:107], v23 offset:32288
  v_mfma_f32_16x16x32_bf16 a[148:151], v[68:71], a[36:39], a[148:151]
  v_mfma_f32_16x16x32_bf16 a[152:155], v[68:71], a[40:43], a[152:155]
  s_add_u32 s62, s4, s63
  ds_read_b64_tr_b16 v[108:109], v23 offset:27712
  v_mfma_f32_16x16x32_bf16 a[156:159], v[68:71], a[44:47], a[156:159]
  v_mfma_f32_16x16x32_bf16 a[160:163], v[72:75], a[32:35], a[160:163]
  ds_read_b64_tr_b16 v[110:111], v23 offset:32320
  v_mfma_f32_16x16x32_bf16 a[164:167], v[72:75], a[36:39], a[164:167]
  buffer_load_dwordx4 a[96:99], v3, s[12:15], s62 offen offset:0 sc1
  ds_read_b64_tr_b16 v[112:113], v23 offset:27744
  v_mfma_f32_16x16x32_bf16 a[168:171], v[72:75], a[40:43], a[168:171]
  v_mfma_f32_16x16x32_bf16 a[172:175], v[72:75], a[44:47], a[172:175]
  buffer_load_dwordx4 a[100:103], v3, s[12:15], s62 offen offset:1024 sc1
  ds_read_b64_tr_b16 v[114:115], v23 offset:32352
  v_mfma_f32_16x16x32_bf16 a[176:179], v[76:79], a[32:35], a[176:179]
  ds_read_b64_tr_b16 v[116:117], v23 offset:27776
  v_mfma_f32_16x16x32_bf16 a[180:183], v[76:79], a[36:39], a[180:183]
  buffer_load_dwordx4 a[104:107], v3, s[12:15], s62 offen offset:2048 sc1
  v_mfma_f32_16x16x32_bf16 a[184:187], v[76:79], a[40:43], a[184:187]
  ds_read_b64_tr_b16 v[118:119], v23 offset:32384
  v_mfma_f32_16x16x32_bf16 a[188:191], v[76:79], a[44:47], a[188:191]
  buffer_load_dwordx4 a[108:111], v3, s[12:15], s62 offen offset:3072 sc1
  v_mfma_f32_16x16x32_bf16 a[192:195], v[80:83], a[32:35], a[192:195]
  ds_read_b64_tr_b16 v[120:121], v23 offset:27808
  v_mfma_f32_16x16x32_bf16 a[196:199], v[80:83], a[36:39], a[196:199]
  ds_read_b64_tr_b16 v[122:123], v23 offset:32416
  v_mfma_f32_16x16x32_bf16 a[200:203], v[80:83], a[40:43], a[200:203]
  s_add_u32 s3, s99, 4
  v_mfma_f32_16x16x32_bf16 a[204:207], v[80:83], a[44:47], a[204:207]
  ds_read_b64_tr_b16 v[124:125], v23 offset:27840
  v_mfma_f32_16x16x32_bf16 a[208:211], v[84:87], a[32:35], a[208:211]
  s_lshl2_add_u32 s3, s3, 1
  ds_read_b64_tr_b16 v[126:127], v23 offset:32448
  v_mfma_f32_16x16x32_bf16 a[212:215], v[84:87], a[36:39], a[212:215]
  v_mfma_f32_16x16x32_bf16 a[216:219], v[84:87], a[40:43], a[216:219]
  s_mul_i32 s61, s3, 36864
  ds_read_b64_tr_b16 v[128:129], v23 offset:27872
  v_mfma_f32_16x16x32_bf16 a[220:223], v[84:87], a[44:47], a[220:223]
  v_mfma_f32_16x16x32_bf16 a[224:227], v[88:91], a[32:35], a[224:227]
  s_add_u32 m0, s60, 18432
  ds_read_b64_tr_b16 v[130:131], v23 offset:32480
  v_mfma_f32_16x16x32_bf16 a[228:231], v[88:91], a[36:39], a[228:231]
  ds_read_b64_tr_b16 v[132:133], v23 offset:27904
  v_mfma_f32_16x16x32_bf16 a[232:235], v[88:91], a[40:43], a[232:235]
  v_mfma_f32_16x16x32_bf16 a[236:239], v[88:91], a[44:47], a[236:239]
  buffer_load_dwordx4 v20, s[40:43], s61 offen lds
  ds_read_b64_tr_b16 v[134:135], v23 offset:32512
  v_mfma_f32_16x16x32_bf16 a[240:243], v[92:95], a[32:35], a[240:243]
  v_mfma_f32_16x16x32_bf16 a[244:247], v[92:95], a[36:39], a[244:247]
  buffer_load_dwordx4 v21, s[40:43], s61 offen offset:1024 lds
  v_mfma_f32_16x16x32_bf16 a[248:251], v[92:95], a[40:43], a[248:251]
  v_mfma_f32_16x16x32_bf16 a[252:255], v[92:95], a[44:47], a[252:255]
  s_mov_b64 exec, 0xffff
  buffer_load_dwordx4 v22, s[40:43], s61 offen offset:2048 lds
  s_mov_b64 exec, -1
  v_mfma_f32_16x16x32_bf16 v[240:243], v[96:99], a[32:35], v[240:243]
  v_mfma_f32_16x16x32_bf16 v[244:247], v[96:99], a[36:39], v[244:247]
  v_mfma_f32_16x16x32_bf16 v[248:251], v[96:99], a[40:43], v[248:251]
  v_mfma_f32_16x16x32_bf16 v[252:255], v[96:99], a[44:47], v[252:255]
  s_waitcnt vmcnt(24) lgkmcnt(0)
  s_barrier
  v_mfma_f32_16x16x32_bf16 a[128:131], v[100:103], a[48:51], a[128:131]
  buffer_load_dword v25, v24, s[12:15], s55 offen sc1
  ds_read_b64_tr_b16 v[64:65], v23 offset:36864
  v_mfma_f32_16x16x32_bf16 a[132:135], v[100:103], a[52:55], a[132:135]
  ds_read_b64_tr_b16 v[66:67], v23 offset:41472
  v_mfma_f32_16x16x32_bf16 a[136:139], v[100:103], a[56:59], a[136:139]
  s_xor_b32 s4, s19, 3
  v_mfma_f32_16x16x32_bf16 a[140:143], v[100:103], a[60:63], a[140:143]
  ds_read_b64_tr_b16 v[68:69], v23 offset:36896
  v_mfma_f32_16x16x32_bf16 a[144:147], v[104:107], a[48:51], a[144:147]
  s_lshl2_add_u32 s4, s4, 3
  ds_read_b64_tr_b16 v[70:71], v23 offset:41504
  v_mfma_f32_16x16x32_bf16 a[148:151], v[104:107], a[52:55], a[148:151]
  v_mfma_f32_16x16x32_bf16 a[152:155], v[104:107], a[56:59], a[152:155]
  s_lshl_b32 s4, s4, 17
  ds_read_b64_tr_b16 v[72:73], v23 offset:36928
  v_mfma_f32_16x16x32_bf16 a[156:159], v[104:107], a[60:63], a[156:159]
  v_mfma_f32_16x16x32_bf16 a[160:163], v[108:111], a[48:51], a[160:163]
  s_add_u32 s62, s4, s63
  ds_read_b64_tr_b16 v[74:75], v23 offset:41536
  v_mfma_f32_16x16x32_bf16 a[164:167], v[108:111], a[52:55], a[164:167]
  ds_read_b64_tr_b16 v[76:77], v23 offset:36960
  v_mfma_f32_16x16x32_bf16 a[168:171], v[108:111], a[56:59], a[168:171]
  buffer_load_dwordx4 a[112:115], v3, s[12:15], s62 offen offset:0 sc1
  v_mfma_f32_16x16x32_bf16 a[172:175], v[108:111], a[60:63], a[172:175]
  ds_read_b64_tr_b16 v[78:79], v23 offset:41568
  v_mfma_f32_16x16x32_bf16 a[176:179], v[112:115], a[48:51], a[176:179]
  buffer_load_dwordx4 a[116:119], v3, s[12:15], s62 offen offset:1024 sc1
  ds_read_b64_tr_b16 v[80:81], v23 offset:36992
  v_mfma_f32_16x16x32_bf16 a[180:183], v[112:115], a[52:55], a[180:183]
  v_mfma_f32_16x16x32_bf16 a[184:187], v[112:115], a[56:59], a[184:187]
  buffer_load_dwordx4 a[120:123], v3, s[12:15], s62 offen offset:2048 sc1
  ds_read_b64_tr_b16 v[82:83], v23 offset:41600
  v_mfma_f32_16x16x32_bf16 a[188:191], v[112:115], a[60:63], a[188:191]
  v_mfma_f32_16x16x32_bf16 a[192:195], v[116:119], a[48:51], a[192:195]
  ds_read_b64_tr_b16 v[84:85], v23 offset:37024
  v_mfma_f32_16x16x32_bf16 a[196:199], v[116:119], a[52:55], a[196:199]
  buffer_load_dwordx4 a[124:127], v3, s[12:15], s62 offen offset:3072 sc1
  ds_read_b64_tr_b16 v[86:87], v23 offset:41632
  v_mfma_f32_16x16x32_bf16 a[200:203], v[116:119], a[56:59], a[200:203]
  v_mfma_f32_16x16x32_bf16 a[204:207], v[116:119], a[60:63], a[204:207]
  s_add_u32 s3, s99, 5
  ds_read_b64_tr_b16 v[88:89], v23 offset:37056
  v_mfma_f32_16x16x32_bf16 a[208:211], v[120:123], a[48:51], a[208:211]
  ds_read_b64_tr_b16 v[90:91], v23 offset:41664
  v_mfma_f32_16x16x32_bf16 a[212:215], v[120:123], a[52:55], a[212:215]
  s_lshl2_add_u32 s3, s3, 1
  v_mfma_f32_16x16x32_bf16 a[216:219], v[120:123], a[56:59], a[216:219]
  ds_read_b64_tr_b16 v[92:93], v23 offset:37088
  v_mfma_f32_16x16x32_bf16 a[220:223], v[120:123], a[60:63], a[220:223]
  s_mul_i32 s61, s3, 36864
  v_mfma_f32_16x16x32_bf16 a[224:227], v[124:127], a[48:51], a[224:227]
  ds_read_b64_tr_b16 v[94:95], v23 offset:41696
  v_mfma_f32_16x16x32_bf16 a[228:231], v[124:127], a[52:55], a[228:231]
  s_add_u32 m0, s60, 27648
  ds_read_b64_tr_b16 v[96:97], v23 offset:37120
  v_mfma_f32_16x16x32_bf16 a[232:235], v[124:127], a[56:59], a[232:235]
  v_mfma_f32_16x16x32_bf16 a[236:239], v[124:127], a[60:63], a[236:239]
  buffer_load_dwordx4 v20, s[40:43], s61 offen lds
  ds_read_b64_tr_b16 v[98:99], v23 offset:41728
  v_mfma_f32_16x16x32_bf16 a[240:243], v[128:131], a[48:51], a[240:243]
  v_mfma_f32_16x16x32_bf16 a[244:247], v[128:131], a[52:55], a[244:247]
  buffer_load_dwordx4 v21, s[40:43], s61 offen offset:1024 lds
  v_mfma_f32_16x16x32_bf16 a[248:251], v[128:131], a[56:59], a[248:251]
  v_mfma_f32_16x16x32_bf16 a[252:255], v[128:131], a[60:63], a[252:255]
  s_mov_b64 exec, 0xffff
  buffer_load_dwordx4 v22, s[40:43], s61 offen offset:2048 lds
  s_mov_b64 exec, -1
  v_mfma_f32_16x16x32_bf16 v[240:243], v[132:135], a[48:51], v[240:243]
  v_mfma_f32_16x16x32_bf16 v[244:247], v[132:135], a[52:55], v[244:247]
  v_mfma_f32_16x16x32_bf16 v[248:251], v[132:135], a[56:59], v[248:251]
  v_mfma_f32_16x16x32_bf16 v[252:255], v[132:135], a[60:63], v[252:255]
  s_waitcnt vmcnt(25) lgkmcnt(0)
  s_barrier
  v_mfma_f32_16x16x32_bf16 a[128:131], v[64:67], a[64:67], a[128:131]
  s_waitcnt vmcnt(7)
  v_cmp_gt_u32 s[6:7], 2, v25
  s_cmp_lg_u64 s[6:7], 0
  s_cbranch_scc1 SP_pO20
RT_pO20:
  v_mfma_f32_16x16x32_bf16 a[132:135], v[64:67], a[68:71], a[132:135]
  ds_read_b64_tr_b16 v[100:101], v23 offset:46080
  ds_read_b64_tr_b16 v[102:103], v23 offset:50688
  v_mfma_f32_16x16x32_bf16 a[136:139], v[64:67], a[72:75], a[136:139]
  s_add_u32 s4, s99, 4
  v_mfma_f32_16x16x32_bf16 a[140:143], v[64:67], a[76:79], a[140:143]
  ds_read_b64_tr_b16 v[104:105], v23 offset:46112
  v_mfma_f32_16x16x32_bf16 a[144:147], v[68:71], a[64:67], a[144:147]
  s_lshl2_add_u32 s4, s4, 1
  ds_read_b64_tr_b16 v[106:107], v23 offset:50720
  v_mfma_f32_16x16x32_bf16 a[148:151], v[68:71], a[68:71], a[148:151]
  v_mfma_f32_16x16x32_bf16 a[152:155], v[68:71], a[72:75], a[152:155]
  s_lshl_b32 s4, s4, 17
  ds_read_b64_tr_b16 v[108:109], v23 offset:46144
  v_mfma_f32_16x16x32_bf16 a[156:159], v[68:71], a[76:79], a[156:159]
  v_mfma_f32_16x16x32_bf16 a[160:163], v[72:75], a[64:67], a[160:163]
  s_add_u32 s62, s4, s63
  ds_read_b64_tr_b16 v[110:111], v23 offset:50752
  v_mfma_f32_16x16x32_bf16 a[164:167], v[72:75], a[68:71], a[164:167]
  ds_read_b64_tr_b16 v[112:113], v23 offset:46176
  v_mfma_f32_16x16x32_bf16 a[168:171], v[72:75], a[72:75], a[168:171]
  buffer_load_dwordx4 a[0:3], v3, s[12:15], s62 offen offset:0 sc1
  v_mfma_f32_16x16x32_bf16 a[172:175], v[72:75], a[76:79], a[172:175]
  ds_read_b64_tr_b16 v[114:115], v23 offset:50784
  v_mfma_f32_16x16x32_bf16 a[176:179], v[76:79], a[64:67], a[176:179]
  buffer_load_dwordx4 a[4:7], v3, s[12:15], s62 offen offset:1024 sc1
  ds_read_b64_tr_b16 v[116:117], v23 offset:46208
  v_mfma_f32_16x16x32_bf16 a[180:183], v[76:79], a[68:71], a[180:183]
  v_mfma_f32_16x16x32_bf16 a[184:187], v[76:79], a[72:75], a[184:187]
  buffer_load_dwordx4 a[8:11], v3, s[12:15], s62 offen offset:2048 sc1
  ds_read_b64_tr_b16 v[118:119], v23 offset:50816
  v_mfma_f32_16x16x32_bf16 a[188:191], v[76:79], a[76:79], a[188:191]
  v_mfma_f32_16x16x32_bf16 a[192:195], v[80:83], a[64:67], a[192:195]
  ds_read_b64_tr_b16 v[120:121], v23 offset:46240
  v_mfma_f32_16x16x32_bf16 a[196:199], v[80:83], a[68:71], a[196:199]
  buffer_load_dwordx4 a[12:15], v3, s[12:15], s62 offen offset:3072 sc1
  ds_read_b64_tr_b16 v[122:123], v23 offset:50848
  v_mfma_f32_16x16x32_bf16 a[200:203], v[80:83], a[72:75], a[200:203]
  v_mfma_f32_16x16x32_bf16 a[204:207], v[80:83], a[76:79], a[204:207]
  s_add_u32 s3, s99, 6
  ds_read_b64_tr_b16 v[124:125], v23 offset:46272
  v_mfma_f32_16x16x32_bf16 a[208:211], v[84:87], a[64:67], a[208:211]
  ds_read_b64_tr_b16 v[126:127], v23 offset:50880
  v_mfma_f32_16x16x32_bf16 a[212:215], v[84:87], a[68:71], a[212:215]
  s_lshl2_add_u32 s3, s3, 1
  v_mfma_f32_16x16x32_bf16 a[216:219], v[84:87], a[72:75], a[216:219]
  ds_read_b64_tr_b16 v[128:129], v23 offset:46304
  v_mfma_f32_16x16x32_bf16 a[220:223], v[84:87], a[76:79], a[220:223]
  s_mul_i32 s61, s3, 36864
  v_mfma_f32_16x16x32_bf16 a[224:227], v[88:91], a[64:67], a[224:227]
  ds_read_b64_tr_b16 v[130:131], v23 offset:50912
  v_mfma_f32_16x16x32_bf16 a[228:231], v[88:91], a[68:71], a[228:231]
  s_add_u32 m0, s60, 36864
  ds_read_b64_tr_b16 v[132:133], v23 offset:46336
  v_mfma_f32_16x16x32_bf16 a[232:235], v[88:91], a[72:75], a[232:235]
  v_mfma_f32_16x16x32_bf16 a[236:239], v[88:91], a[76:79], a[236:239]
  buffer_load_dwordx4 v20, s[40:43], s61 offen lds
  ds_read_b64_tr_b16 v[134:135], v23 offset:50944
  v_mfma_f32_16x16x32_bf16 a[240:243], v[92:95], a[64:67], a[240:243]
  v_mfma_f32_16x16x32_bf16 a[244:247], v[92:95], a[68:71], a[244:247]
  buffer_load_dwordx4 v21, s[40:43], s61 offen offset:1024 lds
  v_mfma_f32_16x16x32_bf16 a[248:251], v[92:95], a[72:75], a[248:251]
  v_mfma_f32_16x16x32_bf16 a[252:255], v[92:95], a[76:79], a[252:255]
  s_mov_b64 exec, 0xffff
  buffer_load_dwordx4 v22, s[40:43], s61 offen offset:2048 lds
  s_mov_b64 exec, -1
  v_mfma_f32_16x16x32_bf16 v[240:243], v[96:99], a[64:67], v[240:243]
  v_mfma_f32_16x16x32_bf16 v[244:247], v[96:99], a[68:71], v[244:247]
  v_mfma_f32_16x16x32_bf16 v[248:251], v[96:99], a[72:75], v[248:251]
  v_mfma_f32_16x16x32_bf16 v[252:255], v[96:99], a[76:79], v[252:255]
  s_waitcnt lgkmcnt(0)
  s_barrier
  v_mfma_f32_16x16x32_bf16 a[128:131], v[100:103], a[80:83], a[128:131]
  s_add_u32 s4, s99, 5
  ds_read_b64_tr_b16 v[64:65], v23 offset:0
  v_mfma_f32_16x16x32_bf16 a[132:135], v[100:103], a[84:87], a[132:135]
  ds_read_b64_tr_b16 v[66:67], v23 offset:4608
  v_mfma_f32_16x16x32_bf16 a[136:139], v[100:103], a[88:91], a[136:139]
  s_lshl2_add_u32 s4, s4, 1
  v_mfma_f32_16x16x32_bf16 a[140:143], v[100:103], a[92:95], a[140:143]
  ds_read_b64_tr_b16 v[68:69], v23 offset:32
  v_mfma_f32_16x16x32_bf16 a[144:147], v[104:107], a[80:83], a[144:147]
  s_lshl_b32 s4, s4, 17
  ds_read_b64_tr_b16 v[70:71], v23 offset:4640
  v_mfma_f32_16x16x32_bf16 a[148:151], v[104:107], a[84:87], a[148:151]
  v_mfma_f32_16x16x32_bf16 a[152:155], v[104:107], a[88:91], a[152:155]
  s_add_u32 s62, s4, s63
  ds_read_b64_tr_b16 v[72:73], v23 offset:64
  v_mfma_f32_16x16x32_bf16 a[156:159], v[104:107], a[92:95], a[156:159]
  v_mfma_f32_16x16x32_bf16 a[160:163], v[108:111], a[80:83], a[160:163]
  ds_read_b64_tr_b16 v[74:75], v23 offset:4672
  v_mfma_f32_16x16x32_bf16 a[164:167], v[108:111], a[84:87], a[164:167]
  buffer_load_dwordx4 a[16:19], v3, s[12:15], s62 offen offset:0 sc1
  ds_read_b64_tr_b16 v[76:77], v23 offset:96
  v_mfma_f32_16x16x32_bf16 a[168:171], v[108:111], a[88:91], a[168:171]
  v_mfma_f32_16x16x32_bf16 a[172:175], v[108:111], a[92:95], a[172:175]
  buffer_load_dwordx4 a[20:23], v3, s[12:15], s62 offen offset:1024 sc1
  ds_read_b64_tr_b16 v[78:79], v23 offset:4704
  v_mfma_f32_16x16x32_bf16 a[176:179], v[112:115], a[80:83], a[176:179]
  ds_read_b64_tr_b16 v[80:81], v23 offset:128
  v_mfma_f32_16x16x32_bf16 a[180:183], v[112:115], a[84:87], a[180:183]
  buffer_load_dwordx4 a[24:27], v3, s[12:15], s62 offen offset:2048 sc1
  v_mfma_f32_16x16x32_bf16 a[184:187], v[112:115], a[88:91], a[184:187]
  ds_read_b64_tr_b16 v[82:83], v23 offset:4736
  v_mfma_f32_16x16x32_bf16 a[188:191], v[112:115], a[92:95], a[188:191]
  buffer_load_dwordx4 a[28:31], v3, s[12:15], s62 offen offset:3072 sc1
  v_mfma_f32_16x16x32_bf16 a[192:195], v[116:119], a[80:83], a[192:195]
  ds_read_b64_tr_b16 v[84:85], v23 offset:160
  v_mfma_f32_16x16x32_bf16 a[196:199], v[116:119], a[84:87], a[196:199]
  ds_read_b64_tr_b16 v[86:87], v23 offset:4768
  v_mfma_f32_16x16x32_bf16 a[200:203], v[116:119], a[88:91], a[200:203]
  s_add_u32 s3, s99, 7
  v_mfma_f32_16x16x32_bf16 a[204:207], v[116:119], a[92:95], a[204:207]
TP_15:
  s_cbranch_execz TP_25
  ds_read_b64_tr_b16 v[88:89], v23 offset:192
  v_mfma_f32_16x16x32_bf16 a[208:211], v[120:123], a[80:83], a[208:211]
  s_lshl2_add_u32 s3, s3, 1
  ds_read_b64_tr_b16 v[90:91], v23 offset:4800
  v_mfma_f32_16x16x32_bf16 a[212:215], v[120:123], a[84:87], a[212:215]
  v_mfma_f32_16x16x32_bf16 a[216:219], v[120:123], a[88:91], a[216:219]
  s_mul_i32 s61, s3, 36864
  ds_read_b64_tr_b16 v[92:93], v23 offset:224
  v_mfma_f32_16x16x32_bf16 a[220:223], v[120:123], a[92:95], a[220:223]
  v_mfma_f32_16x16x32_bf16 a[224:227], v[124:127], a[80:83], a[224:227]
  s_add_u32 m0, s60, 46080
  ds_read_b64_tr_b16 v[94:95], v23 offset:4832
  v_mfma_f32_16x16x32_bf16 a[228:231], v[124:127], a[84:87], a[228:231]
  ds_read_b64_tr_b16 v[96:97], v23 offset:256
  v_mfma_f32_16x16x32_bf16 a[232:235], v[124:127], a[88:91], a[232:235]
  v_mfma_f32_16x16x32_bf16 a[236:239], v[124:127], a[92:95], a[236:239]
  buffer_load_dwordx4 v20, s[40:43], s61 offen lds
  ds_read_b64_tr_b16 v[98:99], v23 offset:4864
  v_mfma_f32_16x16x32_bf16 a[240:243], v[128:131], a[80:83], a[240:243]
  v_mfma_f32_16x16x32_bf16 a[244:247], v[128:131], a[84:87], a[244:247]
  buffer_load_dwordx4 v21, s[40:43], s61 offen offset:1024 lds
  v_mfma_f32_16x16x32_bf16 a[248:251], v[128:131], a[88:91], a[248:251]
  v_mfma_f32_16x16x32_bf16 a[252:255], v[128:131], a[92:95], a[252:255]
  s_mov_b64 exec, 0xffff
  buffer_load_dwordx4 v22, s[40:43], s61 offen offset:2048 lds
  s_mov_b64 exec, -1
  v_mfma_f32_16x16x32_bf16 v[240:243], v[132:135], a[80:83], v[240:243]
  v_mfma_f32_16x16x32_bf16 v[244:247], v[132:135], a[84:87], v[244:247]
  v_mfma_f32_16x16x32_bf16 v[248:251], v[132:135], a[88:91], v[248:251]
  v_mfma_f32_16x16x32_bf16 v[252:255], v[132:135], a[92:95], v[252:255]
  s_waitcnt lgkmcnt(0)
  s_barrier
  v_mfma_f32_16x16x32_bf16 a[128:131], v[64:67], a[96:99], a[128:131]
  s_add_u32 s4, s99, 6
  ds_read_b64_tr_b16 v[100:101], v23 offset:9216
  v_mfma_f32_16x16x32_bf16 a[132:135], v[64:67], a[100:103], a[132:135]
  ds_read_b64_tr_b16 v[102:103], v23 offset:13824
  v_mfma_f32_16x16x32_bf16 a[136:139], v[64:67], a[104:107], a[136:139]
  s_lshl2_add_u32 s4, s4, 1
  v_mfma_f32_16x16x32_bf16 a[140:143], v[64:67], a[108:111], a[140:143]
  ds_read_b64_tr_b16 v[104:105], v23 offset:9248
  v_mfma_f32_16x16x32_bf16 a[144:147], v[68:71], a[96:99], a[144:147]
  s_lshl_b32 s4, s4, 17
  ds_read_b64_tr_b16 v[106:107], v23 offset:13856
  v_mfma_f32_16x16x32_bf16 a[148:151], v[68:71], a[100:103], a[148:151]
  v_mfma_f32_16x16x32_bf16 a[152:155], v[68:71], a[104:107], a[152:155]
  s_add_u32 s62, s4, s63
  ds_read_b64_tr_b16 v[108:109], v23 offset:9280
  v_mfma_f32_16x16x32_bf16 a[156:159], v[68:71], a[108:111], a[156:159]
  v_mfma_f32_16x16x32_bf16 a[160:163], v[72:75], a[96:99], a[160:163]
  ds_read_b64_tr_b16 v[110:111], v23 offset:13888
  v_mfma_f32_16x16x32_bf16 a[164:167], v[72:75], a[100:103], a[164:167]
  buffer_load_dwordx4 a[32:35], v3, s[12:15], s62 offen offset:0 sc1
  ds_read_b64_tr_b16 v[112:113], v23 offset:9312
  v_mfma_f32_16x16x32_bf16 a[168:171], v[72:75], a[104:107], a[168:171]
  v_mfma_f32_16x16x32_bf16 a[172:175], v[72:75], a[108:111], a[172:175]
  buffer_load_dwordx4 a[36:39], v3, s[12:15], s62 offen offset:1024 sc1
  ds_read_b64_tr_b16 v[114:115], v23 offset:13920
  v_mfma_f32_16x16x32_bf16 a[176:179], v[76:79], a[96:99], a[176:179]
  ds_read_b64_tr_b16 v[116:117], v23 offset:9344
  v_mfma_f32_16x16x32_bf16 a[180:183], v[76:79], a[100:103], a[180:183]
  buffer_load_dwordx4 a[40:43], v3, s[12:15], s62 offen offset:2048 sc1
  v_mfma_f32_16x16x32_bf16 a[184:187], v[76:79], a[104:107], a[184:187]
  ds_read_b64_tr_b16 v[118:119], v23 offset:13952
  v_mfma_f32_16x16x32_bf16 a[188:191], v[76:79], a[108:111], a[188:191]
  buffer_load_dwordx4 a[44:47], v3, s[12:15], s62 offen offset:3072 sc1
  v_mfma_f32_16x16x32_bf16 a[192:195], v[80:83], a[96:99], a[192:195]
  ds_read_b64_tr_b16 v[120:121], v23 offset:9376
  v_mfma_f32_16x16x32_bf16 a[196:199], v[80:83], a[100:103], a[196:199]
  ds_read_b64_tr_b16 v[122:123], v23 offset:13984
  v_mfma_f32_16x16x32_bf16 a[200:203], v[80:83], a[104:107], a[200:203]
  s_add_u32 s3, s99, 4
  v_mfma_f32_16x16x32_bf16 a[204:207], v[80:83], a[108:111], a[204:207]
  ds_read_b64_tr_b16 v[124:125], v23 offset:9408
  v_mfma_f32_16x16x32_bf16 a[208:211], v[84:87], a[96:99], a[208:211]
  s_lshl2_add_u32 s3, s3, 2
  ds_read_b64_tr_b16 v[126:127], v23 offset:14016
  v_mfma_f32_16x16x32_bf16 a[212:215], v[84:87], a[100:103], a[212:215]
  v_mfma_f32_16x16x32_bf16 a[216:219], v[84:87], a[104:107], a[216:219]
  s_mul_i32 s61, s3, 36864
  ds_read_b64_tr_b16 v[128:129], v23 offset:9440
  v_mfma_f32_16x16x32_bf16 a[220:223], v[84:87], a[108:111], a[220:223]
  v_mfma_f32_16x16x32_bf16 a[224:227], v[88:91], a[96:99], a[224:227]
  s_add_u32 m0, s60, 0
  ds_read_b64_tr_b16 v[130:131], v23 offset:14048
  v_mfma_f32_16x16x32_bf16 a[228:231], v[88:91], a[100:103], a[228:231]
  ds_read_b64_tr_b16 v[132:133], v23 offset:9472
  v_mfma_f32_16x16x32_bf16 a[232:235], v[88:91], a[104:107], a[232:235]
  v_mfma_f32_16x16x32_bf16 a[236:239], v[88:91], a[108:111], a[236:239]
  buffer_load_dwordx4 v20, s[40:43], s61 offen lds
  ds_read_b64_tr_b16 v[134:135], v23 offset:14080
  v_mfma_f32_16x16x32_bf16 a[240:243], v[92:95], a[96:99], a[240:243]
  v_mfma_f32_16x16x32_bf16 a[244:247], v[92:95], a[100:103], a[244:247]
  buffer_load_dwordx4 v21, s[40:43], s61 offen offset:1024 lds
  v_mfma_f32_16x16x32_bf16 a[248:251], v[92:95], a[104:107], a[248:251]
  v_mfma_f32_16x16x32_bf16 a[252:255], v[92:95], a[108:111], a[252:255]
  s_mov_b64 exec, 0xffff
  buffer_load_dwordx4 v22, s[40:43], s61 offen offset:2048 lds
  s_mov_b64 exec, -1
  v_mfma_f32_16x16x32_bf16 v[240:243], v[96:99], a[96:99], v[240:243]
  v_mfma_f32_16x16x32_bf16 v[244:247], v[96:99], a[100:103], v[244:247]
  v_mfma_f32_16x16x32_bf16 v[248:251], v[96:99], a[104:107], v[248:251]
  v_mfma_f32_16x16x32_bf16 v[252:255], v[96:99], a[108:111], v[252:255]
  s_waitcnt vmcnt(24) lgkmcnt(0)
  s_barrier
  v_mfma_f32_16x16x32_bf16 a[128:131], v[100:103], a[112:115], a[128:131]
  buffer_load_dword v25, v24, s[12:15], s55 offen sc1
  ds_read_b64_tr_b16 v[64:65], v23 offset:18432
  v_mfma_f32_16x16x32_bf16 a[132:135], v[100:103], a[116:119], a[132:135]
  ds_read_b64_tr_b16 v[66:67], v23 offset:23040
  v_mfma_f32_16x16x32_bf16 a[136:139], v[100:103], a[120:123], a[136:139]
  s_add_u32 s4, s99, 7
  v_mfma_f32_16x16x32_bf16 a[140:143], v[100:103], a[124:127], a[140:143]
  ds_read_b64_tr_b16 v[68:69], v23 offset:18464
  v_mfma_f32_16x16x32_bf16 a[144:147], v[104:107], a[112:115], a[144:147]
  s_lshl2_add_u32 s4, s4, 1
  ds_read_b64_tr_b16 v[70:71], v23 offset:23072
  v_mfma_f32_16x16x32_bf16 a[148:151], v[104:107], a[116:119], a[148:151]
  v_mfma_f32_16x16x32_bf16 a[152:155], v[104:107], a[120:123], a[152:155]
  s_lshl_b32 s4, s4, 17
  ds_read_b64_tr_b16 v[72:73], v23 offset:18496
  v_mfma_f32_16x16x32_bf16 a[156:159], v[104:107], a[124:127], a[156:159]
  v_mfma_f32_16x16x32_bf16 a[160:163], v[108:111], a[112:115], a[160:163]
  s_add_u32 s62, s4, s63
  ds_read_b64_tr_b16 v[74:75], v23 offset:23104
  v_mfma_f32_16x16x32_bf16 a[164:167], v[108:111], a[116:119], a[164:167]
  ds_read_b64_tr_b16 v[76:77], v23 offset:18528
  v_mfma_f32_16x16x32_bf16 a[168:171], v[108:111], a[120:123], a[168:171]
  buffer_load_dwordx4 a[48:51], v3, s[12:15], s62 offen offset:0 sc1
  v_mfma_f32_16x16x32_bf16 a[172:175], v[108:111], a[124:127], a[172:175]
  ds_read_b64_tr_b16 v[78:79], v23 offset:23136
  v_mfma_f32_16x16x32_bf16 a[176:179], v[112:115], a[112:115], a[176:179]
  buffer_load_dwordx4 a[52:55], v3, s[12:15], s62 offen offset:1024 sc1
  ds_read_b64_tr_b16 v[80:81], v23 offset:18560
  v_mfma_f32_16x16x32_bf16 a[180:183], v[112:115], a[116:119], a[180:183]
  v_mfma_f32_16x16x32_bf16 a[184:187], v[112:115], a[120:123], a[184:187]
  buffer_load_dwordx4 a[56:59], v3, s[12:15], s62 offen offset:2048 sc1
  ds_read_b64_tr_b16 v[82:83], v23 offset:23168
  v_mfma_f32_16x16x32_bf16 a[188:191], v[112:115], a[124:127], a[188:191]
  v_mfma_f32_16x16x32_bf16 a[192:195], v[116:119], a[112:115], a[192:195]
  ds_read_b64_tr_b16 v[84:85], v23 offset:18592
  v_mfma_f32_16x16x32_bf16 a[196:199], v[116:119], a[116:119], a[196:199]
  buffer_load_dwordx4 a[60:63], v3, s[12:15], s62 offen offset:3072 sc1
  ds_read_b64_tr_b16 v[86:87], v23 offset:23200
  v_mfma_f32_16x16x32_bf16 a[200:203], v[116:119], a[120:123], a[200:203]
  v_mfma_f32_16x16x32_bf16 a[204:207], v[116:119], a[124:127], a[204:207]
  s_add_u32 s3, s99, 5
  ds_read_b64_tr_b16 v[88:89], v23 offset:18624
  v_mfma_f32_16x16x32_bf16 a[208:211], v[120:123], a[112:115], a[208:211]
  ds_read_b64_tr_b16 v[90:91], v23 offset:23232
  v_mfma_f32_16x16x32_bf16 a[212:215], v[120:123], a[116:119], a[212:215]
  s_lshl2_add_u32 s3, s3, 2
  v_mfma_f32_16x16x32_bf16 a[216:219], v[120:123], a[120:123], a[216:219]
  ds_read_b64_tr_b16 v[92:93], v23 offset:18656
  v_mfma_f32_16x16x32_bf16 a[220:223], v[120:123], a[124:127], a[220:223]
  s_mul_i32 s61, s3, 36864
  v_mfma_f32_16x16x32_bf16 a[224:227], v[124:127], a[112:115], a[224:227]
  ds_read_b64_tr_b16 v[94:95], v23 offset:23264
  v_mfma_f32_16x16x32_bf16 a[228:231], v[124:127], a[116:119], a[228:231]
  s_add_u32 m0, s60, 9216
  ds_read_b64_tr_b16 v[96:97], v23 offset:18688
  v_mfma_f32_16x16x32_bf16 a[232:235], v[124:127], a[120:123], a[232:235]
  v_mfma_f32_16x16x32_bf16 a[236:239], v[124:127], a[124:127], a[236:239]
  buffer_load_dwordx4 v20, s[40:43], s61 offen lds
  ds_read_b64_tr_b16 v[98:99], v23 offset:23296
  v_mfma_f32_16x16x32_bf16 a[240:243], v[128:131], a[112:115], a[240:243]
  v_mfma_f32_16x16x32_bf16 a[244:247], v[128:131], a[116:119], a[244:247]
  buffer_load_dwordx4 v21, s[40:43], s61 offen offset:1024 lds
  v_mfma_f32_16x16x32_bf16 a[248:251], v[128:131], a[120:123], a[248:251]
  v_mfma_f32_16x16x32_bf16 a[252:255], v[128:131], a[124:127], a[252:255]
  s_mov_b64 exec, 0xffff
  buffer_load_dwordx4 v22, s[40:43], s61 offen offset:2048 lds
  s_mov_b64 exec, -1
  v_mfma_f32_16x16x32_bf16 v[240:243], v[132:135], a[112:115], v[240:243]
  v_mfma_f32_16x16x32_bf16 v[244:247], v[132:135], a[116:119], v[244:247]
  v_mfma_f32_16x16x32_bf16 v[248:251], v[132:135], a[120:123], v[248:251]
  v_mfma_f32_16x16x32_bf16 v[252:255], v[132:135], a[124:127], v[252:255]
  s_waitcnt vmcnt(25) lgkmcnt(0)
  s_barrier
  v_mfma_f32_16x16x32_bf16 a[128:131], v[64:67], a[0:3], a[128:131]
  s_waitcnt vmcnt(7)
  v_cmp_gt_u32 s[6:7], 3, v25
  s_cmp_lg_u64 s[6:7], 0
  s_cbranch_scc1 SP_pO24
RT_pO24:
  v_mfma_f32_16x16x32_bf16 a[132:135], v[64:67], a[4:7], a[132:135]
  s_lshl_b32 s92, s17, 3
  ds_read_b64_tr_b16 v[100:101], v23 offset:27648
  ds_read_b64_tr_b16 v[102:103], v23 offset:32256
  v_mfma_f32_16x16x32_bf16 a[136:139], v[64:67], a[8:11], a[136:139]
  s_add_u32 s4, s99, 4
  s_lshl_b32 s93, s18, 1
  s_add_u32 s92, s92, s93
  v_mfma_f32_16x16x32_bf16 a[140:143], v[64:67], a[12:15], a[140:143]
  s_lshl_b32 s92, s92, 3
  s_add_u32 s92, s92, s16
  ds_read_b64_tr_b16 v[104:105], v23 offset:27680
  v_mfma_f32_16x16x32_bf16 a[144:147], v[68:71], a[0:3], a[144:147]
  s_lshl2_add_u32 s4, s4, 2
  s_mul_i32 s92, s92, 9216
  ds_read_b64_tr_b16 v[106:107], v23 offset:32288
  v_mfma_f32_16x16x32_bf16 a[148:151], v[68:71], a[4:7], a[148:151]
  s_add_u32 s92, s92, 27262976
  s_add_u32 s93, s92, 73728
  v_mov_b32 v44, v3
  v_mfma_f32_16x16x32_bf16 a[152:155], v[68:71], a[8:11], a[152:155]
  s_lshl_b32 s4, s4, 17
  ds_read_b64_tr_b16 v[108:109], v23 offset:27712
  v_add_u32 v45, 4096, v3
  v_mfma_f32_16x16x32_bf16 a[156:159], v[68:71], a[12:15], a[156:159]
  v_add_u32 v46, 8192, v3
  v_mfma_f32_16x16x32_bf16 a[160:163], v[72:75], a[0:3], a[160:163]
  s_add_u32 s62, s4, s63
  s_lshr_b32 s56, s17, 2
  ds_read_b64_tr_b16 v[110:111], v23 offset:32320
  v_mfma_f32_16x16x32_bf16 a[164:167], v[72:75], a[4:7], a[164:167]
  s_lshl_b32 s56, s56, 8
  s_lshl_b32 s57, s16, 5
  ds_read_b64_tr_b16 v[112:113], v23 offset:27744
  v_mfma_f32_16x16x32_bf16 a[168:171], v[72:75], a[8:11], a[168:171]
  s_add_u32 s56, s56, s57
  s_and_b32 s57, s17, 3
  buffer_load_dwordx4 a[64:67], v3, s[12:15], s62 offen offset:0 sc1
  v_mfma_f32_16x16x32_bf16 a[172:175], v[72:75], a[12:15], a[172:175]
  s_mul_i32 s57, s57, 288
  s_lshl_b32 s58, s17, 3
  ds_read_b64_tr_b16 v[114:115], v23 offset:32352
  v_mfma_f32_16x16x32_bf16 a[176:179], v[76:79], a[0:3], a[176:179]
  s_add_u32 s58, s58, s16
  buffer_load_dwordx4 a[68:71], v3, s[12:15], s62 offen offset:1024 sc1
  ds_read_b64_tr_b16 v[116:117], v23 offset:27776
  v_mfma_f32_16x16x32_bf16 a[180:183], v[76:79], a[4:7], a[180:183]
  s_mul_i32 s58, s58, 73728
  s_add_u32 s58, s58, 27262976
  s_lshl_b32 s59, s17, 7
  v_mfma_f32_16x16x32_bf16 a[184:187], v[76:79], a[8:11], a[184:187]
  s_add_u32 s59, s59, 26288128
  buffer_load_dwordx4 a[72:75], v3, s[12:15], s62 offen offset:2048 sc1
  ds_read_b64_tr_b16 v[118:119], v23 offset:32384
  v_mfma_f32_16x16x32_bf16 a[188:191], v[76:79], a[12:15], a[188:191]
  s_lshl_b32 s94, s16, 2
  s_add_u32 s94, s59, s94
  s_add_u32 s95, s59, 16
  v_mfma_f32_16x16x32_bf16 a[192:195], v[80:83], a[0:3], a[192:195]
  ds_read_b64_tr_b16 v[120:121], v23 offset:27808
  v_add_u32 v4, 0, v0
  v_mfma_f32_16x16x32_bf16 a[196:199], v[80:83], a[4:7], a[196:199]
  buffer_load_dwordx4 a[76:79], v3, s[12:15], s62 offen offset:3072 sc1
  ds_read_b64_tr_b16 v[122:123], v23 offset:32416
  v_mfma_f32_16x16x32_bf16 a[200:203], v[80:83], a[8:11], a[200:203]
  v_mul_u32_u24 v5, 3641, v4
  v_lshrrev_b32 v5, 16, v5
  v_mfma_f32_16x16x32_bf16 a[204:207], v[80:83], a[12:15], a[204:207]
  s_add_u32 s3, s99, 6
  ds_read_b64_tr_b16 v[124:125], v23 offset:27840
  v_mul_u32_u24 v6, 18, v5
  v_mfma_f32_16x16x32_bf16 a[208:211], v[84:87], a[0:3], a[208:211]
  ds_read_b64_tr_b16 v[126:127], v23 offset:32448
  v_sub_u32 v6, v4, v6
  v_mfma_f32_16x16x32_bf16 a[212:215], v[84:87], a[4:7], a[212:215]
  s_lshl2_add_u32 s3, s3, 2
  v_add_u32 v5, s56, v5
  v_mul_u32_u24 v5, 1152, v5
  v_mfma_f32_16x16x32_bf16 a[216:219], v[84:87], a[8:11], a[216:219]
  ds_read_b64_tr_b16 v[128:129], v23 offset:27872
  v_lshl_add_u32 v16, v6, 4, v5
  v_mfma_f32_16x16x32_bf16 a[220:223], v[84:87], a[12:15], a[220:223]
  s_mul_i32 s61, s3, 36864
  v_add_u32 v4, 256, v0
  v_mul_u32_u24 v5, 3641, v4
  v_mfma_f32_16x16x32_bf16 a[224:227], v[88:91], a[0:3], a[224:227]
  ds_read_b64_tr_b16 v[130:131], v23 offset:32480
  v_lshrrev_b32 v5, 16, v5
  v_mfma_f32_16x16x32_bf16 a[228:231], v[88:91], a[4:7], a[228:231]
  s_add_u32 m0, s60, 18432
  ds_read_b64_tr_b16 v[132:133], v23 offset:27904
  v_mul_u32_u24 v6, 18, v5
  v_mfma_f32_16x16x32_bf16 a[232:235], v[88:91], a[8:11], a[232:235]
  v_sub_u32 v6, v4, v6
  v_add_u32 v5, s56, v5
  v_mfma_f32_16x16x32_bf16 a[236:239], v[88:91], a[12:15], a[236:239]
  buffer_load_dwordx4 v20, s[40:43], s61 offen lds
  ds_read_b64_tr_b16 v[134:135], v23 offset:32512
  v_mfma_f32_16x16x32_bf16 a[240:243], v[92:95], a[0:3], a[240:243]
  v_mul_u32_u24 v5, 1152, v5
  v_lshl_add_u32 v17, v6, 4, v5
  v_mfma_f32_16x16x32_bf16 a[244:247], v[92:95], a[4:7], a[244:247]
  buffer_load_dwordx4 v21, s[40:43], s61 offen offset:1024 lds
  v_add_u32 v4, 512, v0
  v_mfma_f32_16x16x32_bf16 a[248:251], v[92:95], a[8:11], a[248:251]
  v_mul_u32_u24 v5, 3641, v4
  v_lshrrev_b32 v5, 16, v5
  v_mfma_f32_16x16x32_bf16 a[252:255], v[92:95], a[12:15], a[252:255]
  s_mov_b64 exec, 0xffff
  buffer_load_dwordx4 v22, s[40:43], s61 offen offset:2048 lds
  s_mov_b64 exec, -1
  v_mfma_f32_16x16x32_bf16 v[240:243], v[96:99], a[0:3], v[240:243]
  v_mul_u32_u24 v6, 18, v5
  v_sub_u32 v6, v4, v6
  v_mfma_f32_16x16x32_bf16 v[244:247], v[96:99], a[4:7], v[244:247]
  v_add_u32 v5, s56, v5
  v_mul_u32_u24 v5, 1152, v5
  v_mfma_f32_16x16x32_bf16 v[248:251], v[96:99], a[8:11], v[248:251]
  v_lshl_add_u32 v18, v6, 4, v5
  v_mov_b32 v4, 0x7fff0000
  v_mfma_f32_16x16x32_bf16 v[252:255], v[96:99], a[12:15], v[252:255]
  s_waitcnt lgkmcnt(0)
  s_barrier
  v_mfma_f32_16x16x32_bf16 a[128:131], v[100:103], a[16:19], a[128:131]
  s_add_u32 s4, s99, 5
  ds_read_b64_tr_b16 v[64:65], v23 offset:36864
  v_cmp_lt_u32 vcc, 63, v0
  v_mfma_f32_16x16x32_bf16 a[132:135], v[100:103], a[20:23], a[132:135]
  ds_read_b64_tr_b16 v[66:67], v23 offset:41472
  v_and_b32 v47, 7, v2
  v_mfma_f32_16x16x32_bf16 a[136:139], v[100:103], a[24:27], a[136:139]
  s_lshl2_add_u32 s4, s4, 2
  v_lshlrev_b32 v47, 2, v47
  v_cndmask_b32 v18, v18, v4, vcc
  v_mfma_f32_16x16x32_bf16 a[140:143], v[100:103], a[28:31], a[140:143]
  ds_read_b64_tr_b16 v[68:69], v23 offset:36896
  v_bfe_u32 v4, v0, 2, 4
  v_mfma_f32_16x16x32_bf16 a[144:147], v[104:107], a[16:19], a[144:147]
  s_lshl_b32 s4, s4, 17
  ds_read_b64_tr_b16 v[70:71], v23 offset:41504
  v_add_u32 v5, s56, v4
  v_mfma_f32_16x16x32_bf16 a[148:151], v[104:107], a[20:23], a[148:151]
  v_lshlrev_b32 v19, 1, v5
  v_lshrrev_b32 v6, 6, v0
  v_mfma_f32_16x16x32_bf16 a[152:155], v[104:107], a[24:27], a[152:155]
  s_add_u32 s62, s4, s63
  ds_read_b64_tr_b16 v[72:73], v23 offset:36928
  v_and_b32 v7, 1, v0
  v_mfma_f32_16x16x32_bf16 a[156:159], v[104:107], a[28:31], a[156:159]
  v_lshlrev_b32 v7, 2, v7
  v_lshl_add_u32 v7, v6, 3, v7
  v_mfma_f32_16x16x32_bf16 a[160:163], v[108:111], a[16:19], a[160:163]
  ds_read_b64_tr_b16 v[74:75], v23 offset:41536
  v_bfe_u32 v6, v0, 1, 1
  v_mfma_f32_16x16x32_bf16 a[164:167], v[108:111], a[20:23], a[164:167]
  buffer_load_dwordx4 a[80:83], v3, s[12:15], s62 offen offset:0 sc1
  ds_read_b64_tr_b16 v[76:77], v23 offset:36960
  v_mfma_f32_16x16x32_bf16 a[168:171], v[108:111], a[24:27], a[168:171]
  v_mul_u32_u24 v4, 288, v4
  v_add_u32 v4, v4, v7
  v_mfma_f32_16x16x32_bf16 a[172:175], v[108:111], a[28:31], a[172:175]
  buffer_load_dwordx4 a[84:87], v3, s[12:15], s62 offen offset:1024 sc1
  ds_read_b64_tr_b16 v[78:79], v23 offset:41568
  v_mfma_f32_16x16x32_bf16 a[176:179], v[112:115], a[16:19], a[176:179]
  ds_read_b64_tr_b16 v[80:81], v23 offset:36992
  v_lshl_add_u32 v12, v6, 5, v4
  v_mfma_f32_16x16x32_bf16 a[180:183], v[112:115], a[20:23], a[180:183]
  buffer_load_dwordx4 a[88:91], v3, s[12:15], s62 offen offset:2048 sc1
  v_mul_u32_u24 v13, 4608, v6
  v_mfma_f32_16x16x32_bf16 a[184:187], v[112:115], a[24:27], a[184:187]
  ds_read_b64_tr_b16 v[82:83], v23 offset:41600
  v_add3_u32 v13, v13, v4, 64
  v_mfma_f32_16x16x32_bf16 a[188:191], v[112:115], a[28:31], a[188:191]
  buffer_load_dwordx4 a[92:95], v3, s[12:15], s62 offen offset:3072 sc1
  v_mul_u32_u24 v5, 1152, v5
  v_mfma_f32_16x16x32_bf16 a[192:195], v[116:119], a[16:19], a[192:195]
  ds_read_b64_tr_b16 v[84:85], v23 offset:37024
  v_add_u32 v5, v5, v7
  v_mfma_f32_16x16x32_bf16 a[196:199], v[116:119], a[20:23], a[196:199]
  ds_read_b64_tr_b16 v[86:87], v23 offset:41632
  v_lshl_add_u32 v10, v6, 5, v5
  v_mfma_f32_16x16x32_bf16 a[200:203], v[116:119], a[24:27], a[200:203]
  s_add_u32 s3, s99, 7
  v_add_u32 v11, 18432, v10
  v_mul_u32_u24 v14, 18432, v6
  v_mfma_f32_16x16x32_bf16 a[204:207], v[116:119], a[28:31], a[204:207]
  ds_read_b64_tr_b16 v[88:89], v23 offset:37056
  v_add_u32 v14, v14, v5
  v_mfma_f32_16x16x32_bf16 a[208:211], v[120:123], a[16:19], a[208:211]
  s_lshl2_add_u32 s3, s3, 2
  ds_read_b64_tr_b16 v[90:91], v23 offset:41664
  v_lshlrev_b32 v15, 2, v0
  v_mfma_f32_16x16x32_bf16 a[212:215], v[120:123], a[20:23], a[212:215]
  v_mfma_f32_16x16x32_bf16 a[216:219], v[120:123], a[24:27], a[216:219]
  s_mul_i32 s61, s3, 36864
  ds_read_b64_tr_b16 v[92:93], v23 offset:37088
  v_mfma_f32_16x16x32_bf16 a[220:223], v[120:123], a[28:31], a[220:223]
  v_mfma_f32_16x16x32_bf16 a[224:227], v[124:127], a[16:19], a[224:227]
  s_add_u32 m0, s60, 27648
  ds_read_b64_tr_b16 v[94:95], v23 offset:41696
  v_mfma_f32_16x16x32_bf16 a[228:231], v[124:127], a[20:23], a[228:231]
  ds_read_b64_tr_b16 v[96:97], v23 offset:37120
  v_mfma_f32_16x16x32_bf16 a[232:235], v[124:127], a[24:27], a[232:235]
  v_mfma_f32_16x16x32_bf16 a[236:239], v[124:127], a[28:31], a[236:239]
  buffer_load_dwordx4 v20, s[40:43], s61 offen lds
  ds_read_b64_tr_b16 v[98:99], v23 offset:41728
  v_mfma_f32_16x16x32_bf16 a[240:243], v[128:131], a[16:19], a[240:243]
  v_mfma_f32_16x16x32_bf16 a[244:247], v[128:131], a[20:23], a[244:247]
  buffer_load_dwordx4 v21, s[40:43], s61 offen offset:1024 lds
  v_mfma_f32_16x16x32_bf16 a[248:251], v[128:131], a[24:27], a[248:251]
  v_mfma_f32_16x16x32_bf16 a[252:255], v[128:131], a[28:31], a[252:255]
  s_mov_b64 exec, 0xffff
  buffer_load_dwordx4 v22, s[40:43], s61 offen offset:2048 lds
  s_mov_b64 exec, -1
  v_mfma_f32_16x16x32_bf16 v[240:243], v[132:135], a[16:19], v[240:243]
  v_mfma_f32_16x16x32_bf16 v[244:247], v[132:135], a[20:23], v[244:247]
  v_mfma_f32_16x16x32_bf16 v[248:251], v[132:135], a[24:27], v[248:251]
  v_mfma_f32_16x16x32_bf16 v[252:255], v[132:135], a[28:31], v[252:255]
  s_waitcnt lgkmcnt(0)
  s_barrier
  v_mfma_f32_16x16x32_bf16 a[128:131], v[64:67], a[32:35], a[128:131]
  s_add_u32 s4, s99, 6
  ds_read_b64_tr_b16 v[100:101], v23 offset:46080
  v_mfma_f32_16x16x32_bf16 a[132:135], v[64:67], a[36:39], a[132:135]
  ds_read_b64_tr_b16 v[102:103], v23 offset:50688
  v_mfma_f32_16x16x32_bf16 a[136:139], v[64:67], a[40:43], a[136:139]
  s_lshl2_add_u32 s4, s4, 2
  v_mfma_f32_16x16x32_bf16 a[140:143], v[64:67], a[44:47], a[140:143]
  ds_read_b64_tr_b16 v[104:105], v23 offset:46112
  v_mfma_f32_16x16x32_bf16 a[144:147], v[68:71], a[32:35], a[144:147]
  s_lshl_b32 s4, s4, 17
  ds_read_b64_tr_b16 v[106:107], v23 offset:50720
  v_mfma_f32_16x16x32_bf16 a[148:151], v[68:71], a[36:39], a[148:151]
  v_mfma_f32_16x16x32_bf16 a[152:155], v[68:71], a[40:43], a[152:155]
  s_add_u32 s62, s4, s63
  ds_read_b64_tr_b16 v[108:109], v23 offset:46144
  v_mfma_f32_16x16x32_bf16 a[156:159], v[68:71], a[44:47], a[156:159]
  v_mfma_f32_16x16x32_bf16 a[160:163], v[72:75], a[32:35], a[160:163]
  ds_read_b64_tr_b16 v[110:111], v23 offset:50752
  v_mfma_f32_16x16x32_bf16 a[164:167], v[72:75], a[36:39], a[164:167]
  buffer_load_dwordx4 a[96:99], v3, s[12:15], s62 offen offset:0 sc1
  ds_read_b64_tr_b16 v[112:113], v23 offset:46176
  v_mfma_f32_16x16x32_bf16 a[168:171], v[72:75], a[40:43], a[168:171]
  v_mfma_f32_16x16x32_bf16 a[172:175], v[72:75], a[44:47], a[172:175]
  buffer_load_dwordx4 a[100:103], v3, s[12:15], s62 offen offset:1024 sc1
  ds_read_b64_tr_b16 v[114:115], v23 offset:50784
  v_mfma_f32_16x16x32_bf16 a[176:179], v[76:79], a[32:35], a[176:179]
  ds_read_b64_tr_b16 v[116:117], v23 offset:46208
  v_mfma_f32_16x16x32_bf16 a[180:183], v[76:79], a[36:39], a[180:183]
  buffer_load_dwordx4 a[104:107], v3, s[12:15], s62 offen offset:2048 sc1
  v_mfma_f32_16x16x32_bf16 a[184:187], v[76:79], a[40:43], a[184:187]
  ds_read_b64_tr_b16 v[118:119], v23 offset:50816
  v_mfma_f32_16x16x32_bf16 a[188:191], v[76:79], a[44:47], a[188:191]
  buffer_load_dwordx4 a[108:111], v3, s[12:15], s62 offen offset:3072 sc1
  v_mfma_f32_16x16x32_bf16 a[192:195], v[80:83], a[32:35], a[192:195]
  ds_read_b64_tr_b16 v[120:121], v23 offset:46240
  v_mfma_f32_16x16x32_bf16 a[196:199], v[80:83], a[36:39], a[196:199]
  ds_read_b64_tr_b16 v[122:123], v23 offset:50848
  v_mfma_f32_16x16x32_bf16 a[200:203], v[80:83], a[40:43], a[200:203]
  s_add_u32 s3, s99, 4
  v_mfma_f32_16x16x32_bf16 a[204:207], v[80:83], a[44:47], a[204:207]
  ds_read_b64_tr_b16 v[124:125], v23 offset:46272
  v_mfma_f32_16x16x32_bf16 a[208:211], v[84:87], a[32:35], a[208:211]
  s_lshl2_add_u32 s3, s3, 3
  ds_read_b64_tr_b16 v[126:127], v23 offset:50880
  v_mfma_f32_16x16x32_bf16 a[212:215], v[84:87], a[36:39], a[212:215]
  v_mfma_f32_16x16x32_bf16 a[216:219], v[84:87], a[40:43], a[216:219]
  s_mul_i32 s61, s3, 36864
  ds_read_b64_tr_b16 v[128:129], v23 offset:46304
  v_mfma_f32_16x16x32_bf16 a[220:223], v[84:87], a[44:47], a[220:223]
  v_mfma_f32_16x16x32_bf16 a[224:227], v[88:91], a[32:35], a[224:227]
  s_add_u32 m0, s60, 36864
  ds_read_b64_tr_b16 v[130:131], v23 offset:50912
  v_mfma_f32_16x16x32_bf16 a[228:231], v[88:91], a[36:39], a[228:231]
  ds_read_b64_tr_b16 v[132:133], v23 offset:46336
  v_mfma_f32_16x16x32_bf16 a[232:235], v[88:91], a[40:43], a[232:235]
  v_mfma_f32_16x16x32_bf16 a[236:239], v[88:91], a[44:47], a[236:239]
  buffer_load_dwordx4 v20, s[40:43], s61 offen lds
  ds_read_b64_tr_b16 v[134:135], v23 offset:50944
  v_mfma_f32_16x16x32_bf16 a[240:243], v[92:95], a[32:35], a[240:243]
  v_mfma_f32_16x16x32_bf16 a[244:247], v[92:95], a[36:39], a[244:247]
  buffer_load_dwordx4 v21, s[40:43], s61 offen offset:1024 lds
  v_mfma_f32_16x16x32_bf16 a[248:251], v[92:95], a[40:43], a[248:251]
  v_mfma_f32_16x16x32_bf16 a[252:255], v[92:95], a[44:47], a[252:255]
  s_mov_b64 exec, 0xffff
  buffer_load_dwordx4 v22, s[40:43], s61 offen offset:2048 lds
  s_mov_b64 exec, -1
  v_mfma_f32_16x16x32_bf16 v[240:243], v[96:99], a[32:35], v[240:243]
  v_mfma_f32_16x16x32_bf16 v[244:247], v[96:99], a[36:39], v[244:247]
  v_mfma_f32_16x16x32_bf16 v[248:251], v[96:99], a[40:43], v[248:251]
  v_mfma_f32_16x16x32_bf16 v[252:255], v[96:99], a[44:47], v[252:255]
  s_waitcnt vmcnt(24) lgkmcnt(0)
  s_barrier
  v_mfma_f32_16x16x32_bf16 a[128:131], v[100:103], a[48:51], a[128:131]
  buffer_load_dword v25, v24, s[12:15], s55 offen sc1
  ds_read_b64_tr_b16 v[64:65], v23 offset:0
  v_mfma_f32_16x16x32_bf16 a[132:135], v[100:103], a[52:55], a[132:135]
  ds_read_b64_tr_b16 v[66:67], v23 offset:4608
  v_mfma_f32_16x16x32_bf16 a[136:139], v[100:103], a[56:59], a[136:139]
  s_add_u32 s4, s99, 7
  v_mfma_f32_16x16x32_bf16 a[140:143], v[100:103], a[60:63], a[140:143]
  ds_read_b64_tr_b16 v[68:69], v23 offset:32
  v_mfma_f32_16x16x32_bf16 a[144:147], v[104:107], a[48:51], a[144:147]
  s_lshl2_add_u32 s4, s4, 2
  ds_read_b64_tr_b16 v[70:71], v23 offset:4640
  v_mfma_f32_16x16x32_bf16 a[148:151], v[104:107], a[52:55], a[148:151]
  v_mfma_f32_16x16x32_bf16 a[152:155], v[104:107], a[56:59], a[152:155]
  s_lshl_b32 s4, s4, 17
  ds_read_b64_tr_b16 v[72:73], v23 offset:64
  v_mfma_f32_16x16x32_bf16 a[156:159], v[104:107], a[60:63], a[156:159]
  v_mfma_f32_16x16x32_bf16 a[160:163], v[108:111], a[48:51], a[160:163]
  s_add_u32 s62, s4, s63
  ds_read_b64_tr_b16 v[74:75], v23 offset:4672
  v_mfma_f32_16x16x32_bf16 a[164:167], v[108:111], a[52:55], a[164:167]
  ds_read_b64_tr_b16 v[76:77], v23 offset:96
  v_mfma_f32_16x16x32_bf16 a[168:171], v[108:111], a[56:59], a[168:171]
  buffer_load_dwordx4 a[112:115], v3, s[12:15], s62 offen offset:0 sc1
  v_mfma_f32_16x16x32_bf16 a[172:175], v[108:111], a[60:63], a[172:175]
  ds_read_b64_tr_b16 v[78:79], v23 offset:4704
  v_mfma_f32_16x16x32_bf16 a[176:179], v[112:115], a[48:51], a[176:179]
  buffer_load_dwordx4 a[116:119], v3, s[12:15], s62 offen offset:1024 sc1
  ds_read_b64_tr_b16 v[80:81], v23 offset:128
  v_mfma_f32_16x16x32_bf16 a[180:183], v[112:115], a[52:55], a[180:183]
  v_mfma_f32_16x16x32_bf16 a[184:187], v[112:115], a[56:59], a[184:187]
  buffer_load_dwordx4 a[120:123], v3, s[12:15], s62 offen offset:2048 sc1
  ds_read_b64_tr_b16 v[82:83], v23 offset:4736
  v_mfma_f32_16x16x32_bf16 a[188:191], v[112:115], a[60:63], a[188:191]
  v_mfma_f32_16x16x32_bf16 a[192:195], v[116:119], a[48:51], a[192:195]
  ds_read_b64_tr_b16 v[84:85], v23 offset:160
  v_mfma_f32_16x16x32_bf16 a[196:199], v[116:119], a[52:55], a[196:199]
  buffer_load_dwordx4 a[124:127], v3, s[12:15], s62 offen offset:3072 sc1
  ds_read_b64_tr_b16 v[86:87], v23 offset:4768
  v_mfma_f32_16x16x32_bf16 a[200:203], v[116:119], a[56:59], a[200:203]
  v_mfma_f32_16x16x32_bf16 a[204:207], v[116:119], a[60:63], a[204:207]
  s_add_u32 s3, s99, 5
  ds_read_b64_tr_b16 v[88:89], v23 offset:192
  v_mfma_f32_16x16x32_bf16 a[208:211], v[120:123], a[48:51], a[208:211]
  ds_read_b64_tr_b16 v[90:91], v23 offset:4800
  v_mfma_f32_16x16x32_bf16 a[212:215], v[120:123], a[52:55], a[212:215]
  s_lshl2_add_u32 s3, s3, 3
  v_mfma_f32_16x16x32_bf16 a[216:219], v[120:123], a[56:59], a[216:219]
  ds_read_b64_tr_b16 v[92:93], v23 offset:224
  v_mfma_f32_16x16x32_bf16 a[220:223], v[120:123], a[60:63], a[220:223]
  s_mul_i32 s61, s3, 36864
  v_mfma_f32_16x16x32_bf16 a[224:227], v[124:127], a[48:51], a[224:227]
  ds_read_b64_tr_b16 v[94:95], v23 offset:4832
  v_mfma_f32_16x16x32_bf16 a[228:231], v[124:127], a[52:55], a[228:231]
  s_add_u32 m0, s60, 46080
  ds_read_b64_tr_b16 v[96:97], v23 offset:256
  v_mfma_f32_16x16x32_bf16 a[232:235], v[124:127], a[56:59], a[232:235]
  v_mfma_f32_16x16x32_bf16 a[236:239], v[124:127], a[60:63], a[236:239]
  buffer_load_dwordx4 v20, s[40:43], s61 offen lds
  ds_read_b64_tr_b16 v[98:99], v23 offset:4864
  v_mfma_f32_16x16x32_bf16 a[240:243], v[128:131], a[48:51], a[240:243]
  v_mfma_f32_16x16x32_bf16 a[244:247], v[128:131], a[52:55], a[244:247]
  buffer_load_dwordx4 v21, s[40:43], s61 offen offset:1024 lds
  v_mfma_f32_16x16x32_bf16 a[248:251], v[128:131], a[56:59], a[248:251]
  v_mfma_f32_16x16x32_bf16 a[252:255], v[128:131], a[60:63], a[252:255]
  s_mov_b64 exec, 0xffff
  buffer_load_dwordx4 v22, s[40:43], s61 offen offset:2048 lds
  s_mov_b64 exec, -1
  v_mfma_f32_16x16x32_bf16 v[240:243], v[132:135], a[48:51], v[240:243]
  v_mfma_f32_16x16x32_bf16 v[244:247], v[132:135], a[52:55], v[244:247]
  v_mfma_f32_16x16x32_bf16 v[248:251], v[132:135], a[56:59], v[248:251]
  v_mfma_f32_16x16x32_bf16 v[252:255], v[132:135], a[60:63], v[252:255]
  s_waitcnt vmcnt(25) lgkmcnt(0)
  s_barrier
  v_mfma_f32_16x16x32_bf16 a[128:131], v[64:67], a[64:67], a[128:131]
  s_waitcnt vmcnt(7)
  v_cmp_gt_u32 s[6:7], 4, v25
  s_cmp_lg_u64 s[6:7], 0
  s_cbranch_scc1 SP_pO28
RT_pO28:
  v_mfma_f32_16x16x32_bf16 a[132:135], v[64:67], a[68:71], a[132:135]
  s_add_u32 s4, s99, 4
  ds_read_b64_tr_b16 v[100:101], v23 offset:9216
  ds_read_b64_tr_b16 v[102:103], v23 offset:13824
  v_mfma_f32_16x16x32_bf16 a[136:139], v[64:67], a[72:75], a[136:139]
  s_lshl2_add_u32 s4, s4, 3
  v_mfma_f32_16x16x32_bf16 a[140:143], v[64:67], a[76:79], a[140:143]
  ds_read_b64_tr_b16 v[104:105], v23 offset:9248
  v_mfma_f32_16x16x32_bf16 a[144:147], v[68:71], a[64:67], a[144:147]
  s_lshl_b32 s4, s4, 17
  ds_read_b64_tr_b16 v[106:107], v23 offset:13856
  v_mfma_f32_16x16x32_bf16 a[148:151], v[68:71], a[68:71], a[148:151]
TP_16:
  s_cbranch_execz TR_3
  s_add_u32 s62, s4, s63
  v_mfma_f32_16x16x32_bf16 a[152:155], v[68:71], a[72:75], a[152:155]
  ds_read_b64_tr_b16 v[108:109], v23 offset:9280
  v_mfma_f32_16x16x32_bf16 a[156:159], v[68:71], a[76:79], a[156:159]
  buffer_load_dwordx4 a[0:3], v3, s[12:15], s62 offen offset:0 sc1
  v_mfma_f32_16x16x32_bf16 a[160:163], v[72:75], a[64:67], a[160:163]
  buffer_load_dwordx4 a[4:7], v3, s[12:15], s62 offen offset:1024 sc1
  ds_read_b64_tr_b16 v[110:111], v23 offset:13888
  v_mfma_f32_16x16x32_bf16 a[164:167], v[72:75], a[68:71], a[164:167]
  buffer_load_dwordx4 a[8:11], v3, s[12:15], s62 offen offset:2048 sc1
  ds_read_b64_tr_b16 v[112:113], v23 offset:9312
  v_mfma_f32_16x16x32_bf16 a[168:171], v[72:75], a[72:75], a[168:171]
  v_mfma_f32_16x16x32_bf16 a[172:175], v[72:75], a[76:79], a[172:175]
  buffer_load_dwordx4 a[12:15], v3, s[12:15], s62 offen offset:3072 sc1
  ds_read_b64_tr_b16 v[114:115], v23 offset:13920
  v_mfma_f32_16x16x32_bf16 a[176:179], v[76:79], a[64:67], a[176:179]
  s_add_u32 s4, s99, 5
  ds_read_b64_tr_b16 v[116:117], v23 offset:9344
  v_mfma_f32_16x16x32_bf16 a[180:183], v[76:79], a[68:71], a[180:183]
  v_mfma_f32_16x16x32_bf16 a[184:187], v[76:79], a[72:75], a[184:187]
  s_lshl2_add_u32 s4, s4, 3
  ds_read_b64_tr_b16 v[118:119], v23 offset:13952
  v_mfma_f32_16x16x32_bf16 a[188:191], v[76:79], a[76:79], a[188:191]
  s_lshl_b32 s4, s4, 17
  v_mfma_f32_16x16x32_bf16 a[192:195], v[80:83], a[64:67], a[192:195]
  ds_read_b64_tr_b16 v[120:121], v23 offset:9376
  v_mfma_f32_16x16x32_bf16 a[196:199], v[80:83], a[68:71], a[196:199]
  s_add_u32 s62, s4, s63
  ds_read_b64_tr_b16 v[122:123], v23 offset:13984
  v_mfma_f32_16x16x32_bf16 a[200:203], v[80:83], a[72:75], a[200:203]
  buffer_load_dwordx4 a[16:19], v3, s[12:15], s62 offen offset:0 sc1
  v_mfma_f32_16x16x32_bf16 a[204:207], v[80:83], a[76:79], a[204:207]
  buffer_load_dwordx4 a[20:23], v3, s[12:15], s62 offen offset:1024 sc1
  ds_read_b64_tr_b16 v[124:125], v23 offset:9408
  v_mfma_f32_16x16x32_bf16 a[208:211], v[84:87], a[64:67], a[208:211]
  ds_read_b64_tr_b16 v[126:127], v23 offset:14016
  v_mfma_f32_16x16x32_bf16 a[212:215], v[84:87], a[68:71], a[212:215]
  buffer_load_dwordx4 a[24:27], v3, s[12:15], s62 offen offset:2048 sc1
  v_mfma_f32_16x16x32_bf16 a[216:219], v[84:87], a[72:75], a[216:219]
  buffer_load_dwordx4 a[28:31], v3, s[12:15], s62 offen offset:3072 sc1
  ds_read_b64_tr_b16 v[128:129], v23 offset:9440
  v_mfma_f32_16x16x32_bf16 a[220:223], v[84:87], a[76:79], a[220:223]
  v_mfma_f32_16x16x32_bf16 a[224:227], v[88:91], a[64:67], a[224:227]
  s_add_u32 s3, s99, 6
  ds_read_b64_tr_b16 v[130:131], v23 offset:14048
  v_mfma_f32_16x16x32_bf16 a[228:231], v[88:91], a[68:71], a[228:231]
  s_lshl2_add_u32 s3, s3, 3
  ds_read_b64_tr_b16 v[132:133], v23 offset:9472
  v_mfma_f32_16x16x32_bf16 a[232:235], v[88:91], a[72:75], a[232:235]
  s_mul_i32 s61, s3, 36864
  v_mfma_f32_16x16x32_bf16 a[236:239], v[88:91], a[76:79], a[236:239]
  ds_read_b64_tr_b16 v[134:135], v23 offset:14080
  v_mfma_f32_16x16x32_bf16 a[240:243], v[92:95], a[64:67], a[240:243]
  s_add_u32 m0, s60, 0
  v_mfma_f32_16x16x32_bf16 a[244:247], v[92:95], a[68:71], a[244:247]
  buffer_load_dwordx4 v20, s[40:43], s61 offen lds
  v_mfma_f32_16x16x32_bf16 a[248:251], v[92:95], a[72:75], a[248:251]
  v_mfma_f32_16x16x32_bf16 a[252:255], v[92:95], a[76:79], a[252:255]
  buffer_load_dwordx4 v21, s[40:43], s61 offen offset:1024 lds
  v_mfma_f32_16x16x32_bf16 v[240:243], v[96:99], a[64:67], v[240:243]
  s_mov_b64 exec, 0xffff
  buffer_load_dwordx4 v22, s[40:43], s61 offen offset:2048 lds
  s_mov_b64 exec, -1
  v_mfma_f32_16x16x32_bf16 v[244:247], v[96:99], a[68:71], v[244:247]
  v_mfma_f32_16x16x32_bf16 v[248:251], v[96:99], a[72:75], v[248:251]
  v_mfma_f32_16x16x32_bf16 v[252:255], v[96:99], a[76:79], v[252:255]
  s_waitcnt lgkmcnt(0)
  s_barrier
  v_mfma_f32_16x16x32_bf16 a[128:131], v[100:103], a[80:83], a[128:131]
  s_add_u32 s4, s99, 6
  ds_read_b64_tr_b16 v[64:65], v23 offset:18432
  v_mfma_f32_16x16x32_bf16 a[132:135], v[100:103], a[84:87], a[132:135]
  s_lshl2_add_u32 s4, s4, 3
  ds_read_b64_tr_b16 v[66:67], v23 offset:23040
  v_mfma_f32_16x16x32_bf16 a[136:139], v[100:103], a[88:91], a[136:139]
  s_lshl_b32 s4, s4, 17
  v_mfma_f32_16x16x32_bf16 a[140:143], v[100:103], a[92:95], a[140:143]
  ds_read_b64_tr_b16 v[68:69], v23 offset:18464
  v_mfma_f32_16x16x32_bf16 a[144:147], v[104:107], a[80:83], a[144:147]
  s_add_u32 s62, s4, s63
  ds_read_b64_tr_b16 v[70:71], v23 offset:23072
  v_mfma_f32_16x16x32_bf16 a[148:151], v[104:107], a[84:87], a[148:151]
  buffer_load_dwordx4 a[32:35], v3, s[12:15], s62 offen offset:0 sc1
  v_mfma_f32_16x16x32_bf16 a[152:155], v[104:107], a[88:91], a[152:155]
  ds_read_b64_tr_b16 v[72:73], v23 offset:18496
  v_mfma_f32_16x16x32_bf16 a[156:159], v[104:107], a[92:95], a[156:159]
  buffer_load_dwordx4 a[36:39], v3, s[12:15], s62 offen offset:1024 sc1
  v_mfma_f32_16x16x32_bf16 a[160:163], v[108:111], a[80:83], a[160:163]
  buffer_load_dwordx4 a[40:43], v3, s[12:15], s62 offen offset:2048 sc1
  ds_read_b64_tr_b16 v[74:75], v23 offset:23104
  v_mfma_f32_16x16x32_bf16 a[164:167], v[108:111], a[84:87], a[164:167]
  ds_read_b64_tr_b16 v[76:77], v23 offset:18528
  v_mfma_f32_16x16x32_bf16 a[168:171], v[108:111], a[88:91], a[168:171]
  buffer_load_dwordx4 a[44:47], v3, s[12:15], s62 offen offset:3072 sc1
  v_mfma_f32_16x16x32_bf16 a[172:175], v[108:111], a[92:95], a[172:175]
  s_add_u32 s4, s99, 7
  ds_read_b64_tr_b16 v[78:79], v23 offset:23136
  v_mfma_f32_16x16x32_bf16 a[176:179], v[112:115], a[80:83], a[176:179]
  ds_read_b64_tr_b16 v[80:81], v23 offset:18560
  v_mfma_f32_16x16x32_bf16 a[180:183], v[112:115], a[84:87], a[180:183]
  s_lshl2_add_u32 s4, s4, 3
  v_mfma_f32_16x16x32_bf16 a[184:187], v[112:115], a[88:91], a[184:187]
  s_lshl_b32 s4, s4, 17
  ds_read_b64_tr_b16 v[82:83], v23 offset:23168
  v_mfma_f32_16x16x32_bf16 a[188:191], v[112:115], a[92:95], a[188:191]
  v_mfma_f32_16x16x32_bf16 a[192:195], v[116:119], a[80:83], a[192:195]
  s_add_u32 s62, s4, s63
  ds_read_b64_tr_b16 v[84:85], v23 offset:18592
  v_mfma_f32_16x16x32_bf16 a[196:199], v[116:119], a[84:87], a[196:199]
  buffer_load_dwordx4 a[48:51], v3, s[12:15], s62 offen offset:0 sc1
  ds_read_b64_tr_b16 v[86:87], v23 offset:23200
  v_mfma_f32_16x16x32_bf16 a[200:203], v[116:119], a[88:91], a[200:203]
  v_mfma_f32_16x16x32_bf16 a[204:207], v[116:119], a[92:95], a[204:207]
  buffer_load_dwordx4 a[52:55], v3, s[12:15], s62 offen offset:1024 sc1
  ds_read_b64_tr_b16 v[88:89], v23 offset:18624
  v_mfma_f32_16x16x32_bf16 a[208:211], v[120:123], a[80:83], a[208:211]
  buffer_load_dwordx4 a[56:59], v3, s[12:15], s62 offen offset:2048 sc1
  ds_read_b64_tr_b16 v[90:91], v23 offset:23232
  v_mfma_f32_16x16x32_bf16 a[212:215], v[120:123], a[84:87], a[212:215]
  v_mfma_f32_16x16x32_bf16 a[216:219], v[120:123], a[88:91], a[216:219]
  buffer_load_dwordx4 a[60:63], v3, s[12:15], s62 offen offset:3072 sc1
  ds_read_b64_tr_b16 v[92:93], v23 offset:18656
  v_mfma_f32_16x16x32_bf16 a[220:223], v[120:123], a[92:95], a[220:223]
  s_add_u32 s3, s99, 7
  v_mfma_f32_16x16x32_bf16 a[224:227], v[124:127], a[80:83], a[224:227]
  ds_read_b64_tr_b16 v[94:95], v23 offset:23264
  v_mfma_f32_16x16x32_bf16 a[228:231], v[124:127], a[84:87], a[228:231]
  s_lshl2_add_u32 s3, s3, 3
  ds_read_b64_tr_b16 v[96:97], v23 offset:18688
  v_mfma_f32_16x16x32_bf16 a[232:235], v[124:127], a[88:91], a[232:235]
  s_mul_i32 s61, s3, 36864
  v_mfma_f32_16x16x32_bf16 a[236:239], v[124:127], a[92:95], a[236:239]
  ds_read_b64_tr_b16 v[98:99], v23 offset:23296
  v_mfma_f32_16x16x32_bf16 a[240:243], v[128:131], a[80:83], a[240:243]
  s_add_u32 m0, s60, 9216
  v_mfma_f32_16x16x32_bf16 a[244:247], v[128:131], a[84:87], a[244:247]
  buffer_load_dwordx4 v20, s[40:43], s61 offen lds
  v_mfma_f32_16x16x32_bf16 a[248:251], v[128:131], a[88:91], a[248:251]
  v_mfma_f32_16x16x32_bf16 a[252:255], v[128:131], a[92:95], a[252:255]
  buffer_load_dwordx4 v21, s[40:43], s61 offen offset:1024 lds
  v_mfma_f32_16x16x32_bf16 v[240:243], v[132:135], a[80:83], v[240:243]
  s_mov_b64 exec, 0xffff
  buffer_load_dwordx4 v22, s[40:43], s61 offen offset:2048 lds
  s_mov_b64 exec, -1
  v_mfma_f32_16x16x32_bf16 v[244:247], v[132:135], a[84:87], v[244:247]
  v_mfma_f32_16x16x32_bf16 v[248:251], v[132:135], a[88:91], v[248:251]
  v_mfma_f32_16x16x32_bf16 v[252:255], v[132:135], a[92:95], v[252:255]
  s_waitcnt lgkmcnt(0)
  s_barrier
  v_mfma_f32_16x16x32_bf16 a[128:131], v[64:67], a[96:99], a[128:131]
  ds_read_b64_tr_b16 v[100:101], v23 offset:27648
  v_mfma_f32_16x16x32_bf16 a[132:135], v[64:67], a[100:103], a[132:135]
  ds_read_b64_tr_b16 v[102:103], v23 offset:32256
  v_mfma_f32_16x16x32_bf16 a[136:139], v[64:67], a[104:107], a[136:139]
  v_mfma_f32_16x16x32_bf16 a[140:143], v[64:67], a[108:111], a[140:143]
  ds_read_b64_tr_b16 v[104:105], v23 offset:27680
  v_mfma_f32_16x16x32_bf16 a[144:147], v[68:71], a[96:99], a[144:147]
  ds_read_b64_tr_b16 v[106:107], v23 offset:32288
  v_mfma_f32_16x16x32_bf16 a[148:151], v[68:71], a[100:103], a[148:151]
  v_mfma_f32_16x16x32_bf16 a[152:155], v[68:71], a[104:107], a[152:155]
  ds_read_b64_tr_b16 v[108:109], v23 offset:27712
  v_mfma_f32_16x16x32_bf16 a[156:159], v[68:71], a[108:111], a[156:159]
  v_mfma_f32_16x16x32_bf16 a[160:163], v[72:75], a[96:99], a[160:163]
  ds_read_b64_tr_b16 v[110:111], v23 offset:32320
  v_mfma_f32_16x16x32_bf16 a[164:167], v[72:75], a[100:103], a[164:167]
  ds_read_b64_tr_b16 v[112:113], v23 offset:27744
  v_mfma_f32_16x16x32_bf16 a[168:171], v[72:75], a[104:107], a[168:171]
  v_mfma_f32_16x16x32_bf16 a[172:175], v[72:75], a[108:111], a[172:175]
  ds_read_b64_tr_b16 v[114:115], v23 offset:32352
  v_mfma_f32_16x16x32_bf16 a[176:179], v[76:79], a[96:99], a[176:179]
  ds_read_b64_tr_b16 v[116:117], v23 offset:27776
  v_mfma_f32_16x16x32_bf16 a[180:183], v[76:79], a[100:103], a[180:183]
  v_mfma_f32_16x16x32_bf16 a[184:187], v[76:79], a[104:107], a[184:187]
  ds_read_b64_tr_b16 v[118:119], v23 offset:32384
  v_mfma_f32_16x16x32_bf16 a[188:191], v[76:79], a[108:111], a[188:191]
  v_mfma_f32_16x16x32_bf16 a[192:195], v[80:83], a[96:99], a[192:195]
  ds_read_b64_tr_b16 v[120:121], v23 offset:27808
  v_mfma_f32_16x16x32_bf16 a[196:199], v[80:83], a[100:103], a[196:199]
  ds_read_b64_tr_b16 v[122:123], v23 offset:32416
  v_mfma_f32_16x16x32_bf16 a[200:203], v[80:83], a[104:107], a[200:203]
  v_mfma_f32_16x16x32_bf16 a[204:207], v[80:83], a[108:111], a[204:207]
  ds_read_b64_tr_b16 v[124:125], v23 offset:27840
  v_mfma_f32_16x16x32_bf16 a[208:211], v[84:87], a[96:99], a[208:211]
  ds_read_b64_tr_b16 v[126:127], v23 offset:32448
  v_mfma_f32_16x16x32_bf16 a[212:215], v[84:87], a[100:103], a[212:215]
  v_mfma_f32_16x16x32_bf16 a[216:219], v[84:87], a[104:107], a[216:219]
  ds_read_b64_tr_b16 v[128:129], v23 offset:27872
  v_mfma_f32_16x16x32_bf16 a[220:223], v[84:87], a[108:111], a[220:223]
  v_mfma_f32_16x16x32_bf16 a[224:227], v[88:91], a[96:99], a[224:227]
  ds_read_b64_tr_b16 v[130:131], v23 offset:32480
  v_mfma_f32_16x16x32_bf16 a[228:231], v[88:91], a[100:103], a[228:231]
  ds_read_b64_tr_b16 v[132:133], v23 offset:27904
  v_mfma_f32_16x16x32_bf16 a[232:235], v[88:91], a[104:107], a[232:235]
  v_mfma_f32_16x16x32_bf16 a[236:239], v[88:91], a[108:111], a[236:239]
  ds_read_b64_tr_b16 v[134:135], v23 offset:32512
  v_mfma_f32_16x16x32_bf16 a[240:243], v[92:95], a[96:99], a[240:243]
  v_mfma_f32_16x16x32_bf16 a[244:247], v[92:95], a[100:103], a[244:247]
  v_mfma_f32_16x16x32_bf16 a[248:251], v[92:95], a[104:107], a[248:251]
  v_mfma_f32_16x16x32_bf16 a[252:255], v[92:95], a[108:111], a[252:255]
  v_mfma_f32_16x16x32_bf16 v[240:243], v[96:99], a[96:99], v[240:243]
  v_mfma_f32_16x16x32_bf16 v[244:247], v[96:99], a[100:103], v[244:247]
  v_mfma_f32_16x16x32_bf16 v[248:251], v[96:99], a[104:107], v[248:251]
  v_mfma_f32_16x16x32_bf16 v[252:255], v[96:99], a[108:111], v[252:255]
  s_waitcnt vmcnt(25) lgkmcnt(0)
  s_barrier
  v_mfma_f32_16x16x32_bf16 a[128:131], v[100:103], a[112:115], a[128:131]
  ds_read_b64_tr_b16 v[64:65], v23 offset:36864
  v_mfma_f32_16x16x32_bf16 a[132:135], v[100:103], a[116:119], a[132:135]
  ds_read_b64_tr_b16 v[66:67], v23 offset:41472
  v_mfma_f32_16x16x32_bf16 a[136:139], v[100:103], a[120:123], a[136:139]
  v_mfma_f32_16x16x32_bf16 a[140:143], v[100:103], a[124:127], a[140:143]
  ds_read_b64_tr_b16 v[68:69], v23 offset:36896
  v_mfma_f32_16x16x32_bf16 a[144:147], v[104:107], a[112:115], a[144:147]
  ds_read_b64_tr_b16 v[70:71], v23 offset:41504
  v_mfma_f32_16x16x32_bf16 a[148:151], v[104:107], a[116:119], a[148:151]
  v_mfma_f32_16x16x32_bf16 a[152:155], v[104:107], a[120:123], a[152:155]
  ds_read_b64_tr_b16 v[72:73], v23 offset:36928
  v_mfma_f32_16x16x32_bf16 a[156:159], v[104:107], a[124:127], a[156:159]
  v_mfma_f32_16x16x32_bf16 a[160:163], v[108:111], a[112:115], a[160:163]
  ds_read_b64_tr_b16 v[74:75], v23 offset:41536
  v_mfma_f32_16x16x32_bf16 a[164:167], v[108:111], a[116:119], a[164:167]
  ds_read_b64_tr_b16 v[76:77], v23 offset:36960
  v_mfma_f32_16x16x32_bf16 a[168:171], v[108:111], a[120:123], a[168:171]
  v_mfma_f32_16x16x32_bf16 a[172:175], v[108:111], a[124:127], a[172:175]
  ds_read_b64_tr_b16 v[78:79], v23 offset:41568
  v_mfma_f32_16x16x32_bf16 a[176:179], v[112:115], a[112:115], a[176:179]
  ds_read_b64_tr_b16 v[80:81], v23 offset:36992
  v_mfma_f32_16x16x32_bf16 a[180:183], v[112:115], a[116:119], a[180:183]
  v_mfma_f32_16x16x32_bf16 a[184:187], v[112:115], a[120:123], a[184:187]
  ds_read_b64_tr_b16 v[82:83], v23 offset:41600
  v_mfma_f32_16x16x32_bf16 a[188:191], v[112:115], a[124:127], a[188:191]
  v_mfma_f32_16x16x32_bf16 a[192:195], v[116:119], a[112:115], a[192:195]
  ds_read_b64_tr_b16 v[84:85], v23 offset:37024
  v_mfma_f32_16x16x32_bf16 a[196:199], v[116:119], a[116:119], a[196:199]
  ds_read_b64_tr_b16 v[86:87], v23 offset:41632
  v_mfma_f32_16x16x32_bf16 a[200:203], v[116:119], a[120:123], a[200:203]
  v_mfma_f32_16x16x32_bf16 a[204:207], v[116:119], a[124:127], a[204:207]
  ds_read_b64_tr_b16 v[88:89], v23 offset:37056
  v_mfma_f32_16x16x32_bf16 a[208:211], v[120:123], a[112:115], a[208:211]
  ds_read_b64_tr_b16 v[90:91], v23 offset:41664
  v_mfma_f32_16x16x32_bf16 a[212:215], v[120:123], a[116:119], a[212:215]
  v_mfma_f32_16x16x32_bf16 a[216:219], v[120:123], a[120:123], a[216:219]
  ds_read_b64_tr_b16 v[92:93], v23 offset:37088
  v_mfma_f32_16x16x32_bf16 a[220:223], v[120:123], a[124:127], a[220:223]
  v_mfma_f32_16x16x32_bf16 a[224:227], v[124:127], a[112:115], a[224:227]
  ds_read_b64_tr_b16 v[94:95], v23 offset:41696
  v_mfma_f32_16x16x32_bf16 a[228:231], v[124:127], a[116:119], a[228:231]
  ds_read_b64_tr_b16 v[96:97], v23 offset:37120
  v_mfma_f32_16x16x32_bf16 a[232:235], v[124:127], a[120:123], a[232:235]
  v_mfma_f32_16x16x32_bf16 a[236:239], v[124:127], a[124:127], a[236:239]
  ds_read_b64_tr_b16 v[98:99], v23 offset:41728
  v_mfma_f32_16x16x32_bf16 a[240:243], v[128:131], a[112:115], a[240:243]
  v_mfma_f32_16x16x32_bf16 a[244:247], v[128:131], a[116:119], a[244:247]
  v_mfma_f32_16x16x32_bf16 a[248:251], v[128:131], a[120:123], a[248:251]
  v_mfma_f32_16x16x32_bf16 a[252:255], v[128:131], a[124:127], a[252:255]
  v_mfma_f32_16x16x32_bf16 v[240:243], v[132:135], a[112:115], v[240:243]
  v_mfma_f32_16x16x32_bf16 v[244:247], v[132:135], a[116:119], v[244:247]
  v_mfma_f32_16x16x32_bf16 v[248:251], v[132:135], a[120:123], v[248:251]
  v_mfma_f32_16x16x32_bf16 v[252:255], v[132:135], a[124:127], v[252:255]
  s_waitcnt vmcnt(0) lgkmcnt(0)
  s_barrier
  v_mfma_f32_16x16x32_bf16 a[128:131], v[64:67], a[0:3], a[128:131]
  ds_read_b64_tr_b16 v[136:137], v23 offset:46336
  v_mfma_f32_16x16x32_bf16 a[132:135], v[64:67], a[4:7], a[132:135]
  v_mfma_f32_16x16x32_bf16 a[136:139], v[64:67], a[8:11], a[136:139]
  v_mfma_f32_16x16x32_bf16 a[140:143], v[64:67], a[12:15], a[140:143]
  v_mfma_f32_16x16x32_bf16 a[144:147], v[68:71], a[0:3], a[144:147]
  ds_read_b64_tr_b16 v[138:139], v23 offset:50944
  v_mfma_f32_16x16x32_bf16 a[148:151], v[68:71], a[4:7], a[148:151]
  v_mfma_f32_16x16x32_bf16 a[152:155], v[68:71], a[8:11], a[152:155]
  v_mfma_f32_16x16x32_bf16 a[156:159], v[68:71], a[12:15], a[156:159]
  v_mfma_f32_16x16x32_bf16 a[160:163], v[72:75], a[0:3], a[160:163]
  v_mfma_f32_16x16x32_bf16 a[164:167], v[72:75], a[4:7], a[164:167]
  ds_read_b64_tr_b16 v[140:141], v23 offset:256
  v_mfma_f32_16x16x32_bf16 a[168:171], v[72:75], a[8:11], a[168:171]
  v_mfma_f32_16x16x32_bf16 a[172:175], v[72:75], a[12:15], a[172:175]
  v_mfma_f32_16x16x32_bf16 a[176:179], v[76:79], a[0:3], a[176:179]
  v_mfma_f32_16x16x32_bf16 a[180:183], v[76:79], a[4:7], a[180:183]
  v_mfma_f32_16x16x32_bf16 a[184:187], v[76:79], a[8:11], a[184:187]
  ds_read_b64_tr_b16 v[142:143], v23 offset:4864
  v_mfma_f32_16x16x32_bf16 a[188:191], v[76:79], a[12:15], a[188:191]
  v_mfma_f32_16x16x32_bf16 a[192:195], v[80:83], a[0:3], a[192:195]
  v_mfma_f32_16x16x32_bf16 a[196:199], v[80:83], a[4:7], a[196:199]
  v_mfma_f32_16x16x32_bf16 a[200:203], v[80:83], a[8:11], a[200:203]
  v_mfma_f32_16x16x32_bf16 a[204:207], v[80:83], a[12:15], a[204:207]
  ds_read_b64_tr_b16 v[144:145], v23 offset:9472
  v_mfma_f32_16x16x32_bf16 a[208:211], v[84:87], a[0:3], a[208:211]
  v_mfma_f32_16x16x32_bf16 a[212:215], v[84:87], a[4:7], a[212:215]
  v_mfma_f32_16x16x32_bf16 a[216:219], v[84:87], a[8:11], a[216:219]
  v_mfma_f32_16x16x32_bf16 a[220:223], v[84:87], a[12:15], a[220:223]
  v_mfma_f32_16x16x32_bf16 a[224:227], v[88:91], a[0:3], a[224:227]
  ds_read_b64_tr_b16 v[146:147], v23 offset:14080
  v_mfma_f32_16x16x32_bf16 a[228:231], v[88:91], a[4:7], a[228:231]
  v_mfma_f32_16x16x32_bf16 a[232:235], v[88:91], a[8:11], a[232:235]
  v_mfma_f32_16x16x32_bf16 a[236:239], v[88:91], a[12:15], a[236:239]
  v_mfma_f32_16x16x32_bf16 a[240:243], v[92:95], a[0:3], a[240:243]
  v_mfma_f32_16x16x32_bf16 a[244:247], v[92:95], a[4:7], a[244:247]
  v_mfma_f32_16x16x32_bf16 a[248:251], v[92:95], a[8:11], a[248:251]
  v_mfma_f32_16x16x32_bf16 a[252:255], v[92:95], a[12:15], a[252:255]
  v_mfma_f32_16x16x32_bf16 v[240:243], v[96:99], a[0:3], v[240:243]
  v_mfma_f32_16x16x32_bf16 v[244:247], v[96:99], a[4:7], v[244:247]
  v_mfma_f32_16x16x32_bf16 v[248:251], v[96:99], a[8:11], v[248:251]
  v_mfma_f32_16x16x32_bf16 v[252:255], v[96:99], a[12:15], v[252:255]
  s_waitcnt lgkmcnt(0)
  v_mfma_f32_16x16x32_bf16 v[240:243], v[136:139], a[16:19], v[240:243]
  ds_read_b64_tr_b16 v[148:149], v23 offset:46080
  v_mfma_f32_16x16x32_bf16 v[244:247], v[136:139], a[20:23], v[244:247]
  ds_read_b64_tr_b16 v[150:151], v23 offset:50688
  v_mfma_f32_16x16x32_bf16 v[248:251], v[136:139], a[24:27], v[248:251]
  ds_read_b64_tr_b16 v[152:153], v23 offset:0
  v_mfma_f32_16x16x32_bf16 v[252:255], v[136:139], a[28:31], v[252:255]
  ds_read_b64_tr_b16 v[154:155], v23 offset:4608
  v_mfma_f32_16x16x32_bf16 v[240:243], v[140:143], a[32:35], v[240:243]
  ds_read_b64_tr_b16 v[156:157], v23 offset:9216
  v_mfma_f32_16x16x32_bf16 v[244:247], v[140:143], a[36:39], v[244:247]
  ds_read_b64_tr_b16 v[158:159], v23 offset:13824
  v_mfma_f32_16x16x32_bf16 v[248:251], v[140:143], a[40:43], v[248:251]
  v_mfma_f32_16x16x32_bf16 v[252:255], v[140:143], a[44:47], v[252:255]
  v_mfma_f32_16x16x32_bf16 v[240:243], v[144:147], a[48:51], v[240:243]
  v_mfma_f32_16x16x32_bf16 v[244:247], v[144:147], a[52:55], v[244:247]
  v_mfma_f32_16x16x32_bf16 v[248:251], v[144:147], a[56:59], v[248:251]
  v_mfma_f32_16x16x32_bf16 v[252:255], v[144:147], a[60:63], v[252:255]
  s_waitcnt lgkmcnt(0)
  v_mfma_f32_16x16x32_bf16 a[128:131], v[148:151], a[16:19], a[128:131]
  ds_read_b64_tr_b16 v[136:137], v23 offset:46112
  v_mfma_f32_16x16x32_bf16 a[132:135], v[148:151], a[20:23], a[132:135]
  ds_read_b64_tr_b16 v[138:139], v23 offset:50720
  v_mfma_f32_16x16x32_bf16 a[136:139], v[148:151], a[24:27], a[136:139]
  ds_read_b64_tr_b16 v[140:141], v23 offset:32
  v_mfma_f32_16x16x32_bf16 a[140:143], v[148:151], a[28:31], a[140:143]
  ds_read_b64_tr_b16 v[142:143], v23 offset:4640
  v_cvt_pk_bf16_f32 v72, v240, v241
  v_cvt_pk_bf16_f32 v73, v242, v243
  v_mfma_f32_16x16x32_bf16 a[128:131], v[152:155], a[32:35], a[128:131]
  ds_read_b64_tr_b16 v[144:145], v23 offset:9248
  v_cvt_pk_bf16_f32 v74, v244, v245
  v_cvt_pk_bf16_f32 v75, v246, v247
  v_mfma_f32_16x16x32_bf16 a[132:135], v[152:155], a[36:39], a[132:135]
  ds_read_b64_tr_b16 v[146:147], v23 offset:13856
  buffer_store_dwordx4 v[72:75], v46, s[12:15], s92 offen offset:0 sc1
  v_mfma_f32_16x16x32_bf16 a[136:139], v[152:155], a[40:43], a[136:139]
  v_cvt_pk_bf16_f32 v84, v248, v249
  v_cvt_pk_bf16_f32 v85, v250, v251
  v_cvt_pk_bf16_f32 v86, v252, v253
  v_mfma_f32_16x16x32_bf16 a[140:143], v[152:155], a[44:47], a[140:143]
  v_cvt_pk_bf16_f32 v87, v254, v255
  v_mfma_f32_16x16x32_bf16 a[128:131], v[156:159], a[48:51], a[128:131]
  buffer_store_dwordx4 v[84:87], v46, s[12:15], s93 offen offset:0 sc1
  v_mfma_f32_16x16x32_bf16 a[132:135], v[156:159], a[52:55], a[132:135]
  v_mfma_f32_16x16x32_bf16 a[136:139], v[156:159], a[56:59], a[136:139]
  v_mfma_f32_16x16x32_bf16 a[140:143], v[156:159], a[60:63], a[140:143]
  s_waitcnt lgkmcnt(0)
  v_mfma_f32_16x16x32_bf16 a[144:147], v[136:139], a[16:19], a[144:147]
  ds_read_b64_tr_b16 v[148:149], v23 offset:46144
  v_mfma_f32_16x16x32_bf16 a[148:151], v[136:139], a[20:23], a[148:151]
  ds_read_b64_tr_b16 v[150:151], v23 offset:50752
  v_mfma_f32_16x16x32_bf16 a[152:155], v[136:139], a[24:27], a[152:155]
  ds_read_b64_tr_b16 v[152:153], v23 offset:64
  v_mfma_f32_16x16x32_bf16 a[156:159], v[136:139], a[28:31], a[156:159]
  ds_read_b64_tr_b16 v[154:155], v23 offset:4672
  v_mfma_f32_16x16x32_bf16 a[144:147], v[140:143], a[32:35], a[144:147]
  ds_read_b64_tr_b16 v[156:157], v23 offset:9280
  v_mfma_f32_16x16x32_bf16 a[148:151], v[140:143], a[36:39], a[148:151]
  ds_read_b64_tr_b16 v[158:159], v23 offset:13888
  v_mfma_f32_16x16x32_bf16 a[152:155], v[140:143], a[40:43], a[152:155]
  v_mfma_f32_16x16x32_bf16 a[156:159], v[140:143], a[44:47], a[156:159]
  v_mfma_f32_16x16x32_bf16 a[144:147], v[144:147], a[48:51], a[144:147]
  v_mfma_f32_16x16x32_bf16 a[148:151], v[144:147], a[52:55], a[148:151]
  v_mfma_f32_16x16x32_bf16 a[152:155], v[144:147], a[56:59], a[152:155]
  v_mfma_f32_16x16x32_bf16 a[156:159], v[144:147], a[60:63], a[156:159]
  s_waitcnt lgkmcnt(0)
  v_mfma_f32_16x16x32_bf16 a[160:163], v[148:151], a[16:19], a[160:163]
  ds_read_b64_tr_b16 v[136:137], v23 offset:46176
  v_mfma_f32_16x16x32_bf16 a[164:167], v[148:151], a[20:23], a[164:167]
  ds_read_b64_tr_b16 v[138:139], v23 offset:50784
  v_mfma_f32_16x16x32_bf16 a[168:171], v[148:151], a[24:27], a[168:171]
  ds_read_b64_tr_b16 v[140:141], v23 offset:96
  v_mfma_f32_16x16x32_bf16 a[172:175], v[148:151], a[28:31], a[172:175]
  ds_read_b64_tr_b16 v[142:143], v23 offset:4704
  v_accvgpr_read_b32 v88, a128
  v_accvgpr_read_b32 v89, a129
  v_mfma_f32_16x16x32_bf16 a[160:163], v[152:155], a[32:35], a[160:163]
  ds_read_b64_tr_b16 v[144:145], v23 offset:9312
  v_accvgpr_read_b32 v90, a130
  v_accvgpr_read_b32 v91, a131
  v_mfma_f32_16x16x32_bf16 a[164:167], v[152:155], a[36:39], a[164:167]
  ds_read_b64_tr_b16 v[146:147], v23 offset:13920
  v_accvgpr_read_b32 v92, a144
  v_accvgpr_read_b32 v93, a145
  v_mfma_f32_16x16x32_bf16 a[168:171], v[152:155], a[40:43], a[168:171]
  v_accvgpr_read_b32 v94, a146
  v_accvgpr_read_b32 v95, a147
  v_cvt_pk_bf16_f32 v96, v88, v89
  v_mfma_f32_16x16x32_bf16 a[172:175], v[152:155], a[44:47], a[172:175]
  v_cvt_pk_bf16_f32 v97, v90, v91
  v_cvt_pk_bf16_f32 v98, v92, v93
  v_cvt_pk_bf16_f32 v99, v94, v95
  v_mfma_f32_16x16x32_bf16 a[160:163], v[156:159], a[48:51], a[160:163]
  buffer_store_dwordx4 v[96:99], v44, s[12:15], s92 offen offset:0 sc1
  v_mfma_f32_16x16x32_bf16 a[164:167], v[156:159], a[52:55], a[164:167]
  v_accvgpr_read_b32 v100, a132
  v_accvgpr_read_b32 v101, a133
  v_accvgpr_read_b32 v102, a134
  v_mfma_f32_16x16x32_bf16 a[168:171], v[156:159], a[56:59], a[168:171]
  v_accvgpr_read_b32 v103, a135
  v_accvgpr_read_b32 v104, a148
  v_accvgpr_read_b32 v105, a149
  v_mfma_f32_16x16x32_bf16 a[172:175], v[156:159], a[60:63], a[172:175]
  s_waitcnt lgkmcnt(0)
  v_accvgpr_read_b32 v106, a150
  v_accvgpr_read_b32 v107, a151
  v_cvt_pk_bf16_f32 v108, v100, v101
  v_mfma_f32_16x16x32_bf16 a[176:179], v[136:139], a[16:19], a[176:179]
  ds_read_b64_tr_b16 v[148:149], v23 offset:46208
  v_cvt_pk_bf16_f32 v109, v102, v103
  v_cvt_pk_bf16_f32 v110, v104, v105
  v_mfma_f32_16x16x32_bf16 a[180:183], v[136:139], a[20:23], a[180:183]
  ds_read_b64_tr_b16 v[150:151], v23 offset:50816
  v_cvt_pk_bf16_f32 v111, v106, v107
  v_mfma_f32_16x16x32_bf16 a[184:187], v[136:139], a[24:27], a[184:187]
  ds_read_b64_tr_b16 v[152:153], v23 offset:128
  buffer_store_dwordx4 v[108:111], v44, s[12:15], s92 offen offset:1024 sc1
  v_mfma_f32_16x16x32_bf16 a[188:191], v[136:139], a[28:31], a[188:191]
  ds_read_b64_tr_b16 v[154:155], v23 offset:4736
  v_accvgpr_read_b32 v64, a136
  v_accvgpr_read_b32 v65, a137
  v_mfma_f32_16x16x32_bf16 a[176:179], v[140:143], a[32:35], a[176:179]
  ds_read_b64_tr_b16 v[156:157], v23 offset:9344
  v_accvgpr_read_b32 v66, a138
  v_accvgpr_read_b32 v67, a139
  v_mfma_f32_16x16x32_bf16 a[180:183], v[140:143], a[36:39], a[180:183]
  ds_read_b64_tr_b16 v[158:159], v23 offset:13952
  v_accvgpr_read_b32 v68, a152
  v_accvgpr_read_b32 v69, a153
  v_mfma_f32_16x16x32_bf16 a[184:187], v[140:143], a[40:43], a[184:187]
  v_accvgpr_read_b32 v70, a154
  v_accvgpr_read_b32 v71, a155
  v_cvt_pk_bf16_f32 v72, v64, v65
  v_mfma_f32_16x16x32_bf16 a[188:191], v[140:143], a[44:47], a[188:191]
  v_cvt_pk_bf16_f32 v73, v66, v67
  v_cvt_pk_bf16_f32 v74, v68, v69
  v_cvt_pk_bf16_f32 v75, v70, v71
  v_mfma_f32_16x16x32_bf16 a[176:179], v[144:147], a[48:51], a[176:179]
  buffer_store_dwordx4 v[72:75], v44, s[12:15], s93 offen offset:0 sc1
  v_mfma_f32_16x16x32_bf16 a[180:183], v[144:147], a[52:55], a[180:183]
  v_accvgpr_read_b32 v76, a140
  v_accvgpr_read_b32 v77, a141
  v_accvgpr_read_b32 v78, a142
  v_mfma_f32_16x16x32_bf16 a[184:187], v[144:147], a[56:59], a[184:187]
  v_accvgpr_read_b32 v79, a143
  v_accvgpr_read_b32 v80, a156
  v_accvgpr_read_b32 v81, a157
  v_mfma_f32_16x16x32_bf16 a[188:191], v[144:147], a[60:63], a[188:191]
  s_waitcnt lgkmcnt(0)
  v_accvgpr_read_b32 v82, a158
  v_accvgpr_read_b32 v83, a159
  v_cvt_pk_bf16_f32 v84, v76, v77
  v_mfma_f32_16x16x32_bf16 a[192:195], v[148:151], a[16:19], a[192:195]
  ds_read_b64_tr_b16 v[136:137], v23 offset:46240
  v_cvt_pk_bf16_f32 v85, v78, v79
  v_cvt_pk_bf16_f32 v86, v80, v81
  v_mfma_f32_16x16x32_bf16 a[196:199], v[148:151], a[20:23], a[196:199]
  ds_read_b64_tr_b16 v[138:139], v23 offset:50848
  v_cvt_pk_bf16_f32 v87, v82, v83
  v_mfma_f32_16x16x32_bf16 a[200:203], v[148:151], a[24:27], a[200:203]
  ds_read_b64_tr_b16 v[140:141], v23 offset:160
  buffer_store_dwordx4 v[84:87], v44, s[12:15], s93 offen offset:1024 sc1
  v_mfma_f32_16x16x32_bf16 a[204:207], v[148:151], a[28:31], a[204:207]
  ds_read_b64_tr_b16 v[142:143], v23 offset:4768
  v_accvgpr_read_b32 v88, a160
  v_accvgpr_read_b32 v89, a161
  v_mfma_f32_16x16x32_bf16 a[192:195], v[152:155], a[32:35], a[192:195]
  ds_read_b64_tr_b16 v[144:145], v23 offset:9376
  v_accvgpr_read_b32 v90, a162
  v_accvgpr_read_b32 v91, a163
  v_mfma_f32_16x16x32_bf16 a[196:199], v[152:155], a[36:39], a[196:199]
  ds_read_b64_tr_b16 v[146:147], v23 offset:13984
  v_accvgpr_read_b32 v92, a176
  v_accvgpr_read_b32 v93, a177
  v_mfma_f32_16x16x32_bf16 a[200:203], v[152:155], a[40:43], a[200:203]
  v_accvgpr_read_b32 v94, a178
  v_accvgpr_read_b32 v95, a179
  v_cvt_pk_bf16_f32 v96, v88, v89
  v_mfma_f32_16x16x32_bf16 a[204:207], v[152:155], a[44:47], a[204:207]
  v_cvt_pk_bf16_f32 v97, v90, v91
  v_cvt_pk_bf16_f32 v98, v92, v93
  v_cvt_pk_bf16_f32 v99, v94, v95
  v_mfma_f32_16x16x32_bf16 a[192:195], v[156:159], a[48:51], a[192:195]
  buffer_store_dwordx4 v[96:99], v44, s[12:15], s92 offen offset:2048 sc1
  v_mfma_f32_16x16x32_bf16 a[196:199], v[156:159], a[52:55], a[196:199]
  v_accvgpr_read_b32 v100, a164
  v_accvgpr_read_b32 v101, a165
  v_accvgpr_read_b32 v102, a166
  v_mfma_f32_16x16x32_bf16 a[200:203], v[156:159], a[56:59], a[200:203]
  v_accvgpr_read_b32 v103, a167
  v_accvgpr_read_b32 v104, a180
  v_accvgpr_read_b32 v105, a181
  v_mfma_f32_16x16x32_bf16 a[204:207], v[156:159], a[60:63], a[204:207]
  s_waitcnt lgkmcnt(0)
  v_accvgpr_read_b32 v106, a182
  v_accvgpr_read_b32 v107, a183
  v_cvt_pk_bf16_f32 v108, v100, v101
  v_mfma_f32_16x16x32_bf16 a[208:211], v[136:139], a[16:19], a[208:211]
  ds_read_b64_tr_b16 v[148:149], v23 offset:46272
  v_cvt_pk_bf16_f32 v109, v102, v103
  v_cvt_pk_bf16_f32 v110, v104, v105
  v_mfma_f32_16x16x32_bf16 a[212:215], v[136:139], a[20:23], a[212:215]
  ds_read_b64_tr_b16 v[150:151], v23 offset:50880
  v_cvt_pk_bf16_f32 v111, v106, v107
  v_mfma_f32_16x16x32_bf16 a[216:219], v[136:139], a[24:27], a[216:219]
  ds_read_b64_tr_b16 v[152:153], v23 offset:192
  buffer_store_dwordx4 v[108:111], v44, s[12:15], s92 offen offset:3072 sc1
  v_mfma_f32_16x16x32_bf16 a[220:223], v[136:139], a[28:31], a[220:223]
  ds_read_b64_tr_b16 v[154:155], v23 offset:4800
  ds_read_b64_tr_b16 v[136:137], v23 offset:46304
  ds_read_b64_tr_b16 v[138:139], v23 offset:50912
  v_mfma_f32_16x16x32_bf16 a[208:211], v[140:143], a[32:35], a[208:211]
  ds_read_b64_tr_b16 v[156:157], v23 offset:9408
  v_accvgpr_read_b32 v64, a168
  v_accvgpr_read_b32 v65, a169
  v_mfma_f32_16x16x32_bf16 a[212:215], v[140:143], a[36:39], a[212:215]
  ds_read_b64_tr_b16 v[158:159], v23 offset:14016
  v_accvgpr_read_b32 v66, a170
  v_accvgpr_read_b32 v67, a171
  v_mfma_f32_16x16x32_bf16 a[216:219], v[140:143], a[40:43], a[216:219]
  v_accvgpr_read_b32 v68, a184
  v_accvgpr_read_b32 v69, a185
  v_accvgpr_read_b32 v70, a186
  v_mfma_f32_16x16x32_bf16 a[220:223], v[140:143], a[44:47], a[220:223]
TP_17:
  s_cbranch_execz TR_3
  ds_read_b64_tr_b16 v[140:141], v23 offset:224
  ds_read_b64_tr_b16 v[142:143], v23 offset:4832
  v_accvgpr_read_b32 v71, a187
  v_mfma_f32_16x16x32_bf16 a[208:211], v[144:147], a[48:51], a[208:211]
  v_cvt_pk_bf16_f32 v72, v64, v65
  v_cvt_pk_bf16_f32 v73, v66, v67
  v_cvt_pk_bf16_f32 v74, v68, v69
  v_mfma_f32_16x16x32_bf16 a[212:215], v[144:147], a[52:55], a[212:215]
  v_cvt_pk_bf16_f32 v75, v70, v71
  v_mfma_f32_16x16x32_bf16 a[216:219], v[144:147], a[56:59], a[216:219]
  buffer_store_dwordx4 v[72:75], v44, s[12:15], s93 offen offset:2048 sc1
  v_mfma_f32_16x16x32_bf16 a[220:223], v[144:147], a[60:63], a[220:223]
  s_waitcnt lgkmcnt(2)
  ds_read_b64_tr_b16 v[144:145], v23 offset:9440
  ds_read_b64_tr_b16 v[146:147], v23 offset:14048
  v_accvgpr_read_b32 v76, a172
  v_mfma_f32_16x16x32_bf16 a[224:227], v[148:151], a[16:19], a[224:227]
  v_accvgpr_read_b32 v77, a173
  v_accvgpr_read_b32 v78, a174
  v_accvgpr_read_b32 v79, a175
  v_mfma_f32_16x16x32_bf16 a[224:227], v[152:155], a[32:35], a[224:227]
  v_accvgpr_read_b32 v80, a188
  v_accvgpr_read_b32 v81, a189
  v_accvgpr_read_b32 v82, a190
  v_mfma_f32_16x16x32_bf16 a[224:227], v[156:159], a[48:51], a[224:227]
  s_waitcnt lgkmcnt(0)
  v_accvgpr_read_b32 v83, a191
  v_cvt_pk_bf16_f32 v84, v76, v77
  v_cvt_pk_bf16_f32 v85, v78, v79
  v_mfma_f32_16x16x32_bf16 a[240:243], v[136:139], a[16:19], a[240:243]
  v_cvt_pk_bf16_f32 v86, v80, v81
  v_cvt_pk_bf16_f32 v87, v82, v83
  v_mfma_f32_16x16x32_bf16 a[240:243], v[140:143], a[32:35], a[240:243]
  buffer_store_dwordx4 v[84:87], v44, s[12:15], s93 offen offset:3072 sc1
  v_mfma_f32_16x16x32_bf16 a[240:243], v[144:147], a[48:51], a[240:243]
  v_accvgpr_read_b32 v88, a192
  v_accvgpr_read_b32 v89, a193
  v_accvgpr_read_b32 v90, a194
  v_mfma_f32_16x16x32_bf16 a[228:231], v[148:151], a[20:23], a[228:231]
  v_accvgpr_read_b32 v91, a195
  v_accvgpr_read_b32 v92, a208
  v_accvgpr_read_b32 v93, a209
  v_mfma_f32_16x16x32_bf16 a[228:231], v[152:155], a[36:39], a[228:231]
  v_accvgpr_read_b32 v94, a210
  v_accvgpr_read_b32 v95, a211
  v_cvt_pk_bf16_f32 v96, v88, v89
  v_mfma_f32_16x16x32_bf16 a[228:231], v[156:159], a[52:55], a[228:231]
  v_cvt_pk_bf16_f32 v97, v90, v91
  v_cvt_pk_bf16_f32 v98, v92, v93
  v_cvt_pk_bf16_f32 v99, v94, v95
  v_mfma_f32_16x16x32_bf16 a[244:247], v[136:139], a[20:23], a[244:247]
  buffer_store_dwordx4 v[96:99], v45, s[12:15], s92 offen offset:0 sc1
  v_mfma_f32_16x16x32_bf16 a[244:247], v[140:143], a[36:39], a[244:247]
  v_accvgpr_read_b32 v100, a196
  v_accvgpr_read_b32 v101, a197
  v_accvgpr_read_b32 v102, a198
  v_mfma_f32_16x16x32_bf16 a[244:247], v[144:147], a[52:55], a[244:247]
  v_accvgpr_read_b32 v103, a199
  v_accvgpr_read_b32 v104, a212
  v_accvgpr_read_b32 v105, a213
  v_mfma_f32_16x16x32_bf16 a[232:235], v[148:151], a[24:27], a[232:235]
  v_accvgpr_read_b32 v106, a214
  v_accvgpr_read_b32 v107, a215
  v_cvt_pk_bf16_f32 v108, v100, v101
  v_mfma_f32_16x16x32_bf16 a[232:235], v[152:155], a[40:43], a[232:235]
  v_cvt_pk_bf16_f32 v109, v102, v103
  v_cvt_pk_bf16_f32 v110, v104, v105
  v_cvt_pk_bf16_f32 v111, v106, v107
  v_mfma_f32_16x16x32_bf16 a[232:235], v[156:159], a[56:59], a[232:235]
  buffer_store_dwordx4 v[108:111], v45, s[12:15], s92 offen offset:1024 sc1
  v_mfma_f32_16x16x32_bf16 a[248:251], v[136:139], a[24:27], a[248:251]
  v_accvgpr_read_b32 v64, a200
  v_accvgpr_read_b32 v65, a201
  v_accvgpr_read_b32 v66, a202
  v_mfma_f32_16x16x32_bf16 a[248:251], v[140:143], a[40:43], a[248:251]
  v_accvgpr_read_b32 v67, a203
  v_accvgpr_read_b32 v68, a216
  v_accvgpr_read_b32 v69, a217
  v_mfma_f32_16x16x32_bf16 a[248:251], v[144:147], a[56:59], a[248:251]
  v_accvgpr_read_b32 v70, a218
  v_accvgpr_read_b32 v71, a219
  v_cvt_pk_bf16_f32 v72, v64, v65
  v_mfma_f32_16x16x32_bf16 a[236:239], v[148:151], a[28:31], a[236:239]
  v_cvt_pk_bf16_f32 v73, v66, v67
  v_cvt_pk_bf16_f32 v74, v68, v69
  v_cvt_pk_bf16_f32 v75, v70, v71
  v_mfma_f32_16x16x32_bf16 a[236:239], v[152:155], a[44:47], a[236:239]
  buffer_store_dwordx4 v[72:75], v45, s[12:15], s93 offen offset:0 sc1
  v_mfma_f32_16x16x32_bf16 a[236:239], v[156:159], a[60:63], a[236:239]
  v_accvgpr_read_b32 v76, a204
  v_accvgpr_read_b32 v77, a205
  v_accvgpr_read_b32 v78, a206
  v_mfma_f32_16x16x32_bf16 a[252:255], v[136:139], a[28:31], a[252:255]
  v_accvgpr_read_b32 v79, a207
  v_accvgpr_read_b32 v80, a220
  v_accvgpr_read_b32 v81, a221
  v_mfma_f32_16x16x32_bf16 a[252:255], v[140:143], a[44:47], a[252:255]
  v_accvgpr_read_b32 v82, a222
  v_accvgpr_read_b32 v83, a223
  v_cvt_pk_bf16_f32 v84, v76, v77
  v_mfma_f32_16x16x32_bf16 a[252:255], v[144:147], a[60:63], a[252:255]
  v_cvt_pk_bf16_f32 v85, v78, v79
  v_cvt_pk_bf16_f32 v86, v80, v81
  v_cvt_pk_bf16_f32 v87, v82, v83
  s_nop 7
  buffer_store_dwordx4 v[84:87], v45, s[12:15], s93 offen offset:1024 sc1
  v_accvgpr_read_b32 v88, a224
  v_accvgpr_read_b32 v89, a225
  v_accvgpr_read_b32 v90, a226
  v_accvgpr_read_b32 v91, a227
  v_accvgpr_read_b32 v92, a240
  v_accvgpr_read_b32 v93, a241
  v_accvgpr_read_b32 v94, a242
  v_accvgpr_read_b32 v95, a243
  v_cvt_pk_bf16_f32 v96, v88, v89
  v_cvt_pk_bf16_f32 v97, v90, v91
  v_cvt_pk_bf16_f32 v98, v92, v93
  v_cvt_pk_bf16_f32 v99, v94, v95
  buffer_store_dwordx4 v[96:99], v45, s[12:15], s92 offen offset:2048 sc1
  v_accvgpr_read_b32 v100, a228
  v_accvgpr_read_b32 v101, a229
  v_accvgpr_read_b32 v102, a230
  v_accvgpr_read_b32 v103, a231
  v_accvgpr_read_b32 v104, a244
  v_accvgpr_read_b32 v105, a245
  v_accvgpr_read_b32 v106, a246
  v_accvgpr_read_b32 v107, a247
  v_cvt_pk_bf16_f32 v108, v100, v101
  v_cvt_pk_bf16_f32 v109, v102, v103
  v_cvt_pk_bf16_f32 v110, v104, v105
  v_cvt_pk_bf16_f32 v111, v106, v107
  buffer_store_dwordx4 v[108:111], v45, s[12:15], s92 offen offset:3072 sc1
  v_accvgpr_read_b32 v64, a232
  v_accvgpr_read_b32 v65, a233
  v_accvgpr_read_b32 v66, a234
  v_accvgpr_read_b32 v67, a235
  v_accvgpr_read_b32 v68, a248
  v_accvgpr_read_b32 v69, a249
  v_accvgpr_read_b32 v70, a250
  v_accvgpr_read_b32 v71, a251
  v_cvt_pk_bf16_f32 v72, v64, v65
  v_cvt_pk_bf16_f32 v73, v66, v67
  v_cvt_pk_bf16_f32 v74, v68, v69
  v_cvt_pk_bf16_f32 v75, v70, v71
  buffer_store_dwordx4 v[72:75], v45, s[12:15], s93 offen offset:2048 sc1
  v_accvgpr_read_b32 v76, a236
  v_accvgpr_read_b32 v77, a237
  v_accvgpr_read_b32 v78, a238
  v_accvgpr_read_b32 v79, a239
  v_accvgpr_read_b32 v80, a252
  v_accvgpr_read_b32 v81, a253
  v_accvgpr_read_b32 v82, a254
  v_accvgpr_read_b32 v83, a255
  v_cvt_pk_bf16_f32 v84, v76, v77
  v_cvt_pk_bf16_f32 v85, v78, v79
  v_cvt_pk_bf16_f32 v86, v80, v81
  v_cvt_pk_bf16_f32 v87, v82, v83
  buffer_store_dwordx4 v[84:87], v45, s[12:15], s93 offen offset:3072 sc1
  s_branch K_tail
K_U:
TP_18:
  s_cbranch_execz TP_22
  s_and_b32 s3, s17, 3
  s_mul_i32 s3, s3, 9216
  s_mul_i32 s60, s18, 2304
  s_add_u32 s3, s3, s60
  v_add_u32 v20, s3, v3
  s_and_b32 s4, s16, 3
  s_mul_i32 s61, s4, 1327104
  s_add_u32 s61, s61, 16777216
  s_mul_i32 s62, s4, 4718592
  s_lshl_b32 s54, s4, 8
  s_add_u32 s54, s54, 26284032
  v_min_u32 v31, 53, v2
  v_lshlrev_b32 v31, 2, v31
  v_and_b32 v4, 31, v2
  v_lshlrev_b32 v4, 4, v4
  v_lshrrev_b32 v5, 5, v2
  v_lshl_add_u32 v4, v5, 16, v4
  s_lshl_b32 s3, s18, 14
  s_lshr_b32 s4, s17, 2
  s_lshl_b32 s4, s4, 9
  s_add_u32 s3, s3, s4
  v_add_u32 v21, s3, v4
  v_add_u32 v22, 3040, v21
  v_add_u32 v23, 6080, v21
  v_add_u32 v24, 9120, v21
  s_mul_i32 s63, s18, 4224
  s_add_u32 s63, s63, 9216
  v_lshrrev_b32 v4, 2, v2
  v_mul_u32_u24 v4, 1056, v4
  v_and_b32 v5, 3, v2
  v_lshl_add_u32 v4, v5, 3, v4
  s_lshl_b32 s3, s18, 7
  s_add_u32 s3, s3, 9216
  v_add_u32 v25, s3, v4
  v_add_u32 v26, 52224, v25
  v_add_u32 v27, 104448, v25
  v_mov_b32 v28, v3
  v_mov_b32 v33, 2
  v_add_u32 v29, 52224, v3
  v_add_u32 v30, 104448, v3
  buffer_load_dword v32, v31, s[12:15], s54 offen sc1
  v_mfma_f32_16x16x32_bf16 v[64:67], a[128:131], v[192:195], v[160:163]
  v_exp_f32 v112, v112
  v_mfma_f32_16x16x32_bf16 v[68:71], a[128:131], v[208:211], v[164:167]
  v_exp_f32 v113, v113
  v_mfma_f32_16x16x32_bf16 v[72:75], a[128:131], v[224:227], v[168:171]
  ds_read_b64_tr_b16 a[160:161], v52 offset:8192
  v_cvt_pk_bf16_f32 v146, v112, v113
  v_mfma_f32_16x16x32_bf16 v[76:79], a[128:131], v[240:243], v[172:175]
  v_exp_f32 v114, v114
  v_mfma_f32_16x16x32_bf16 v[64:67], a[132:135], v[196:199], v[64:67]
  ds_read_b64_tr_b16 a[162:163], v52 offset:8704
  ds_read_b64_tr_b16 a[164:165], v52 offset:8224
  v_mfma_f32_16x16x32_bf16 v[68:71], a[132:135], v[212:215], v[68:71]
  v_exp_f32 v115, v115
  v_mfma_f32_16x16x32_bf16 v[72:75], a[132:135], v[228:231], v[72:75]
  ds_read_b64_tr_b16 a[166:167], v52 offset:8736
  v_cvt_pk_bf16_f32 v147, v114, v115
  v_mfma_f32_16x16x32_bf16 v[76:79], a[132:135], v[244:247], v[76:79]
  v_exp_f32 v116, v116
  v_mfma_f32_16x16x32_bf16 v[64:67], a[136:139], v[200:203], v[64:67]
  ds_read_b64_tr_b16 a[168:169], v52 offset:8256
  ds_read_b64_tr_b16 a[170:171], v52 offset:8768
  v_mfma_f32_16x16x32_bf16 v[68:71], a[136:139], v[216:219], v[68:71]
  v_exp_f32 v117, v117
  v_mfma_f32_16x16x32_bf16 v[72:75], a[136:139], v[232:235], v[72:75]
  ds_read_b64_tr_b16 a[172:173], v52 offset:8288
  v_cvt_pk_bf16_f32 v150, v116, v117
  v_mfma_f32_16x16x32_bf16 v[76:79], a[136:139], v[248:251], v[76:79]
  v_exp_f32 v118, v118
  v_mfma_f32_16x16x32_bf16 v[64:67], a[140:143], v[204:207], v[64:67]
  ds_read_b64_tr_b16 a[174:175], v52 offset:8800
  v_mfma_f32_16x16x32_bf16 v[68:71], a[140:143], v[220:223], v[68:71]
  v_exp_f32 v119, v119
  v_mfma_f32_16x16x32_bf16 v[72:75], a[140:143], v[236:239], v[72:75]
  ds_read_b64_tr_b16 a[176:177], v52 offset:8320
  v_cvt_pk_bf16_f32 v151, v118, v119
  v_mfma_f32_16x16x32_bf16 v[76:79], a[140:143], v[252:255], v[76:79]
  v_exp_f32 v120, v120
  v_mfma_f32_16x16x32_bf16 v[80:83], a[144:147], v[192:195], v[160:163]
  v_exp_f32 v121, v121
  v_mfma_f32_16x16x32_bf16 v[84:87], a[144:147], v[208:211], v[164:167]
  ds_read_b64_tr_b16 a[178:179], v52 offset:8832
  ds_read_b64_tr_b16 a[180:181], v52 offset:8352
  v_cvt_pk_bf16_f32 v154, v120, v121
  v_mfma_f32_16x16x32_bf16 v[88:91], a[144:147], v[224:227], v[168:171]
  v_exp_f32 v122, v122
  v_mfma_f32_16x16x32_bf16 v[92:95], a[144:147], v[240:243], v[172:175]
  ds_read_b64_tr_b16 a[182:183], v52 offset:8864
  ds_read_b64_tr_b16 a[184:185], v52 offset:8384
  v_mfma_f32_16x16x32_bf16 v[80:83], a[148:151], v[196:199], v[80:83]
  v_exp_f32 v123, v123
  v_mfma_f32_16x16x32_bf16 v[84:87], a[148:151], v[212:215], v[84:87]
  ds_read_b64_tr_b16 a[186:187], v52 offset:8896
  v_cvt_pk_bf16_f32 v155, v122, v123
  v_mfma_f32_16x16x32_bf16 v[88:91], a[148:151], v[228:231], v[88:91]
  v_exp_f32 v124, v124
  v_mfma_f32_16x16x32_bf16 v[92:95], a[148:151], v[244:247], v[92:95]
  ds_read_b64_tr_b16 a[188:189], v52 offset:8416
  v_add_f32 v62, v62, v120
  v_mfma_f32_16x16x32_bf16 v[80:83], a[152:155], v[200:203], v[80:83]
  v_exp_f32 v125, v125
  v_mfma_f32_16x16x32_bf16 v[84:87], a[152:155], v[216:219], v[84:87]
  ds_read_b64_tr_b16 a[190:191], v52 offset:8928
  v_cvt_pk_bf16_f32 v158, v124, v125
  v_mfma_f32_16x16x32_bf16 v[88:91], a[152:155], v[232:235], v[88:91]
  v_exp_f32 v126, v126
  v_mfma_f32_16x16x32_bf16 v[92:95], a[152:155], v[248:251], v[92:95]
  v_add_f32 v62, v62, v121
  v_add_f32 v62, v62, v122
  v_mfma_f32_16x16x32_bf16 v[80:83], a[156:159], v[204:207], v[80:83]
  v_exp_f32 v127, v127
  v_mfma_f32_16x16x32_bf16 v[84:87], a[156:159], v[220:223], v[84:87]
  v_cvt_pk_bf16_f32 v159, v126, v127
  v_add_f32 v62, v62, v123
  v_mfma_f32_16x16x32_bf16 v[88:91], a[156:159], v[236:239], v[88:91]
  v_add_f32 v63, v63, v124
  v_add_f32 v63, v63, v125
  v_mfma_f32_16x16x32_bf16 v[92:95], a[156:159], v[252:255], v[92:95]
  s_waitcnt vmcnt(6) lgkmcnt(0)
  s_barrier
  v_mfma_f32_16x16x32_bf16 v[176:179], v[36:39], v[144:147], v[176:179]
  v_exp_f32 v64, v64
  v_mfma_f32_16x16x32_bf16 v[180:183], v[36:39], v[148:151], v[180:183]
  ds_read_b128 a[128:131], v48 offset:16640
  s_waitcnt vmcnt(0)
  v_cmp_gt_u32 s[6:7], 1, v32
  s_cmp_lg_u64 s[6:7], 0
  s_cbranch_scc1 SP_pU
RT_pU:
  v_mfma_f32_16x16x32_bf16 a[0:3], a[160:163], v[144:147], a[0:3]
  s_add_u32 m0, s63, 0
  v_exp_f32 v65, v65
  v_mfma_f32_16x16x32_bf16 a[4:7], a[160:163], v[148:151], a[4:7]
  ds_read_b128 a[132:135], v49 offset:16640
  v_cvt_pk_bf16_f32 v128, v64, v65
  v_mfma_f32_16x16x32_bf16 a[8:11], a[160:163], v[152:155], a[8:11]
  v_exp_f32 v66, v66
  v_mfma_f32_16x16x32_bf16 a[12:15], a[160:163], v[156:159], a[12:15]
  buffer_load_dwordx4 v21, s[40:43], s62 offen offset:0 lds
  v_add_f32 v63, v63, v126
  v_mfma_f32_16x16x32_bf16 a[16:19], a[164:167], v[144:147], a[16:19]
  v_exp_f32 v67, v67
  v_mfma_f32_16x16x32_bf16 a[20:23], a[164:167], v[148:151], a[20:23]
  ds_read_b128 a[136:139], v50 offset:16640
  v_cvt_pk_bf16_f32 v129, v66, v67
  v_mfma_f32_16x16x32_bf16 a[24:27], a[164:167], v[152:155], a[24:27]
  v_exp_f32 v68, v68
  v_mfma_f32_16x16x32_bf16 a[28:31], a[164:167], v[156:159], a[28:31]
  buffer_load_dwordx4 v22, s[40:43], s62 offen offset:1056 lds
  v_add_f32 v63, v63, v127
  v_mfma_f32_16x16x32_bf16 a[32:35], a[168:171], v[144:147], a[32:35]
  v_exp_f32 v69, v69
  v_mfma_f32_16x16x32_bf16 a[36:39], a[168:171], v[148:151], a[36:39]
  ds_read_b128 a[140:143], v51 offset:16640
  v_cvt_pk_bf16_f32 v132, v68, v69
  v_mfma_f32_16x16x32_bf16 a[40:43], a[168:171], v[152:155], a[40:43]
  v_exp_f32 v70, v70
  v_mfma_f32_16x16x32_bf16 a[44:47], a[168:171], v[156:159], a[44:47]
  buffer_load_dwordx4 v23, s[40:43], s62 offen offset:2112 lds
  buffer_load_dwordx4 v24, s[40:43], s62 offen offset:3168 lds
  v_mfma_f32_16x16x32_bf16 a[48:51], a[172:175], v[144:147], a[48:51]
  v_exp_f32 v71, v71
  v_mfma_f32_16x16x32_bf16 a[52:55], a[172:175], v[148:151], a[52:55]
  ds_read_b128 a[144:147], v48 offset:20736
  v_cvt_pk_bf16_f32 v133, v70, v71
  v_mfma_f32_16x16x32_bf16 a[56:59], a[172:175], v[152:155], a[56:59]
  s_add_u32 m0, s60, 0
  v_exp_f32 v72, v72
  v_mfma_f32_16x16x32_bf16 a[60:63], a[172:175], v[156:159], a[60:63]
  ds_read_b128 a[148:151], v49 offset:20736
  v_add_f32 v62, v62, v72
  v_mfma_f32_16x16x32_bf16 a[64:67], a[176:179], v[144:147], a[64:67]
  s_add_u32 s62, s62, 131072
  v_exp_f32 v73, v73
  v_mfma_f32_16x16x32_bf16 a[68:71], a[176:179], v[148:151], a[68:71]
  v_cvt_pk_bf16_f32 v136, v72, v73
  v_add_f32 v62, v62, v73
  v_mfma_f32_16x16x32_bf16 a[72:75], a[176:179], v[152:155], a[72:75]
  v_exp_f32 v74, v74
  v_mfma_f32_16x16x32_bf16 a[76:79], a[176:179], v[156:159], a[76:79]
  ds_read_b128 a[152:155], v50 offset:20736
  buffer_load_dwordx4 v20, s[12:15], s61 offen sc1 lds
  v_mfma_f32_16x16x32_bf16 a[80:83], a[180:183], v[144:147], a[80:83]
  v_exp_f32 v75, v75
  v_mfma_f32_16x16x32_bf16 a[84:87], a[180:183], v[148:151], a[84:87]
  v_cvt_pk_bf16_f32 v137, v74, v75
  v_add_f32 v62, v62, v74
  v_mfma_f32_16x16x32_bf16 a[88:91], a[180:183], v[152:155], a[88:91]
  v_exp_f32 v76, v76
  v_mfma_f32_16x16x32_bf16 a[92:95], a[180:183], v[156:159], a[92:95]
  ds_read_b128 a[156:159], v51 offset:20736
  buffer_load_dwordx4 v20, s[12:15], s61 offen offset:1024 sc1 lds
  v_mfma_f32_16x16x32_bf16 a[96:99], a[184:187], v[144:147], a[96:99]
  v_exp_f32 v77, v77
  v_mfma_f32_16x16x32_bf16 a[100:103], a[184:187], v[148:151], a[100:103]
  v_cvt_pk_bf16_f32 v140, v76, v77
  v_add_f32 v62, v62, v75
  v_mfma_f32_16x16x32_bf16 a[104:107], a[184:187], v[152:155], a[104:107]
  v_exp_f32 v78, v78
  v_mfma_f32_16x16x32_bf16 a[108:111], a[184:187], v[156:159], a[108:111]
  s_mov_b64 exec, 0xffff
  buffer_load_dwordx4 v20, s[12:15], s61 offen offset:2048 sc1 lds
  s_mov_b64 exec, -1
  v_mfma_f32_16x16x32_bf16 a[112:115], a[188:191], v[144:147], a[112:115]
  s_add_u32 s61, s61, 36864
  v_exp_f32 v79, v79
  v_mfma_f32_16x16x32_bf16 a[116:119], a[188:191], v[148:151], a[116:119]
  v_cvt_pk_bf16_f32 v141, v78, v79
  v_add_f32 v63, v63, v76
  v_add_f32 v63, v63, v79
  v_mfma_f32_16x16x32_bf16 a[120:123], a[188:191], v[152:155], a[120:123]
  v_add_f32 v63, v63, v77
  v_add_f32 v63, v63, v78
  v_mfma_f32_16x16x32_bf16 a[124:127], a[188:191], v[156:159], a[124:127]
  s_waitcnt lgkmcnt(0)
  v_mfma_f32_16x16x32_bf16 v[96:99], a[128:131], v[192:195], v[160:163]
  s_add_u32 m0, s63, 26112
  v_exp_f32 v80, v80
  v_mfma_f32_16x16x32_bf16 v[100:103], a[128:131], v[208:211], v[164:167]
  v_exp_f32 v81, v81
  v_mfma_f32_16x16x32_bf16 v[104:107], a[128:131], v[224:227], v[168:171]
  ds_read_b64_tr_b16 a[160:161], v52 offset:24832
  buffer_load_dwordx4 v21, s[40:43], s62 offen offset:0 lds
  v_cvt_pk_bf16_f32 v130, v80, v81
  v_mfma_f32_16x16x32_bf16 v[108:111], a[128:131], v[240:243], v[172:175]
  v_exp_f32 v82, v82
  v_mfma_f32_16x16x32_bf16 v[96:99], a[132:135], v[196:199], v[96:99]
  ds_read_b64_tr_b16 a[162:163], v52 offset:25344
  ds_read_b64_tr_b16 a[164:165], v52 offset:24864
  v_mfma_f32_16x16x32_bf16 v[100:103], a[132:135], v[212:215], v[100:103]
  buffer_load_dwordx4 v22, s[40:43], s62 offen offset:1056 lds
  v_exp_f32 v83, v83
  v_mfma_f32_16x16x32_bf16 v[104:107], a[132:135], v[228:231], v[104:107]
  ds_read_b64_tr_b16 a[166:167], v52 offset:25376
  v_cvt_pk_bf16_f32 v131, v82, v83
  v_mfma_f32_16x16x32_bf16 v[108:111], a[132:135], v[244:247], v[108:111]
  v_exp_f32 v84, v84
  v_mfma_f32_16x16x32_bf16 v[96:99], a[136:139], v[200:203], v[96:99]
  ds_read_b64_tr_b16 a[168:169], v52 offset:24896
  ds_read_b64_tr_b16 a[170:171], v52 offset:25408
  buffer_load_dwordx4 v23, s[40:43], s62 offen offset:2112 lds
  v_mfma_f32_16x16x32_bf16 v[100:103], a[136:139], v[216:219], v[100:103]
  v_exp_f32 v85, v85
  v_mfma_f32_16x16x32_bf16 v[104:107], a[136:139], v[232:235], v[104:107]
  ds_read_b64_tr_b16 a[172:173], v52 offset:24928
  v_cvt_pk_bf16_f32 v134, v84, v85
  v_mfma_f32_16x16x32_bf16 v[108:111], a[136:139], v[248:251], v[108:111]
  v_exp_f32 v86, v86
  v_mfma_f32_16x16x32_bf16 v[96:99], a[140:143], v[204:207], v[96:99]
  ds_read_b64_tr_b16 a[174:175], v52 offset:25440
  buffer_load_dwordx4 v24, s[40:43], s62 offen offset:3168 lds
  v_mfma_f32_16x16x32_bf16 v[100:103], a[140:143], v[220:223], v[100:103]
  s_add_u32 m0, s60, 26112
  v_exp_f32 v87, v87
  v_mfma_f32_16x16x32_bf16 v[104:107], a[140:143], v[236:239], v[104:107]
  ds_read_b64_tr_b16 a[176:177], v52 offset:24960
  v_cvt_pk_bf16_f32 v135, v86, v87
  v_mfma_f32_16x16x32_bf16 v[108:111], a[140:143], v[252:255], v[108:111]
  v_exp_f32 v88, v88
  v_mfma_f32_16x16x32_bf16 v[112:115], a[144:147], v[192:195], v[160:163]
  s_add_u32 s62, s62, 131072
  v_exp_f32 v89, v89
  v_mfma_f32_16x16x32_bf16 v[116:119], a[144:147], v[208:211], v[164:167]
  ds_read_b64_tr_b16 a[178:179], v52 offset:25472
  ds_read_b64_tr_b16 a[180:181], v52 offset:24992
  v_cvt_pk_bf16_f32 v138, v88, v89
  v_mfma_f32_16x16x32_bf16 v[120:123], a[144:147], v[224:227], v[168:171]
  v_exp_f32 v90, v90
  v_mfma_f32_16x16x32_bf16 v[124:127], a[144:147], v[240:243], v[172:175]
  ds_read_b64_tr_b16 a[182:183], v52 offset:25504
  ds_read_b64_tr_b16 a[184:185], v52 offset:25024
  buffer_load_dwordx4 v20, s[12:15], s61 offen sc1 lds
  v_mfma_f32_16x16x32_bf16 v[112:115], a[148:151], v[196:199], v[112:115]
  v_exp_f32 v91, v91
  v_mfma_f32_16x16x32_bf16 v[116:119], a[148:151], v[212:215], v[116:119]
  ds_read_b64_tr_b16 a[186:187], v52 offset:25536
  v_cvt_pk_bf16_f32 v139, v90, v91
  v_mfma_f32_16x16x32_bf16 v[120:123], a[148:151], v[228:231], v[120:123]
  v_exp_f32 v92, v92
  v_mfma_f32_16x16x32_bf16 v[124:127], a[148:151], v[244:247], v[124:127]
  ds_read_b64_tr_b16 a[188:189], v52 offset:25056
  buffer_load_dwordx4 v20, s[12:15], s61 offen offset:1024 sc1 lds
  v_mfma_f32_16x16x32_bf16 v[112:115], a[152:155], v[200:203], v[112:115]
  v_exp_f32 v93, v93
  v_mfma_f32_16x16x32_bf16 v[116:119], a[152:155], v[216:219], v[116:119]
  ds_read_b64_tr_b16 a[190:191], v52 offset:25568
  v_cvt_pk_bf16_f32 v142, v92, v93
  v_mfma_f32_16x16x32_bf16 v[120:123], a[152:155], v[232:235], v[120:123]
  v_exp_f32 v94, v94
  v_mfma_f32_16x16x32_bf16 v[124:127], a[152:155], v[248:251], v[124:127]
  s_mov_b64 exec, 0xffff
  buffer_load_dwordx4 v20, s[12:15], s61 offen offset:2048 sc1 lds
  s_mov_b64 exec, -1
  v_mfma_f32_16x16x32_bf16 v[112:115], a[156:159], v[204:207], v[112:115]
  s_add_u32 s61, s61, 36864
  v_exp_f32 v95, v95
  v_mfma_f32_16x16x32_bf16 v[116:119], a[156:159], v[220:223], v[116:119]
  v_cvt_pk_bf16_f32 v143, v94, v95
  v_add_f32 v62, v62, v88
  v_mfma_f32_16x16x32_bf16 v[120:123], a[156:159], v[236:239], v[120:123]
  v_add_f32 v62, v62, v89
  v_add_f32 v62, v62, v90
  v_mfma_f32_16x16x32_bf16 v[124:127], a[156:159], v[252:255], v[124:127]
  s_waitcnt lgkmcnt(0)
  s_barrier
  v_mfma_f32_16x16x32_bf16 v[176:179], v[36:39], v[128:131], v[176:179]
  s_add_u32 m0, s63, 52224
  v_exp_f32 v96, v96
  v_mfma_f32_16x16x32_bf16 v[180:183], v[36:39], v[132:135], v[180:183]
  v_add_f32 v62, v62, v91
  v_add_f32 v63, v63, v92
  v_mfma_f32_16x16x32_bf16 a[0:3], a[160:163], v[128:131], a[0:3]
  v_exp_f32 v97, v97
  v_mfma_f32_16x16x32_bf16 a[4:7], a[160:163], v[132:135], a[4:7]
  buffer_load_dwordx4 v21, s[40:43], s62 offen offset:0 lds
  v_cvt_pk_bf16_f32 v144, v96, v97
  v_mfma_f32_16x16x32_bf16 a[8:11], a[160:163], v[136:139], a[8:11]
  v_exp_f32 v98, v98
  v_mfma_f32_16x16x32_bf16 a[12:15], a[160:163], v[140:143], a[12:15]
  buffer_load_dwordx4 v22, s[40:43], s62 offen offset:1056 lds
  v_add_f32 v63, v63, v93
  v_mfma_f32_16x16x32_bf16 a[16:19], a[164:167], v[128:131], a[16:19]
  v_exp_f32 v99, v99
  v_mfma_f32_16x16x32_bf16 a[20:23], a[164:167], v[132:135], a[20:23]
  v_cvt_pk_bf16_f32 v145, v98, v99
  v_add_f32 v63, v63, v94
  v_mfma_f32_16x16x32_bf16 a[24:27], a[164:167], v[136:139], a[24:27]
  v_exp_f32 v100, v100
  v_mfma_f32_16x16x32_bf16 a[28:31], a[164:167], v[140:143], a[28:31]
  buffer_load_dwordx4 v23, s[40:43], s62 offen offset:2112 lds
  v_add_f32 v63, v63, v95
  v_mfma_f32_16x16x32_bf16 a[32:35], a[168:171], v[128:131], a[32:35]
  v_exp_f32 v101, v101
  v_mfma_f32_16x16x32_bf16 a[36:39], a[168:171], v[132:135], a[36:39]
  buffer_load_dwordx4 v24, s[40:43], s62 offen offset:3168 lds
  v_cvt_pk_bf16_f32 v148, v100, v101
  v_mfma_f32_16x16x32_bf16 a[40:43], a[168:171], v[136:139], a[40:43]
  v_exp_f32 v102, v102
  v_mfma_f32_16x16x32_bf16 a[44:47], a[168:171], v[140:143], a[44:47]
  v_mfma_f32_16x16x32_bf16 a[48:51], a[172:175], v[128:131], a[48:51]
  s_add_u32 m0, s60, 52224
  v_exp_f32 v103, v103
  v_mfma_f32_16x16x32_bf16 a[52:55], a[172:175], v[132:135], a[52:55]
  v_cvt_pk_bf16_f32 v149, v102, v103
  v_mfma_f32_16x16x32_bf16 a[56:59], a[172:175], v[136:139], a[56:59]
  v_exp_f32 v104, v104
  v_mfma_f32_16x16x32_bf16 a[60:63], a[172:175], v[140:143], a[60:63]
  s_add_u32 s62, s62, 131072
  v_add_f32 v62, v62, v104
  v_mfma_f32_16x16x32_bf16 a[64:67], a[176:179], v[128:131], a[64:67]
  v_exp_f32 v105, v105
  v_mfma_f32_16x16x32_bf16 a[68:71], a[176:179], v[132:135], a[68:71]
  v_cvt_pk_bf16_f32 v152, v104, v105
  v_add_f32 v62, v62, v105
  v_mfma_f32_16x16x32_bf16 a[72:75], a[176:179], v[136:139], a[72:75]
  v_exp_f32 v106, v106
  v_mfma_f32_16x16x32_bf16 a[76:79], a[176:179], v[140:143], a[76:79]
  buffer_load_dwordx4 v20, s[12:15], s61 offen sc1 lds
  v_add_f32 v62, v62, v106
  v_mfma_f32_16x16x32_bf16 a[80:83], a[180:183], v[128:131], a[80:83]
  v_exp_f32 v107, v107
  v_mfma_f32_16x16x32_bf16 a[84:87], a[180:183], v[132:135], a[84:87]
  buffer_load_dwordx4 v20, s[12:15], s61 offen offset:1024 sc1 lds
  v_cvt_pk_bf16_f32 v153, v106, v107
  v_mfma_f32_16x16x32_bf16 a[88:91], a[180:183], v[136:139], a[88:91]
  v_exp_f32 v108, v108
  v_mfma_f32_16x16x32_bf16 a[92:95], a[180:183], v[140:143], a[92:95]
  v_add_f32 v62, v62, v107
  v_add_f32 v63, v63, v108
  v_mfma_f32_16x16x32_bf16 a[96:99], a[184:187], v[128:131], a[96:99]
  v_exp_f32 v109, v109
  v_mfma_f32_16x16x32_bf16 a[100:103], a[184:187], v[132:135], a[100:103]
  v_cvt_pk_bf16_f32 v156, v108, v109
  v_add_f32 v63, v63, v109
  v_mfma_f32_16x16x32_bf16 a[104:107], a[184:187], v[136:139], a[104:107]
  v_exp_f32 v110, v110
  v_mfma_f32_16x16x32_bf16 a[108:111], a[184:187], v[140:143], a[108:111]
  s_mov_b64 exec, 0xffff
  buffer_load_dwordx4 v20, s[12:15], s61 offen offset:2048 sc1 lds
  s_mov_b64 exec, -1
  v_mfma_f32_16x16x32_bf16 a[112:115], a[188:191], v[128:131], a[112:115]
  s_add_u32 s61, s61, 36864
  v_exp_f32 v111, v111
  v_mfma_f32_16x16x32_bf16 a[116:119], a[188:191], v[132:135], a[116:119]
  v_cvt_pk_bf16_f32 v157, v110, v111
  v_add_f32 v63, v63, v110
  v_mfma_f32_16x16x32_bf16 a[120:123], a[188:191], v[136:139], a[120:123]
  v_add_f32 v63, v63, v111
  v_mfma_f32_16x16x32_bf16 a[124:127], a[188:191], v[140:143], a[124:127]
  s_waitcnt lgkmcnt(0)
  ds_read_b64_tr_b16 a[160:161], v52 offset:41472
  ds_read_b64_tr_b16 a[162:163], v52 offset:41984
  ds_read_b64_tr_b16 a[164:165], v52 offset:41504
  ds_read_b64_tr_b16 a[166:167], v52 offset:42016
  ds_read_b64_tr_b16 a[168:169], v52 offset:41536
  ds_read_b64_tr_b16 a[170:171], v52 offset:42048
  ds_read_b64_tr_b16 a[172:173], v52 offset:41568
  ds_read_b64_tr_b16 a[174:175], v52 offset:42080
  ds_read_b64_tr_b16 a[176:177], v52 offset:41600
  ds_read_b64_tr_b16 a[178:179], v52 offset:42112
  ds_read_b64_tr_b16 a[180:181], v52 offset:41632
  ds_read_b64_tr_b16 a[182:183], v52 offset:42144
  ds_read_b64_tr_b16 a[184:185], v52 offset:41664
  ds_read_b64_tr_b16 a[186:187], v52 offset:42176
  ds_read_b64_tr_b16 a[188:189], v52 offset:41696
  ds_read_b64_tr_b16 a[190:191], v52 offset:42208
  v_exp_f32 v112, v112
  v_exp_f32 v113, v113
  v_exp_f32 v114, v114
  v_exp_f32 v115, v115
  v_exp_f32 v116, v116
  v_exp_f32 v117, v117
  v_exp_f32 v118, v118
  v_exp_f32 v119, v119
  v_exp_f32 v120, v120
  v_exp_f32 v121, v121
  v_exp_f32 v122, v122
  v_exp_f32 v123, v123
  v_exp_f32 v124, v124
  v_exp_f32 v125, v125
  v_exp_f32 v126, v126
  v_exp_f32 v127, v127
  v_cvt_pk_bf16_f32 v146, v112, v113
  v_cvt_pk_bf16_f32 v147, v114, v115
  v_cvt_pk_bf16_f32 v150, v116, v117
  v_cvt_pk_bf16_f32 v151, v118, v119
  v_cvt_pk_bf16_f32 v154, v120, v121
  v_cvt_pk_bf16_f32 v155, v122, v123
  v_cvt_pk_bf16_f32 v158, v124, v125
  v_cvt_pk_bf16_f32 v159, v126, v127
  v_add_f32 v62, v62, v120
TP_19:
  s_cbranch_execz TP_23
  v_add_f32 v62, v62, v121
  v_add_f32 v62, v62, v122
  v_add_f32 v62, v62, v123
  v_add_f32 v63, v63, v124
  v_add_f32 v63, v63, v125
  v_add_f32 v63, v63, v126
  v_add_f32 v63, v63, v127
  s_waitcnt vmcnt(14) lgkmcnt(0)
  s_barrier
  v_mfma_f32_16x16x32_bf16 v[176:179], v[36:39], v[144:147], v[176:179]
  s_add_u32 m0, s63, 78336
  v_mfma_f32_16x16x32_bf16 v[180:183], v[36:39], v[148:151], v[180:183]
  v_mfma_f32_16x16x32_bf16 a[0:3], a[160:163], v[144:147], a[0:3]
  buffer_load_dwordx4 v21, s[40:43], s62 offen offset:0 lds
  ds_read_b64_tr_b16 v[100:101], v25 offset:0
  v_mfma_f32_16x16x32_bf16 a[4:7], a[160:163], v[148:151], a[4:7]
  ds_read_b64_tr_b16 v[102:103], v25 offset:512
  v_mfma_f32_16x16x32_bf16 a[8:11], a[160:163], v[152:155], a[8:11]
  v_mfma_f32_16x16x32_bf16 a[12:15], a[160:163], v[156:159], a[12:15]
  buffer_load_dwordx4 v22, s[40:43], s62 offen offset:1056 lds
  ds_read_b64_tr_b16 v[104:105], v25 offset:32
  v_mfma_f32_16x16x32_bf16 a[16:19], a[164:167], v[144:147], a[16:19]
  ds_read_b64_tr_b16 v[106:107], v25 offset:544
  v_mfma_f32_16x16x32_bf16 a[20:23], a[164:167], v[148:151], a[20:23]
  v_mfma_f32_16x16x32_bf16 a[24:27], a[164:167], v[152:155], a[24:27]
  buffer_load_dwordx4 v23, s[40:43], s62 offen offset:2112 lds
  ds_read_b64_tr_b16 v[108:109], v25 offset:64
  v_mfma_f32_16x16x32_bf16 a[28:31], a[164:167], v[156:159], a[28:31]
  ds_read_b64_tr_b16 v[110:111], v25 offset:576
  v_mfma_f32_16x16x32_bf16 a[32:35], a[168:171], v[144:147], a[32:35]
  v_mfma_f32_16x16x32_bf16 a[36:39], a[168:171], v[148:151], a[36:39]
  buffer_load_dwordx4 v24, s[40:43], s62 offen offset:3168 lds
  ds_read_b64_tr_b16 v[112:113], v25 offset:96
  v_mfma_f32_16x16x32_bf16 a[40:43], a[168:171], v[152:155], a[40:43]
  v_mfma_f32_16x16x32_bf16 a[44:47], a[168:171], v[156:159], a[44:47]
  ds_read_b64_tr_b16 v[114:115], v25 offset:608
  v_mfma_f32_16x16x32_bf16 a[48:51], a[172:175], v[144:147], a[48:51]
  s_add_u32 m0, s60, 78336
  ds_read_b128 v[64:67], v28 offset:0
  v_mfma_f32_16x16x32_bf16 a[52:55], a[172:175], v[148:151], a[52:55]
  v_mfma_f32_16x16x32_bf16 a[56:59], a[172:175], v[152:155], a[56:59]
  ds_read_b128 v[68:71], v28 offset:1024
  v_mfma_f32_16x16x32_bf16 a[60:63], a[172:175], v[156:159], a[60:63]
  s_add_u32 s62, s62, 131072
  ds_read_b128 v[72:75], v28 offset:2048
  v_mfma_f32_16x16x32_bf16 a[64:67], a[176:179], v[144:147], a[64:67]
  v_mfma_f32_16x16x32_bf16 a[68:71], a[176:179], v[148:151], a[68:71]
  ds_read_b128 v[76:79], v28 offset:3072
  v_mfma_f32_16x16x32_bf16 a[72:75], a[176:179], v[152:155], a[72:75]
  buffer_load_dwordx4 v20, s[12:15], s61 offen sc1 lds
  v_mfma_f32_16x16x32_bf16 a[76:79], a[176:179], v[156:159], a[76:79]
  ds_read_b128 v[80:83], v28 offset:4096
  v_mfma_f32_16x16x32_bf16 a[80:83], a[180:183], v[144:147], a[80:83]
  ds_read_b128 v[84:87], v28 offset:5120
  v_mfma_f32_16x16x32_bf16 a[84:87], a[180:183], v[148:151], a[84:87]
  buffer_load_dwordx4 v20, s[12:15], s61 offen offset:1024 sc1 lds
  v_mfma_f32_16x16x32_bf16 a[88:91], a[180:183], v[152:155], a[88:91]
  ds_read_b128 v[88:91], v28 offset:6144
  v_mfma_f32_16x16x32_bf16 a[92:95], a[180:183], v[156:159], a[92:95]
  ds_read_b128 v[92:95], v28 offset:7168
  v_mfma_f32_16x16x32_bf16 a[96:99], a[184:187], v[144:147], a[96:99]
  s_mov_b64 exec, 0xffff
  buffer_load_dwordx4 v20, s[12:15], s61 offen offset:2048 sc1 lds
  s_mov_b64 exec, -1
  v_mfma_f32_16x16x32_bf16 a[100:103], a[184:187], v[148:151], a[100:103]
  ds_read_b128 v[96:99], v28 offset:8192
  v_mfma_f32_16x16x32_bf16 a[104:107], a[184:187], v[152:155], a[104:107]
  v_mfma_f32_16x16x32_bf16 a[108:111], a[184:187], v[156:159], a[108:111]
  s_add_u32 s61, s61, 36864
  v_mfma_f32_16x16x32_bf16 a[112:115], a[188:191], v[144:147], a[112:115]
  v_mfma_f32_16x16x32_bf16 a[116:119], a[188:191], v[148:151], a[116:119]
  v_mfma_f32_16x16x32_bf16 a[120:123], a[188:191], v[152:155], a[120:123]
  v_mfma_f32_16x16x32_bf16 a[124:127], a[188:191], v[156:159], a[124:127]
  s_waitcnt lgkmcnt(0)
  s_lshl_b32 s11, s19, 19
  s_lshl_b32 s4, s5, 12
  s_add_u32 s11, s11, s4
  s_add_u32 s11, s11, 0
  s_nop 2
  v_mov_b32 v44, v60
  v_mov_b32 v45, v61
  v_mov_b32 v46, v62
  v_mov_b32 v47, v63
  s_nop 0
  v_permlane16_swap_b32 v60, v44
  v_permlane16_swap_b32 v61, v45
  v_permlane16_swap_b32 v62, v46
  v_permlane16_swap_b32 v63, v47
  v_add_f32 v60, v60, v44
  v_add_f32 v61, v61, v45
  v_add_f32 v62, v62, v46
  v_add_f32 v63, v63, v47
  v_mov_b32 v44, v60
  v_mov_b32 v45, v61
  v_mov_b32 v46, v62
  v_mov_b32 v47, v63
  s_nop 0
  v_permlane32_swap_b32 v60, v44
  v_permlane32_swap_b32 v61, v45
  v_permlane32_swap_b32 v62, v46
  v_permlane32_swap_b32 v63, v47
  v_add_f32 v60, v60, v44
  v_add_f32 v61, v61, v45
  v_add_f32 v62, v62, v46
  v_add_f32 v63, v63, v47
  v_add_f32 v60, v60, v176
  v_add_f32 v61, v61, v180
  v_add_f32 v45, v60, v61
  v_add_f32 v46, v62, v63
  v_add_f32 v44, v45, v46
  v_mov_b32 v45, 0x5f800000
  v_cmp_nlt_f32 s[6:7], v44, v45
  s_cmp_lg_u64 s[6:7], 0
  s_cbranch_scc0 FBR_U
  s_call_b64 s[6:7], K_fallback
FBR_U:
  v_rcp_f32 v40, v60
  v_rcp_f32 v41, v61
  v_rcp_f32 v42, v62
  v_rcp_f32 v43, v63
  s_waitcnt vmcnt(14)
  s_barrier
  v_mov_b32 v58, 3
  v_mov_b32 v59, 4
  v_mfma_f32_16x16x32_bf16 a[128:131], v[64:67], v[100:103], 0
  s_add_u32 m0, s63, 104448
  ds_read_b64_tr_b16 v[152:153], v25 offset:26112
  v_accvgpr_read_b32 v184, a0
  v_mfma_f32_16x16x32_bf16 a[132:135], v[64:67], v[104:107], 0
  ds_read_b64_tr_b16 v[154:155], v25 offset:26624
  v_accvgpr_read_b32 v185, a1
  v_mfma_f32_16x16x32_bf16 a[136:139], v[64:67], v[108:111], 0
  v_accvgpr_read_b32 v186, a2
  v_accvgpr_read_b32 v187, a3
  v_mfma_f32_16x16x32_bf16 a[140:143], v[64:67], v[112:115], 0
  buffer_load_dwordx4 v21, s[40:43], s62 offen offset:0 lds
  ds_read_b64_tr_b16 v[156:157], v25 offset:26144
  v_mfma_f32_16x16x32_bf16 a[144:147], v[68:71], v[100:103], 0
  v_accvgpr_read_b32 v188, a16
  v_accvgpr_read_b32 v189, a17
  v_mfma_f32_16x16x32_bf16 a[148:151], v[68:71], v[104:107], 0
  ds_read_b64_tr_b16 v[158:159], v25 offset:26656
  v_accvgpr_read_b32 v190, a18
  v_mfma_f32_16x16x32_bf16 a[152:155], v[68:71], v[108:111], 0
  buffer_load_dwordx4 v22, s[40:43], s62 offen offset:1056 lds
  ds_read_b64_tr_b16 v[160:161], v25 offset:26176
  v_mfma_f32_16x16x32_bf16 a[156:159], v[68:71], v[112:115], 0
  v_accvgpr_read_b32 v191, a19
  v_mul_f32 v184, v184, v40
  v_mfma_f32_16x16x32_bf16 a[160:163], v[72:75], v[100:103], 0
  ds_read_b64_tr_b16 v[162:163], v25 offset:26688
  v_mul_f32 v185, v185, v40
  v_mfma_f32_16x16x32_bf16 a[164:167], v[72:75], v[104:107], 0
  buffer_load_dwordx4 v23, s[40:43], s62 offen offset:2112 lds
  v_mul_f32 v186, v186, v40
  v_mfma_f32_16x16x32_bf16 a[168:171], v[72:75], v[108:111], 0
  ds_read_b64_tr_b16 v[164:165], v25 offset:26208
  v_mul_f32 v187, v187, v40
  v_mfma_f32_16x16x32_bf16 a[172:175], v[72:75], v[112:115], 0
  ds_read_b64_tr_b16 v[166:167], v25 offset:26720
  v_mul_f32 v188, v188, v40
  v_mfma_f32_16x16x32_bf16 a[176:179], v[76:79], v[100:103], 0
  buffer_load_dwordx4 v24, s[40:43], s62 offen offset:3168 lds
  v_mul_f32 v189, v189, v40
  v_mfma_f32_16x16x32_bf16 a[180:183], v[76:79], v[104:107], 0
  ds_read_b128 v[116:119], v28 offset:26112
  v_mul_f32 v190, v190, v40
  v_mfma_f32_16x16x32_bf16 a[184:187], v[76:79], v[108:111], 0
  v_mul_f32 v191, v191, v40
  v_cvt_pk_bf16_f32 v216, v184, v185
  v_mfma_f32_16x16x32_bf16 a[188:191], v[76:79], v[112:115], 0
  s_add_u32 m0, s60, 104448
  ds_read_b128 v[120:123], v28 offset:27136
  v_cvt_pk_bf16_f32 v217, v186, v187
  v_mfma_f32_16x16x32_bf16 a[192:195], v[80:83], v[100:103], 0
  v_cvt_pk_bf16_f32 v218, v188, v189
  v_cvt_pk_bf16_f32 v219, v190, v191
  v_mfma_f32_16x16x32_bf16 a[196:199], v[80:83], v[104:107], 0
  ds_read_b128 v[124:127], v28 offset:28160
  buffer_store_dwordx4 v[216:219], v3, s[12:15], s11 offen offset:0 sc1
  v_mfma_f32_16x16x32_bf16 a[200:203], v[80:83], v[108:111], 0
  s_add_u32 s62, s62, 131072
  ds_read_b128 v[128:131], v28 offset:29184
  v_mfma_f32_16x16x32_bf16 a[204:207], v[80:83], v[112:115], 0
  v_mfma_f32_16x16x32_bf16 a[208:211], v[84:87], v[100:103], 0
  ds_read_b128 v[132:135], v28 offset:30208
  v_mfma_f32_16x16x32_bf16 a[212:215], v[84:87], v[104:107], 0
  buffer_load_dwordx4 v20, s[12:15], s61 offen sc1 lds
  v_mfma_f32_16x16x32_bf16 a[216:219], v[84:87], v[108:111], 0
  ds_read_b128 v[136:139], v28 offset:31232
  v_mfma_f32_16x16x32_bf16 a[220:223], v[84:87], v[112:115], 0
  ds_read_b128 v[140:143], v28 offset:32256
  v_mfma_f32_16x16x32_bf16 a[224:227], v[88:91], v[100:103], 0
  buffer_load_dwordx4 v20, s[12:15], s61 offen offset:1024 sc1 lds
  v_mfma_f32_16x16x32_bf16 a[228:231], v[88:91], v[104:107], 0
  ds_read_b128 v[144:147], v28 offset:33280
  v_mfma_f32_16x16x32_bf16 a[232:235], v[88:91], v[108:111], 0
  v_mfma_f32_16x16x32_bf16 a[236:239], v[88:91], v[112:115], 0
  s_mov_b64 exec, 0xffff
  buffer_load_dwordx4 v20, s[12:15], s61 offen offset:2048 sc1 lds
  s_mov_b64 exec, -1
  v_mfma_f32_16x16x32_bf16 a[240:243], v[92:95], v[100:103], 0
  ds_read_b128 v[148:151], v28 offset:34304
  v_mfma_f32_16x16x32_bf16 a[244:247], v[92:95], v[104:107], 0
  v_mfma_f32_16x16x32_bf16 a[248:251], v[92:95], v[108:111], 0
  s_add_u32 s61, s61, 36864
  v_mfma_f32_16x16x32_bf16 a[252:255], v[92:95], v[112:115], 0
  v_mfma_f32_16x16x32_bf16 v[240:243], v[96:99], v[100:103], 0
  v_mfma_f32_16x16x32_bf16 v[244:247], v[96:99], v[104:107], 0
  v_mfma_f32_16x16x32_bf16 v[248:251], v[96:99], v[108:111], 0
  v_mfma_f32_16x16x32_bf16 v[252:255], v[96:99], v[112:115], 0
  s_waitcnt vmcnt(15) lgkmcnt(0)
  s_barrier
  v_mfma_f32_16x16x32_bf16 a[128:131], v[116:119], v[152:155], a[128:131]
  s_add_u32 m0, s63, 130560
  ds_read_b64_tr_b16 v[100:101], v26 offset:0
  v_accvgpr_read_b32 v192, a4
  v_mfma_f32_16x16x32_bf16 a[132:135], v[116:119], v[156:159], a[132:135]
  ds_read_b64_tr_b16 v[102:103], v26 offset:512
  v_accvgpr_read_b32 v193, a5
  v_mfma_f32_16x16x32_bf16 a[136:139], v[116:119], v[160:163], a[136:139]
  v_accvgpr_read_b32 v194, a6
  v_accvgpr_read_b32 v195, a7
  v_mfma_f32_16x16x32_bf16 a[140:143], v[116:119], v[164:167], a[140:143]
  buffer_load_dwordx4 v21, s[40:43], s62 offen offset:0 lds
  ds_read_b64_tr_b16 v[104:105], v26 offset:32
  v_mfma_f32_16x16x32_bf16 a[144:147], v[120:123], v[152:155], a[144:147]
  v_accvgpr_read_b32 v196, a20
  v_accvgpr_read_b32 v197, a21
  v_mfma_f32_16x16x32_bf16 a[148:151], v[120:123], v[156:159], a[148:151]
  ds_read_b64_tr_b16 v[106:107], v26 offset:544
  v_accvgpr_read_b32 v198, a22
  v_mfma_f32_16x16x32_bf16 a[152:155], v[120:123], v[160:163], a[152:155]
  buffer_load_dwordx4 v22, s[40:43], s62 offen offset:1056 lds
  ds_read_b64_tr_b16 v[108:109], v26 offset:64
  v_mfma_f32_16x16x32_bf16 a[156:159], v[120:123], v[164:167], a[156:159]
  v_accvgpr_read_b32 v199, a23
  v_mul_f32 v192, v192, v41
  v_mfma_f32_16x16x32_bf16 a[160:163], v[124:127], v[152:155], a[160:163]
  ds_read_b64_tr_b16 v[110:111], v26 offset:576
  v_mul_f32 v193, v193, v41
  v_mfma_f32_16x16x32_bf16 a[164:167], v[124:127], v[156:159], a[164:167]
  buffer_load_dwordx4 v23, s[40:43], s62 offen offset:2112 lds
  v_mul_f32 v194, v194, v41
  v_mfma_f32_16x16x32_bf16 a[168:171], v[124:127], v[160:163], a[168:171]
  ds_read_b64_tr_b16 v[112:113], v26 offset:96
  v_mul_f32 v195, v195, v41
  v_mfma_f32_16x16x32_bf16 a[172:175], v[124:127], v[164:167], a[172:175]
  ds_read_b64_tr_b16 v[114:115], v26 offset:608
  v_mul_f32 v196, v196, v41
  v_mfma_f32_16x16x32_bf16 a[176:179], v[128:131], v[152:155], a[176:179]
  buffer_load_dwordx4 v24, s[40:43], s62 offen offset:3168 lds
  v_mul_f32 v197, v197, v41
  v_mfma_f32_16x16x32_bf16 a[180:183], v[128:131], v[156:159], a[180:183]
  ds_read_b128 v[64:67], v29 offset:0
  v_mul_f32 v198, v198, v41
  v_mfma_f32_16x16x32_bf16 a[184:187], v[128:131], v[160:163], a[184:187]
  v_mul_f32 v199, v199, v41
  v_cvt_pk_bf16_f32 v220, v192, v193
  v_mfma_f32_16x16x32_bf16 a[188:191], v[128:131], v[164:167], a[188:191]
  s_add_u32 m0, s60, 130560
  ds_read_b128 v[68:71], v29 offset:1024
  v_cvt_pk_bf16_f32 v221, v194, v195
  v_mfma_f32_16x16x32_bf16 a[192:195], v[132:135], v[152:155], a[192:195]
  v_cvt_pk_bf16_f32 v222, v196, v197
  v_cvt_pk_bf16_f32 v223, v198, v199
  v_mfma_f32_16x16x32_bf16 a[196:199], v[132:135], v[156:159], a[196:199]
  ds_read_b128 v[72:75], v29 offset:2048
  buffer_store_dwordx4 v[220:223], v3, s[12:15], s11 offen offset:1024 sc1
  v_mfma_f32_16x16x32_bf16 a[200:203], v[132:135], v[160:163], a[200:203]
  s_add_u32 s62, s62, 131072
  ds_read_b128 v[76:79], v29 offset:3072
  v_mfma_f32_16x16x32_bf16 a[204:207], v[132:135], v[164:167], a[204:207]
  v_mfma_f32_16x16x32_bf16 a[208:211], v[136:139], v[152:155], a[208:211]
  ds_read_b128 v[80:83], v29 offset:4096
  v_mfma_f32_16x16x32_bf16 a[212:215], v[136:139], v[156:159], a[212:215]
  buffer_load_dwordx4 v20, s[12:15], s61 offen sc1 lds
  v_mfma_f32_16x16x32_bf16 a[216:219], v[136:139], v[160:163], a[216:219]
  ds_read_b128 v[84:87], v29 offset:5120
  v_mfma_f32_16x16x32_bf16 a[220:223], v[136:139], v[164:167], a[220:223]
  ds_read_b128 v[88:91], v29 offset:6144
  v_mfma_f32_16x16x32_bf16 a[224:227], v[140:143], v[152:155], a[224:227]
  buffer_load_dwordx4 v20, s[12:15], s61 offen offset:1024 sc1 lds
  v_mfma_f32_16x16x32_bf16 a[228:231], v[140:143], v[156:159], a[228:231]
  ds_read_b128 v[92:95], v29 offset:7168
  v_mfma_f32_16x16x32_bf16 a[232:235], v[140:143], v[160:163], a[232:235]
  v_mfma_f32_16x16x32_bf16 a[236:239], v[140:143], v[164:167], a[236:239]
  s_mov_b64 exec, 0xffff
  buffer_load_dwordx4 v20, s[12:15], s61 offen offset:2048 sc1 lds
  s_mov_b64 exec, -1
  v_mfma_f32_16x16x32_bf16 a[240:243], v[144:147], v[152:155], a[240:243]
  ds_read_b128 v[96:99], v29 offset:8192
  v_mfma_f32_16x16x32_bf16 a[244:247], v[144:147], v[156:159], a[244:247]
  v_mfma_f32_16x16x32_bf16 a[248:251], v[144:147], v[160:163], a[248:251]
  s_add_u32 s61, s61, 36864
  v_mfma_f32_16x16x32_bf16 a[252:255], v[144:147], v[164:167], a[252:255]
  v_mfma_f32_16x16x32_bf16 v[240:243], v[148:151], v[152:155], v[240:243]
  v_mfma_f32_16x16x32_bf16 v[244:247], v[148:151], v[156:159], v[244:247]
  v_mfma_f32_16x16x32_bf16 v[248:251], v[148:151], v[160:163], v[248:251]
  v_mfma_f32_16x16x32_bf16 v[252:255], v[148:151], v[164:167], v[252:255]
  s_waitcnt vmcnt(16) lgkmcnt(0)
  s_barrier
  v_mfma_f32_16x16x32_bf16 a[128:131], v[64:67], v[100:103], a[128:131]
  s_add_u32 m0, s63, 0
  ds_read_b64_tr_b16 v[152:153], v26 offset:26112
  v_accvgpr_read_b32 v200, a8
  v_mfma_f32_16x16x32_bf16 a[132:135], v[64:67], v[104:107], a[132:135]
  ds_read_b64_tr_b16 v[154:155], v26 offset:26624
  v_accvgpr_read_b32 v201, a9
  v_mfma_f32_16x16x32_bf16 a[136:139], v[64:67], v[108:111], a[136:139]
  v_accvgpr_read_b32 v202, a10
  v_accvgpr_read_b32 v203, a11
  v_mfma_f32_16x16x32_bf16 a[140:143], v[64:67], v[112:115], a[140:143]
  buffer_load_dwordx4 v21, s[40:43], s62 offen offset:0 lds
  ds_read_b64_tr_b16 v[156:157], v26 offset:26144
  v_mfma_f32_16x16x32_bf16 a[144:147], v[68:71], v[100:103], a[144:147]
  v_accvgpr_read_b32 v204, a24
  v_accvgpr_read_b32 v205, a25
  v_mfma_f32_16x16x32_bf16 a[148:151], v[68:71], v[104:107], a[148:151]
  ds_read_b64_tr_b16 v[158:159], v26 offset:26656
  v_accvgpr_read_b32 v206, a26
  v_mfma_f32_16x16x32_bf16 a[152:155], v[68:71], v[108:111], a[152:155]
  buffer_load_dwordx4 v22, s[40:43], s62 offen offset:1056 lds
  ds_read_b64_tr_b16 v[160:161], v26 offset:26176
  v_mfma_f32_16x16x32_bf16 a[156:159], v[68:71], v[112:115], a[156:159]
  v_accvgpr_read_b32 v207, a27
  v_mul_f32 v200, v200, v42
  v_mfma_f32_16x16x32_bf16 a[160:163], v[72:75], v[100:103], a[160:163]
  ds_read_b64_tr_b16 v[162:163], v26 offset:26688
  v_mul_f32 v201, v201, v42
  v_mfma_f32_16x16x32_bf16 a[164:167], v[72:75], v[104:107], a[164:167]
  buffer_load_dwordx4 v23, s[40:43], s62 offen offset:2112 lds
  v_mul_f32 v202, v202, v42
  v_mfma_f32_16x16x32_bf16 a[168:171], v[72:75], v[108:111], a[168:171]
  ds_read_b64_tr_b16 v[164:165], v26 offset:26208
  v_mul_f32 v203, v203, v42
  v_mfma_f32_16x16x32_bf16 a[172:175], v[72:75], v[112:115], a[172:175]
  ds_read_b64_tr_b16 v[166:167], v26 offset:26720
  v_mul_f32 v204, v204, v42
  v_mfma_f32_16x16x32_bf16 a[176:179], v[76:79], v[100:103], a[176:179]
  buffer_load_dwordx4 v24, s[40:43], s62 offen offset:3168 lds
  v_mul_f32 v205, v205, v42
  v_mfma_f32_16x16x32_bf16 a[180:183], v[76:79], v[104:107], a[180:183]
  ds_read_b128 v[116:119], v29 offset:26112
  v_mul_f32 v206, v206, v42
  v_mfma_f32_16x16x32_bf16 a[184:187], v[76:79], v[108:111], a[184:187]
  v_mul_f32 v207, v207, v42
  v_cvt_pk_bf16_f32 v224, v200, v201
  v_mfma_f32_16x16x32_bf16 a[188:191], v[76:79], v[112:115], a[188:191]
  s_add_u32 m0, s60, 0
  ds_read_b128 v[120:123], v29 offset:27136
  v_cvt_pk_bf16_f32 v225, v202, v203
  v_mfma_f32_16x16x32_bf16 a[192:195], v[80:83], v[100:103], a[192:195]
  v_cvt_pk_bf16_f32 v226, v204, v205
  v_cvt_pk_bf16_f32 v227, v206, v207
  v_mfma_f32_16x16x32_bf16 a[196:199], v[80:83], v[104:107], a[196:199]
  ds_read_b128 v[124:127], v29 offset:28160
  buffer_store_dwordx4 v[224:227], v3, s[12:15], s11 offen offset:2048 sc1
  v_mfma_f32_16x16x32_bf16 a[200:203], v[80:83], v[108:111], a[200:203]
  s_add_u32 s62, s62, 131072
  ds_read_b128 v[128:131], v29 offset:29184
  v_mfma_f32_16x16x32_bf16 a[204:207], v[80:83], v[112:115], a[204:207]
  v_mfma_f32_16x16x32_bf16 a[208:211], v[84:87], v[100:103], a[208:211]
  ds_read_b128 v[132:135], v29 offset:30208
  v_mfma_f32_16x16x32_bf16 a[212:215], v[84:87], v[104:107], a[212:215]
  buffer_load_dwordx4 v20, s[12:15], s61 offen sc1 lds
  v_mfma_f32_16x16x32_bf16 a[216:219], v[84:87], v[108:111], a[216:219]
  ds_read_b128 v[136:139], v29 offset:31232
  v_mfma_f32_16x16x32_bf16 a[220:223], v[84:87], v[112:115], a[220:223]
  ds_read_b128 v[140:143], v29 offset:32256
  v_mfma_f32_16x16x32_bf16 a[224:227], v[88:91], v[100:103], a[224:227]
  buffer_load_dwordx4 v20, s[12:15], s61 offen offset:1024 sc1 lds
  v_mfma_f32_16x16x32_bf16 a[228:231], v[88:91], v[104:107], a[228:231]
  ds_read_b128 v[144:147], v29 offset:33280
  v_mfma_f32_16x16x32_bf16 a[232:235], v[88:91], v[108:111], a[232:235]
  v_mfma_f32_16x16x32_bf16 a[236:239], v[88:91], v[112:115], a[236:239]
  s_mov_b64 exec, 0xffff
  buffer_load_dwordx4 v20, s[12:15], s61 offen offset:2048 sc1 lds
  s_mov_b64 exec, -1
  v_mfma_f32_16x16x32_bf16 a[240:243], v[92:95], v[100:103], a[240:243]
  ds_read_b128 v[148:151], v29 offset:34304
  v_mfma_f32_16x16x32_bf16 a[244:247], v[92:95], v[104:107], a[244:247]
  v_mfma_f32_16x16x32_bf16 a[248:251], v[92:95], v[108:111], a[248:251]
  s_add_u32 s61, s61, 36864
  v_mfma_f32_16x16x32_bf16 a[252:255], v[92:95], v[112:115], a[252:255]
  v_mfma_f32_16x16x32_bf16 v[240:243], v[96:99], v[100:103], v[240:243]
  v_mfma_f32_16x16x32_bf16 v[244:247], v[96:99], v[104:107], v[244:247]
  v_mfma_f32_16x16x32_bf16 v[248:251], v[96:99], v[108:111], v[248:251]
  v_mfma_f32_16x16x32_bf16 v[252:255], v[96:99], v[112:115], v[252:255]
  s_waitcnt vmcnt(16) lgkmcnt(0)
  s_barrier
  v_mfma_f32_16x16x32_bf16 a[128:131], v[116:119], v[152:155], a[128:131]
  s_add_u32 m0, s63, 26112
  ds_read_b64_tr_b16 v[100:101], v27 offset:0
  v_accvgpr_read_b32 v208, a12
  v_mfma_f32_16x16x32_bf16 a[132:135], v[116:119], v[156:159], a[132:135]
  ds_read_b64_tr_b16 v[102:103], v27 offset:512
  v_accvgpr_read_b32 v209, a13
  v_mfma_f32_16x16x32_bf16 a[136:139], v[116:119], v[160:163], a[136:139]
  v_accvgpr_read_b32 v210, a14
  v_accvgpr_read_b32 v211, a15
  v_mfma_f32_16x16x32_bf16 a[140:143], v[116:119], v[164:167], a[140:143]
  buffer_load_dwordx4 v21, s[40:43], s62 offen offset:0 lds
  ds_read_b64_tr_b16 v[104:105], v27 offset:32
  v_mfma_f32_16x16x32_bf16 a[144:147], v[120:123], v[152:155], a[144:147]
  v_accvgpr_read_b32 v212, a28
  v_accvgpr_read_b32 v213, a29
  v_mfma_f32_16x16x32_bf16 a[148:151], v[120:123], v[156:159], a[148:151]
  ds_read_b64_tr_b16 v[106:107], v27 offset:544
  v_accvgpr_read_b32 v214, a30
  v_mfma_f32_16x16x32_bf16 a[152:155], v[120:123], v[160:163], a[152:155]
  buffer_load_dwordx4 v22, s[40:43], s62 offen offset:1056 lds
  ds_read_b64_tr_b16 v[108:109], v27 offset:64
  v_mfma_f32_16x16x32_bf16 a[156:159], v[120:123], v[164:167], a[156:159]
  v_accvgpr_read_b32 v215, a31
  v_mul_f32 v208, v208, v43
  v_mfma_f32_16x16x32_bf16 a[160:163], v[124:127], v[152:155], a[160:163]
  ds_read_b64_tr_b16 v[110:111], v27 offset:576
  v_mul_f32 v209, v209, v43
  v_mfma_f32_16x16x32_bf16 a[164:167], v[124:127], v[156:159], a[164:167]
  buffer_load_dwordx4 v23, s[40:43], s62 offen offset:2112 lds
  v_mul_f32 v210, v210, v43
  v_mfma_f32_16x16x32_bf16 a[168:171], v[124:127], v[160:163], a[168:171]
  ds_read_b64_tr_b16 v[112:113], v27 offset:96
  v_mul_f32 v211, v211, v43
  v_mfma_f32_16x16x32_bf16 a[172:175], v[124:127], v[164:167], a[172:175]
  ds_read_b64_tr_b16 v[114:115], v27 offset:608
  v_mul_f32 v212, v212, v43
  v_mfma_f32_16x16x32_bf16 a[176:179], v[128:131], v[152:155], a[176:179]
  buffer_load_dwordx4 v24, s[40:43], s62 offen offset:3168 lds
  v_mul_f32 v213, v213, v43
  v_mfma_f32_16x16x32_bf16 a[180:183], v[128:131], v[156:159], a[180:183]
  ds_read_b128 v[64:67], v30 offset:0
  v_mul_f32 v214, v214, v43
  v_mfma_f32_16x16x32_bf16 a[184:187], v[128:131], v[160:163], a[184:187]
  v_mul_f32 v215, v215, v43
  v_cvt_pk_bf16_f32 v228, v208, v209
  v_mfma_f32_16x16x32_bf16 a[188:191], v[128:131], v[164:167], a[188:191]
  s_add_u32 m0, s60, 26112
  ds_read_b128 v[68:71], v30 offset:1024
  v_cvt_pk_bf16_f32 v229, v210, v211
  v_mfma_f32_16x16x32_bf16 a[192:195], v[132:135], v[152:155], a[192:195]
  v_cvt_pk_bf16_f32 v230, v212, v213
  v_cvt_pk_bf16_f32 v231, v214, v215
  v_mfma_f32_16x16x32_bf16 a[196:199], v[132:135], v[156:159], a[196:199]
  ds_read_b128 v[72:75], v30 offset:2048
  buffer_store_dwordx4 v[228:231], v3, s[12:15], s11 offen offset:3072 sc1
  v_mfma_f32_16x16x32_bf16 a[200:203], v[132:135], v[160:163], a[200:203]
  s_add_u32 s62, s62, 131072
  s_add_u32 s11, s11, 131072
  ds_read_b128 v[76:79], v30 offset:3072
  v_mfma_f32_16x16x32_bf16 a[204:207], v[132:135], v[164:167], a[204:207]
  v_mfma_f32_16x16x32_bf16 a[208:211], v[136:139], v[152:155], a[208:211]
  ds_read_b128 v[80:83], v30 offset:4096
  v_mfma_f32_16x16x32_bf16 a[212:215], v[136:139], v[156:159], a[212:215]
  buffer_load_dwordx4 v20, s[12:15], s61 offen sc1 lds
  v_mfma_f32_16x16x32_bf16 a[216:219], v[136:139], v[160:163], a[216:219]
  ds_read_b128 v[84:87], v30 offset:5120
  v_mfma_f32_16x16x32_bf16 a[220:223], v[136:139], v[164:167], a[220:223]
  ds_read_b128 v[88:91], v30 offset:6144
  v_mfma_f32_16x16x32_bf16 a[224:227], v[140:143], v[152:155], a[224:227]
  buffer_load_dwordx4 v20, s[12:15], s61 offen offset:1024 sc1 lds
  v_mfma_f32_16x16x32_bf16 a[228:231], v[140:143], v[156:159], a[228:231]
  ds_read_b128 v[92:95], v30 offset:7168
  v_mfma_f32_16x16x32_bf16 a[232:235], v[140:143], v[160:163], a[232:235]
  v_mfma_f32_16x16x32_bf16 a[236:239], v[140:143], v[164:167], a[236:239]
  s_mov_b64 exec, 0xffff
  buffer_load_dwordx4 v20, s[12:15], s61 offen offset:2048 sc1 lds
  s_mov_b64 exec, -1
  v_mfma_f32_16x16x32_bf16 a[240:243], v[144:147], v[152:155], a[240:243]
  ds_read_b128 v[96:99], v30 offset:8192
  v_mfma_f32_16x16x32_bf16 a[244:247], v[144:147], v[156:159], a[244:247]
  v_mfma_f32_16x16x32_bf16 a[248:251], v[144:147], v[160:163], a[248:251]
  s_add_u32 s61, s61, 36864
  v_mfma_f32_16x16x32_bf16 a[252:255], v[144:147], v[164:167], a[252:255]
  v_mfma_f32_16x16x32_bf16 v[240:243], v[148:151], v[152:155], v[240:243]
  v_mfma_f32_16x16x32_bf16 v[244:247], v[148:151], v[156:159], v[244:247]
  v_mfma_f32_16x16x32_bf16 v[248:251], v[148:151], v[160:163], v[248:251]
  v_mfma_f32_16x16x32_bf16 v[252:255], v[148:151], v[164:167], v[252:255]
  s_waitcnt vmcnt(16) lgkmcnt(0)
  s_barrier
  v_mfma_f32_16x16x32_bf16 a[128:131], v[64:67], v[100:103], a[128:131]
  s_add_u32 m0, s63, 52224
  ds_read_b64_tr_b16 v[152:153], v27 offset:26112
  v_mfma_f32_16x16x32_bf16 a[132:135], v[64:67], v[104:107], a[132:135]
  buffer_load_dwordx4 v21, s[40:43], s62 offen offset:0 lds
  ds_read_b64_tr_b16 v[154:155], v27 offset:26624
  v_mfma_f32_16x16x32_bf16 a[136:139], v[64:67], v[108:111], a[136:139]
  v_mfma_f32_16x16x32_bf16 a[140:143], v[64:67], v[112:115], a[140:143]
  buffer_load_dwordx4 v22, s[40:43], s62 offen offset:1056 lds
  ds_read_b64_tr_b16 v[156:157], v27 offset:26144
  v_mfma_f32_16x16x32_bf16 a[144:147], v[68:71], v[100:103], a[144:147]
  buffer_load_dwordx4 v23, s[40:43], s62 offen offset:2112 lds
  v_mfma_f32_16x16x32_bf16 a[148:151], v[68:71], v[104:107], a[148:151]
  ds_read_b64_tr_b16 v[158:159], v27 offset:26656
  v_mfma_f32_16x16x32_bf16 a[152:155], v[68:71], v[108:111], a[152:155]
  buffer_load_dwordx4 v24, s[40:43], s62 offen offset:3168 lds
  ds_read_b64_tr_b16 v[160:161], v27 offset:26176
  v_mfma_f32_16x16x32_bf16 a[156:159], v[68:71], v[112:115], a[156:159]
  s_add_u32 m0, s60, 52224
  v_mfma_f32_16x16x32_bf16 a[160:163], v[72:75], v[100:103], a[160:163]
  ds_read_b64_tr_b16 v[162:163], v27 offset:26688
  v_mfma_f32_16x16x32_bf16 a[164:167], v[72:75], v[104:107], a[164:167]
  s_add_u32 s62, s62, 131072
  v_mfma_f32_16x16x32_bf16 a[168:171], v[72:75], v[108:111], a[168:171]
  buffer_load_dwordx4 v20, s[12:15], s61 offen sc1 lds
  ds_read_b64_tr_b16 v[164:165], v27 offset:26208
  v_mfma_f32_16x16x32_bf16 a[172:175], v[72:75], v[112:115], a[172:175]
  ds_read_b64_tr_b16 v[166:167], v27 offset:26720
  v_mfma_f32_16x16x32_bf16 a[176:179], v[76:79], v[100:103], a[176:179]
  buffer_load_dwordx4 v20, s[12:15], s61 offen offset:1024 sc1 lds
  v_mfma_f32_16x16x32_bf16 a[180:183], v[76:79], v[104:107], a[180:183]
  s_mov_b64 exec, 0xffff
  buffer_load_dwordx4 v20, s[12:15], s61 offen offset:2048 sc1 lds
  s_mov_b64 exec, -1
  v_mfma_f32_16x16x32_bf16 a[184:187], v[76:79], v[108:111], a[184:187]
  ds_read_b128 v[116:119], v30 offset:26112
  v_mfma_f32_16x16x32_bf16 a[188:191], v[76:79], v[112:115], a[188:191]
  s_add_u32 s61, s61, 36864
  ds_read_b128 v[120:123], v30 offset:27136
  v_mfma_f32_16x16x32_bf16 a[192:195], v[80:83], v[100:103], a[192:195]
  v_mfma_f32_16x16x32_bf16 a[196:199], v[80:83], v[104:107], a[196:199]
  s_add_u32 m0, s63, 78336
  ds_read_b128 v[124:127], v30 offset:28160
  v_mfma_f32_16x16x32_bf16 a[200:203], v[80:83], v[108:111], a[200:203]
  buffer_load_dwordx4 v21, s[40:43], s62 offen offset:0 lds
  ds_read_b128 v[128:131], v30 offset:29184
  v_mfma_f32_16x16x32_bf16 a[204:207], v[80:83], v[112:115], a[204:207]
  v_mfma_f32_16x16x32_bf16 a[208:211], v[84:87], v[100:103], a[208:211]
  buffer_load_dwordx4 v22, s[40:43], s62 offen offset:1056 lds
  ds_read_b128 v[132:135], v30 offset:30208
  v_mfma_f32_16x16x32_bf16 a[212:215], v[84:87], v[104:107], a[212:215]
  buffer_load_dwordx4 v23, s[40:43], s62 offen offset:2112 lds
  v_mfma_f32_16x16x32_bf16 a[216:219], v[84:87], v[108:111], a[216:219]
  ds_read_b128 v[136:139], v30 offset:31232
  v_mfma_f32_16x16x32_bf16 a[220:223], v[84:87], v[112:115], a[220:223]
  buffer_load_dwordx4 v24, s[40:43], s62 offen offset:3168 lds
  ds_read_b128 v[140:143], v30 offset:32256
  v_mfma_f32_16x16x32_bf16 a[224:227], v[88:91], v[100:103], a[224:227]
  s_add_u32 m0, s60, 78336
  v_mfma_f32_16x16x32_bf16 a[228:231], v[88:91], v[104:107], a[228:231]
  ds_read_b128 v[144:147], v30 offset:33280
  v_mfma_f32_16x16x32_bf16 a[232:235], v[88:91], v[108:111], a[232:235]
  s_add_u32 s62, s62, 131072
  v_mfma_f32_16x16x32_bf16 a[236:239], v[88:91], v[112:115], a[236:239]
  buffer_load_dwordx4 v20, s[12:15], s61 offen sc1 lds
  ds_read_b128 v[148:151], v30 offset:34304
  v_mfma_f32_16x16x32_bf16 a[240:243], v[92:95], v[100:103], a[240:243]
  v_mfma_f32_16x16x32_bf16 a[244:247], v[92:95], v[104:107], a[244:247]
  buffer_load_dwordx4 v20, s[12:15], s61 offen offset:1024 sc1 lds
  v_mfma_f32_16x16x32_bf16 a[248:251], v[92:95], v[108:111], a[248:251]
  s_mov_b64 exec, 0xffff
  buffer_load_dwordx4 v20, s[12:15], s61 offen offset:2048 sc1 lds
  s_mov_b64 exec, -1
  v_mfma_f32_16x16x32_bf16 a[252:255], v[92:95], v[112:115], a[252:255]
  v_mfma_f32_16x16x32_bf16 v[240:243], v[96:99], v[100:103], v[240:243]
  s_add_u32 s61, s61, 36864
  v_mfma_f32_16x16x32_bf16 v[244:247], v[96:99], v[104:107], v[244:247]
  v_mfma_f32_16x16x32_bf16 v[248:251], v[96:99], v[108:111], v[248:251]
  v_mfma_f32_16x16x32_bf16 v[252:255], v[96:99], v[112:115], v[252:255]
  s_waitcnt vmcnt(22) lgkmcnt(0)
  s_barrier
  v_mfma_f32_16x16x32_bf16 a[128:131], v[116:119], v[152:155], a[128:131]
TP_20:
  s_cbranch_execz TP_24
  s_add_u32 m0, s63, 104448
  ds_read_b64_tr_b16 v[100:101], v25 offset:0
  v_accvgpr_read_b32 v184, a32
  v_mfma_f32_16x16x32_bf16 a[132:135], v[116:119], v[156:159], a[132:135]
  ds_read_b64_tr_b16 v[102:103], v25 offset:512
  v_accvgpr_read_b32 v185, a33
  v_mfma_f32_16x16x32_bf16 a[136:139], v[116:119], v[160:163], a[136:139]
  v_accvgpr_read_b32 v186, a34
  v_accvgpr_read_b32 v187, a35
  v_mfma_f32_16x16x32_bf16 a[140:143], v[116:119], v[164:167], a[140:143]
  buffer_load_dwordx4 v21, s[40:43], s62 offen offset:0 lds
  ds_read_b64_tr_b16 v[104:105], v25 offset:32
  v_mfma_f32_16x16x32_bf16 a[144:147], v[120:123], v[152:155], a[144:147]
  v_accvgpr_read_b32 v188, a48
  v_accvgpr_read_b32 v189, a49
  v_mfma_f32_16x16x32_bf16 a[148:151], v[120:123], v[156:159], a[148:151]
  ds_read_b64_tr_b16 v[106:107], v25 offset:544
  v_accvgpr_read_b32 v190, a50
  v_mfma_f32_16x16x32_bf16 a[152:155], v[120:123], v[160:163], a[152:155]
  buffer_load_dwordx4 v22, s[40:43], s62 offen offset:1056 lds
  ds_read_b64_tr_b16 v[108:109], v25 offset:64
  v_mfma_f32_16x16x32_bf16 a[156:159], v[120:123], v[164:167], a[156:159]
  v_accvgpr_read_b32 v191, a51
  v_mul_f32 v184, v184, v40
  v_mfma_f32_16x16x32_bf16 a[160:163], v[124:127], v[152:155], a[160:163]
  ds_read_b64_tr_b16 v[110:111], v25 offset:576
  v_mul_f32 v185, v185, v40
  v_mfma_f32_16x16x32_bf16 a[164:167], v[124:127], v[156:159], a[164:167]
  buffer_load_dwordx4 v23, s[40:43], s62 offen offset:2112 lds
  v_mul_f32 v186, v186, v40
  v_mfma_f32_16x16x32_bf16 a[168:171], v[124:127], v[160:163], a[168:171]
  ds_read_b64_tr_b16 v[112:113], v25 offset:96
  v_mul_f32 v187, v187, v40
  v_mfma_f32_16x16x32_bf16 a[172:175], v[124:127], v[164:167], a[172:175]
  ds_read_b64_tr_b16 v[114:115], v25 offset:608
  v_mul_f32 v188, v188, v40
  v_mfma_f32_16x16x32_bf16 a[176:179], v[128:131], v[152:155], a[176:179]
  buffer_load_dwordx4 v24, s[40:43], s62 offen offset:3168 lds
  v_mul_f32 v189, v189, v40
  v_mfma_f32_16x16x32_bf16 a[180:183], v[128:131], v[156:159], a[180:183]
  ds_read_b128 v[64:67], v28 offset:0
  v_mul_f32 v190, v190, v40
  v_mfma_f32_16x16x32_bf16 a[184:187], v[128:131], v[160:163], a[184:187]
  v_mul_f32 v191, v191, v40
  v_cvt_pk_bf16_f32 v216, v184, v185
  v_mfma_f32_16x16x32_bf16 a[188:191], v[128:131], v[164:167], a[188:191]
  s_add_u32 m0, s60, 104448
  ds_read_b128 v[68:71], v28 offset:1024
  v_cvt_pk_bf16_f32 v217, v186, v187
  v_mfma_f32_16x16x32_bf16 a[192:195], v[132:135], v[152:155], a[192:195]
  v_cvt_pk_bf16_f32 v218, v188, v189
  v_cvt_pk_bf16_f32 v219, v190, v191
  v_mfma_f32_16x16x32_bf16 a[196:199], v[132:135], v[156:159], a[196:199]
  ds_read_b128 v[72:75], v28 offset:2048
  buffer_store_dwordx4 v[216:219], v3, s[12:15], s11 offen offset:0 sc1
  v_mfma_f32_16x16x32_bf16 a[200:203], v[132:135], v[160:163], a[200:203]
  s_add_u32 s62, s62, 131072
  ds_read_b128 v[76:79], v28 offset:3072
  v_mfma_f32_16x16x32_bf16 a[204:207], v[132:135], v[164:167], a[204:207]
  v_mfma_f32_16x16x32_bf16 a[208:211], v[136:139], v[152:155], a[208:211]
  ds_read_b128 v[80:83], v28 offset:4096
  v_mfma_f32_16x16x32_bf16 a[212:215], v[136:139], v[156:159], a[212:215]
  buffer_load_dwordx4 v20, s[12:15], s61 offen sc1 lds
  v_mfma_f32_16x16x32_bf16 a[216:219], v[136:139], v[160:163], a[216:219]
  ds_read_b128 v[84:87], v28 offset:5120
  v_mfma_f32_16x16x32_bf16 a[220:223], v[136:139], v[164:167], a[220:223]
  ds_read_b128 v[88:91], v28 offset:6144
  v_mfma_f32_16x16x32_bf16 a[224:227], v[140:143], v[152:155], a[224:227]
  buffer_load_dwordx4 v20, s[12:15], s61 offen offset:1024 sc1 lds
  v_mfma_f32_16x16x32_bf16 a[228:231], v[140:143], v[156:159], a[228:231]
  ds_read_b128 v[92:95], v28 offset:7168
  v_mfma_f32_16x16x32_bf16 a[232:235], v[140:143], v[160:163], a[232:235]
  v_mfma_f32_16x16x32_bf16 a[236:239], v[140:143], v[164:167], a[236:239]
  s_mov_b64 exec, 0xffff
  buffer_load_dwordx4 v20, s[12:15], s61 offen offset:2048 sc1 lds
  s_mov_b64 exec, -1
  v_mfma_f32_16x16x32_bf16 a[240:243], v[144:147], v[152:155], a[240:243]
  ds_read_b128 v[96:99], v28 offset:8192
  v_mfma_f32_16x16x32_bf16 a[244:247], v[144:147], v[156:159], a[244:247]
  v_mfma_f32_16x16x32_bf16 a[248:251], v[144:147], v[160:163], a[248:251]
  s_add_u32 s61, s61, 36864
  v_mfma_f32_16x16x32_bf16 a[252:255], v[144:147], v[164:167], a[252:255]
  v_mfma_f32_16x16x32_bf16 v[240:243], v[148:151], v[152:155], v[240:243]
  v_mfma_f32_16x16x32_bf16 v[244:247], v[148:151], v[156:159], v[244:247]
  v_mfma_f32_16x16x32_bf16 v[248:251], v[148:151], v[160:163], v[248:251]
  v_mfma_f32_16x16x32_bf16 v[252:255], v[148:151], v[164:167], v[252:255]
  s_waitcnt vmcnt(22) lgkmcnt(0)
  s_barrier
  v_mfma_f32_16x16x32_bf16 a[128:131], v[64:67], v[100:103], a[128:131]
  buffer_store_dword v9, v8, s[12:15], s44 offen sc1
  ds_read_b64_tr_b16 v[152:153], v25 offset:26112
  v_mfma_f32_16x16x32_bf16 a[132:135], v[64:67], v[104:107], a[132:135]
  s_add_u32 m0, s63, 130560
  ds_read_b64_tr_b16 v[154:155], v25 offset:26624
  v_mfma_f32_16x16x32_bf16 a[136:139], v[64:67], v[108:111], a[136:139]
  buffer_load_dwordx4 v21, s[40:43], s62 offen offset:0 lds
  v_mfma_f32_16x16x32_bf16 a[140:143], v[64:67], v[112:115], a[140:143]
  ds_read_b64_tr_b16 v[156:157], v25 offset:26144
  v_mfma_f32_16x16x32_bf16 a[144:147], v[68:71], v[100:103], a[144:147]
  buffer_load_dwordx4 v22, s[40:43], s62 offen offset:1056 lds
  v_mfma_f32_16x16x32_bf16 a[148:151], v[68:71], v[104:107], a[148:151]
  buffer_load_dwordx4 v23, s[40:43], s62 offen offset:2112 lds
  ds_read_b64_tr_b16 v[158:159], v25 offset:26656
  v_mfma_f32_16x16x32_bf16 a[152:155], v[68:71], v[108:111], a[152:155]
  ds_read_b64_tr_b16 v[160:161], v25 offset:26176
  v_mfma_f32_16x16x32_bf16 a[156:159], v[68:71], v[112:115], a[156:159]
  buffer_load_dwordx4 v24, s[40:43], s62 offen offset:3168 lds
  v_mfma_f32_16x16x32_bf16 a[160:163], v[72:75], v[100:103], a[160:163]
  s_add_u32 m0, s60, 130560
  ds_read_b64_tr_b16 v[162:163], v25 offset:26688
  v_mfma_f32_16x16x32_bf16 a[164:167], v[72:75], v[104:107], a[164:167]
  v_mfma_f32_16x16x32_bf16 a[168:171], v[72:75], v[108:111], a[168:171]
  s_add_u32 s62, s62, 131072
  ds_read_b64_tr_b16 v[164:165], v25 offset:26208
  v_mfma_f32_16x16x32_bf16 a[172:175], v[72:75], v[112:115], a[172:175]
  buffer_load_dwordx4 v20, s[12:15], s61 offen sc1 lds
  ds_read_b64_tr_b16 v[166:167], v25 offset:26720
  v_mfma_f32_16x16x32_bf16 a[176:179], v[76:79], v[100:103], a[176:179]
  v_mfma_f32_16x16x32_bf16 a[180:183], v[76:79], v[104:107], a[180:183]
  buffer_load_dwordx4 v20, s[12:15], s61 offen offset:1024 sc1 lds
  ds_read_b128 v[116:119], v28 offset:26112
  v_mfma_f32_16x16x32_bf16 a[184:187], v[76:79], v[108:111], a[184:187]
  s_mov_b64 exec, 0xffff
  buffer_load_dwordx4 v20, s[12:15], s61 offen offset:2048 sc1 lds
  s_mov_b64 exec, -1
  v_mfma_f32_16x16x32_bf16 a[188:191], v[76:79], v[112:115], a[188:191]
  ds_read_b128 v[120:123], v28 offset:27136
  v_mfma_f32_16x16x32_bf16 a[192:195], v[80:83], v[100:103], a[192:195]
  s_add_u32 s61, s61, 36864
  v_mfma_f32_16x16x32_bf16 a[196:199], v[80:83], v[104:107], a[196:199]
  s_add_u32 m0, s63, 0
  ds_read_b128 v[124:127], v28 offset:28160
  v_mfma_f32_16x16x32_bf16 a[200:203], v[80:83], v[108:111], a[200:203]
  ds_read_b128 v[128:131], v28 offset:29184
  v_mfma_f32_16x16x32_bf16 a[204:207], v[80:83], v[112:115], a[204:207]
  buffer_load_dwordx4 v21, s[40:43], s62 offen offset:0 lds
  v_mfma_f32_16x16x32_bf16 a[208:211], v[84:87], v[100:103], a[208:211]
  buffer_load_dwordx4 v22, s[40:43], s62 offen offset:1056 lds
  ds_read_b128 v[132:135], v28 offset:30208
  v_mfma_f32_16x16x32_bf16 a[212:215], v[84:87], v[104:107], a[212:215]
  v_mfma_f32_16x16x32_bf16 a[216:219], v[84:87], v[108:111], a[216:219]
  buffer_load_dwordx4 v23, s[40:43], s62 offen offset:2112 lds
  ds_read_b128 v[136:139], v28 offset:31232
  v_mfma_f32_16x16x32_bf16 a[220:223], v[84:87], v[112:115], a[220:223]
  buffer_load_dwordx4 v24, s[40:43], s62 offen offset:3168 lds
  ds_read_b128 v[140:143], v28 offset:32256
  v_mfma_f32_16x16x32_bf16 a[224:227], v[88:91], v[100:103], a[224:227]
  v_mfma_f32_16x16x32_bf16 a[228:231], v[88:91], v[104:107], a[228:231]
  s_add_u32 m0, s60, 0
  ds_read_b128 v[144:147], v28 offset:33280
  v_mfma_f32_16x16x32_bf16 a[232:235], v[88:91], v[108:111], a[232:235]
  s_add_u32 s62, s62, 131072
  v_mfma_f32_16x16x32_bf16 a[236:239], v[88:91], v[112:115], a[236:239]
  ds_read_b128 v[148:151], v28 offset:34304
  v_mfma_f32_16x16x32_bf16 a[240:243], v[92:95], v[100:103], a[240:243]
  buffer_load_dwordx4 v20, s[12:15], s61 offen sc1 lds
  v_mfma_f32_16x16x32_bf16 a[244:247], v[92:95], v[104:107], a[244:247]
  buffer_load_dwordx4 v20, s[12:15], s61 offen offset:1024 sc1 lds
  v_mfma_f32_16x16x32_bf16 a[248:251], v[92:95], v[108:111], a[248:251]
  v_mfma_f32_16x16x32_bf16 a[252:255], v[92:95], v[112:115], a[252:255]
  s_mov_b64 exec, 0xffff
  buffer_load_dwordx4 v20, s[12:15], s61 offen offset:2048 sc1 lds
  s_mov_b64 exec, -1
  v_mfma_f32_16x16x32_bf16 v[240:243], v[96:99], v[100:103], v[240:243]
  s_add_u32 s61, s61, 36864
  v_mfma_f32_16x16x32_bf16 v[244:247], v[96:99], v[104:107], v[244:247]
  v_mfma_f32_16x16x32_bf16 v[248:251], v[96:99], v[108:111], v[248:251]
  v_mfma_f32_16x16x32_bf16 v[252:255], v[96:99], v[112:115], v[252:255]
  s_waitcnt vmcnt(30) lgkmcnt(0)
  s_barrier
  v_mfma_f32_16x16x32_bf16 a[128:131], v[116:119], v[152:155], a[128:131]
  s_add_u32 m0, s63, 26112
  ds_read_b64_tr_b16 v[100:101], v26 offset:0
  v_accvgpr_read_b32 v192, a36
  v_mfma_f32_16x16x32_bf16 a[132:135], v[116:119], v[156:159], a[132:135]
  ds_read_b64_tr_b16 v[102:103], v26 offset:512
  v_accvgpr_read_b32 v193, a37
  v_mfma_f32_16x16x32_bf16 a[136:139], v[116:119], v[160:163], a[136:139]
  v_accvgpr_read_b32 v194, a38
  v_accvgpr_read_b32 v195, a39
  v_mfma_f32_16x16x32_bf16 a[140:143], v[116:119], v[164:167], a[140:143]
  buffer_load_dwordx4 v21, s[40:43], s62 offen offset:0 lds
  ds_read_b64_tr_b16 v[104:105], v26 offset:32
  v_mfma_f32_16x16x32_bf16 a[144:147], v[120:123], v[152:155], a[144:147]
  v_accvgpr_read_b32 v196, a52
  v_accvgpr_read_b32 v197, a53
  v_mfma_f32_16x16x32_bf16 a[148:151], v[120:123], v[156:159], a[148:151]
  ds_read_b64_tr_b16 v[106:107], v26 offset:544
  v_accvgpr_read_b32 v198, a54
  v_mfma_f32_16x16x32_bf16 a[152:155], v[120:123], v[160:163], a[152:155]
  buffer_load_dwordx4 v22, s[40:43], s62 offen offset:1056 lds
  ds_read_b64_tr_b16 v[108:109], v26 offset:64
  v_mfma_f32_16x16x32_bf16 a[156:159], v[120:123], v[164:167], a[156:159]
  v_accvgpr_read_b32 v199, a55
  v_mul_f32 v192, v192, v41
  v_mfma_f32_16x16x32_bf16 a[160:163], v[124:127], v[152:155], a[160:163]
  ds_read_b64_tr_b16 v[110:111], v26 offset:576
  v_mul_f32 v193, v193, v41
  v_mfma_f32_16x16x32_bf16 a[164:167], v[124:127], v[156:159], a[164:167]
  buffer_load_dwordx4 v23, s[40:43], s62 offen offset:2112 lds
  v_mul_f32 v194, v194, v41
  v_mfma_f32_16x16x32_bf16 a[168:171], v[124:127], v[160:163], a[168:171]
  ds_read_b64_tr_b16 v[112:113], v26 offset:96
  v_mul_f32 v195, v195, v41
  v_mfma_f32_16x16x32_bf16 a[172:175], v[124:127], v[164:167], a[172:175]
  ds_read_b64_tr_b16 v[114:115], v26 offset:608
  v_mul_f32 v196, v196, v41
  v_mfma_f32_16x16x32_bf16 a[176:179], v[128:131], v[152:155], a[176:179]
  buffer_load_dwordx4 v24, s[40:43], s62 offen offset:3168 lds
  v_mul_f32 v197, v197, v41
  v_mfma_f32_16x16x32_bf16 a[180:183], v[128:131], v[156:159], a[180:183]
  ds_read_b128 v[64:67], v29 offset:0
  v_mul_f32 v198, v198, v41
  v_mfma_f32_16x16x32_bf16 a[184:187], v[128:131], v[160:163], a[184:187]
  v_mul_f32 v199, v199, v41
  v_cvt_pk_bf16_f32 v220, v192, v193
  v_mfma_f32_16x16x32_bf16 a[188:191], v[128:131], v[164:167], a[188:191]
  s_add_u32 m0, s60, 26112
  ds_read_b128 v[68:71], v29 offset:1024
  v_cvt_pk_bf16_f32 v221, v194, v195
  v_mfma_f32_16x16x32_bf16 a[192:195], v[132:135], v[152:155], a[192:195]
  v_cvt_pk_bf16_f32 v222, v196, v197
  v_cvt_pk_bf16_f32 v223, v198, v199
  v_mfma_f32_16x16x32_bf16 a[196:199], v[132:135], v[156:159], a[196:199]
  ds_read_b128 v[72:75], v29 offset:2048
  buffer_store_dwordx4 v[220:223], v3, s[12:15], s11 offen offset:1024 sc1
  v_mfma_f32_16x16x32_bf16 a[200:203], v[132:135], v[160:163], a[200:203]
  s_add_u32 s62, s62, 131072
  ds_read_b128 v[76:79], v29 offset:3072
  v_mfma_f32_16x16x32_bf16 a[204:207], v[132:135], v[164:167], a[204:207]
  v_mfma_f32_16x16x32_bf16 a[208:211], v[136:139], v[152:155], a[208:211]
  ds_read_b128 v[80:83], v29 offset:4096
  v_mfma_f32_16x16x32_bf16 a[212:215], v[136:139], v[156:159], a[212:215]
  buffer_load_dwordx4 v20, s[12:15], s61 offen sc1 lds
  v_mfma_f32_16x16x32_bf16 a[216:219], v[136:139], v[160:163], a[216:219]
  ds_read_b128 v[84:87], v29 offset:5120
  v_mfma_f32_16x16x32_bf16 a[220:223], v[136:139], v[164:167], a[220:223]
  ds_read_b128 v[88:91], v29 offset:6144
  v_mfma_f32_16x16x32_bf16 a[224:227], v[140:143], v[152:155], a[224:227]
  buffer_load_dwordx4 v20, s[12:15], s61 offen offset:1024 sc1 lds
  v_mfma_f32_16x16x32_bf16 a[228:231], v[140:143], v[156:159], a[228:231]
  ds_read_b128 v[92:95], v29 offset:7168
  v_mfma_f32_16x16x32_bf16 a[232:235], v[140:143], v[160:163], a[232:235]
  v_mfma_f32_16x16x32_bf16 a[236:239], v[140:143], v[164:167], a[236:239]
  s_mov_b64 exec, 0xffff
  buffer_load_dwordx4 v20, s[12:15], s61 offen offset:2048 sc1 lds
  s_mov_b64 exec, -1
  v_mfma_f32_16x16x32_bf16 a[240:243], v[144:147], v[152:155], a[240:243]
  ds_read_b128 v[96:99], v29 offset:8192
  v_mfma_f32_16x16x32_bf16 a[244:247], v[144:147], v[156:159], a[244:247]
  v_mfma_f32_16x16x32_bf16 a[248:251], v[144:147], v[160:163], a[248:251]
  s_add_u32 s61, s61, 36864
  v_mfma_f32_16x16x32_bf16 a[252:255], v[144:147], v[164:167], a[252:255]
  v_mfma_f32_16x16x32_bf16 v[240:243], v[148:151], v[152:155], v[240:243]
  v_mfma_f32_16x16x32_bf16 v[244:247], v[148:151], v[156:159], v[244:247]
  v_mfma_f32_16x16x32_bf16 v[248:251], v[148:151], v[160:163], v[248:251]
  v_mfma_f32_16x16x32_bf16 v[252:255], v[148:151], v[164:167], v[252:255]
  s_waitcnt vmcnt(31) lgkmcnt(0)
  s_barrier
  v_mfma_f32_16x16x32_bf16 a[128:131], v[64:67], v[100:103], a[128:131]
  s_add_u32 m0, s63, 52224
  ds_read_b64_tr_b16 v[152:153], v26 offset:26112
  v_accvgpr_read_b32 v200, a40
  v_mfma_f32_16x16x32_bf16 a[132:135], v[64:67], v[104:107], a[132:135]
  ds_read_b64_tr_b16 v[154:155], v26 offset:26624
  v_accvgpr_read_b32 v201, a41
  v_mfma_f32_16x16x32_bf16 a[136:139], v[64:67], v[108:111], a[136:139]
  v_accvgpr_read_b32 v202, a42
  v_accvgpr_read_b32 v203, a43
  v_mfma_f32_16x16x32_bf16 a[140:143], v[64:67], v[112:115], a[140:143]
  buffer_load_dwordx4 v21, s[40:43], s62 offen offset:0 lds
  ds_read_b64_tr_b16 v[156:157], v26 offset:26144
  v_mfma_f32_16x16x32_bf16 a[144:147], v[68:71], v[100:103], a[144:147]
  v_accvgpr_read_b32 v204, a56
  v_accvgpr_read_b32 v205, a57
  v_mfma_f32_16x16x32_bf16 a[148:151], v[68:71], v[104:107], a[148:151]
  ds_read_b64_tr_b16 v[158:159], v26 offset:26656
  v_accvgpr_read_b32 v206, a58
  v_mfma_f32_16x16x32_bf16 a[152:155], v[68:71], v[108:111], a[152:155]
  buffer_load_dwordx4 v22, s[40:43], s62 offen offset:1056 lds
  ds_read_b64_tr_b16 v[160:161], v26 offset:26176
  v_mfma_f32_16x16x32_bf16 a[156:159], v[68:71], v[112:115], a[156:159]
  v_accvgpr_read_b32 v207, a59
  v_mul_f32 v200, v200, v42
  v_mfma_f32_16x16x32_bf16 a[160:163], v[72:75], v[100:103], a[160:163]
  ds_read_b64_tr_b16 v[162:163], v26 offset:26688
  v_mul_f32 v201, v201, v42
  v_mfma_f32_16x16x32_bf16 a[164:167], v[72:75], v[104:107], a[164:167]
  buffer_load_dwordx4 v23, s[40:43], s62 offen offset:2112 lds
  v_mul_f32 v202, v202, v42
  v_mfma_f32_16x16x32_bf16 a[168:171], v[72:75], v[108:111], a[168:171]
  ds_read_b64_tr_b16 v[164:165], v26 offset:26208
  v_mul_f32 v203, v203, v42
  v_mfma_f32_16x16x32_bf16 a[172:175], v[72:75], v[112:115], a[172:175]
  ds_read_b64_tr_b16 v[166:167], v26 offset:26720
  v_mul_f32 v204, v204, v42
  v_mfma_f32_16x16x32_bf16 a[176:179], v[76:79], v[100:103], a[176:179]
  buffer_load_dwordx4 v24, s[40:43], s62 offen offset:3168 lds
  v_mul_f32 v205, v205, v42
  v_mfma_f32_16x16x32_bf16 a[180:183], v[76:79], v[104:107], a[180:183]
  ds_read_b128 v[116:119], v29 offset:26112
  v_mul_f32 v206, v206, v42
  v_mfma_f32_16x16x32_bf16 a[184:187], v[76:79], v[108:111], a[184:187]
  v_mul_f32 v207, v207, v42
  v_cvt_pk_bf16_f32 v224, v200, v201
  v_mfma_f32_16x16x32_bf16 a[188:191], v[76:79], v[112:115], a[188:191]
  s_add_u32 m0, s60, 52224
  ds_read_b128 v[120:123], v29 offset:27136
  v_cvt_pk_bf16_f32 v225, v202, v203
  v_mfma_f32_16x16x32_bf16 a[192:195], v[80:83], v[100:103], a[192:195]
  v_cvt_pk_bf16_f32 v226, v204, v205
  v_cvt_pk_bf16_f32 v227, v206, v207
  v_mfma_f32_16x16x32_bf16 a[196:199], v[80:83], v[104:107], a[196:199]
  ds_read_b128 v[124:127], v29 offset:28160
  buffer_store_dwordx4 v[224:227], v3, s[12:15], s11 offen offset:2048 sc1
  v_mfma_f32_16x16x32_bf16 a[200:203], v[80:83], v[108:111], a[200:203]
  s_add_u32 s62, s62, 131072
  ds_read_b128 v[128:131], v29 offset:29184
  v_mfma_f32_16x16x32_bf16 a[204:207], v[80:83], v[112:115], a[204:207]
  v_mfma_f32_16x16x32_bf16 a[208:211], v[84:87], v[100:103], a[208:211]
  ds_read_b128 v[132:135], v29 offset:30208
  v_mfma_f32_16x16x32_bf16 a[212:215], v[84:87], v[104:107], a[212:215]
  buffer_load_dwordx4 v20, s[12:15], s61 offen sc1 lds
  v_mfma_f32_16x16x32_bf16 a[216:219], v[84:87], v[108:111], a[216:219]
  ds_read_b128 v[136:139], v29 offset:31232
  v_mfma_f32_16x16x32_bf16 a[220:223], v[84:87], v[112:115], a[220:223]
  ds_read_b128 v[140:143], v29 offset:32256
  v_mfma_f32_16x16x32_bf16 a[224:227], v[88:91], v[100:103], a[224:227]
  buffer_load_dwordx4 v20, s[12:15], s61 offen offset:1024 sc1 lds
  v_mfma_f32_16x16x32_bf16 a[228:231], v[88:91], v[104:107], a[228:231]
  ds_read_b128 v[144:147], v29 offset:33280
  v_mfma_f32_16x16x32_bf16 a[232:235], v[88:91], v[108:111], a[232:235]
  v_mfma_f32_16x16x32_bf16 a[236:239], v[88:91], v[112:115], a[236:239]
  s_mov_b64 exec, 0xffff
  buffer_load_dwordx4 v20, s[12:15], s61 offen offset:2048 sc1 lds
  s_mov_b64 exec, -1
  v_mfma_f32_16x16x32_bf16 a[240:243], v[92:95], v[100:103], a[240:243]
  ds_read_b128 v[148:151], v29 offset:34304
  v_mfma_f32_16x16x32_bf16 a[244:247], v[92:95], v[104:107], a[244:247]
  v_mfma_f32_16x16x32_bf16 a[248:251], v[92:95], v[108:111], a[248:251]
  s_add_u32 s61, s61, 36864
  v_mfma_f32_16x16x32_bf16 a[252:255], v[92:95], v[112:115], a[252:255]
  v_mfma_f32_16x16x32_bf16 v[240:243], v[96:99], v[100:103], v[240:243]
  v_mfma_f32_16x16x32_bf16 v[244:247], v[96:99], v[104:107], v[244:247]
  v_mfma_f32_16x16x32_bf16 v[248:251], v[96:99], v[108:111], v[248:251]
  v_mfma_f32_16x16x32_bf16 v[252:255], v[96:99], v[112:115], v[252:255]
  s_waitcnt vmcnt(31) lgkmcnt(0)
  s_barrier
  v_mfma_f32_16x16x32_bf16 a[128:131], v[116:119], v[152:155], a[128:131]
  s_add_u32 m0, s63, 78336
  ds_read_b64_tr_b16 v[100:101], v27 offset:0
  v_mfma_f32_16x16x32_bf16 a[132:135], v[116:119], v[156:159], a[132:135]
  ds_read_b64_tr_b16 v[102:103], v27 offset:512
  v_mfma_f32_16x16x32_bf16 a[136:139], v[116:119], v[160:163], a[136:139]
  v_mfma_f32_16x16x32_bf16 a[140:143], v[116:119], v[164:167], a[140:143]
  buffer_load_dwordx4 v21, s[40:43], s62 offen offset:0 lds
  ds_read_b64_tr_b16 v[104:105], v27 offset:32
  v_mfma_f32_16x16x32_bf16 a[144:147], v[120:123], v[152:155], a[144:147]
  v_mfma_f32_16x16x32_bf16 a[148:151], v[120:123], v[156:159], a[148:151]
  ds_read_b64_tr_b16 v[106:107], v27 offset:544
  v_mfma_f32_16x16x32_bf16 a[152:155], v[120:123], v[160:163], a[152:155]
  buffer_load_dwordx4 v22, s[40:43], s62 offen offset:1056 lds
  ds_read_b64_tr_b16 v[108:109], v27 offset:64
  v_mfma_f32_16x16x32_bf16 a[156:159], v[120:123], v[164:167], a[156:159]
  v_mfma_f32_16x16x32_bf16 a[160:163], v[124:127], v[152:155], a[160:163]
  ds_read_b64_tr_b16 v[110:111], v27 offset:576
  v_mfma_f32_16x16x32_bf16 a[164:167], v[124:127], v[156:159], a[164:167]
  buffer_load_dwordx4 v23, s[40:43], s62 offen offset:2112 lds
  v_mfma_f32_16x16x32_bf16 a[168:171], v[124:127], v[160:163], a[168:171]
  ds_read_b64_tr_b16 v[112:113], v27 offset:96
  v_mfma_f32_16x16x32_bf16 a[172:175], v[124:127], v[164:167], a[172:175]
  ds_read_b64_tr_b16 v[114:115], v27 offset:608
  v_mfma_f32_16x16x32_bf16 a[176:179], v[128:131], v[152:155], a[176:179]
  buffer_load_dwordx4 v24, s[40:43], s62 offen offset:3168 lds
  v_mfma_f32_16x16x32_bf16 a[180:183], v[128:131], v[156:159], a[180:183]
  ds_read_b128 v[64:67], v30 offset:0
  v_mfma_f32_16x16x32_bf16 a[184:187], v[128:131], v[160:163], a[184:187]
  v_mfma_f32_16x16x32_bf16 a[188:191], v[128:131], v[164:167], a[188:191]
  s_add_u32 m0, s60, 78336
  ds_read_b128 v[68:71], v30 offset:1024
  v_mfma_f32_16x16x32_bf16 a[192:195], v[132:135], v[152:155], a[192:195]
  v_mfma_f32_16x16x32_bf16 a[196:199], v[132:135], v[156:159], a[196:199]
  ds_read_b128 v[72:75], v30 offset:2048
  v_mfma_f32_16x16x32_bf16 a[200:203], v[132:135], v[160:163], a[200:203]
  s_add_u32 s62, s62, 131072
  ds_read_b128 v[76:79], v30 offset:3072
  v_mfma_f32_16x16x32_bf16 a[204:207], v[132:135], v[164:167], a[204:207]
  v_mfma_f32_16x16x32_bf16 a[208:211], v[136:139], v[152:155], a[208:211]
  ds_read_b128 v[80:83], v30 offset:4096
  v_mfma_f32_16x16x32_bf16 a[212:215], v[136:139], v[156:159], a[212:215]
  buffer_load_dwordx4 v20, s[12:15], s61 offen sc1 lds
  v_mfma_f32_16x16x32_bf16 a[216:219], v[136:139], v[160:163], a[216:219]
  ds_read_b128 v[84:87], v30 offset:5120
  v_mfma_f32_16x16x32_bf16 a[220:223], v[136:139], v[164:167], a[220:223]
  ds_read_b128 v[88:91], v30 offset:6144
  v_mfma_f32_16x16x32_bf16 a[224:227], v[140:143], v[152:155], a[224:227]
  buffer_load_dwordx4 v20, s[12:15], s61 offen offset:1024 sc1 lds
  v_mfma_f32_16x16x32_bf16 a[228:231], v[140:143], v[156:159], a[228:231]
  ds_read_b128 v[92:95], v30 offset:7168
  v_mfma_f32_16x16x32_bf16 a[232:235], v[140:143], v[160:163], a[232:235]
  v_mfma_f32_16x16x32_bf16 a[236:239], v[140:143], v[164:167], a[236:239]
  s_mov_b64 exec, 0xffff
  buffer_load_dwordx4 v20, s[12:15], s61 offen offset:2048 sc1 lds
  s_mov_b64 exec, -1
  v_mfma_f32_16x16x32_bf16 a[240:243], v[144:147], v[152:155], a[240:243]
  ds_read_b128 v[96:99], v30 offset:8192
  v_mfma_f32_16x16x32_bf16 a[244:247], v[144:147], v[156:159], a[244:247]
  v_mfma_f32_16x16x32_bf16 a[248:251], v[144:147], v[160:163], a[248:251]
  s_add_u32 s61, s61, 36864
  v_mfma_f32_16x16x32_bf16 a[252:255], v[144:147], v[164:167], a[252:255]
  v_mfma_f32_16x16x32_bf16 v[240:243], v[148:151], v[152:155], v[240:243]
  v_mfma_f32_16x16x32_bf16 v[244:247], v[148:151], v[156:159], v[244:247]
  v_mfma_f32_16x16x32_bf16 v[248:251], v[148:151], v[160:163], v[248:251]
  v_mfma_f32_16x16x32_bf16 v[252:255], v[148:151], v[164:167], v[252:255]
  s_waitcnt vmcnt(30) lgkmcnt(0)
  s_barrier
  v_mfma_f32_16x16x32_bf16 a[128:131], v[64:67], v[100:103], a[128:131]
  s_add_u32 m0, s63, 104448
  ds_read_b64_tr_b16 v[152:153], v27 offset:26112
  v_accvgpr_read_b32 v208, a44
  v_mfma_f32_16x16x32_bf16 a[132:135], v[64:67], v[104:107], a[132:135]
  ds_read_b64_tr_b16 v[154:155], v27 offset:26624
  v_accvgpr_read_b32 v209, a45
  v_mfma_f32_16x16x32_bf16 a[136:139], v[64:67], v[108:111], a[136:139]
  v_accvgpr_read_b32 v210, a46
  v_accvgpr_read_b32 v211, a47
  v_mfma_f32_16x16x32_bf16 a[140:143], v[64:67], v[112:115], a[140:143]
  buffer_load_dwordx4 v21, s[40:43], s62 offen offset:0 lds
  ds_read_b64_tr_b16 v[156:157], v27 offset:26144
  v_mfma_f32_16x16x32_bf16 a[144:147], v[68:71], v[100:103], a[144:147]
  v_accvgpr_read_b32 v212, a60
  v_accvgpr_read_b32 v213, a61
  v_mfma_f32_16x16x32_bf16 a[148:151], v[68:71], v[104:107], a[148:151]
  ds_read_b64_tr_b16 v[158:159], v27 offset:26656
  v_accvgpr_read_b32 v214, a62
  v_mfma_f32_16x16x32_bf16 a[152:155], v[68:71], v[108:111], a[152:155]
  buffer_load_dwordx4 v22, s[40:43], s62 offen offset:1056 lds
  ds_read_b64_tr_b16 v[160:161], v27 offset:26176
  v_mfma_f32_16x16x32_bf16 a[156:159], v[68:71], v[112:115], a[156:159]
  v_accvgpr_read_b32 v215, a63
  v_mul_f32 v208, v208, v43
  v_mfma_f32_16x16x32_bf16 a[160:163], v[72:75], v[100:103], a[160:163]
  ds_read_b64_tr_b16 v[162:163], v27 offset:26688
  v_mul_f32 v209, v209, v43
  v_mfma_f32_16x16x32_bf16 a[164:167], v[72:75], v[104:107], a[164:167]
  buffer_load_dwordx4 v23, s[40:43], s62 offen offset:2112 lds
  v_mul_f32 v210, v210, v43
  v_mfma_f32_16x16x32_bf16 a[168:171], v[72:75], v[108:111], a[168:171]
  ds_read_b64_tr_b16 v[164:165], v27 offset:26208
  v_mul_f32 v211, v211, v43
  v_mfma_f32_16x16x32_bf16 a[172:175], v[72:75], v[112:115], a[172:175]
  ds_read_b64_tr_b16 v[166:167], v27 offset:26720
  v_mul_f32 v212, v212, v43
  v_mfma_f32_16x16x32_bf16 a[176:179], v[76:79], v[100:103], a[176:179]
  buffer_load_dwordx4 v24, s[40:43], s62 offen offset:3168 lds
  v_mul_f32 v213, v213, v43
  v_mfma_f32_16x16x32_bf16 a[180:183], v[76:79], v[104:107], a[180:183]
  ds_read_b128 v[116:119], v30 offset:26112
  v_mul_f32 v214, v214, v43
  v_mfma_f32_16x16x32_bf16 a[184:187], v[76:79], v[108:111], a[184:187]
  v_mul_f32 v215, v215, v43
  v_cvt_pk_bf16_f32 v228, v208, v209
  v_mfma_f32_16x16x32_bf16 a[188:191], v[76:79], v[112:115], a[188:191]
  s_add_u32 m0, s60, 104448
  ds_read_b128 v[120:123], v30 offset:27136
  v_cvt_pk_bf16_f32 v229, v210, v211
  v_mfma_f32_16x16x32_bf16 a[192:195], v[80:83], v[100:103], a[192:195]
  v_cvt_pk_bf16_f32 v230, v212, v213
  v_cvt_pk_bf16_f32 v231, v214, v215
  v_mfma_f32_16x16x32_bf16 a[196:199], v[80:83], v[104:107], a[196:199]
  ds_read_b128 v[124:127], v30 offset:28160
  buffer_store_dwordx4 v[228:231], v3, s[12:15], s11 offen offset:3072 sc1
  v_mfma_f32_16x16x32_bf16 a[200:203], v[80:83], v[108:111], a[200:203]
  s_add_u32 s62, s62, 131072
  s_add_u32 s11, s11, 131072
  ds_read_b128 v[128:131], v30 offset:29184
  v_mfma_f32_16x16x32_bf16 a[204:207], v[80:83], v[112:115], a[204:207]
  v_mfma_f32_16x16x32_bf16 a[208:211], v[84:87], v[100:103], a[208:211]
  ds_read_b128 v[132:135], v30 offset:30208
  v_mfma_f32_16x16x32_bf16 a[212:215], v[84:87], v[104:107], a[212:215]
  buffer_load_dwordx4 v20, s[12:15], s61 offen sc1 lds
  v_mfma_f32_16x16x32_bf16 a[216:219], v[84:87], v[108:111], a[216:219]
  ds_read_b128 v[136:139], v30 offset:31232
  v_mfma_f32_16x16x32_bf16 a[220:223], v[84:87], v[112:115], a[220:223]
  ds_read_b128 v[140:143], v30 offset:32256
  v_mfma_f32_16x16x32_bf16 a[224:227], v[88:91], v[100:103], a[224:227]
  buffer_load_dwordx4 v20, s[12:15], s61 offen offset:1024 sc1 lds
  v_mfma_f32_16x16x32_bf16 a[228:231], v[88:91], v[104:107], a[228:231]
  ds_read_b128 v[144:147], v30 offset:33280
  v_mfma_f32_16x16x32_bf16 a[232:235], v[88:91], v[108:111], a[232:235]
  v_mfma_f32_16x16x32_bf16 a[236:239], v[88:91], v[112:115], a[236:239]
  s_mov_b64 exec, 0xffff
  buffer_load_dwordx4 v20, s[12:15], s61 offen offset:2048 sc1 lds
  s_mov_b64 exec, -1
  v_mfma_f32_16x16x32_bf16 a[240:243], v[92:95], v[100:103], a[240:243]
  ds_read_b128 v[148:151], v30 offset:34304
  v_mfma_f32_16x16x32_bf16 a[244:247], v[92:95], v[104:107], a[244:247]
  v_mfma_f32_16x16x32_bf16 a[248:251], v[92:95], v[108:111], a[248:251]
  s_add_u32 s61, s61, 36864
  v_mfma_f32_16x16x32_bf16 a[252:255], v[92:95], v[112:115], a[252:255]
  v_mfma_f32_16x16x32_bf16 v[240:243], v[96:99], v[100:103], v[240:243]
  v_mfma_f32_16x16x32_bf16 v[244:247], v[96:99], v[104:107], v[244:247]
  v_mfma_f32_16x16x32_bf16 v[248:251], v[96:99], v[108:111], v[248:251]
  v_mfma_f32_16x16x32_bf16 v[252:255], v[96:99], v[112:115], v[252:255]
  s_waitcnt vmcnt(31) lgkmcnt(0)
  s_barrier
  v_mfma_f32_16x16x32_bf16 a[128:131], v[116:119], v[152:155], a[128:131]
  s_add_u32 m0, s63, 130560
  ds_read_b64_tr_b16 v[100:101], v25 offset:0
  v_accvgpr_read_b32 v184, a64
  v_mfma_f32_16x16x32_bf16 a[132:135], v[116:119], v[156:159], a[132:135]
  ds_read_b64_tr_b16 v[102:103], v25 offset:512
  v_accvgpr_read_b32 v185, a65
  v_mfma_f32_16x16x32_bf16 a[136:139], v[116:119], v[160:163], a[136:139]
  v_accvgpr_read_b32 v186, a66
  v_accvgpr_read_b32 v187, a67
  v_mfma_f32_16x16x32_bf16 a[140:143], v[116:119], v[164:167], a[140:143]
  buffer_load_dwordx4 v21, s[40:43], s62 offen offset:0 lds
  ds_read_b64_tr_b16 v[104:105], v25 offset:32
  v_mfma_f32_16x16x32_bf16 a[144:147], v[120:123], v[152:155], a[144:147]
  v_accvgpr_read_b32 v188, a80
  v_accvgpr_read_b32 v189, a81
  v_mfma_f32_16x16x32_bf16 a[148:151], v[120:123], v[156:159], a[148:151]
  ds_read_b64_tr_b16 v[106:107], v25 offset:544
  v_accvgpr_read_b32 v190, a82
  v_mfma_f32_16x16x32_bf16 a[152:155], v[120:123], v[160:163], a[152:155]
  buffer_load_dwordx4 v22, s[40:43], s62 offen offset:1056 lds
  ds_read_b64_tr_b16 v[108:109], v25 offset:64
  v_mfma_f32_16x16x32_bf16 a[156:159], v[120:123], v[164:167], a[156:159]
  v_accvgpr_read_b32 v191, a83
  v_mul_f32 v184, v184, v40
  v_mfma_f32_16x16x32_bf16 a[160:163], v[124:127], v[152:155], a[160:163]
  ds_read_b64_tr_b16 v[110:111], v25 offset:576
  v_mul_f32 v185, v185, v40
  v_mfma_f32_16x16x32_bf16 a[164:167], v[124:127], v[156:159], a[164:167]
  buffer_load_dwordx4 v23, s[40:43], s62 offen offset:2112 lds
  v_mul_f32 v186, v186, v40
  v_mfma_f32_16x16x32_bf16 a[168:171], v[124:127], v[160:163], a[168:171]
TP_21:
  s_cbranch_execz TP_25
  ds_read_b64_tr_b16 v[112:113], v25 offset:96
  v_mul_f32 v187, v187, v40
  v_mfma_f32_16x16x32_bf16 a[172:175], v[124:127], v[164:167], a[172:175]
  ds_read_b64_tr_b16 v[114:115], v25 offset:608
  v_mul_f32 v188, v188, v40
  v_mfma_f32_16x16x32_bf16 a[176:179], v[128:131], v[152:155], a[176:179]
  buffer_load_dwordx4 v24, s[40:43], s62 offen offset:3168 lds
  v_mul_f32 v189, v189, v40
  v_mfma_f32_16x16x32_bf16 a[180:183], v[128:131], v[156:159], a[180:183]
  ds_read_b128 v[64:67], v28 offset:0
  v_mul_f32 v190, v190, v40
  v_mfma_f32_16x16x32_bf16 a[184:187], v[128:131], v[160:163], a[184:187]
  v_mul_f32 v191, v191, v40
  v_cvt_pk_bf16_f32 v216, v184, v185
  v_mfma_f32_16x16x32_bf16 a[188:191], v[128:131], v[164:167], a[188:191]
  s_add_u32 m0, s60, 130560
  ds_read_b128 v[68:71], v28 offset:1024
  v_cvt_pk_bf16_f32 v217, v186, v187
  v_mfma_f32_16x16x32_bf16 a[192:195], v[132:135], v[152:155], a[192:195]
  v_cvt_pk_bf16_f32 v218, v188, v189
  v_cvt_pk_bf16_f32 v219, v190, v191
  v_mfma_f32_16x16x32_bf16 a[196:199], v[132:135], v[156:159], a[196:199]
  ds_read_b128 v[72:75], v28 offset:2048
  buffer_store_dwordx4 v[216:219], v3, s[12:15], s11 offen offset:0 sc1
  v_mfma_f32_16x16x32_bf16 a[200:203], v[132:135], v[160:163], a[200:203]
  s_add_u32 s62, s62, 131072
  ds_read_b128 v[76:79], v28 offset:3072
  v_mfma_f32_16x16x32_bf16 a[204:207], v[132:135], v[164:167], a[204:207]
  v_mfma_f32_16x16x32_bf16 a[208:211], v[136:139], v[152:155], a[208:211]
  ds_read_b128 v[80:83], v28 offset:4096
  v_mfma_f32_16x16x32_bf16 a[212:215], v[136:139], v[156:159], a[212:215]
  buffer_load_dwordx4 v20, s[12:15], s61 offen sc1 lds
  v_mfma_f32_16x16x32_bf16 a[216:219], v[136:139], v[160:163], a[216:219]
  ds_read_b128 v[84:87], v28 offset:5120
  v_mfma_f32_16x16x32_bf16 a[220:223], v[136:139], v[164:167], a[220:223]
  ds_read_b128 v[88:91], v28 offset:6144
  v_mfma_f32_16x16x32_bf16 a[224:227], v[140:143], v[152:155], a[224:227]
  buffer_load_dwordx4 v20, s[12:15], s61 offen offset:1024 sc1 lds
  v_mfma_f32_16x16x32_bf16 a[228:231], v[140:143], v[156:159], a[228:231]
  ds_read_b128 v[92:95], v28 offset:7168
  v_mfma_f32_16x16x32_bf16 a[232:235], v[140:143], v[160:163], a[232:235]
  v_mfma_f32_16x16x32_bf16 a[236:239], v[140:143], v[164:167], a[236:239]
  s_mov_b64 exec, 0xffff
  buffer_load_dwordx4 v20, s[12:15], s61 offen offset:2048 sc1 lds
  s_mov_b64 exec, -1
  v_mfma_f32_16x16x32_bf16 a[240:243], v[144:147], v[152:155], a[240:243]
  ds_read_b128 v[96:99], v28 offset:8192
  v_mfma_f32_16x16x32_bf16 a[244:247], v[144:147], v[156:159], a[244:247]
  v_mfma_f32_16x16x32_bf16 a[248:251], v[144:147], v[160:163], a[248:251]
  s_add_u32 s61, s61, 36864
  v_mfma_f32_16x16x32_bf16 a[252:255], v[144:147], v[164:167], a[252:255]
  v_mfma_f32_16x16x32_bf16 v[240:243], v[148:151], v[152:155], v[240:243]
  v_mfma_f32_16x16x32_bf16 v[244:247], v[148:151], v[156:159], v[244:247]
  v_mfma_f32_16x16x32_bf16 v[248:251], v[148:151], v[160:163], v[248:251]
  v_mfma_f32_16x16x32_bf16 v[252:255], v[148:151], v[164:167], v[252:255]
  s_waitcnt vmcnt(31) lgkmcnt(0)
  s_barrier
  v_mfma_f32_16x16x32_bf16 a[128:131], v[64:67], v[100:103], a[128:131]
  s_add_u32 m0, s63, 0
  ds_read_b64_tr_b16 v[152:153], v25 offset:26112
  v_mfma_f32_16x16x32_bf16 a[132:135], v[64:67], v[104:107], a[132:135]
  ds_read_b64_tr_b16 v[154:155], v25 offset:26624
  v_mfma_f32_16x16x32_bf16 a[136:139], v[64:67], v[108:111], a[136:139]
  v_mfma_f32_16x16x32_bf16 a[140:143], v[64:67], v[112:115], a[140:143]
  buffer_load_dwordx4 v21, s[40:43], s62 offen offset:0 lds
  ds_read_b64_tr_b16 v[156:157], v25 offset:26144
  v_mfma_f32_16x16x32_bf16 a[144:147], v[68:71], v[100:103], a[144:147]
  v_mfma_f32_16x16x32_bf16 a[148:151], v[68:71], v[104:107], a[148:151]
  ds_read_b64_tr_b16 v[158:159], v25 offset:26656
  v_mfma_f32_16x16x32_bf16 a[152:155], v[68:71], v[108:111], a[152:155]
  buffer_load_dwordx4 v22, s[40:43], s62 offen offset:1056 lds
  ds_read_b64_tr_b16 v[160:161], v25 offset:26176
  v_mfma_f32_16x16x32_bf16 a[156:159], v[68:71], v[112:115], a[156:159]
  v_mfma_f32_16x16x32_bf16 a[160:163], v[72:75], v[100:103], a[160:163]
  ds_read_b64_tr_b16 v[162:163], v25 offset:26688
  v_mfma_f32_16x16x32_bf16 a[164:167], v[72:75], v[104:107], a[164:167]
  buffer_load_dwordx4 v23, s[40:43], s62 offen offset:2112 lds
  v_mfma_f32_16x16x32_bf16 a[168:171], v[72:75], v[108:111], a[168:171]
  ds_read_b64_tr_b16 v[164:165], v25 offset:26208
  v_mfma_f32_16x16x32_bf16 a[172:175], v[72:75], v[112:115], a[172:175]
  ds_read_b64_tr_b16 v[166:167], v25 offset:26720
  v_mfma_f32_16x16x32_bf16 a[176:179], v[76:79], v[100:103], a[176:179]
  buffer_load_dwordx4 v24, s[40:43], s62 offen offset:3168 lds
  v_mfma_f32_16x16x32_bf16 a[180:183], v[76:79], v[104:107], a[180:183]
  ds_read_b128 v[116:119], v28 offset:26112
  v_mfma_f32_16x16x32_bf16 a[184:187], v[76:79], v[108:111], a[184:187]
  v_mfma_f32_16x16x32_bf16 a[188:191], v[76:79], v[112:115], a[188:191]
  s_add_u32 m0, s60, 0
  ds_read_b128 v[120:123], v28 offset:27136
  v_mfma_f32_16x16x32_bf16 a[192:195], v[80:83], v[100:103], a[192:195]
  v_mfma_f32_16x16x32_bf16 a[196:199], v[80:83], v[104:107], a[196:199]
  ds_read_b128 v[124:127], v28 offset:28160
  v_mfma_f32_16x16x32_bf16 a[200:203], v[80:83], v[108:111], a[200:203]
  s_add_u32 s62, s62, 131072
  ds_read_b128 v[128:131], v28 offset:29184
  v_mfma_f32_16x16x32_bf16 a[204:207], v[80:83], v[112:115], a[204:207]
  v_mfma_f32_16x16x32_bf16 a[208:211], v[84:87], v[100:103], a[208:211]
  ds_read_b128 v[132:135], v28 offset:30208
  v_mfma_f32_16x16x32_bf16 a[212:215], v[84:87], v[104:107], a[212:215]
  buffer_load_dwordx4 v20, s[12:15], s61 offen sc1 lds
  v_mfma_f32_16x16x32_bf16 a[216:219], v[84:87], v[108:111], a[216:219]
  ds_read_b128 v[136:139], v28 offset:31232
  v_mfma_f32_16x16x32_bf16 a[220:223], v[84:87], v[112:115], a[220:223]
  ds_read_b128 v[140:143], v28 offset:32256
  v_mfma_f32_16x16x32_bf16 a[224:227], v[88:91], v[100:103], a[224:227]
  buffer_load_dwordx4 v20, s[12:15], s61 offen offset:1024 sc1 lds
  v_mfma_f32_16x16x32_bf16 a[228:231], v[88:91], v[104:107], a[228:231]
  ds_read_b128 v[144:147], v28 offset:33280
  v_mfma_f32_16x16x32_bf16 a[232:235], v[88:91], v[108:111], a[232:235]
  v_mfma_f32_16x16x32_bf16 a[236:239], v[88:91], v[112:115], a[236:239]
  s_mov_b64 exec, 0xffff
  buffer_load_dwordx4 v20, s[12:15], s61 offen offset:2048 sc1 lds
  s_mov_b64 exec, -1
  v_mfma_f32_16x16x32_bf16 a[240:243], v[92:95], v[100:103], a[240:243]
  ds_read_b128 v[148:151], v28 offset:34304
  v_mfma_f32_16x16x32_bf16 a[244:247], v[92:95], v[104:107], a[244:247]
  v_mfma_f32_16x16x32_bf16 a[248:251], v[92:95], v[108:111], a[248:251]
  s_add_u32 s61, s61, 36864
  v_mfma_f32_16x16x32_bf16 a[252:255], v[92:95], v[112:115], a[252:255]
  v_mfma_f32_16x16x32_bf16 v[240:243], v[96:99], v[100:103], v[240:243]
  v_mfma_f32_16x16x32_bf16 v[244:247], v[96:99], v[104:107], v[244:247]
  v_mfma_f32_16x16x32_bf16 v[248:251], v[96:99], v[108:111], v[248:251]
  v_mfma_f32_16x16x32_bf16 v[252:255], v[96:99], v[112:115], v[252:255]
  s_waitcnt vmcnt(18) lgkmcnt(0)
  s_barrier
  v_mfma_f32_16x16x32_bf16 a[128:131], v[116:119], v[152:155], a[128:131]
  buffer_store_dword v33, v8, s[12:15], s44 offen sc1
  ds_read_b64_tr_b16 v[100:101], v26 offset:0
  v_mfma_f32_16x16x32_bf16 a[132:135], v[116:119], v[156:159], a[132:135]
  ds_read_b64_tr_b16 v[102:103], v26 offset:512
  v_accvgpr_read_b32 v192, a68
  v_mfma_f32_16x16x32_bf16 a[136:139], v[116:119], v[160:163], a[136:139]
  s_add_u32 m0, s63, 26112
  v_accvgpr_read_b32 v193, a69
  v_accvgpr_read_b32 v194, a70
  v_mfma_f32_16x16x32_bf16 a[140:143], v[116:119], v[164:167], a[140:143]
  ds_read_b64_tr_b16 v[104:105], v26 offset:32
  v_accvgpr_read_b32 v195, a71
  v_mfma_f32_16x16x32_bf16 a[144:147], v[120:123], v[152:155], a[144:147]
  v_accvgpr_read_b32 v196, a84
  v_accvgpr_read_b32 v197, a85
  v_mfma_f32_16x16x32_bf16 a[148:151], v[120:123], v[156:159], a[148:151]
  buffer_load_dwordx4 v21, s[40:43], s62 offen offset:0 lds
  ds_read_b64_tr_b16 v[106:107], v26 offset:544
  v_mfma_f32_16x16x32_bf16 a[152:155], v[120:123], v[160:163], a[152:155]
  ds_read_b64_tr_b16 v[108:109], v26 offset:64
  v_accvgpr_read_b32 v198, a86
  v_mfma_f32_16x16x32_bf16 a[156:159], v[120:123], v[164:167], a[156:159]
  v_accvgpr_read_b32 v199, a87
  v_mul_f32 v192, v192, v41
  v_mfma_f32_16x16x32_bf16 a[160:163], v[124:127], v[152:155], a[160:163]
  buffer_load_dwordx4 v22, s[40:43], s62 offen offset:1056 lds
  ds_read_b64_tr_b16 v[110:111], v26 offset:576
  v_mfma_f32_16x16x32_bf16 a[164:167], v[124:127], v[156:159], a[164:167]
  v_mul_f32 v193, v193, v41
  v_mul_f32 v194, v194, v41
  v_mfma_f32_16x16x32_bf16 a[168:171], v[124:127], v[160:163], a[168:171]
  ds_read_b64_tr_b16 v[112:113], v26 offset:96
  v_mul_f32 v195, v195, v41
  v_mfma_f32_16x16x32_bf16 a[172:175], v[124:127], v[164:167], a[172:175]
  buffer_load_dwordx4 v23, s[40:43], s62 offen offset:2112 lds
  ds_read_b64_tr_b16 v[114:115], v26 offset:608
  v_mfma_f32_16x16x32_bf16 a[176:179], v[128:131], v[152:155], a[176:179]
  v_mul_f32 v196, v196, v41
  v_mul_f32 v197, v197, v41
  v_mfma_f32_16x16x32_bf16 a[180:183], v[128:131], v[156:159], a[180:183]
  ds_read_b128 v[64:67], v29 offset:0
  v_mul_f32 v198, v198, v41
  v_mfma_f32_16x16x32_bf16 a[184:187], v[128:131], v[160:163], a[184:187]
  buffer_load_dwordx4 v24, s[40:43], s62 offen offset:3168 lds
  v_mul_f32 v199, v199, v41
  v_mfma_f32_16x16x32_bf16 a[188:191], v[128:131], v[164:167], a[188:191]
  ds_read_b128 v[68:71], v29 offset:1024
  v_cvt_pk_bf16_f32 v220, v192, v193
  v_mfma_f32_16x16x32_bf16 a[192:195], v[132:135], v[152:155], a[192:195]
  v_cvt_pk_bf16_f32 v221, v194, v195
  v_cvt_pk_bf16_f32 v222, v196, v197
  v_mfma_f32_16x16x32_bf16 a[196:199], v[132:135], v[156:159], a[196:199]
  s_add_u32 m0, s60, 26112
  ds_read_b128 v[72:75], v29 offset:2048
  v_cvt_pk_bf16_f32 v223, v198, v199
  v_mfma_f32_16x16x32_bf16 a[200:203], v[132:135], v[160:163], a[200:203]
  ds_read_b128 v[76:79], v29 offset:3072
  buffer_store_dwordx4 v[220:223], v3, s[12:15], s11 offen offset:1024 sc1
  v_mfma_f32_16x16x32_bf16 a[204:207], v[132:135], v[164:167], a[204:207]
  s_add_u32 s62, s62, 131072
  v_mfma_f32_16x16x32_bf16 a[208:211], v[136:139], v[152:155], a[208:211]
  ds_read_b128 v[80:83], v29 offset:4096
  v_mfma_f32_16x16x32_bf16 a[212:215], v[136:139], v[156:159], a[212:215]
  v_mfma_f32_16x16x32_bf16 a[216:219], v[136:139], v[160:163], a[216:219]
  buffer_load_dwordx4 v20, s[12:15], s61 offen sc1 lds
  ds_read_b128 v[84:87], v29 offset:5120
  v_mfma_f32_16x16x32_bf16 a[220:223], v[136:139], v[164:167], a[220:223]
  ds_read_b128 v[88:91], v29 offset:6144
  v_mfma_f32_16x16x32_bf16 a[224:227], v[140:143], v[152:155], a[224:227]
  v_mfma_f32_16x16x32_bf16 a[228:231], v[140:143], v[156:159], a[228:231]
  buffer_load_dwordx4 v20, s[12:15], s61 offen offset:1024 sc1 lds
  ds_read_b128 v[92:95], v29 offset:7168
  v_mfma_f32_16x16x32_bf16 a[232:235], v[140:143], v[160:163], a[232:235]
  v_mfma_f32_16x16x32_bf16 a[236:239], v[140:143], v[164:167], a[236:239]
  ds_read_b128 v[96:99], v29 offset:8192
  v_mfma_f32_16x16x32_bf16 a[240:243], v[144:147], v[152:155], a[240:243]
  s_mov_b64 exec, 0xffff
  buffer_load_dwordx4 v20, s[12:15], s61 offen offset:2048 sc1 lds
  s_mov_b64 exec, -1
  v_mfma_f32_16x16x32_bf16 a[244:247], v[144:147], v[156:159], a[244:247]
  v_mfma_f32_16x16x32_bf16 a[248:251], v[144:147], v[160:163], a[248:251]
  v_mfma_f32_16x16x32_bf16 a[252:255], v[144:147], v[164:167], a[252:255]
  s_add_u32 s61, s61, 36864
  v_mfma_f32_16x16x32_bf16 v[240:243], v[148:151], v[152:155], v[240:243]
  v_mfma_f32_16x16x32_bf16 v[244:247], v[148:151], v[156:159], v[244:247]
  v_mfma_f32_16x16x32_bf16 v[248:251], v[148:151], v[160:163], v[248:251]
  v_mfma_f32_16x16x32_bf16 v[252:255], v[148:151], v[164:167], v[252:255]
  s_waitcnt lgkmcnt(0)
  s_barrier
  v_mfma_f32_16x16x32_bf16 a[128:131], v[64:67], v[100:103], a[128:131]
  s_add_u32 m0, s63, 52224
  ds_read_b64_tr_b16 v[152:153], v26 offset:26112
  v_accvgpr_read_b32 v200, a72
  v_mfma_f32_16x16x32_bf16 a[132:135], v[64:67], v[104:107], a[132:135]
  ds_read_b64_tr_b16 v[154:155], v26 offset:26624
  v_accvgpr_read_b32 v201, a73
  v_mfma_f32_16x16x32_bf16 a[136:139], v[64:67], v[108:111], a[136:139]
  v_accvgpr_read_b32 v202, a74
  v_accvgpr_read_b32 v203, a75
  v_mfma_f32_16x16x32_bf16 a[140:143], v[64:67], v[112:115], a[140:143]
  buffer_load_dwordx4 v21, s[40:43], s62 offen offset:0 lds
  ds_read_b64_tr_b16 v[156:157], v26 offset:26144
  v_mfma_f32_16x16x32_bf16 a[144:147], v[68:71], v[100:103], a[144:147]
  v_accvgpr_read_b32 v204, a88
  v_accvgpr_read_b32 v205, a89
  v_mfma_f32_16x16x32_bf16 a[148:151], v[68:71], v[104:107], a[148:151]
  ds_read_b64_tr_b16 v[158:159], v26 offset:26656
  v_accvgpr_read_b32 v206, a90
  v_mfma_f32_16x16x32_bf16 a[152:155], v[68:71], v[108:111], a[152:155]
  buffer_load_dwordx4 v22, s[40:43], s62 offen offset:1056 lds
  ds_read_b64_tr_b16 v[160:161], v26 offset:26176
  v_mfma_f32_16x16x32_bf16 a[156:159], v[68:71], v[112:115], a[156:159]
  v_accvgpr_read_b32 v207, a91
  v_mul_f32 v200, v200, v42
  v_mfma_f32_16x16x32_bf16 a[160:163], v[72:75], v[100:103], a[160:163]
  ds_read_b64_tr_b16 v[162:163], v26 offset:26688
  v_mul_f32 v201, v201, v42
  v_mfma_f32_16x16x32_bf16 a[164:167], v[72:75], v[104:107], a[164:167]
  buffer_load_dwordx4 v23, s[40:43], s62 offen offset:2112 lds
  v_mul_f32 v202, v202, v42
  v_mfma_f32_16x16x32_bf16 a[168:171], v[72:75], v[108:111], a[168:171]
  ds_read_b64_tr_b16 v[164:165], v26 offset:26208
  v_mul_f32 v203, v203, v42
  v_mfma_f32_16x16x32_bf16 a[172:175], v[72:75], v[112:115], a[172:175]
  ds_read_b64_tr_b16 v[166:167], v26 offset:26720
  v_mul_f32 v204, v204, v42
  v_mfma_f32_16x16x32_bf16 a[176:179], v[76:79], v[100:103], a[176:179]
  buffer_load_dwordx4 v24, s[40:43], s62 offen offset:3168 lds
  v_mul_f32 v205, v205, v42
  v_mfma_f32_16x16x32_bf16 a[180:183], v[76:79], v[104:107], a[180:183]
  ds_read_b128 v[116:119], v29 offset:26112
  v_mul_f32 v206, v206, v42
  v_mfma_f32_16x16x32_bf16 a[184:187], v[76:79], v[108:111], a[184:187]
  v_mul_f32 v207, v207, v42
  v_cvt_pk_bf16_f32 v224, v200, v201
  v_mfma_f32_16x16x32_bf16 a[188:191], v[76:79], v[112:115], a[188:191]
  s_add_u32 m0, s60, 52224
  ds_read_b128 v[120:123], v29 offset:27136
  v_cvt_pk_bf16_f32 v225, v202, v203
  v_mfma_f32_16x16x32_bf16 a[192:195], v[80:83], v[100:103], a[192:195]
  v_cvt_pk_bf16_f32 v226, v204, v205
  v_cvt_pk_bf16_f32 v227, v206, v207
  v_mfma_f32_16x16x32_bf16 a[196:199], v[80:83], v[104:107], a[196:199]
  ds_read_b128 v[124:127], v29 offset:28160
  buffer_store_dwordx4 v[224:227], v3, s[12:15], s11 offen offset:2048 sc1
  v_mfma_f32_16x16x32_bf16 a[200:203], v[80:83], v[108:111], a[200:203]
  s_add_u32 s62, s62, 131072
  ds_read_b128 v[128:131], v29 offset:29184
  v_mfma_f32_16x16x32_bf16 a[204:207], v[80:83], v[112:115], a[204:207]
  v_mfma_f32_16x16x32_bf16 a[208:211], v[84:87], v[100:103], a[208:211]
  ds_read_b128 v[132:135], v29 offset:30208
  v_mfma_f32_16x16x32_bf16 a[212:215], v[84:87], v[104:107], a[212:215]
  buffer_load_dwordx4 v20, s[12:15], s61 offen sc1 lds
  v_mfma_f32_16x16x32_bf16 a[216:219], v[84:87], v[108:111], a[216:219]
  ds_read_b128 v[136:139], v29 offset:31232
  v_mfma_f32_16x16x32_bf16 a[220:223], v[84:87], v[112:115], a[220:223]
  ds_read_b128 v[140:143], v29 offset:32256
  v_mfma_f32_16x16x32_bf16 a[224:227], v[88:91], v[100:103], a[224:227]
  buffer_load_dwordx4 v20, s[12:15], s61 offen offset:1024 sc1 lds
  v_mfma_f32_16x16x32_bf16 a[228:231], v[88:91], v[104:107], a[228:231]
  ds_read_b128 v[144:147], v29 offset:33280
  v_mfma_f32_16x16x32_bf16 a[232:235], v[88:91], v[108:111], a[232:235]
  v_mfma_f32_16x16x32_bf16 a[236:239], v[88:91], v[112:115], a[236:239]
  s_mov_b64 exec, 0xffff
  buffer_load_dwordx4 v20, s[12:15], s61 offen offset:2048 sc1 lds
  s_mov_b64 exec, -1
  v_mfma_f32_16x16x32_bf16 a[240:243], v[92:95], v[100:103], a[240:243]
  ds_read_b128 v[148:151], v29 offset:34304
  v_mfma_f32_16x16x32_bf16 a[244:247], v[92:95], v[104:107], a[244:247]
  v_mfma_f32_16x16x32_bf16 a[248:251], v[92:95], v[108:111], a[248:251]
  s_add_u32 s61, s61, 36864
  v_mfma_f32_16x16x32_bf16 a[252:255], v[92:95], v[112:115], a[252:255]
  v_mfma_f32_16x16x32_bf16 v[240:243], v[96:99], v[100:103], v[240:243]
  v_mfma_f32_16x16x32_bf16 v[244:247], v[96:99], v[104:107], v[244:247]
  v_mfma_f32_16x16x32_bf16 v[248:251], v[96:99], v[108:111], v[248:251]
  v_mfma_f32_16x16x32_bf16 v[252:255], v[96:99], v[112:115], v[252:255]
  s_waitcnt vmcnt(32) lgkmcnt(0)
  s_barrier
  v_mfma_f32_16x16x32_bf16 a[128:131], v[116:119], v[152:155], a[128:131]
  s_add_u32 m0, s63, 78336
  ds_read_b64_tr_b16 v[100:101], v27 offset:0
  v_mfma_f32_16x16x32_bf16 a[132:135], v[116:119], v[156:159], a[132:135]
  ds_read_b64_tr_b16 v[102:103], v27 offset:512
  v_mfma_f32_16x16x32_bf16 a[136:139], v[116:119], v[160:163], a[136:139]
  v_mfma_f32_16x16x32_bf16 a[140:143], v[116:119], v[164:167], a[140:143]
  buffer_load_dwordx4 v21, s[40:43], s62 offen offset:0 lds
  ds_read_b64_tr_b16 v[104:105], v27 offset:32
  v_mfma_f32_16x16x32_bf16 a[144:147], v[120:123], v[152:155], a[144:147]
  v_mfma_f32_16x16x32_bf16 a[148:151], v[120:123], v[156:159], a[148:151]
  ds_read_b64_tr_b16 v[106:107], v27 offset:544
  v_mfma_f32_16x16x32_bf16 a[152:155], v[120:123], v[160:163], a[152:155]
  buffer_load_dwordx4 v22, s[40:43], s62 offen offset:1056 lds
  ds_read_b64_tr_b16 v[108:109], v27 offset:64
  v_mfma_f32_16x16x32_bf16 a[156:159], v[120:123], v[164:167], a[156:159]
  v_mfma_f32_16x16x32_bf16 a[160:163], v[124:127], v[152:155], a[160:163]
  ds_read_b64_tr_b16 v[110:111], v27 offset:576
  v_mfma_f32_16x16x32_bf16 a[164:167], v[124:127], v[156:159], a[164:167]
  buffer_load_dwordx4 v23, s[40:43], s62 offen offset:2112 lds
  v_mfma_f32_16x16x32_bf16 a[168:171], v[124:127], v[160:163], a[168:171]
  ds_read_b64_tr_b16 v[112:113], v27 offset:96
  v_mfma_f32_16x16x32_bf16 a[172:175], v[124:127], v[164:167], a[172:175]
  ds_read_b64_tr_b16 v[114:115], v27 offset:608
  v_mfma_f32_16x16x32_bf16 a[176:179], v[128:131], v[152:155], a[176:179]
  buffer_load_dwordx4 v24, s[40:43], s62 offen offset:3168 lds
  v_mfma_f32_16x16x32_bf16 a[180:183], v[128:131], v[156:159], a[180:183]
  ds_read_b128 v[64:67], v30 offset:0
  v_mfma_f32_16x16x32_bf16 a[184:187], v[128:131], v[160:163], a[184:187]
  v_mfma_f32_16x16x32_bf16 a[188:191], v[128:131], v[164:167], a[188:191]
  s_add_u32 m0, s60, 78336
  ds_read_b128 v[68:71], v30 offset:1024
  v_mfma_f32_16x16x32_bf16 a[192:195], v[132:135], v[152:155], a[192:195]
  v_mfma_f32_16x16x32_bf16 a[196:199], v[132:135], v[156:159], a[196:199]
  ds_read_b128 v[72:75], v30 offset:2048
  v_mfma_f32_16x16x32_bf16 a[200:203], v[132:135], v[160:163], a[200:203]
  s_add_u32 s62, s62, 131072
  ds_read_b128 v[76:79], v30 offset:3072
  v_mfma_f32_16x16x32_bf16 a[204:207], v[132:135], v[164:167], a[204:207]
  v_mfma_f32_16x16x32_bf16 a[208:211], v[136:139], v[152:155], a[208:211]
  ds_read_b128 v[80:83], v30 offset:4096
  v_mfma_f32_16x16x32_bf16 a[212:215], v[136:139], v[156:159], a[212:215]
  buffer_load_dwordx4 v20, s[12:15], s61 offen sc1 lds
  v_mfma_f32_16x16x32_bf16 a[216:219], v[136:139], v[160:163], a[216:219]
  ds_read_b128 v[84:87], v30 offset:5120
  v_mfma_f32_16x16x32_bf16 a[220:223], v[136:139], v[164:167], a[220:223]
  ds_read_b128 v[88:91], v30 offset:6144
  v_mfma_f32_16x16x32_bf16 a[224:227], v[140:143], v[152:155], a[224:227]
  buffer_load_dwordx4 v20, s[12:15], s61 offen offset:1024 sc1 lds
  v_mfma_f32_16x16x32_bf16 a[228:231], v[140:143], v[156:159], a[228:231]
  ds_read_b128 v[92:95], v30 offset:7168
  v_mfma_f32_16x16x32_bf16 a[232:235], v[140:143], v[160:163], a[232:235]
  v_mfma_f32_16x16x32_bf16 a[236:239], v[140:143], v[164:167], a[236:239]
  s_mov_b64 exec, 0xffff
  buffer_load_dwordx4 v20, s[12:15], s61 offen offset:2048 sc1 lds
  s_mov_b64 exec, -1
  v_mfma_f32_16x16x32_bf16 a[240:243], v[144:147], v[152:155], a[240:243]
  ds_read_b128 v[96:99], v30 offset:8192
  v_mfma_f32_16x16x32_bf16 a[244:247], v[144:147], v[156:159], a[244:247]
  v_mfma_f32_16x16x32_bf16 a[248:251], v[144:147], v[160:163], a[248:251]
  s_add_u32 s61, s61, 36864
  v_mfma_f32_16x16x32_bf16 a[252:255], v[144:147], v[164:167], a[252:255]
  v_mfma_f32_16x16x32_bf16 v[240:243], v[148:151], v[152:155], v[240:243]
  v_mfma_f32_16x16x32_bf16 v[244:247], v[148:151], v[156:159], v[244:247]
  v_mfma_f32_16x16x32_bf16 v[248:251], v[148:151], v[160:163], v[248:251]
  v_mfma_f32_16x16x32_bf16 v[252:255], v[148:151], v[164:167], v[252:255]
  s_waitcnt vmcnt(31) lgkmcnt(0)
  s_barrier
  v_mfma_f32_16x16x32_bf16 a[128:131], v[64:67], v[100:103], a[128:131]
  s_add_u32 m0, s63, 104448
  ds_read_b64_tr_b16 v[152:153], v27 offset:26112
  v_accvgpr_read_b32 v208, a76
  v_mfma_f32_16x16x32_bf16 a[132:135], v[64:67], v[104:107], a[132:135]
  ds_read_b64_tr_b16 v[154:155], v27 offset:26624
  v_accvgpr_read_b32 v209, a77
  v_mfma_f32_16x16x32_bf16 a[136:139], v[64:67], v[108:111], a[136:139]
  v_accvgpr_read_b32 v210, a78
  v_accvgpr_read_b32 v211, a79
  v_mfma_f32_16x16x32_bf16 a[140:143], v[64:67], v[112:115], a[140:143]
  buffer_load_dwordx4 v21, s[40:43], s62 offen offset:0 lds
  ds_read_b64_tr_b16 v[156:157], v27 offset:26144
  v_mfma_f32_16x16x32_bf16 a[144:147], v[68:71], v[100:103], a[144:147]
  v_accvgpr_read_b32 v212, a92
  v_accvgpr_read_b32 v213, a93
  v_mfma_f32_16x16x32_bf16 a[148:151], v[68:71], v[104:107], a[148:151]
  ds_read_b64_tr_b16 v[158:159], v27 offset:26656
  v_accvgpr_read_b32 v214, a94
  v_mfma_f32_16x16x32_bf16 a[152:155], v[68:71], v[108:111], a[152:155]
  buffer_load_dwordx4 v22, s[40:43], s62 offen offset:1056 lds
  ds_read_b64_tr_b16 v[160:161], v27 offset:26176
  v_mfma_f32_16x16x32_bf16 a[156:159], v[68:71], v[112:115], a[156:159]
  v_accvgpr_read_b32 v215, a95
  v_mul_f32 v208, v208, v43
  v_mfma_f32_16x16x32_bf16 a[160:163], v[72:75], v[100:103], a[160:163]
  ds_read_b64_tr_b16 v[162:163], v27 offset:26688
  v_mul_f32 v209, v209, v43
  v_mfma_f32_16x16x32_bf16 a[164:167], v[72:75], v[104:107], a[164:167]
  buffer_load_dwordx4 v23, s[40:43], s62 offen offset:2112 lds
  v_mul_f32 v210, v210, v43
  v_mfma_f32_16x16x32_bf16 a[168:171], v[72:75], v[108:111], a[168:171]
  ds_read_b64_tr_b16 v[164:165], v27 offset:26208
  v_mul_f32 v211, v211, v43
  v_mfma_f32_16x16x32_bf16 a[172:175], v[72:75], v[112:115], a[172:175]
  ds_read_b64_tr_b16 v[166:167], v27 offset:26720
  v_mul_f32 v212, v212, v43
  v_mfma_f32_16x16x32_bf16 a[176:179], v[76:79], v[100:103], a[176:179]
  buffer_load_dwordx4 v24, s[40:43], s62 offen offset:3168 lds
  v_mul_f32 v213, v213, v43
  v_mfma_f32_16x16x32_bf16 a[180:183], v[76:79], v[104:107], a[180:183]
  ds_read_b128 v[116:119], v30 offset:26112
  v_mul_f32 v214, v214, v43
  v_mfma_f32_16x16x32_bf16 a[184:187], v[76:79], v[108:111], a[184:187]
  v_mul_f32 v215, v215, v43
  v_cvt_pk_bf16_f32 v228, v208, v209
  v_mfma_f32_16x16x32_bf16 a[188:191], v[76:79], v[112:115], a[188:191]
  s_add_u32 m0, s60, 104448
  ds_read_b128 v[120:123], v30 offset:27136
  v_cvt_pk_bf16_f32 v229, v210, v211
  v_mfma_f32_16x16x32_bf16 a[192:195], v[80:83], v[100:103], a[192:195]
  v_cvt_pk_bf16_f32 v230, v212, v213
  v_cvt_pk_bf16_f32 v231, v214, v215
  v_mfma_f32_16x16x32_bf16 a[196:199], v[80:83], v[104:107], a[196:199]
  ds_read_b128 v[124:127], v30 offset:28160
  buffer_store_dwordx4 v[228:231], v3, s[12:15], s11 offen offset:3072 sc1
  v_mfma_f32_16x16x32_bf16 a[200:203], v[80:83], v[108:111], a[200:203]
  s_add_u32 s62, s62, 131072
  s_add_u32 s11, s11, 131072
  ds_read_b128 v[128:131], v30 offset:29184
  v_mfma_f32_16x16x32_bf16 a[204:207], v[80:83], v[112:115], a[204:207]
  v_mfma_f32_16x16x32_bf16 a[208:211], v[84:87], v[100:103], a[208:211]
  ds_read_b128 v[132:135], v30 offset:30208
  v_mfma_f32_16x16x32_bf16 a[212:215], v[84:87], v[104:107], a[212:215]
  buffer_load_dwordx4 v20, s[12:15], s61 offen sc1 lds
  v_mfma_f32_16x16x32_bf16 a[216:219], v[84:87], v[108:111], a[216:219]
  ds_read_b128 v[136:139], v30 offset:31232
  v_mfma_f32_16x16x32_bf16 a[220:223], v[84:87], v[112:115], a[220:223]
  ds_read_b128 v[140:143], v30 offset:32256
  v_mfma_f32_16x16x32_bf16 a[224:227], v[88:91], v[100:103], a[224:227]
  buffer_load_dwordx4 v20, s[12:15], s61 offen offset:1024 sc1 lds
  v_mfma_f32_16x16x32_bf16 a[228:231], v[88:91], v[104:107], a[228:231]
  ds_read_b128 v[144:147], v30 offset:33280
  v_mfma_f32_16x16x32_bf16 a[232:235], v[88:91], v[108:111], a[232:235]
  v_mfma_f32_16x16x32_bf16 a[236:239], v[88:91], v[112:115], a[236:239]
  s_mov_b64 exec, 0xffff
  buffer_load_dwordx4 v20, s[12:15], s61 offen offset:2048 sc1 lds
  s_mov_b64 exec, -1
  v_mfma_f32_16x16x32_bf16 a[240:243], v[92:95], v[100:103], a[240:243]
  ds_read_b128 v[148:151], v30 offset:34304
  v_mfma_f32_16x16x32_bf16 a[244:247], v[92:95], v[104:107], a[244:247]
  v_mfma_f32_16x16x32_bf16 a[248:251], v[92:95], v[108:111], a[248:251]
  s_add_u32 s61, s61, 36864
  v_mfma_f32_16x16x32_bf16 a[252:255], v[92:95], v[112:115], a[252:255]
  v_mfma_f32_16x16x32_bf16 v[240:243], v[96:99], v[100:103], v[240:243]
  v_mfma_f32_16x16x32_bf16 v[244:247], v[96:99], v[104:107], v[244:247]
  v_mfma_f32_16x16x32_bf16 v[248:251], v[96:99], v[108:111], v[248:251]
  v_mfma_f32_16x16x32_bf16 v[252:255], v[96:99], v[112:115], v[252:255]
  s_waitcnt vmcnt(32) lgkmcnt(0)
  s_barrier
  v_mfma_f32_16x16x32_bf16 a[128:131], v[116:119], v[152:155], a[128:131]
  s_add_u32 m0, s63, 130560
  ds_read_b64_tr_b16 v[100:101], v25 offset:0
  v_accvgpr_read_b32 v184, a96
  v_mfma_f32_16x16x32_bf16 a[132:135], v[116:119], v[156:159], a[132:135]
  ds_read_b64_tr_b16 v[102:103], v25 offset:512
  v_accvgpr_read_b32 v185, a97
  v_mfma_f32_16x16x32_bf16 a[136:139], v[116:119], v[160:163], a[136:139]
  v_accvgpr_read_b32 v186, a98
  v_accvgpr_read_b32 v187, a99
  v_mfma_f32_16x16x32_bf16 a[140:143], v[116:119], v[164:167], a[140:143]
  buffer_load_dwordx4 v21, s[40:43], s62 offen offset:0 lds
  ds_read_b64_tr_b16 v[104:105], v25 offset:32
  v_mfma_f32_16x16x32_bf16 a[144:147], v[120:123], v[152:155], a[144:147]
  v_accvgpr_read_b32 v188, a112
  v_accvgpr_read_b32 v189, a113
  v_mfma_f32_16x16x32_bf16 a[148:151], v[120:123], v[156:159], a[148:151]
  ds_read_b64_tr_b16 v[106:107], v25 offset:544
  v_accvgpr_read_b32 v190, a114
  v_mfma_f32_16x16x32_bf16 a[152:155], v[120:123], v[160:163], a[152:155]
  buffer_load_dwordx4 v22, s[40:43], s62 offen offset:1056 lds
  ds_read_b64_tr_b16 v[108:109], v25 offset:64
  v_mfma_f32_16x16x32_bf16 a[156:159], v[120:123], v[164:167], a[156:159]
  v_accvgpr_read_b32 v191, a115
  v_mul_f32 v184, v184, v40
  v_mfma_f32_16x16x32_bf16 a[160:163], v[124:127], v[152:155], a[160:163]
  ds_read_b64_tr_b16 v[110:111], v25 offset:576
  v_mul_f32 v185, v185, v40
  v_mfma_f32_16x16x32_bf16 a[164:167], v[124:127], v[156:159], a[164:167]
  buffer_load_dwordx4 v23, s[40:43], s62 offen offset:2112 lds
  v_mul_f32 v186, v186, v40
  v_mfma_f32_16x16x32_bf16 a[168:171], v[124:127], v[160:163], a[168:171]
  ds_read_b64_tr_b16 v[112:113], v25 offset:96
  v_mul_f32 v187, v187, v40
  v_mfma_f32_16x16x32_bf16 a[172:175], v[124:127], v[164:167], a[172:175]
  ds_read_b64_tr_b16 v[114:115], v25 offset:608
  v_mul_f32 v188, v188, v40
  v_mfma_f32_16x16x32_bf16 a[176:179], v[128:131], v[152:155], a[176:179]
  buffer_load_dwordx4 v24, s[40:43], s62 offen offset:3168 lds
  v_mul_f32 v189, v189, v40
  v_mfma_f32_16x16x32_bf16 a[180:183], v[128:131], v[156:159], a[180:183]
  ds_read_b128 v[64:67], v28 offset:0
  v_mul_f32 v190, v190, v40
  v_mfma_f32_16x16x32_bf16 a[184:187], v[128:131], v[160:163], a[184:187]
  v_mul_f32 v191, v191, v40
  v_cvt_pk_bf16_f32 v216, v184, v185
  v_mfma_f32_16x16x32_bf16 a[188:191], v[128:131], v[164:167], a[188:191]
  s_add_u32 m0, s60, 130560
  ds_read_b128 v[68:71], v28 offset:1024
  v_cvt_pk_bf16_f32 v217, v186, v187
  v_mfma_f32_16x16x32_bf16 a[192:195], v[132:135], v[152:155], a[192:195]
  v_cvt_pk_bf16_f32 v218, v188, v189
  v_cvt_pk_bf16_f32 v219, v190, v191
  v_mfma_f32_16x16x32_bf16 a[196:199], v[132:135], v[156:159], a[196:199]
  ds_read_b128 v[72:75], v28 offset:2048
  buffer_store_dwordx4 v[216:219], v3, s[12:15], s11 offen offset:0 sc1
  v_mfma_f32_16x16x32_bf16 a[200:203], v[132:135], v[160:163], a[200:203]
  s_add_u32 s62, s62, 131072
  ds_read_b128 v[76:79], v28 offset:3072
  v_mfma_f32_16x16x32_bf16 a[204:207], v[132:135], v[164:167], a[204:207]
  v_mfma_f32_16x16x32_bf16 a[208:211], v[136:139], v[152:155], a[208:211]
  ds_read_b128 v[80:83], v28 offset:4096
  v_mfma_f32_16x16x32_bf16 a[212:215], v[136:139], v[156:159], a[212:215]
  buffer_load_dwordx4 v20, s[12:15], s61 offen sc1 lds
  v_mfma_f32_16x16x32_bf16 a[216:219], v[136:139], v[160:163], a[216:219]
  ds_read_b128 v[84:87], v28 offset:5120
  v_mfma_f32_16x16x32_bf16 a[220:223], v[136:139], v[164:167], a[220:223]
  ds_read_b128 v[88:91], v28 offset:6144
  v_mfma_f32_16x16x32_bf16 a[224:227], v[140:143], v[152:155], a[224:227]
  buffer_load_dwordx4 v20, s[12:15], s61 offen offset:1024 sc1 lds
  v_mfma_f32_16x16x32_bf16 a[228:231], v[140:143], v[156:159], a[228:231]
  ds_read_b128 v[92:95], v28 offset:7168
  v_mfma_f32_16x16x32_bf16 a[232:235], v[140:143], v[160:163], a[232:235]
  v_mfma_f32_16x16x32_bf16 a[236:239], v[140:143], v[164:167], a[236:239]
  s_mov_b64 exec, 0xffff
  buffer_load_dwordx4 v20, s[12:15], s61 offen offset:2048 sc1 lds
  s_mov_b64 exec, -1
  v_mfma_f32_16x16x32_bf16 a[240:243], v[144:147], v[152:155], a[240:243]
  ds_read_b128 v[96:99], v28 offset:8192
  v_mfma_f32_16x16x32_bf16 a[244:247], v[144:147], v[156:159], a[244:247]
TP_22:
  s_cbranch_execz TR_3
  v_mfma_f32_16x16x32_bf16 a[248:251], v[144:147], v[160:163], a[248:251]
  s_add_u32 s61, s61, 36864
  v_mfma_f32_16x16x32_bf16 a[252:255], v[144:147], v[164:167], a[252:255]
  v_mfma_f32_16x16x32_bf16 v[240:243], v[148:151], v[152:155], v[240:243]
  v_mfma_f32_16x16x32_bf16 v[244:247], v[148:151], v[156:159], v[244:247]
  v_mfma_f32_16x16x32_bf16 v[248:251], v[148:151], v[160:163], v[248:251]
  v_mfma_f32_16x16x32_bf16 v[252:255], v[148:151], v[164:167], v[252:255]
  s_waitcnt vmcnt(31) lgkmcnt(0)
  s_barrier
  v_mfma_f32_16x16x32_bf16 a[128:131], v[64:67], v[100:103], a[128:131]
  s_add_u32 m0, s63, 0
  ds_read_b64_tr_b16 v[152:153], v25 offset:26112
  v_accvgpr_read_b32 v192, a100
  v_mfma_f32_16x16x32_bf16 a[132:135], v[64:67], v[104:107], a[132:135]
  ds_read_b64_tr_b16 v[154:155], v25 offset:26624
  v_accvgpr_read_b32 v193, a101
  v_mfma_f32_16x16x32_bf16 a[136:139], v[64:67], v[108:111], a[136:139]
  v_accvgpr_read_b32 v194, a102
  v_accvgpr_read_b32 v195, a103
  v_mfma_f32_16x16x32_bf16 a[140:143], v[64:67], v[112:115], a[140:143]
  buffer_load_dwordx4 v21, s[40:43], s62 offen offset:0 lds
  ds_read_b64_tr_b16 v[156:157], v25 offset:26144
  v_mfma_f32_16x16x32_bf16 a[144:147], v[68:71], v[100:103], a[144:147]
  v_accvgpr_read_b32 v196, a116
  v_accvgpr_read_b32 v197, a117
  v_mfma_f32_16x16x32_bf16 a[148:151], v[68:71], v[104:107], a[148:151]
  ds_read_b64_tr_b16 v[158:159], v25 offset:26656
  v_accvgpr_read_b32 v198, a118
  v_mfma_f32_16x16x32_bf16 a[152:155], v[68:71], v[108:111], a[152:155]
  buffer_load_dwordx4 v22, s[40:43], s62 offen offset:1056 lds
  ds_read_b64_tr_b16 v[160:161], v25 offset:26176
  v_mfma_f32_16x16x32_bf16 a[156:159], v[68:71], v[112:115], a[156:159]
  v_accvgpr_read_b32 v199, a119
  v_mul_f32 v192, v192, v41
  v_mfma_f32_16x16x32_bf16 a[160:163], v[72:75], v[100:103], a[160:163]
  ds_read_b64_tr_b16 v[162:163], v25 offset:26688
  v_mul_f32 v193, v193, v41
  v_mfma_f32_16x16x32_bf16 a[164:167], v[72:75], v[104:107], a[164:167]
  buffer_load_dwordx4 v23, s[40:43], s62 offen offset:2112 lds
  v_mul_f32 v194, v194, v41
  v_mfma_f32_16x16x32_bf16 a[168:171], v[72:75], v[108:111], a[168:171]
  ds_read_b64_tr_b16 v[164:165], v25 offset:26208
  v_mul_f32 v195, v195, v41
  v_mfma_f32_16x16x32_bf16 a[172:175], v[72:75], v[112:115], a[172:175]
  ds_read_b64_tr_b16 v[166:167], v25 offset:26720
  v_mul_f32 v196, v196, v41
  v_mfma_f32_16x16x32_bf16 a[176:179], v[76:79], v[100:103], a[176:179]
  buffer_load_dwordx4 v24, s[40:43], s62 offen offset:3168 lds
  v_mul_f32 v197, v197, v41
  v_mfma_f32_16x16x32_bf16 a[180:183], v[76:79], v[104:107], a[180:183]
  ds_read_b128 v[116:119], v28 offset:26112
  v_mul_f32 v198, v198, v41
  v_mfma_f32_16x16x32_bf16 a[184:187], v[76:79], v[108:111], a[184:187]
  v_mul_f32 v199, v199, v41
  v_cvt_pk_bf16_f32 v220, v192, v193
  v_mfma_f32_16x16x32_bf16 a[188:191], v[76:79], v[112:115], a[188:191]
  s_add_u32 m0, s60, 0
  ds_read_b128 v[120:123], v28 offset:27136
  v_cvt_pk_bf16_f32 v221, v194, v195
  v_mfma_f32_16x16x32_bf16 a[192:195], v[80:83], v[100:103], a[192:195]
  v_cvt_pk_bf16_f32 v222, v196, v197
  v_cvt_pk_bf16_f32 v223, v198, v199
  v_mfma_f32_16x16x32_bf16 a[196:199], v[80:83], v[104:107], a[196:199]
  ds_read_b128 v[124:127], v28 offset:28160
  buffer_store_dwordx4 v[220:223], v3, s[12:15], s11 offen offset:1024 sc1
  v_mfma_f32_16x16x32_bf16 a[200:203], v[80:83], v[108:111], a[200:203]
  s_add_u32 s62, s62, 131072
  ds_read_b128 v[128:131], v28 offset:29184
  v_mfma_f32_16x16x32_bf16 a[204:207], v[80:83], v[112:115], a[204:207]
  v_mfma_f32_16x16x32_bf16 a[208:211], v[84:87], v[100:103], a[208:211]
  ds_read_b128 v[132:135], v28 offset:30208
  v_mfma_f32_16x16x32_bf16 a[212:215], v[84:87], v[104:107], a[212:215]
  buffer_load_dwordx4 v20, s[12:15], s61 offen sc1 lds
  v_mfma_f32_16x16x32_bf16 a[216:219], v[84:87], v[108:111], a[216:219]
  ds_read_b128 v[136:139], v28 offset:31232
  v_mfma_f32_16x16x32_bf16 a[220:223], v[84:87], v[112:115], a[220:223]
  ds_read_b128 v[140:143], v28 offset:32256
  v_mfma_f32_16x16x32_bf16 a[224:227], v[88:91], v[100:103], a[224:227]
  buffer_load_dwordx4 v20, s[12:15], s61 offen offset:1024 sc1 lds
  v_mfma_f32_16x16x32_bf16 a[228:231], v[88:91], v[104:107], a[228:231]
  ds_read_b128 v[144:147], v28 offset:33280
  v_mfma_f32_16x16x32_bf16 a[232:235], v[88:91], v[108:111], a[232:235]
  v_mfma_f32_16x16x32_bf16 a[236:239], v[88:91], v[112:115], a[236:239]
  s_mov_b64 exec, 0xffff
  buffer_load_dwordx4 v20, s[12:15], s61 offen offset:2048 sc1 lds
  s_mov_b64 exec, -1
  v_mfma_f32_16x16x32_bf16 a[240:243], v[92:95], v[100:103], a[240:243]
  ds_read_b128 v[148:151], v28 offset:34304
  v_mfma_f32_16x16x32_bf16 a[244:247], v[92:95], v[104:107], a[244:247]
  v_mfma_f32_16x16x32_bf16 a[248:251], v[92:95], v[108:111], a[248:251]
  s_add_u32 s61, s61, 36864
  v_mfma_f32_16x16x32_bf16 a[252:255], v[92:95], v[112:115], a[252:255]
  v_mfma_f32_16x16x32_bf16 v[240:243], v[96:99], v[100:103], v[240:243]
  v_mfma_f32_16x16x32_bf16 v[244:247], v[96:99], v[104:107], v[244:247]
  v_mfma_f32_16x16x32_bf16 v[248:251], v[96:99], v[108:111], v[248:251]
  v_mfma_f32_16x16x32_bf16 v[252:255], v[96:99], v[112:115], v[252:255]
  s_waitcnt vmcnt(19) lgkmcnt(0)
  s_barrier
  v_mfma_f32_16x16x32_bf16 a[128:131], v[116:119], v[152:155], a[128:131]
  buffer_store_dword v58, v8, s[12:15], s44 offen sc1
  ds_read_b64_tr_b16 v[100:101], v26 offset:0
  v_mfma_f32_16x16x32_bf16 a[132:135], v[116:119], v[156:159], a[132:135]
  ds_read_b64_tr_b16 v[102:103], v26 offset:512
  v_mfma_f32_16x16x32_bf16 a[136:139], v[116:119], v[160:163], a[136:139]
  s_add_u32 m0, s63, 26112
  v_mfma_f32_16x16x32_bf16 a[140:143], v[116:119], v[164:167], a[140:143]
  ds_read_b64_tr_b16 v[104:105], v26 offset:32
  v_mfma_f32_16x16x32_bf16 a[144:147], v[120:123], v[152:155], a[144:147]
  v_mfma_f32_16x16x32_bf16 a[148:151], v[120:123], v[156:159], a[148:151]
  buffer_load_dwordx4 v21, s[40:43], s62 offen offset:0 lds
  ds_read_b64_tr_b16 v[106:107], v26 offset:544
  v_mfma_f32_16x16x32_bf16 a[152:155], v[120:123], v[160:163], a[152:155]
  ds_read_b64_tr_b16 v[108:109], v26 offset:64
  v_mfma_f32_16x16x32_bf16 a[156:159], v[120:123], v[164:167], a[156:159]
  v_mfma_f32_16x16x32_bf16 a[160:163], v[124:127], v[152:155], a[160:163]
  buffer_load_dwordx4 v22, s[40:43], s62 offen offset:1056 lds
  ds_read_b64_tr_b16 v[110:111], v26 offset:576
  v_mfma_f32_16x16x32_bf16 a[164:167], v[124:127], v[156:159], a[164:167]
  v_mfma_f32_16x16x32_bf16 a[168:171], v[124:127], v[160:163], a[168:171]
  ds_read_b64_tr_b16 v[112:113], v26 offset:96
  v_mfma_f32_16x16x32_bf16 a[172:175], v[124:127], v[164:167], a[172:175]
  buffer_load_dwordx4 v23, s[40:43], s62 offen offset:2112 lds
  ds_read_b64_tr_b16 v[114:115], v26 offset:608
  v_mfma_f32_16x16x32_bf16 a[176:179], v[128:131], v[152:155], a[176:179]
  v_mfma_f32_16x16x32_bf16 a[180:183], v[128:131], v[156:159], a[180:183]
  ds_read_b128 v[64:67], v29 offset:0
  v_mfma_f32_16x16x32_bf16 a[184:187], v[128:131], v[160:163], a[184:187]
  buffer_load_dwordx4 v24, s[40:43], s62 offen offset:3168 lds
  v_mfma_f32_16x16x32_bf16 a[188:191], v[128:131], v[164:167], a[188:191]
  ds_read_b128 v[68:71], v29 offset:1024
  v_mfma_f32_16x16x32_bf16 a[192:195], v[132:135], v[152:155], a[192:195]
  v_mfma_f32_16x16x32_bf16 a[196:199], v[132:135], v[156:159], a[196:199]
  s_add_u32 m0, s60, 26112
  ds_read_b128 v[72:75], v29 offset:2048
  v_mfma_f32_16x16x32_bf16 a[200:203], v[132:135], v[160:163], a[200:203]
  ds_read_b128 v[76:79], v29 offset:3072
  v_mfma_f32_16x16x32_bf16 a[204:207], v[132:135], v[164:167], a[204:207]
  s_add_u32 s62, s62, 131072
  v_mfma_f32_16x16x32_bf16 a[208:211], v[136:139], v[152:155], a[208:211]
  ds_read_b128 v[80:83], v29 offset:4096
  v_mfma_f32_16x16x32_bf16 a[212:215], v[136:139], v[156:159], a[212:215]
  v_mfma_f32_16x16x32_bf16 a[216:219], v[136:139], v[160:163], a[216:219]
  buffer_load_dwordx4 v20, s[12:15], s61 offen sc1 lds
  ds_read_b128 v[84:87], v29 offset:5120
  v_mfma_f32_16x16x32_bf16 a[220:223], v[136:139], v[164:167], a[220:223]
  ds_read_b128 v[88:91], v29 offset:6144
  v_mfma_f32_16x16x32_bf16 a[224:227], v[140:143], v[152:155], a[224:227]
  v_mfma_f32_16x16x32_bf16 a[228:231], v[140:143], v[156:159], a[228:231]
  buffer_load_dwordx4 v20, s[12:15], s61 offen offset:1024 sc1 lds
  ds_read_b128 v[92:95], v29 offset:7168
  v_mfma_f32_16x16x32_bf16 a[232:235], v[140:143], v[160:163], a[232:235]
  v_mfma_f32_16x16x32_bf16 a[236:239], v[140:143], v[164:167], a[236:239]
  ds_read_b128 v[96:99], v29 offset:8192
  v_mfma_f32_16x16x32_bf16 a[240:243], v[144:147], v[152:155], a[240:243]
  s_mov_b64 exec, 0xffff
  buffer_load_dwordx4 v20, s[12:15], s61 offen offset:2048 sc1 lds
  s_mov_b64 exec, -1
  v_mfma_f32_16x16x32_bf16 a[244:247], v[144:147], v[156:159], a[244:247]
  v_mfma_f32_16x16x32_bf16 a[248:251], v[144:147], v[160:163], a[248:251]
  v_mfma_f32_16x16x32_bf16 a[252:255], v[144:147], v[164:167], a[252:255]
  s_add_u32 s61, s61, 36864
  v_mfma_f32_16x16x32_bf16 v[240:243], v[148:151], v[152:155], v[240:243]
  v_mfma_f32_16x16x32_bf16 v[244:247], v[148:151], v[156:159], v[244:247]
  v_mfma_f32_16x16x32_bf16 v[248:251], v[148:151], v[160:163], v[248:251]
  v_mfma_f32_16x16x32_bf16 v[252:255], v[148:151], v[164:167], v[252:255]
  s_waitcnt lgkmcnt(0)
  s_barrier
  v_mfma_f32_16x16x32_bf16 a[128:131], v[64:67], v[100:103], a[128:131]
  s_add_u32 m0, s63, 52224
  ds_read_b64_tr_b16 v[152:153], v26 offset:26112
  v_accvgpr_read_b32 v200, a104
  v_mfma_f32_16x16x32_bf16 a[132:135], v[64:67], v[104:107], a[132:135]
  ds_read_b64_tr_b16 v[154:155], v26 offset:26624
  v_accvgpr_read_b32 v201, a105
  v_mfma_f32_16x16x32_bf16 a[136:139], v[64:67], v[108:111], a[136:139]
  v_accvgpr_read_b32 v202, a106
  v_accvgpr_read_b32 v203, a107
  v_mfma_f32_16x16x32_bf16 a[140:143], v[64:67], v[112:115], a[140:143]
  buffer_load_dwordx4 v21, s[40:43], s62 offen offset:0 lds
  ds_read_b64_tr_b16 v[156:157], v26 offset:26144
  v_mfma_f32_16x16x32_bf16 a[144:147], v[68:71], v[100:103], a[144:147]
  v_accvgpr_read_b32 v204, a120
  v_accvgpr_read_b32 v205, a121
  v_mfma_f32_16x16x32_bf16 a[148:151], v[68:71], v[104:107], a[148:151]
  ds_read_b64_tr_b16 v[158:159], v26 offset:26656
  v_accvgpr_read_b32 v206, a122
  v_mfma_f32_16x16x32_bf16 a[152:155], v[68:71], v[108:111], a[152:155]
  buffer_load_dwordx4 v22, s[40:43], s62 offen offset:1056 lds
  ds_read_b64_tr_b16 v[160:161], v26 offset:26176
  v_mfma_f32_16x16x32_bf16 a[156:159], v[68:71], v[112:115], a[156:159]
  v_accvgpr_read_b32 v207, a123
  v_mul_f32 v200, v200, v42
  v_mfma_f32_16x16x32_bf16 a[160:163], v[72:75], v[100:103], a[160:163]
  ds_read_b64_tr_b16 v[162:163], v26 offset:26688
  v_mul_f32 v201, v201, v42
  v_mfma_f32_16x16x32_bf16 a[164:167], v[72:75], v[104:107], a[164:167]
  buffer_load_dwordx4 v23, s[40:43], s62 offen offset:2112 lds
  v_mul_f32 v202, v202, v42
  v_mfma_f32_16x16x32_bf16 a[168:171], v[72:75], v[108:111], a[168:171]
  ds_read_b64_tr_b16 v[164:165], v26 offset:26208
  v_mul_f32 v203, v203, v42
  v_mfma_f32_16x16x32_bf16 a[172:175], v[72:75], v[112:115], a[172:175]
  ds_read_b64_tr_b16 v[166:167], v26 offset:26720
  v_mul_f32 v204, v204, v42
  v_mfma_f32_16x16x32_bf16 a[176:179], v[76:79], v[100:103], a[176:179]
  buffer_load_dwordx4 v24, s[40:43], s62 offen offset:3168 lds
  v_mul_f32 v205, v205, v42
  v_mfma_f32_16x16x32_bf16 a[180:183], v[76:79], v[104:107], a[180:183]
  ds_read_b128 v[116:119], v29 offset:26112
  v_mul_f32 v206, v206, v42
  v_mfma_f32_16x16x32_bf16 a[184:187], v[76:79], v[108:111], a[184:187]
  v_mul_f32 v207, v207, v42
  v_cvt_pk_bf16_f32 v224, v200, v201
  v_mfma_f32_16x16x32_bf16 a[188:191], v[76:79], v[112:115], a[188:191]
  s_add_u32 m0, s60, 52224
  ds_read_b128 v[120:123], v29 offset:27136
  v_cvt_pk_bf16_f32 v225, v202, v203
  v_mfma_f32_16x16x32_bf16 a[192:195], v[80:83], v[100:103], a[192:195]
  v_cvt_pk_bf16_f32 v226, v204, v205
  v_cvt_pk_bf16_f32 v227, v206, v207
  v_mfma_f32_16x16x32_bf16 a[196:199], v[80:83], v[104:107], a[196:199]
  ds_read_b128 v[124:127], v29 offset:28160
  buffer_store_dwordx4 v[224:227], v3, s[12:15], s11 offen offset:2048 sc1
  v_mfma_f32_16x16x32_bf16 a[200:203], v[80:83], v[108:111], a[200:203]
  s_add_u32 s62, s62, 131072
  ds_read_b128 v[128:131], v29 offset:29184
  v_mfma_f32_16x16x32_bf16 a[204:207], v[80:83], v[112:115], a[204:207]
  v_mfma_f32_16x16x32_bf16 a[208:211], v[84:87], v[100:103], a[208:211]
  ds_read_b128 v[132:135], v29 offset:30208
  v_mfma_f32_16x16x32_bf16 a[212:215], v[84:87], v[104:107], a[212:215]
  buffer_load_dwordx4 v20, s[12:15], s61 offen sc1 lds
  v_mfma_f32_16x16x32_bf16 a[216:219], v[84:87], v[108:111], a[216:219]
  ds_read_b128 v[136:139], v29 offset:31232
  v_mfma_f32_16x16x32_bf16 a[220:223], v[84:87], v[112:115], a[220:223]
  ds_read_b128 v[140:143], v29 offset:32256
  v_mfma_f32_16x16x32_bf16 a[224:227], v[88:91], v[100:103], a[224:227]
  buffer_load_dwordx4 v20, s[12:15], s61 offen offset:1024 sc1 lds
  v_mfma_f32_16x16x32_bf16 a[228:231], v[88:91], v[104:107], a[228:231]
  ds_read_b128 v[144:147], v29 offset:33280
  v_mfma_f32_16x16x32_bf16 a[232:235], v[88:91], v[108:111], a[232:235]
  v_mfma_f32_16x16x32_bf16 a[236:239], v[88:91], v[112:115], a[236:239]
  s_mov_b64 exec, 0xffff
  buffer_load_dwordx4 v20, s[12:15], s61 offen offset:2048 sc1 lds
  s_mov_b64 exec, -1
  v_mfma_f32_16x16x32_bf16 a[240:243], v[92:95], v[100:103], a[240:243]
  ds_read_b128 v[148:151], v29 offset:34304
  v_mfma_f32_16x16x32_bf16 a[244:247], v[92:95], v[104:107], a[244:247]
  v_mfma_f32_16x16x32_bf16 a[248:251], v[92:95], v[108:111], a[248:251]
  s_add_u32 s61, s61, 36864
  v_mfma_f32_16x16x32_bf16 a[252:255], v[92:95], v[112:115], a[252:255]
  v_mfma_f32_16x16x32_bf16 v[240:243], v[96:99], v[100:103], v[240:243]
  v_mfma_f32_16x16x32_bf16 v[244:247], v[96:99], v[104:107], v[244:247]
  v_mfma_f32_16x16x32_bf16 v[248:251], v[96:99], v[108:111], v[248:251]
  v_mfma_f32_16x16x32_bf16 v[252:255], v[96:99], v[112:115], v[252:255]
  s_waitcnt vmcnt(32) lgkmcnt(0)
  s_barrier
  v_mfma_f32_16x16x32_bf16 a[128:131], v[116:119], v[152:155], a[128:131]
  s_add_u32 m0, s63, 78336
  ds_read_b64_tr_b16 v[100:101], v27 offset:0
  v_accvgpr_read_b32 v208, a108
  v_mfma_f32_16x16x32_bf16 a[132:135], v[116:119], v[156:159], a[132:135]
  ds_read_b64_tr_b16 v[102:103], v27 offset:512
  v_accvgpr_read_b32 v209, a109
  v_mfma_f32_16x16x32_bf16 a[136:139], v[116:119], v[160:163], a[136:139]
  v_accvgpr_read_b32 v210, a110
  v_accvgpr_read_b32 v211, a111
  v_mfma_f32_16x16x32_bf16 a[140:143], v[116:119], v[164:167], a[140:143]
  buffer_load_dwordx4 v21, s[40:43], s62 offen offset:0 lds
  ds_read_b64_tr_b16 v[104:105], v27 offset:32
  v_mfma_f32_16x16x32_bf16 a[144:147], v[120:123], v[152:155], a[144:147]
  v_accvgpr_read_b32 v212, a124
  v_accvgpr_read_b32 v213, a125
  v_mfma_f32_16x16x32_bf16 a[148:151], v[120:123], v[156:159], a[148:151]
  ds_read_b64_tr_b16 v[106:107], v27 offset:544
  v_accvgpr_read_b32 v214, a126
  v_mfma_f32_16x16x32_bf16 a[152:155], v[120:123], v[160:163], a[152:155]
  buffer_load_dwordx4 v22, s[40:43], s62 offen offset:1056 lds
  ds_read_b64_tr_b16 v[108:109], v27 offset:64
  v_mfma_f32_16x16x32_bf16 a[156:159], v[120:123], v[164:167], a[156:159]
  v_accvgpr_read_b32 v215, a127
  v_mul_f32 v208, v208, v43
  v_mfma_f32_16x16x32_bf16 a[160:163], v[124:127], v[152:155], a[160:163]
  ds_read_b64_tr_b16 v[110:111], v27 offset:576
  v_mul_f32 v209, v209, v43
  v_mfma_f32_16x16x32_bf16 a[164:167], v[124:127], v[156:159], a[164:167]
  buffer_load_dwordx4 v23, s[40:43], s62 offen offset:2112 lds
  v_mul_f32 v210, v210, v43
  v_mfma_f32_16x16x32_bf16 a[168:171], v[124:127], v[160:163], a[168:171]
  ds_read_b64_tr_b16 v[112:113], v27 offset:96
  v_mul_f32 v211, v211, v43
  v_mfma_f32_16x16x32_bf16 a[172:175], v[124:127], v[164:167], a[172:175]
  ds_read_b64_tr_b16 v[114:115], v27 offset:608
  v_mul_f32 v212, v212, v43
  v_mfma_f32_16x16x32_bf16 a[176:179], v[128:131], v[152:155], a[176:179]
  buffer_load_dwordx4 v24, s[40:43], s62 offen offset:3168 lds
  v_mul_f32 v213, v213, v43
  v_mfma_f32_16x16x32_bf16 a[180:183], v[128:131], v[156:159], a[180:183]
  ds_read_b128 v[64:67], v30 offset:0
  v_mul_f32 v214, v214, v43
  v_mfma_f32_16x16x32_bf16 a[184:187], v[128:131], v[160:163], a[184:187]
  v_mul_f32 v215, v215, v43
  v_cvt_pk_bf16_f32 v228, v208, v209
  v_mfma_f32_16x16x32_bf16 a[188:191], v[128:131], v[164:167], a[188:191]
  s_add_u32 m0, s60, 78336
  ds_read_b128 v[68:71], v30 offset:1024
  v_cvt_pk_bf16_f32 v229, v210, v211
  v_mfma_f32_16x16x32_bf16 a[192:195], v[132:135], v[152:155], a[192:195]
  v_cvt_pk_bf16_f32 v230, v212, v213
  v_cvt_pk_bf16_f32 v231, v214, v215
  v_mfma_f32_16x16x32_bf16 a[196:199], v[132:135], v[156:159], a[196:199]
  ds_read_b128 v[72:75], v30 offset:2048
  buffer_store_dwordx4 v[228:231], v3, s[12:15], s11 offen offset:3072 sc1
  v_mfma_f32_16x16x32_bf16 a[200:203], v[132:135], v[160:163], a[200:203]
  s_add_u32 s62, s62, 131072
  s_add_u32 s11, s11, 131072
  ds_read_b128 v[76:79], v30 offset:3072
  v_mfma_f32_16x16x32_bf16 a[204:207], v[132:135], v[164:167], a[204:207]
  v_mfma_f32_16x16x32_bf16 a[208:211], v[136:139], v[152:155], a[208:211]
  ds_read_b128 v[80:83], v30 offset:4096
  v_mfma_f32_16x16x32_bf16 a[212:215], v[136:139], v[156:159], a[212:215]
  buffer_load_dwordx4 v20, s[12:15], s61 offen sc1 lds
  v_mfma_f32_16x16x32_bf16 a[216:219], v[136:139], v[160:163], a[216:219]
  ds_read_b128 v[84:87], v30 offset:5120
  v_mfma_f32_16x16x32_bf16 a[220:223], v[136:139], v[164:167], a[220:223]
  ds_read_b128 v[88:91], v30 offset:6144
  v_mfma_f32_16x16x32_bf16 a[224:227], v[140:143], v[152:155], a[224:227]
  buffer_load_dwordx4 v20, s[12:15], s61 offen offset:1024 sc1 lds
  v_mfma_f32_16x16x32_bf16 a[228:231], v[140:143], v[156:159], a[228:231]
  ds_read_b128 v[92:95], v30 offset:7168
  v_mfma_f32_16x16x32_bf16 a[232:235], v[140:143], v[160:163], a[232:235]
  v_mfma_f32_16x16x32_bf16 a[236:239], v[140:143], v[164:167], a[236:239]
  s_mov_b64 exec, 0xffff
  buffer_load_dwordx4 v20, s[12:15], s61 offen offset:2048 sc1 lds
  s_mov_b64 exec, -1
  v_mfma_f32_16x16x32_bf16 a[240:243], v[144:147], v[152:155], a[240:243]
  ds_read_b128 v[96:99], v30 offset:8192
  v_mfma_f32_16x16x32_bf16 a[244:247], v[144:147], v[156:159], a[244:247]
  v_mfma_f32_16x16x32_bf16 a[248:251], v[144:147], v[160:163], a[248:251]
  s_add_u32 s61, s61, 36864
  v_mfma_f32_16x16x32_bf16 a[252:255], v[144:147], v[164:167], a[252:255]
  v_mfma_f32_16x16x32_bf16 v[240:243], v[148:151], v[152:155], v[240:243]
  v_mfma_f32_16x16x32_bf16 v[244:247], v[148:151], v[156:159], v[244:247]
  v_mfma_f32_16x16x32_bf16 v[248:251], v[148:151], v[160:163], v[248:251]
  v_mfma_f32_16x16x32_bf16 v[252:255], v[148:151], v[164:167], v[252:255]
  s_waitcnt vmcnt(32) lgkmcnt(0)
  s_barrier
  v_mfma_f32_16x16x32_bf16 a[128:131], v[64:67], v[100:103], a[128:131]
  s_add_u32 m0, s63, 104448
  ds_read_b64_tr_b16 v[152:153], v27 offset:26112
  v_mfma_f32_16x16x32_bf16 a[132:135], v[64:67], v[104:107], a[132:135]
  ds_read_b64_tr_b16 v[154:155], v27 offset:26624
  v_mfma_f32_16x16x32_bf16 a[136:139], v[64:67], v[108:111], a[136:139]
  v_mfma_f32_16x16x32_bf16 a[140:143], v[64:67], v[112:115], a[140:143]
  buffer_load_dwordx4 v21, s[40:43], s62 offen offset:0 lds
  ds_read_b64_tr_b16 v[156:157], v27 offset:26144
  v_mfma_f32_16x16x32_bf16 a[144:147], v[68:71], v[100:103], a[144:147]
  v_mfma_f32_16x16x32_bf16 a[148:151], v[68:71], v[104:107], a[148:151]
  ds_read_b64_tr_b16 v[158:159], v27 offset:26656
  v_mfma_f32_16x16x32_bf16 a[152:155], v[68:71], v[108:111], a[152:155]
  buffer_load_dwordx4 v22, s[40:43], s62 offen offset:1056 lds
  ds_read_b64_tr_b16 v[160:161], v27 offset:26176
  v_mfma_f32_16x16x32_bf16 a[156:159], v[68:71], v[112:115], a[156:159]
  v_mfma_f32_16x16x32_bf16 a[160:163], v[72:75], v[100:103], a[160:163]
  ds_read_b64_tr_b16 v[162:163], v27 offset:26688
  v_mfma_f32_16x16x32_bf16 a[164:167], v[72:75], v[104:107], a[164:167]
  buffer_load_dwordx4 v23, s[40:43], s62 offen offset:2112 lds
  v_mfma_f32_16x16x32_bf16 a[168:171], v[72:75], v[108:111], a[168:171]
  ds_read_b64_tr_b16 v[164:165], v27 offset:26208
  v_mfma_f32_16x16x32_bf16 a[172:175], v[72:75], v[112:115], a[172:175]
  ds_read_b64_tr_b16 v[166:167], v27 offset:26720
  v_mfma_f32_16x16x32_bf16 a[176:179], v[76:79], v[100:103], a[176:179]
  buffer_load_dwordx4 v24, s[40:43], s62 offen offset:3168 lds
  v_mfma_f32_16x16x32_bf16 a[180:183], v[76:79], v[104:107], a[180:183]
  ds_read_b128 v[116:119], v30 offset:26112
  v_mfma_f32_16x16x32_bf16 a[184:187], v[76:79], v[108:111], a[184:187]
  v_mfma_f32_16x16x32_bf16 a[188:191], v[76:79], v[112:115], a[188:191]
  s_add_u32 m0, s60, 104448
  ds_read_b128 v[120:123], v30 offset:27136
  v_mfma_f32_16x16x32_bf16 a[192:195], v[80:83], v[100:103], a[192:195]
  v_mfma_f32_16x16x32_bf16 a[196:199], v[80:83], v[104:107], a[196:199]
  ds_read_b128 v[124:127], v30 offset:28160
  v_mfma_f32_16x16x32_bf16 a[200:203], v[80:83], v[108:111], a[200:203]
  s_add_u32 s62, s62, 131072
  ds_read_b128 v[128:131], v30 offset:29184
  v_mfma_f32_16x16x32_bf16 a[204:207], v[80:83], v[112:115], a[204:207]
  v_mfma_f32_16x16x32_bf16 a[208:211], v[84:87], v[100:103], a[208:211]
  ds_read_b128 v[132:135], v30 offset:30208
  v_mfma_f32_16x16x32_bf16 a[212:215], v[84:87], v[104:107], a[212:215]
  buffer_load_dwordx4 v20, s[12:15], s61 offen sc1 lds
  v_mfma_f32_16x16x32_bf16 a[216:219], v[84:87], v[108:111], a[216:219]
  ds_read_b128 v[136:139], v30 offset:31232
  v_mfma_f32_16x16x32_bf16 a[220:223], v[84:87], v[112:115], a[220:223]
  ds_read_b128 v[140:143], v30 offset:32256
  v_mfma_f32_16x16x32_bf16 a[224:227], v[88:91], v[100:103], a[224:227]
  buffer_load_dwordx4 v20, s[12:15], s61 offen offset:1024 sc1 lds
  v_mfma_f32_16x16x32_bf16 a[228:231], v[88:91], v[104:107], a[228:231]
  ds_read_b128 v[144:147], v30 offset:33280
  v_mfma_f32_16x16x32_bf16 a[232:235], v[88:91], v[108:111], a[232:235]
  v_mfma_f32_16x16x32_bf16 a[236:239], v[88:91], v[112:115], a[236:239]
  s_mov_b64 exec, 0xffff
  buffer_load_dwordx4 v20, s[12:15], s61 offen offset:2048 sc1 lds
  s_mov_b64 exec, -1
  v_mfma_f32_16x16x32_bf16 a[240:243], v[92:95], v[100:103], a[240:243]
  ds_read_b128 v[148:151], v30 offset:34304
  v_mfma_f32_16x16x32_bf16 a[244:247], v[92:95], v[104:107], a[244:247]
  v_mfma_f32_16x16x32_bf16 a[248:251], v[92:95], v[108:111], a[248:251]
  s_add_u32 s61, s61, 36864
  v_mfma_f32_16x16x32_bf16 a[252:255], v[92:95], v[112:115], a[252:255]
  v_mfma_f32_16x16x32_bf16 v[240:243], v[96:99], v[100:103], v[240:243]
  v_mfma_f32_16x16x32_bf16 v[244:247], v[96:99], v[104:107], v[244:247]
  v_mfma_f32_16x16x32_bf16 v[248:251], v[96:99], v[108:111], v[248:251]
  v_mfma_f32_16x16x32_bf16 v[252:255], v[96:99], v[112:115], v[252:255]
  s_waitcnt vmcnt(31) lgkmcnt(0)
  s_barrier
  v_mfma_f32_16x16x32_bf16 a[128:131], v[116:119], v[152:155], a[128:131]
  s_add_u32 m0, s63, 130560
  ds_read_b64_tr_b16 v[100:101], v25 offset:0
  v_mfma_f32_16x16x32_bf16 a[132:135], v[116:119], v[156:159], a[132:135]
  ds_read_b64_tr_b16 v[102:103], v25 offset:512
  v_mfma_f32_16x16x32_bf16 a[136:139], v[116:119], v[160:163], a[136:139]
  v_mfma_f32_16x16x32_bf16 a[140:143], v[116:119], v[164:167], a[140:143]
  buffer_load_dwordx4 v21, s[40:43], s62 offen offset:0 lds
  ds_read_b64_tr_b16 v[104:105], v25 offset:32
  v_mfma_f32_16x16x32_bf16 a[144:147], v[120:123], v[152:155], a[144:147]
  v_mfma_f32_16x16x32_bf16 a[148:151], v[120:123], v[156:159], a[148:151]
  ds_read_b64_tr_b16 v[106:107], v25 offset:544
  v_mfma_f32_16x16x32_bf16 a[152:155], v[120:123], v[160:163], a[152:155]
  buffer_load_dwordx4 v22, s[40:43], s62 offen offset:1056 lds
  ds_read_b64_tr_b16 v[108:109], v25 offset:64
  v_mfma_f32_16x16x32_bf16 a[156:159], v[120:123], v[164:167], a[156:159]
  v_mfma_f32_16x16x32_bf16 a[160:163], v[124:127], v[152:155], a[160:163]
  ds_read_b64_tr_b16 v[110:111], v25 offset:576
  v_mfma_f32_16x16x32_bf16 a[164:167], v[124:127], v[156:159], a[164:167]
  buffer_load_dwordx4 v23, s[40:43], s62 offen offset:2112 lds
  v_mfma_f32_16x16x32_bf16 a[168:171], v[124:127], v[160:163], a[168:171]
  ds_read_b64_tr_b16 v[112:113], v25 offset:96
  v_mfma_f32_16x16x32_bf16 a[172:175], v[124:127], v[164:167], a[172:175]
  ds_read_b64_tr_b16 v[114:115], v25 offset:608
  v_mfma_f32_16x16x32_bf16 a[176:179], v[128:131], v[152:155], a[176:179]
  buffer_load_dwordx4 v24, s[40:43], s62 offen offset:3168 lds
  v_mfma_f32_16x16x32_bf16 a[180:183], v[128:131], v[156:159], a[180:183]
  ds_read_b128 v[64:67], v28 offset:0
  v_mfma_f32_16x16x32_bf16 a[184:187], v[128:131], v[160:163], a[184:187]
  v_mfma_f32_16x16x32_bf16 a[188:191], v[128:131], v[164:167], a[188:191]
  s_add_u32 m0, s60, 130560
  ds_read_b128 v[68:71], v28 offset:1024
  v_mfma_f32_16x16x32_bf16 a[192:195], v[132:135], v[152:155], a[192:195]
  v_mfma_f32_16x16x32_bf16 a[196:199], v[132:135], v[156:159], a[196:199]
  ds_read_b128 v[72:75], v28 offset:2048
  v_mfma_f32_16x16x32_bf16 a[200:203], v[132:135], v[160:163], a[200:203]
  s_add_u32 s62, s62, 131072
  ds_read_b128 v[76:79], v28 offset:3072
  v_mfma_f32_16x16x32_bf16 a[204:207], v[132:135], v[164:167], a[204:207]
  v_mfma_f32_16x16x32_bf16 a[208:211], v[136:139], v[152:155], a[208:211]
  ds_read_b128 v[80:83], v28 offset:4096
  v_mfma_f32_16x16x32_bf16 a[212:215], v[136:139], v[156:159], a[212:215]
  buffer_load_dwordx4 v20, s[12:15], s61 offen sc1 lds
  v_mfma_f32_16x16x32_bf16 a[216:219], v[136:139], v[160:163], a[216:219]
  ds_read_b128 v[84:87], v28 offset:5120
  v_mfma_f32_16x16x32_bf16 a[220:223], v[136:139], v[164:167], a[220:223]
  ds_read_b128 v[88:91], v28 offset:6144
  v_mfma_f32_16x16x32_bf16 a[224:227], v[140:143], v[152:155], a[224:227]
  buffer_load_dwordx4 v20, s[12:15], s61 offen offset:1024 sc1 lds
  v_mfma_f32_16x16x32_bf16 a[228:231], v[140:143], v[156:159], a[228:231]
  ds_read_b128 v[92:95], v28 offset:7168
  v_mfma_f32_16x16x32_bf16 a[232:235], v[140:143], v[160:163], a[232:235]
  v_mfma_f32_16x16x32_bf16 a[236:239], v[140:143], v[164:167], a[236:239]
  s_mov_b64 exec, 0xffff
  buffer_load_dwordx4 v20, s[12:15], s61 offen offset:2048 sc1 lds
  s_mov_b64 exec, -1
  v_mfma_f32_16x16x32_bf16 a[240:243], v[144:147], v[152:155], a[240:243]
  ds_read_b128 v[96:99], v28 offset:8192
  v_mfma_f32_16x16x32_bf16 a[244:247], v[144:147], v[156:159], a[244:247]
  v_mfma_f32_16x16x32_bf16 a[248:251], v[144:147], v[160:163], a[248:251]
  s_add_u32 s61, s61, 36864
  v_mfma_f32_16x16x32_bf16 a[252:255], v[144:147], v[164:167], a[252:255]
  v_mfma_f32_16x16x32_bf16 v[240:243], v[148:151], v[152:155], v[240:243]
  v_mfma_f32_16x16x32_bf16 v[244:247], v[148:151], v[156:159], v[244:247]
  v_mfma_f32_16x16x32_bf16 v[248:251], v[148:151], v[160:163], v[248:251]
  v_mfma_f32_16x16x32_bf16 v[252:255], v[148:151], v[164:167], v[252:255]
  s_waitcnt vmcnt(17) lgkmcnt(0)
  s_barrier
  v_mfma_f32_16x16x32_bf16 a[128:131], v[64:67], v[100:103], a[128:131]
  buffer_store_dword v59, v8, s[12:15], s44 offen sc1
  ds_read_b64_tr_b16 v[152:153], v25 offset:26112
  v_mfma_f32_16x16x32_bf16 a[132:135], v[64:67], v[104:107], a[132:135]
  ds_read_b64_tr_b16 v[154:155], v25 offset:26624
  v_mfma_f32_16x16x32_bf16 a[136:139], v[64:67], v[108:111], a[136:139]
  s_add_u32 m0, s63, 0
  v_mfma_f32_16x16x32_bf16 a[140:143], v[64:67], v[112:115], a[140:143]
  ds_read_b64_tr_b16 v[156:157], v25 offset:26144
  v_mfma_f32_16x16x32_bf16 a[144:147], v[68:71], v[100:103], a[144:147]
  v_mfma_f32_16x16x32_bf16 a[148:151], v[68:71], v[104:107], a[148:151]
  buffer_load_dwordx4 v21, s[40:43], s62 offen offset:0 lds
  ds_read_b64_tr_b16 v[158:159], v25 offset:26656
  v_mfma_f32_16x16x32_bf16 a[152:155], v[68:71], v[108:111], a[152:155]
  ds_read_b64_tr_b16 v[160:161], v25 offset:26176
  v_mfma_f32_16x16x32_bf16 a[156:159], v[68:71], v[112:115], a[156:159]
  v_mfma_f32_16x16x32_bf16 a[160:163], v[72:75], v[100:103], a[160:163]
  buffer_load_dwordx4 v22, s[40:43], s62 offen offset:1056 lds
  ds_read_b64_tr_b16 v[162:163], v25 offset:26688
  v_mfma_f32_16x16x32_bf16 a[164:167], v[72:75], v[104:107], a[164:167]
  v_mfma_f32_16x16x32_bf16 a[168:171], v[72:75], v[108:111], a[168:171]
  ds_read_b64_tr_b16 v[164:165], v25 offset:26208
  v_mfma_f32_16x16x32_bf16 a[172:175], v[72:75], v[112:115], a[172:175]
  buffer_load_dwordx4 v23, s[40:43], s62 offen offset:2112 lds
  ds_read_b64_tr_b16 v[166:167], v25 offset:26720
  v_mfma_f32_16x16x32_bf16 a[176:179], v[76:79], v[100:103], a[176:179]
  v_mfma_f32_16x16x32_bf16 a[180:183], v[76:79], v[104:107], a[180:183]
  ds_read_b128 v[116:119], v28 offset:26112
  v_mfma_f32_16x16x32_bf16 a[184:187], v[76:79], v[108:111], a[184:187]
  buffer_load_dwordx4 v24, s[40:43], s62 offen offset:3168 lds
  v_mfma_f32_16x16x32_bf16 a[188:191], v[76:79], v[112:115], a[188:191]
  ds_read_b128 v[120:123], v28 offset:27136
  v_mfma_f32_16x16x32_bf16 a[192:195], v[80:83], v[100:103], a[192:195]
  v_mfma_f32_16x16x32_bf16 a[196:199], v[80:83], v[104:107], a[196:199]
  s_add_u32 m0, s60, 0
  ds_read_b128 v[124:127], v28 offset:28160
  v_mfma_f32_16x16x32_bf16 a[200:203], v[80:83], v[108:111], a[200:203]
  ds_read_b128 v[128:131], v28 offset:29184
  v_mfma_f32_16x16x32_bf16 a[204:207], v[80:83], v[112:115], a[204:207]
  s_add_u32 s62, s62, 131072
  v_mfma_f32_16x16x32_bf16 a[208:211], v[84:87], v[100:103], a[208:211]
  ds_read_b128 v[132:135], v28 offset:30208
  v_mfma_f32_16x16x32_bf16 a[212:215], v[84:87], v[104:107], a[212:215]
  v_mfma_f32_16x16x32_bf16 a[216:219], v[84:87], v[108:111], a[216:219]
  buffer_load_dwordx4 v20, s[12:15], s61 offen sc1 lds
  ds_read_b128 v[136:139], v28 offset:31232
  v_mfma_f32_16x16x32_bf16 a[220:223], v[84:87], v[112:115], a[220:223]
  ds_read_b128 v[140:143], v28 offset:32256
  v_mfma_f32_16x16x32_bf16 a[224:227], v[88:91], v[100:103], a[224:227]
  v_mfma_f32_16x16x32_bf16 a[228:231], v[88:91], v[104:107], a[228:231]
  buffer_load_dwordx4 v20, s[12:15], s61 offen offset:1024 sc1 lds
  ds_read_b128 v[144:147], v28 offset:33280
  v_mfma_f32_16x16x32_bf16 a[232:235], v[88:91], v[108:111], a[232:235]
TP_23:
  s_cbranch_execz TR_3
  v_mfma_f32_16x16x32_bf16 a[236:239], v[88:91], v[112:115], a[236:239]
  ds_read_b128 v[148:151], v28 offset:34304
  v_mfma_f32_16x16x32_bf16 a[240:243], v[92:95], v[100:103], a[240:243]
  s_mov_b64 exec, 0xffff
  buffer_load_dwordx4 v20, s[12:15], s61 offen offset:2048 sc1 lds
  s_mov_b64 exec, -1
  v_mfma_f32_16x16x32_bf16 a[244:247], v[92:95], v[104:107], a[244:247]
  v_mfma_f32_16x16x32_bf16 a[248:251], v[92:95], v[108:111], a[248:251]
  v_mfma_f32_16x16x32_bf16 a[252:255], v[92:95], v[112:115], a[252:255]
  s_add_u32 s61, s61, 36864
  v_mfma_f32_16x16x32_bf16 v[240:243], v[96:99], v[100:103], v[240:243]
  v_mfma_f32_16x16x32_bf16 v[244:247], v[96:99], v[104:107], v[244:247]
  v_mfma_f32_16x16x32_bf16 v[248:251], v[96:99], v[108:111], v[248:251]
  v_mfma_f32_16x16x32_bf16 v[252:255], v[96:99], v[112:115], v[252:255]
  s_waitcnt lgkmcnt(0)
  s_barrier
  v_mfma_f32_16x16x32_bf16 a[128:131], v[116:119], v[152:155], a[128:131]
  s_add_u32 m0, s63, 26112
  ds_read_b64_tr_b16 v[100:101], v26 offset:0
  v_mfma_f32_16x16x32_bf16 a[132:135], v[116:119], v[156:159], a[132:135]
  ds_read_b64_tr_b16 v[102:103], v26 offset:512
  v_mfma_f32_16x16x32_bf16 a[136:139], v[116:119], v[160:163], a[136:139]
  v_mfma_f32_16x16x32_bf16 a[140:143], v[116:119], v[164:167], a[140:143]
  buffer_load_dwordx4 v21, s[40:43], s62 offen offset:0 lds
  ds_read_b64_tr_b16 v[104:105], v26 offset:32
  v_mfma_f32_16x16x32_bf16 a[144:147], v[120:123], v[152:155], a[144:147]
  v_mfma_f32_16x16x32_bf16 a[148:151], v[120:123], v[156:159], a[148:151]
  ds_read_b64_tr_b16 v[106:107], v26 offset:544
  v_mfma_f32_16x16x32_bf16 a[152:155], v[120:123], v[160:163], a[152:155]
  buffer_load_dwordx4 v22, s[40:43], s62 offen offset:1056 lds
  ds_read_b64_tr_b16 v[108:109], v26 offset:64
  v_mfma_f32_16x16x32_bf16 a[156:159], v[120:123], v[164:167], a[156:159]
  v_mfma_f32_16x16x32_bf16 a[160:163], v[124:127], v[152:155], a[160:163]
  ds_read_b64_tr_b16 v[110:111], v26 offset:576
  v_mfma_f32_16x16x32_bf16 a[164:167], v[124:127], v[156:159], a[164:167]
  buffer_load_dwordx4 v23, s[40:43], s62 offen offset:2112 lds
  v_mfma_f32_16x16x32_bf16 a[168:171], v[124:127], v[160:163], a[168:171]
  ds_read_b64_tr_b16 v[112:113], v26 offset:96
  v_mfma_f32_16x16x32_bf16 a[172:175], v[124:127], v[164:167], a[172:175]
  ds_read_b64_tr_b16 v[114:115], v26 offset:608
  v_mfma_f32_16x16x32_bf16 a[176:179], v[128:131], v[152:155], a[176:179]
  buffer_load_dwordx4 v24, s[40:43], s62 offen offset:3168 lds
  v_mfma_f32_16x16x32_bf16 a[180:183], v[128:131], v[156:159], a[180:183]
  ds_read_b128 v[64:67], v29 offset:0
  v_mfma_f32_16x16x32_bf16 a[184:187], v[128:131], v[160:163], a[184:187]
  v_mfma_f32_16x16x32_bf16 a[188:191], v[128:131], v[164:167], a[188:191]
  s_add_u32 m0, s60, 26112
  ds_read_b128 v[68:71], v29 offset:1024
  v_mfma_f32_16x16x32_bf16 a[192:195], v[132:135], v[152:155], a[192:195]
  v_mfma_f32_16x16x32_bf16 a[196:199], v[132:135], v[156:159], a[196:199]
  ds_read_b128 v[72:75], v29 offset:2048
  v_mfma_f32_16x16x32_bf16 a[200:203], v[132:135], v[160:163], a[200:203]
  s_add_u32 s62, s62, 131072
  ds_read_b128 v[76:79], v29 offset:3072
  v_mfma_f32_16x16x32_bf16 a[204:207], v[132:135], v[164:167], a[204:207]
  v_mfma_f32_16x16x32_bf16 a[208:211], v[136:139], v[152:155], a[208:211]
  ds_read_b128 v[80:83], v29 offset:4096
  v_mfma_f32_16x16x32_bf16 a[212:215], v[136:139], v[156:159], a[212:215]
  buffer_load_dwordx4 v20, s[12:15], s61 offen sc1 lds
  v_mfma_f32_16x16x32_bf16 a[216:219], v[136:139], v[160:163], a[216:219]
  ds_read_b128 v[84:87], v29 offset:5120
  v_mfma_f32_16x16x32_bf16 a[220:223], v[136:139], v[164:167], a[220:223]
  ds_read_b128 v[88:91], v29 offset:6144
  v_mfma_f32_16x16x32_bf16 a[224:227], v[140:143], v[152:155], a[224:227]
  buffer_load_dwordx4 v20, s[12:15], s61 offen offset:1024 sc1 lds
  v_mfma_f32_16x16x32_bf16 a[228:231], v[140:143], v[156:159], a[228:231]
  ds_read_b128 v[92:95], v29 offset:7168
  v_mfma_f32_16x16x32_bf16 a[232:235], v[140:143], v[160:163], a[232:235]
  v_mfma_f32_16x16x32_bf16 a[236:239], v[140:143], v[164:167], a[236:239]
  s_mov_b64 exec, 0xffff
  buffer_load_dwordx4 v20, s[12:15], s61 offen offset:2048 sc1 lds
  s_mov_b64 exec, -1
  v_mfma_f32_16x16x32_bf16 a[240:243], v[144:147], v[152:155], a[240:243]
  ds_read_b128 v[96:99], v29 offset:8192
  v_mfma_f32_16x16x32_bf16 a[244:247], v[144:147], v[156:159], a[244:247]
  v_mfma_f32_16x16x32_bf16 a[248:251], v[144:147], v[160:163], a[248:251]
  s_add_u32 s61, s61, 36864
  v_mfma_f32_16x16x32_bf16 a[252:255], v[144:147], v[164:167], a[252:255]
  v_mfma_f32_16x16x32_bf16 v[240:243], v[148:151], v[152:155], v[240:243]
  v_mfma_f32_16x16x32_bf16 v[244:247], v[148:151], v[156:159], v[244:247]
  v_mfma_f32_16x16x32_bf16 v[248:251], v[148:151], v[160:163], v[248:251]
  v_mfma_f32_16x16x32_bf16 v[252:255], v[148:151], v[164:167], v[252:255]
  s_waitcnt vmcnt(29) lgkmcnt(0)
  s_barrier
  v_mfma_f32_16x16x32_bf16 a[128:131], v[64:67], v[100:103], a[128:131]
  s_add_u32 m0, s63, 52224
  ds_read_b64_tr_b16 v[152:153], v26 offset:26112
  v_mfma_f32_16x16x32_bf16 a[132:135], v[64:67], v[104:107], a[132:135]
  ds_read_b64_tr_b16 v[154:155], v26 offset:26624
  v_mfma_f32_16x16x32_bf16 a[136:139], v[64:67], v[108:111], a[136:139]
  v_mfma_f32_16x16x32_bf16 a[140:143], v[64:67], v[112:115], a[140:143]
  buffer_load_dwordx4 v21, s[40:43], s62 offen offset:0 lds
  ds_read_b64_tr_b16 v[156:157], v26 offset:26144
  v_mfma_f32_16x16x32_bf16 a[144:147], v[68:71], v[100:103], a[144:147]
  v_mfma_f32_16x16x32_bf16 a[148:151], v[68:71], v[104:107], a[148:151]
  ds_read_b64_tr_b16 v[158:159], v26 offset:26656
  v_mfma_f32_16x16x32_bf16 a[152:155], v[68:71], v[108:111], a[152:155]
  buffer_load_dwordx4 v22, s[40:43], s62 offen offset:1056 lds
  ds_read_b64_tr_b16 v[160:161], v26 offset:26176
  v_mfma_f32_16x16x32_bf16 a[156:159], v[68:71], v[112:115], a[156:159]
  v_mfma_f32_16x16x32_bf16 a[160:163], v[72:75], v[100:103], a[160:163]
  ds_read_b64_tr_b16 v[162:163], v26 offset:26688
  v_mfma_f32_16x16x32_bf16 a[164:167], v[72:75], v[104:107], a[164:167]
  buffer_load_dwordx4 v23, s[40:43], s62 offen offset:2112 lds
  v_mfma_f32_16x16x32_bf16 a[168:171], v[72:75], v[108:111], a[168:171]
  ds_read_b64_tr_b16 v[164:165], v26 offset:26208
  v_mfma_f32_16x16x32_bf16 a[172:175], v[72:75], v[112:115], a[172:175]
  ds_read_b64_tr_b16 v[166:167], v26 offset:26720
  v_mfma_f32_16x16x32_bf16 a[176:179], v[76:79], v[100:103], a[176:179]
  buffer_load_dwordx4 v24, s[40:43], s62 offen offset:3168 lds
  v_mfma_f32_16x16x32_bf16 a[180:183], v[76:79], v[104:107], a[180:183]
  ds_read_b128 v[116:119], v29 offset:26112
  v_mfma_f32_16x16x32_bf16 a[184:187], v[76:79], v[108:111], a[184:187]
  v_mfma_f32_16x16x32_bf16 a[188:191], v[76:79], v[112:115], a[188:191]
  s_add_u32 m0, s60, 52224
  ds_read_b128 v[120:123], v29 offset:27136
  v_mfma_f32_16x16x32_bf16 a[192:195], v[80:83], v[100:103], a[192:195]
  v_mfma_f32_16x16x32_bf16 a[196:199], v[80:83], v[104:107], a[196:199]
  ds_read_b128 v[124:127], v29 offset:28160
  v_mfma_f32_16x16x32_bf16 a[200:203], v[80:83], v[108:111], a[200:203]
  s_add_u32 s62, s62, 131072
  ds_read_b128 v[128:131], v29 offset:29184
  v_mfma_f32_16x16x32_bf16 a[204:207], v[80:83], v[112:115], a[204:207]
  v_mfma_f32_16x16x32_bf16 a[208:211], v[84:87], v[100:103], a[208:211]
  ds_read_b128 v[132:135], v29 offset:30208
  v_mfma_f32_16x16x32_bf16 a[212:215], v[84:87], v[104:107], a[212:215]
  buffer_load_dwordx4 v20, s[12:15], s61 offen sc1 lds
  v_mfma_f32_16x16x32_bf16 a[216:219], v[84:87], v[108:111], a[216:219]
  ds_read_b128 v[136:139], v29 offset:31232
  v_mfma_f32_16x16x32_bf16 a[220:223], v[84:87], v[112:115], a[220:223]
  ds_read_b128 v[140:143], v29 offset:32256
  v_mfma_f32_16x16x32_bf16 a[224:227], v[88:91], v[100:103], a[224:227]
  buffer_load_dwordx4 v20, s[12:15], s61 offen offset:1024 sc1 lds
  v_mfma_f32_16x16x32_bf16 a[228:231], v[88:91], v[104:107], a[228:231]
  ds_read_b128 v[144:147], v29 offset:33280
  v_mfma_f32_16x16x32_bf16 a[232:235], v[88:91], v[108:111], a[232:235]
  v_mfma_f32_16x16x32_bf16 a[236:239], v[88:91], v[112:115], a[236:239]
  s_mov_b64 exec, 0xffff
  buffer_load_dwordx4 v20, s[12:15], s61 offen offset:2048 sc1 lds
  s_mov_b64 exec, -1
  v_mfma_f32_16x16x32_bf16 a[240:243], v[92:95], v[100:103], a[240:243]
  ds_read_b128 v[148:151], v29 offset:34304
  v_mfma_f32_16x16x32_bf16 a[244:247], v[92:95], v[104:107], a[244:247]
  v_mfma_f32_16x16x32_bf16 a[248:251], v[92:95], v[108:111], a[248:251]
  s_add_u32 s61, s61, 36864
  v_mfma_f32_16x16x32_bf16 a[252:255], v[92:95], v[112:115], a[252:255]
  v_mfma_f32_16x16x32_bf16 v[240:243], v[96:99], v[100:103], v[240:243]
  v_mfma_f32_16x16x32_bf16 v[244:247], v[96:99], v[104:107], v[244:247]
  v_mfma_f32_16x16x32_bf16 v[248:251], v[96:99], v[108:111], v[248:251]
  v_mfma_f32_16x16x32_bf16 v[252:255], v[96:99], v[112:115], v[252:255]
  s_waitcnt vmcnt(29) lgkmcnt(0)
  s_barrier
  v_mfma_f32_16x16x32_bf16 a[128:131], v[116:119], v[152:155], a[128:131]
  s_add_u32 m0, s63, 78336
  ds_read_b64_tr_b16 v[100:101], v27 offset:0
  v_mfma_f32_16x16x32_bf16 a[132:135], v[116:119], v[156:159], a[132:135]
  ds_read_b64_tr_b16 v[102:103], v27 offset:512
  v_mfma_f32_16x16x32_bf16 a[136:139], v[116:119], v[160:163], a[136:139]
  v_mfma_f32_16x16x32_bf16 a[140:143], v[116:119], v[164:167], a[140:143]
  buffer_load_dwordx4 v21, s[40:43], s62 offen offset:0 lds
  ds_read_b64_tr_b16 v[104:105], v27 offset:32
  v_mfma_f32_16x16x32_bf16 a[144:147], v[120:123], v[152:155], a[144:147]
  v_mfma_f32_16x16x32_bf16 a[148:151], v[120:123], v[156:159], a[148:151]
  ds_read_b64_tr_b16 v[106:107], v27 offset:544
  v_mfma_f32_16x16x32_bf16 a[152:155], v[120:123], v[160:163], a[152:155]
  buffer_load_dwordx4 v22, s[40:43], s62 offen offset:1056 lds
  ds_read_b64_tr_b16 v[108:109], v27 offset:64
  v_mfma_f32_16x16x32_bf16 a[156:159], v[120:123], v[164:167], a[156:159]
  v_mfma_f32_16x16x32_bf16 a[160:163], v[124:127], v[152:155], a[160:163]
  ds_read_b64_tr_b16 v[110:111], v27 offset:576
  v_mfma_f32_16x16x32_bf16 a[164:167], v[124:127], v[156:159], a[164:167]
  buffer_load_dwordx4 v23, s[40:43], s62 offen offset:2112 lds
  v_mfma_f32_16x16x32_bf16 a[168:171], v[124:127], v[160:163], a[168:171]
  ds_read_b64_tr_b16 v[112:113], v27 offset:96
  v_mfma_f32_16x16x32_bf16 a[172:175], v[124:127], v[164:167], a[172:175]
  ds_read_b64_tr_b16 v[114:115], v27 offset:608
  v_mfma_f32_16x16x32_bf16 a[176:179], v[128:131], v[152:155], a[176:179]
  buffer_load_dwordx4 v24, s[40:43], s62 offen offset:3168 lds
  v_mfma_f32_16x16x32_bf16 a[180:183], v[128:131], v[156:159], a[180:183]
  ds_read_b128 v[64:67], v30 offset:0
  v_mfma_f32_16x16x32_bf16 a[184:187], v[128:131], v[160:163], a[184:187]
  v_mfma_f32_16x16x32_bf16 a[188:191], v[128:131], v[164:167], a[188:191]
  s_add_u32 m0, s60, 78336
  ds_read_b128 v[68:71], v30 offset:1024
  v_mfma_f32_16x16x32_bf16 a[192:195], v[132:135], v[152:155], a[192:195]
  v_mfma_f32_16x16x32_bf16 a[196:199], v[132:135], v[156:159], a[196:199]
  ds_read_b128 v[72:75], v30 offset:2048
  v_mfma_f32_16x16x32_bf16 a[200:203], v[132:135], v[160:163], a[200:203]
  s_add_u32 s62, s62, 131072
  ds_read_b128 v[76:79], v30 offset:3072
  v_mfma_f32_16x16x32_bf16 a[204:207], v[132:135], v[164:167], a[204:207]
  v_mfma_f32_16x16x32_bf16 a[208:211], v[136:139], v[152:155], a[208:211]
  ds_read_b128 v[80:83], v30 offset:4096
  v_mfma_f32_16x16x32_bf16 a[212:215], v[136:139], v[156:159], a[212:215]
  buffer_load_dwordx4 v20, s[12:15], s61 offen sc1 lds
  v_mfma_f32_16x16x32_bf16 a[216:219], v[136:139], v[160:163], a[216:219]
  ds_read_b128 v[84:87], v30 offset:5120
  v_mfma_f32_16x16x32_bf16 a[220:223], v[136:139], v[164:167], a[220:223]
  ds_read_b128 v[88:91], v30 offset:6144
  v_mfma_f32_16x16x32_bf16 a[224:227], v[140:143], v[152:155], a[224:227]
  buffer_load_dwordx4 v20, s[12:15], s61 offen offset:1024 sc1 lds
  v_mfma_f32_16x16x32_bf16 a[228:231], v[140:143], v[156:159], a[228:231]
  ds_read_b128 v[92:95], v30 offset:7168
  v_mfma_f32_16x16x32_bf16 a[232:235], v[140:143], v[160:163], a[232:235]
  v_mfma_f32_16x16x32_bf16 a[236:239], v[140:143], v[164:167], a[236:239]
  s_mov_b64 exec, 0xffff
  buffer_load_dwordx4 v20, s[12:15], s61 offen offset:2048 sc1 lds
  s_mov_b64 exec, -1
  v_mfma_f32_16x16x32_bf16 a[240:243], v[144:147], v[152:155], a[240:243]
  ds_read_b128 v[96:99], v30 offset:8192
  v_mfma_f32_16x16x32_bf16 a[244:247], v[144:147], v[156:159], a[244:247]
  v_mfma_f32_16x16x32_bf16 a[248:251], v[144:147], v[160:163], a[248:251]
  s_add_u32 s61, s61, 36864
  v_mfma_f32_16x16x32_bf16 a[252:255], v[144:147], v[164:167], a[252:255]
  v_mfma_f32_16x16x32_bf16 v[240:243], v[148:151], v[152:155], v[240:243]
  v_mfma_f32_16x16x32_bf16 v[244:247], v[148:151], v[156:159], v[244:247]
  v_mfma_f32_16x16x32_bf16 v[248:251], v[148:151], v[160:163], v[248:251]
  v_mfma_f32_16x16x32_bf16 v[252:255], v[148:151], v[164:167], v[252:255]
  s_waitcnt vmcnt(29) lgkmcnt(0)
  s_barrier
  v_mfma_f32_16x16x32_bf16 a[128:131], v[64:67], v[100:103], a[128:131]
  s_add_u32 m0, s63, 104448
  ds_read_b64_tr_b16 v[152:153], v27 offset:26112
  v_mfma_f32_16x16x32_bf16 a[132:135], v[64:67], v[104:107], a[132:135]
  ds_read_b64_tr_b16 v[154:155], v27 offset:26624
  v_mfma_f32_16x16x32_bf16 a[136:139], v[64:67], v[108:111], a[136:139]
  v_mfma_f32_16x16x32_bf16 a[140:143], v[64:67], v[112:115], a[140:143]
  buffer_load_dwordx4 v21, s[40:43], s62 offen offset:0 lds
  ds_read_b64_tr_b16 v[156:157], v27 offset:26144
  v_mfma_f32_16x16x32_bf16 a[144:147], v[68:71], v[100:103], a[144:147]
  v_mfma_f32_16x16x32_bf16 a[148:151], v[68:71], v[104:107], a[148:151]
  ds_read_b64_tr_b16 v[158:159], v27 offset:26656
  v_mfma_f32_16x16x32_bf16 a[152:155], v[68:71], v[108:111], a[152:155]
  buffer_load_dwordx4 v22, s[40:43], s62 offen offset:1056 lds
  ds_read_b64_tr_b16 v[160:161], v27 offset:26176
  v_mfma_f32_16x16x32_bf16 a[156:159], v[68:71], v[112:115], a[156:159]
  v_mfma_f32_16x16x32_bf16 a[160:163], v[72:75], v[100:103], a[160:163]
  ds_read_b64_tr_b16 v[162:163], v27 offset:26688
  v_mfma_f32_16x16x32_bf16 a[164:167], v[72:75], v[104:107], a[164:167]
  buffer_load_dwordx4 v23, s[40:43], s62 offen offset:2112 lds
  v_mfma_f32_16x16x32_bf16 a[168:171], v[72:75], v[108:111], a[168:171]
  ds_read_b64_tr_b16 v[164:165], v27 offset:26208
  v_mfma_f32_16x16x32_bf16 a[172:175], v[72:75], v[112:115], a[172:175]
  ds_read_b64_tr_b16 v[166:167], v27 offset:26720
  v_mfma_f32_16x16x32_bf16 a[176:179], v[76:79], v[100:103], a[176:179]
  buffer_load_dwordx4 v24, s[40:43], s62 offen offset:3168 lds
  v_mfma_f32_16x16x32_bf16 a[180:183], v[76:79], v[104:107], a[180:183]
  ds_read_b128 v[116:119], v30 offset:26112
  v_mfma_f32_16x16x32_bf16 a[184:187], v[76:79], v[108:111], a[184:187]
  v_mfma_f32_16x16x32_bf16 a[188:191], v[76:79], v[112:115], a[188:191]
  s_add_u32 m0, s60, 104448
  ds_read_b128 v[120:123], v30 offset:27136
  v_mfma_f32_16x16x32_bf16 a[192:195], v[80:83], v[100:103], a[192:195]
  v_mfma_f32_16x16x32_bf16 a[196:199], v[80:83], v[104:107], a[196:199]
  ds_read_b128 v[124:127], v30 offset:28160
  v_mfma_f32_16x16x32_bf16 a[200:203], v[80:83], v[108:111], a[200:203]
  s_add_u32 s62, s62, 131072
  ds_read_b128 v[128:131], v30 offset:29184
  v_mfma_f32_16x16x32_bf16 a[204:207], v[80:83], v[112:115], a[204:207]
  v_mfma_f32_16x16x32_bf16 a[208:211], v[84:87], v[100:103], a[208:211]
  ds_read_b128 v[132:135], v30 offset:30208
  v_mfma_f32_16x16x32_bf16 a[212:215], v[84:87], v[104:107], a[212:215]
  buffer_load_dwordx4 v20, s[12:15], s61 offen sc1 lds
  v_mfma_f32_16x16x32_bf16 a[216:219], v[84:87], v[108:111], a[216:219]
  ds_read_b128 v[136:139], v30 offset:31232
  v_mfma_f32_16x16x32_bf16 a[220:223], v[84:87], v[112:115], a[220:223]
  ds_read_b128 v[140:143], v30 offset:32256
  v_mfma_f32_16x16x32_bf16 a[224:227], v[88:91], v[100:103], a[224:227]
  buffer_load_dwordx4 v20, s[12:15], s61 offen offset:1024 sc1 lds
  v_mfma_f32_16x16x32_bf16 a[228:231], v[88:91], v[104:107], a[228:231]
  ds_read_b128 v[144:147], v30 offset:33280
  v_mfma_f32_16x16x32_bf16 a[232:235], v[88:91], v[108:111], a[232:235]
  v_mfma_f32_16x16x32_bf16 a[236:239], v[88:91], v[112:115], a[236:239]
  s_mov_b64 exec, 0xffff
  buffer_load_dwordx4 v20, s[12:15], s61 offen offset:2048 sc1 lds
  s_mov_b64 exec, -1
  v_mfma_f32_16x16x32_bf16 a[240:243], v[92:95], v[100:103], a[240:243]
  ds_read_b128 v[148:151], v30 offset:34304
  v_mfma_f32_16x16x32_bf16 a[244:247], v[92:95], v[104:107], a[244:247]
  v_mfma_f32_16x16x32_bf16 a[248:251], v[92:95], v[108:111], a[248:251]
  s_add_u32 s61, s61, 36864
  v_mfma_f32_16x16x32_bf16 a[252:255], v[92:95], v[112:115], a[252:255]
  v_mfma_f32_16x16x32_bf16 v[240:243], v[96:99], v[100:103], v[240:243]
  v_mfma_f32_16x16x32_bf16 v[244:247], v[96:99], v[104:107], v[244:247]
  v_mfma_f32_16x16x32_bf16 v[248:251], v[96:99], v[108:111], v[248:251]
  v_mfma_f32_16x16x32_bf16 v[252:255], v[96:99], v[112:115], v[252:255]
  s_waitcnt vmcnt(28) lgkmcnt(0)
  s_barrier
  v_mfma_f32_16x16x32_bf16 a[128:131], v[116:119], v[152:155], a[128:131]
  s_add_u32 m0, s63, 130560
  s_lshl_b32 s92, s17, 3
  ds_read_b64_tr_b16 v[100:101], v25 offset:0
  v_mfma_f32_16x16x32_bf16 a[132:135], v[116:119], v[156:159], a[132:135]
  s_lshl_b32 s93, s18, 1
  s_add_u32 s92, s92, s93
  ds_read_b64_tr_b16 v[102:103], v25 offset:512
  v_mfma_f32_16x16x32_bf16 a[136:139], v[116:119], v[160:163], a[136:139]
  s_lshl_b32 s92, s92, 3
  s_add_u32 s92, s92, s16
  s_mul_i32 s92, s92, 9216
  v_mfma_f32_16x16x32_bf16 a[140:143], v[116:119], v[164:167], a[140:143]
  s_add_u32 s92, s92, 27262976
  buffer_load_dwordx4 v21, s[40:43], s62 offen offset:0 lds
  ds_read_b64_tr_b16 v[104:105], v25 offset:32
  v_mfma_f32_16x16x32_bf16 a[144:147], v[120:123], v[152:155], a[144:147]
  s_add_u32 s93, s92, 73728
  v_mov_b32 v44, v3
  v_add_u32 v45, 4096, v3
  v_mfma_f32_16x16x32_bf16 a[148:151], v[120:123], v[156:159], a[148:151]
  ds_read_b64_tr_b16 v[106:107], v25 offset:544
  v_add_u32 v46, 8192, v3
  v_mfma_f32_16x16x32_bf16 a[152:155], v[120:123], v[160:163], a[152:155]
  s_lshr_b32 s56, s17, 2
  buffer_load_dwordx4 v22, s[40:43], s62 offen offset:1056 lds
  ds_read_b64_tr_b16 v[108:109], v25 offset:64
  v_mfma_f32_16x16x32_bf16 a[156:159], v[120:123], v[164:167], a[156:159]
  s_lshl_b32 s56, s56, 8
  s_lshl_b32 s57, s16, 5
  s_add_u32 s56, s56, s57
  v_mfma_f32_16x16x32_bf16 a[160:163], v[124:127], v[152:155], a[160:163]
  s_and_b32 s57, s17, 3
  s_mul_i32 s57, s57, 288
  ds_read_b64_tr_b16 v[110:111], v25 offset:576
  v_mfma_f32_16x16x32_bf16 a[164:167], v[124:127], v[156:159], a[164:167]
  s_lshl_b32 s58, s17, 3
  s_add_u32 s58, s58, s16
  buffer_load_dwordx4 v23, s[40:43], s62 offen offset:2112 lds
  v_mfma_f32_16x16x32_bf16 a[168:171], v[124:127], v[160:163], a[168:171]
  s_mul_i32 s58, s58, 73728
  s_add_u32 s58, s58, 27262976
  ds_read_b64_tr_b16 v[112:113], v25 offset:96
  v_mfma_f32_16x16x32_bf16 a[172:175], v[124:127], v[164:167], a[172:175]
  s_lshl_b32 s59, s17, 7
  s_add_u32 s59, s59, 26288128
  ds_read_b64_tr_b16 v[114:115], v25 offset:608
  v_mfma_f32_16x16x32_bf16 a[176:179], v[128:131], v[152:155], a[176:179]
  s_lshl_b32 s94, s16, 2
  s_add_u32 s94, s59, s94
  buffer_load_dwordx4 v24, s[40:43], s62 offen offset:3168 lds
  v_mfma_f32_16x16x32_bf16 a[180:183], v[128:131], v[156:159], a[180:183]
  s_add_u32 s95, s59, 16
  ds_read_b128 v[64:67], v28 offset:0
  v_add_u32 v4, 0, v0
  v_mfma_f32_16x16x32_bf16 a[184:187], v[128:131], v[160:163], a[184:187]
  v_mul_u32_u24 v5, 3641, v4
  v_lshrrev_b32 v5, 16, v5
  v_mfma_f32_16x16x32_bf16 a[188:191], v[128:131], v[164:167], a[188:191]
  s_add_u32 m0, s60, 130560
  ds_read_b128 v[68:71], v28 offset:1024
  v_mul_u32_u24 v6, 18, v5
  v_mfma_f32_16x16x32_bf16 a[192:195], v[132:135], v[152:155], a[192:195]
  v_sub_u32 v6, v4, v6
  v_add_u32 v5, s56, v5
  v_mfma_f32_16x16x32_bf16 a[196:199], v[132:135], v[156:159], a[196:199]
  ds_read_b128 v[72:75], v28 offset:2048
  v_mul_u32_u24 v5, 1152, v5
  v_mfma_f32_16x16x32_bf16 a[200:203], v[132:135], v[160:163], a[200:203]
  s_add_u32 s62, s62, 131072
  ds_read_b128 v[76:79], v28 offset:3072
  v_lshl_add_u32 v16, v6, 4, v5
  v_mfma_f32_16x16x32_bf16 a[204:207], v[132:135], v[164:167], a[204:207]
  v_add_u32 v4, 256, v0
  v_mul_u32_u24 v5, 3641, v4
  v_mfma_f32_16x16x32_bf16 a[208:211], v[136:139], v[152:155], a[208:211]
  ds_read_b128 v[80:83], v28 offset:4096
  v_lshrrev_b32 v5, 16, v5
  v_mfma_f32_16x16x32_bf16 a[212:215], v[136:139], v[156:159], a[212:215]
  buffer_load_dwordx4 v20, s[12:15], s61 offen sc1 lds
  v_mul_u32_u24 v6, 18, v5
  v_mfma_f32_16x16x32_bf16 a[216:219], v[136:139], v[160:163], a[216:219]
  ds_read_b128 v[84:87], v28 offset:5120
  v_sub_u32 v6, v4, v6
  v_mfma_f32_16x16x32_bf16 a[220:223], v[136:139], v[164:167], a[220:223]
  ds_read_b128 v[88:91], v28 offset:6144
  v_add_u32 v5, s56, v5
  v_mfma_f32_16x16x32_bf16 a[224:227], v[140:143], v[152:155], a[224:227]
  buffer_load_dwordx4 v20, s[12:15], s61 offen offset:1024 sc1 lds
  v_mul_u32_u24 v5, 1152, v5
  v_mfma_f32_16x16x32_bf16 a[228:231], v[140:143], v[156:159], a[228:231]
  ds_read_b128 v[92:95], v28 offset:7168
  v_lshl_add_u32 v17, v6, 4, v5
  v_mfma_f32_16x16x32_bf16 a[232:235], v[140:143], v[160:163], a[232:235]
  v_add_u32 v4, 512, v0
  v_mul_u32_u24 v5, 3641, v4
  v_mfma_f32_16x16x32_bf16 a[236:239], v[140:143], v[164:167], a[236:239]
  s_mov_b64 exec, 0xffff
  buffer_load_dwordx4 v20, s[12:15], s61 offen offset:2048 sc1 lds
  s_mov_b64 exec, -1
  v_mfma_f32_16x16x32_bf16 a[240:243], v[144:147], v[152:155], a[240:243]
  ds_read_b128 v[96:99], v28 offset:8192
  v_lshrrev_b32 v5, 16, v5
  v_mfma_f32_16x16x32_bf16 a[244:247], v[144:147], v[156:159], a[244:247]
  v_mul_u32_u24 v6, 18, v5
  v_sub_u32 v6, v4, v6
  v_mfma_f32_16x16x32_bf16 a[248:251], v[144:147], v[160:163], a[248:251]
  s_add_u32 s61, s61, 36864
  v_add_u32 v5, s56, v5
  v_mul_u32_u24 v5, 1152, v5
  v_mfma_f32_16x16x32_bf16 a[252:255], v[144:147], v[164:167], a[252:255]
  v_lshl_add_u32 v18, v6, 4, v5
  v_mov_b32 v4, 0x7fff0000
  v_mfma_f32_16x16x32_bf16 v[240:243], v[148:151], v[152:155], v[240:243]
  v_cmp_lt_u32 vcc, 63, v0
  v_and_b32 v47, 7, v2
  v_mfma_f32_16x16x32_bf16 v[244:247], v[148:151], v[156:159], v[244:247]
  v_lshlrev_b32 v47, 2, v47
  v_cndmask_b32 v18, v18, v4, vcc
  v_mfma_f32_16x16x32_bf16 v[248:251], v[148:151], v[160:163], v[248:251]
  v_bfe_u32 v4, v0, 2, 4
  v_add_u32 v5, s56, v4
  v_mfma_f32_16x16x32_bf16 v[252:255], v[148:151], v[164:167], v[252:255]
  s_waitcnt vmcnt(28) lgkmcnt(0)
  s_barrier
  v_mfma_f32_16x16x32_bf16 a[128:131], v[64:67], v[100:103], a[128:131]
  ds_read_b64_tr_b16 v[152:153], v25 offset:26112
  v_lshlrev_b32 v19, 1, v5
  v_mfma_f32_16x16x32_bf16 a[132:135], v[64:67], v[104:107], a[132:135]
  ds_read_b64_tr_b16 v[154:155], v25 offset:26624
  v_lshrrev_b32 v6, 6, v0
  v_mfma_f32_16x16x32_bf16 a[136:139], v[64:67], v[108:111], a[136:139]
  v_and_b32 v7, 1, v0
  v_lshlrev_b32 v7, 2, v7
  v_mfma_f32_16x16x32_bf16 a[140:143], v[64:67], v[112:115], a[140:143]
  ds_read_b64_tr_b16 v[156:157], v25 offset:26144
  v_lshl_add_u32 v7, v6, 3, v7
  v_mfma_f32_16x16x32_bf16 a[144:147], v[68:71], v[100:103], a[144:147]
  v_bfe_u32 v6, v0, 1, 1
  v_mul_u32_u24 v4, 288, v4
  v_mfma_f32_16x16x32_bf16 a[148:151], v[68:71], v[104:107], a[148:151]
  ds_read_b64_tr_b16 v[158:159], v25 offset:26656
  v_add_u32 v4, v4, v7
  v_mfma_f32_16x16x32_bf16 a[152:155], v[68:71], v[108:111], a[152:155]
  ds_read_b64_tr_b16 v[160:161], v25 offset:26176
  v_lshl_add_u32 v12, v6, 5, v4
  v_mfma_f32_16x16x32_bf16 a[156:159], v[68:71], v[112:115], a[156:159]
  v_mul_u32_u24 v13, 4608, v6
  v_add3_u32 v13, v13, v4, 64
  v_mfma_f32_16x16x32_bf16 a[160:163], v[72:75], v[100:103], a[160:163]
  ds_read_b64_tr_b16 v[162:163], v25 offset:26688
  v_mul_u32_u24 v5, 1152, v5
  v_mfma_f32_16x16x32_bf16 a[164:167], v[72:75], v[104:107], a[164:167]
  v_add_u32 v5, v5, v7
  v_lshl_add_u32 v10, v6, 5, v5
  v_mfma_f32_16x16x32_bf16 a[168:171], v[72:75], v[108:111], a[168:171]
  ds_read_b64_tr_b16 v[164:165], v25 offset:26208
  v_add_u32 v11, 18432, v10
  v_mfma_f32_16x16x32_bf16 a[172:175], v[72:75], v[112:115], a[172:175]
  ds_read_b64_tr_b16 v[166:167], v25 offset:26720
  v_mul_u32_u24 v14, 18432, v6
  v_mfma_f32_16x16x32_bf16 a[176:179], v[76:79], v[100:103], a[176:179]
  v_add_u32 v14, v14, v5
  v_lshlrev_b32 v15, 2, v0
  v_mfma_f32_16x16x32_bf16 a[180:183], v[76:79], v[104:107], a[180:183]
  ds_read_b128 v[116:119], v28 offset:26112
  v_mfma_f32_16x16x32_bf16 a[184:187], v[76:79], v[108:111], a[184:187]
  v_mfma_f32_16x16x32_bf16 a[188:191], v[76:79], v[112:115], a[188:191]
  ds_read_b128 v[120:123], v28 offset:27136
  v_mfma_f32_16x16x32_bf16 a[192:195], v[80:83], v[100:103], a[192:195]
  v_mfma_f32_16x16x32_bf16 a[196:199], v[80:83], v[104:107], a[196:199]
  ds_read_b128 v[124:127], v28 offset:28160
  v_mfma_f32_16x16x32_bf16 a[200:203], v[80:83], v[108:111], a[200:203]
  ds_read_b128 v[128:131], v28 offset:29184
  v_mfma_f32_16x16x32_bf16 a[204:207], v[80:83], v[112:115], a[204:207]
  v_mfma_f32_16x16x32_bf16 a[208:211], v[84:87], v[100:103], a[208:211]
  ds_read_b128 v[132:135], v28 offset:30208
  v_mfma_f32_16x16x32_bf16 a[212:215], v[84:87], v[104:107], a[212:215]
  v_mfma_f32_16x16x32_bf16 a[216:219], v[84:87], v[108:111], a[216:219]
  ds_read_b128 v[136:139], v28 offset:31232
  v_mfma_f32_16x16x32_bf16 a[220:223], v[84:87], v[112:115], a[220:223]
  ds_read_b128 v[140:143], v28 offset:32256
  v_mfma_f32_16x16x32_bf16 a[224:227], v[88:91], v[100:103], a[224:227]
  v_mfma_f32_16x16x32_bf16 a[228:231], v[88:91], v[104:107], a[228:231]
  ds_read_b128 v[144:147], v28 offset:33280
  v_mfma_f32_16x16x32_bf16 a[232:235], v[88:91], v[108:111], a[232:235]
  v_mfma_f32_16x16x32_bf16 a[236:239], v[88:91], v[112:115], a[236:239]
  ds_read_b128 v[148:151], v28 offset:34304
  v_mfma_f32_16x16x32_bf16 a[240:243], v[92:95], v[100:103], a[240:243]
  v_mfma_f32_16x16x32_bf16 a[244:247], v[92:95], v[104:107], a[244:247]
  v_mfma_f32_16x16x32_bf16 a[248:251], v[92:95], v[108:111], a[248:251]
  v_mfma_f32_16x16x32_bf16 a[252:255], v[92:95], v[112:115], a[252:255]
  v_mfma_f32_16x16x32_bf16 v[240:243], v[96:99], v[100:103], v[240:243]
  v_mfma_f32_16x16x32_bf16 v[244:247], v[96:99], v[104:107], v[244:247]
  v_mfma_f32_16x16x32_bf16 v[248:251], v[96:99], v[108:111], v[248:251]
  v_mfma_f32_16x16x32_bf16 v[252:255], v[96:99], v[112:115], v[252:255]
  s_waitcnt vmcnt(21) lgkmcnt(0)
  s_barrier
  v_mfma_f32_16x16x32_bf16 a[128:131], v[116:119], v[152:155], a[128:131]
  ds_read_b64_tr_b16 v[100:101], v26 offset:0
  v_mfma_f32_16x16x32_bf16 a[132:135], v[116:119], v[156:159], a[132:135]
  ds_read_b64_tr_b16 v[102:103], v26 offset:512
  v_mfma_f32_16x16x32_bf16 a[136:139], v[116:119], v[160:163], a[136:139]
  v_mfma_f32_16x16x32_bf16 a[140:143], v[116:119], v[164:167], a[140:143]
  ds_read_b64_tr_b16 v[104:105], v26 offset:32
  v_mfma_f32_16x16x32_bf16 a[144:147], v[120:123], v[152:155], a[144:147]
  v_mfma_f32_16x16x32_bf16 a[148:151], v[120:123], v[156:159], a[148:151]
  ds_read_b64_tr_b16 v[106:107], v26 offset:544
  v_mfma_f32_16x16x32_bf16 a[152:155], v[120:123], v[160:163], a[152:155]
  ds_read_b64_tr_b16 v[108:109], v26 offset:64
  v_mfma_f32_16x16x32_bf16 a[156:159], v[120:123], v[164:167], a[156:159]
  v_mfma_f32_16x16x32_bf16 a[160:163], v[124:127], v[152:155], a[160:163]
  ds_read_b64_tr_b16 v[110:111], v26 offset:576
  v_mfma_f32_16x16x32_bf16 a[164:167], v[124:127], v[156:159], a[164:167]
  v_mfma_f32_16x16x32_bf16 a[168:171], v[124:127], v[160:163], a[168:171]
  ds_read_b64_tr_b16 v[112:113], v26 offset:96
  v_mfma_f32_16x16x32_bf16 a[172:175], v[124:127], v[164:167], a[172:175]
  ds_read_b64_tr_b16 v[114:115], v26 offset:608
  v_mfma_f32_16x16x32_bf16 a[176:179], v[128:131], v[152:155], a[176:179]
  v_mfma_f32_16x16x32_bf16 a[180:183], v[128:131], v[156:159], a[180:183]
  ds_read_b128 v[64:67], v29 offset:0
  v_mfma_f32_16x16x32_bf16 a[184:187], v[128:131], v[160:163], a[184:187]
  v_mfma_f32_16x16x32_bf16 a[188:191], v[128:131], v[164:167], a[188:191]
  ds_read_b128 v[68:71], v29 offset:1024
  v_mfma_f32_16x16x32_bf16 a[192:195], v[132:135], v[152:155], a[192:195]
  v_mfma_f32_16x16x32_bf16 a[196:199], v[132:135], v[156:159], a[196:199]
  ds_read_b128 v[72:75], v29 offset:2048
  v_mfma_f32_16x16x32_bf16 a[200:203], v[132:135], v[160:163], a[200:203]
  ds_read_b128 v[76:79], v29 offset:3072
  v_mfma_f32_16x16x32_bf16 a[204:207], v[132:135], v[164:167], a[204:207]
  v_mfma_f32_16x16x32_bf16 a[208:211], v[136:139], v[152:155], a[208:211]
  ds_read_b128 v[80:83], v29 offset:4096
  v_mfma_f32_16x16x32_bf16 a[212:215], v[136:139], v[156:159], a[212:215]
  v_mfma_f32_16x16x32_bf16 a[216:219], v[136:139], v[160:163], a[216:219]
  ds_read_b128 v[84:87], v29 offset:5120
  v_mfma_f32_16x16x32_bf16 a[220:223], v[136:139], v[164:167], a[220:223]
  ds_read_b128 v[88:91], v29 offset:6144
  v_mfma_f32_16x16x32_bf16 a[224:227], v[140:143], v[152:155], a[224:227]
  v_mfma_f32_16x16x32_bf16 a[228:231], v[140:143], v[156:159], a[228:231]
  ds_read_b128 v[92:95], v29 offset:7168
  v_mfma_f32_16x16x32_bf16 a[232:235], v[140:143], v[160:163], a[232:235]
  v_mfma_f32_16x16x32_bf16 a[236:239], v[140:143], v[164:167], a[236:239]
  ds_read_b128 v[96:99], v29 offset:8192
  v_mfma_f32_16x16x32_bf16 a[240:243], v[144:147], v[152:155], a[240:243]
  v_mfma_f32_16x16x32_bf16 a[244:247], v[144:147], v[156:159], a[244:247]
  v_mfma_f32_16x16x32_bf16 a[248:251], v[144:147], v[160:163], a[248:251]
  v_mfma_f32_16x16x32_bf16 a[252:255], v[144:147], v[164:167], a[252:255]
  v_mfma_f32_16x16x32_bf16 v[240:243], v[148:151], v[152:155], v[240:243]
  v_mfma_f32_16x16x32_bf16 v[244:247], v[148:151], v[156:159], v[244:247]
  v_mfma_f32_16x16x32_bf16 v[248:251], v[148:151], v[160:163], v[248:251]
  v_mfma_f32_16x16x32_bf16 v[252:255], v[148:151], v[164:167], v[252:255]
  s_waitcnt vmcnt(0) lgkmcnt(0)
  s_barrier
  v_mfma_f32_16x16x32_bf16 a[128:131], v[64:67], v[100:103], a[128:131]
  ds_read_b64_tr_b16 v[168:169], v26 offset:26112
  v_mfma_f32_16x16x32_bf16 a[132:135], v[64:67], v[104:107], a[132:135]
TP_24:
  s_cbranch_execz TP_26
  ds_read_b64_tr_b16 v[170:171], v26 offset:26624
  v_mfma_f32_16x16x32_bf16 a[136:139], v[64:67], v[108:111], a[136:139]
  ds_read_b64_tr_b16 v[172:173], v26 offset:26144
  v_mfma_f32_16x16x32_bf16 a[140:143], v[64:67], v[112:115], a[140:143]
  ds_read_b64_tr_b16 v[174:175], v26 offset:26656
  v_mfma_f32_16x16x32_bf16 a[144:147], v[68:71], v[100:103], a[144:147]
  ds_read_b64_tr_b16 v[176:177], v26 offset:26176
  v_mfma_f32_16x16x32_bf16 a[148:151], v[68:71], v[104:107], a[148:151]
  ds_read_b64_tr_b16 v[178:179], v26 offset:26688
  v_mfma_f32_16x16x32_bf16 a[152:155], v[68:71], v[108:111], a[152:155]
  ds_read_b64_tr_b16 v[180:181], v26 offset:26208
  v_mfma_f32_16x16x32_bf16 a[156:159], v[68:71], v[112:115], a[156:159]
  ds_read_b64_tr_b16 v[182:183], v26 offset:26720
  v_mfma_f32_16x16x32_bf16 a[160:163], v[72:75], v[100:103], a[160:163]
  ds_read_b64_tr_b16 v[184:185], v27 offset:0
  v_mfma_f32_16x16x32_bf16 a[164:167], v[72:75], v[104:107], a[164:167]
  ds_read_b64_tr_b16 v[186:187], v27 offset:512
  v_mfma_f32_16x16x32_bf16 a[168:171], v[72:75], v[108:111], a[168:171]
  ds_read_b64_tr_b16 v[188:189], v27 offset:32
  v_mfma_f32_16x16x32_bf16 a[172:175], v[72:75], v[112:115], a[172:175]
  ds_read_b64_tr_b16 v[190:191], v27 offset:544
  v_mfma_f32_16x16x32_bf16 a[176:179], v[76:79], v[100:103], a[176:179]
  ds_read_b64_tr_b16 v[192:193], v27 offset:64
  v_mfma_f32_16x16x32_bf16 a[180:183], v[76:79], v[104:107], a[180:183]
  ds_read_b64_tr_b16 v[194:195], v27 offset:576
  v_mfma_f32_16x16x32_bf16 a[184:187], v[76:79], v[108:111], a[184:187]
  v_mfma_f32_16x16x32_bf16 a[188:191], v[76:79], v[112:115], a[188:191]
  ds_read_b64_tr_b16 v[196:197], v27 offset:96
  v_mfma_f32_16x16x32_bf16 a[192:195], v[80:83], v[100:103], a[192:195]
  ds_read_b64_tr_b16 v[198:199], v27 offset:608
  v_mfma_f32_16x16x32_bf16 a[196:199], v[80:83], v[104:107], a[196:199]
  ds_read_b64_tr_b16 v[200:201], v27 offset:26112
  v_mfma_f32_16x16x32_bf16 a[200:203], v[80:83], v[108:111], a[200:203]
  ds_read_b64_tr_b16 v[202:203], v27 offset:26624
  v_mfma_f32_16x16x32_bf16 a[204:207], v[80:83], v[112:115], a[204:207]
  ds_read_b64_tr_b16 v[204:205], v27 offset:26144
  v_mfma_f32_16x16x32_bf16 a[208:211], v[84:87], v[100:103], a[208:211]
  ds_read_b64_tr_b16 v[206:207], v27 offset:26656
  v_mfma_f32_16x16x32_bf16 a[212:215], v[84:87], v[104:107], a[212:215]
  ds_read_b64_tr_b16 v[208:209], v27 offset:26176
  v_mfma_f32_16x16x32_bf16 a[216:219], v[84:87], v[108:111], a[216:219]
  ds_read_b64_tr_b16 v[210:211], v27 offset:26688
  v_mfma_f32_16x16x32_bf16 a[220:223], v[84:87], v[112:115], a[220:223]
  ds_read_b64_tr_b16 v[212:213], v27 offset:26208
  v_mfma_f32_16x16x32_bf16 a[224:227], v[88:91], v[100:103], a[224:227]
  ds_read_b64_tr_b16 v[214:215], v27 offset:26720
  v_mfma_f32_16x16x32_bf16 a[228:231], v[88:91], v[104:107], a[228:231]
  ds_read_b128 v[116:119], v29 offset:34304
  v_mfma_f32_16x16x32_bf16 a[232:235], v[88:91], v[108:111], a[232:235]
  ds_read_b128 v[120:123], v30 offset:8192
  v_mfma_f32_16x16x32_bf16 a[236:239], v[88:91], v[112:115], a[236:239]
  ds_read_b128 v[124:127], v30 offset:34304
  v_mfma_f32_16x16x32_bf16 a[240:243], v[92:95], v[100:103], a[240:243]
  v_mfma_f32_16x16x32_bf16 a[244:247], v[92:95], v[104:107], a[244:247]
  v_mfma_f32_16x16x32_bf16 a[248:251], v[92:95], v[108:111], a[248:251]
  v_mfma_f32_16x16x32_bf16 a[252:255], v[92:95], v[112:115], a[252:255]
  v_mfma_f32_16x16x32_bf16 v[240:243], v[96:99], v[100:103], v[240:243]
  v_mfma_f32_16x16x32_bf16 v[244:247], v[96:99], v[104:107], v[244:247]
  v_mfma_f32_16x16x32_bf16 v[248:251], v[96:99], v[108:111], v[248:251]
  v_mfma_f32_16x16x32_bf16 v[252:255], v[96:99], v[112:115], v[252:255]
  s_waitcnt lgkmcnt(0)
  v_mfma_f32_16x16x32_bf16 v[240:243], v[116:119], v[168:171], v[240:243]
  ds_read_b128 v[128:131], v29 offset:26112
  v_mfma_f32_16x16x32_bf16 v[244:247], v[116:119], v[172:175], v[244:247]
  v_mfma_f32_16x16x32_bf16 v[248:251], v[116:119], v[176:179], v[248:251]
  ds_read_b128 v[132:135], v30 offset:0
  v_mfma_f32_16x16x32_bf16 v[252:255], v[116:119], v[180:183], v[252:255]
  v_mfma_f32_16x16x32_bf16 v[240:243], v[120:123], v[184:187], v[240:243]
  ds_read_b128 v[136:139], v30 offset:26112
  v_mfma_f32_16x16x32_bf16 v[244:247], v[120:123], v[188:191], v[244:247]
  v_mfma_f32_16x16x32_bf16 v[248:251], v[120:123], v[192:195], v[248:251]
  v_mfma_f32_16x16x32_bf16 v[252:255], v[120:123], v[196:199], v[252:255]
  v_mfma_f32_16x16x32_bf16 v[240:243], v[124:127], v[200:203], v[240:243]
  v_mfma_f32_16x16x32_bf16 v[244:247], v[124:127], v[204:207], v[244:247]
  v_mfma_f32_16x16x32_bf16 v[248:251], v[124:127], v[208:211], v[248:251]
  v_mfma_f32_16x16x32_bf16 v[252:255], v[124:127], v[212:215], v[252:255]
  s_waitcnt lgkmcnt(0)
  v_mfma_f32_16x16x32_bf16 a[128:131], v[128:131], v[168:171], a[128:131]
  ds_read_b128 v[116:119], v29 offset:27136
  v_mfma_f32_16x16x32_bf16 a[132:135], v[128:131], v[172:175], a[132:135]
  v_mfma_f32_16x16x32_bf16 a[136:139], v[128:131], v[176:179], a[136:139]
  ds_read_b128 v[120:123], v30 offset:1024
  v_mfma_f32_16x16x32_bf16 a[140:143], v[128:131], v[180:183], a[140:143]
  v_cvt_pk_bf16_f32 v72, v240, v241
  v_cvt_pk_bf16_f32 v73, v242, v243
  v_cvt_pk_bf16_f32 v74, v244, v245
  v_mfma_f32_16x16x32_bf16 a[128:131], v[132:135], v[184:187], a[128:131]
  ds_read_b128 v[124:127], v30 offset:27136
  v_cvt_pk_bf16_f32 v75, v246, v247
  v_mfma_f32_16x16x32_bf16 a[132:135], v[132:135], v[188:191], a[132:135]
  buffer_store_dwordx4 v[72:75], v46, s[12:15], s92 offen offset:0 sc1
  v_mfma_f32_16x16x32_bf16 a[136:139], v[132:135], v[192:195], a[136:139]
  v_cvt_pk_bf16_f32 v84, v248, v249
  v_cvt_pk_bf16_f32 v85, v250, v251
  v_cvt_pk_bf16_f32 v86, v252, v253
  v_mfma_f32_16x16x32_bf16 a[140:143], v[132:135], v[196:199], a[140:143]
  v_cvt_pk_bf16_f32 v87, v254, v255
  v_mfma_f32_16x16x32_bf16 a[128:131], v[136:139], v[200:203], a[128:131]
  buffer_store_dwordx4 v[84:87], v46, s[12:15], s93 offen offset:0 sc1
  v_mfma_f32_16x16x32_bf16 a[132:135], v[136:139], v[204:207], a[132:135]
  v_mfma_f32_16x16x32_bf16 a[136:139], v[136:139], v[208:211], a[136:139]
  v_mfma_f32_16x16x32_bf16 a[140:143], v[136:139], v[212:215], a[140:143]
  s_waitcnt lgkmcnt(0)
  v_mfma_f32_16x16x32_bf16 a[144:147], v[116:119], v[168:171], a[144:147]
  ds_read_b128 v[128:131], v29 offset:28160
  v_mfma_f32_16x16x32_bf16 a[148:151], v[116:119], v[172:175], a[148:151]
  v_mfma_f32_16x16x32_bf16 a[152:155], v[116:119], v[176:179], a[152:155]
  ds_read_b128 v[132:135], v30 offset:2048
  v_mfma_f32_16x16x32_bf16 a[156:159], v[116:119], v[180:183], a[156:159]
  v_mfma_f32_16x16x32_bf16 a[144:147], v[120:123], v[184:187], a[144:147]
  ds_read_b128 v[136:139], v30 offset:28160
  v_mfma_f32_16x16x32_bf16 a[148:151], v[120:123], v[188:191], a[148:151]
  v_mfma_f32_16x16x32_bf16 a[152:155], v[120:123], v[192:195], a[152:155]
  v_mfma_f32_16x16x32_bf16 a[156:159], v[120:123], v[196:199], a[156:159]
  v_mfma_f32_16x16x32_bf16 a[144:147], v[124:127], v[200:203], a[144:147]
  v_mfma_f32_16x16x32_bf16 a[148:151], v[124:127], v[204:207], a[148:151]
  v_mfma_f32_16x16x32_bf16 a[152:155], v[124:127], v[208:211], a[152:155]
  v_mfma_f32_16x16x32_bf16 a[156:159], v[124:127], v[212:215], a[156:159]
  s_waitcnt lgkmcnt(0)
  v_mfma_f32_16x16x32_bf16 a[160:163], v[128:131], v[168:171], a[160:163]
  ds_read_b128 v[116:119], v29 offset:29184
  v_mfma_f32_16x16x32_bf16 a[164:167], v[128:131], v[172:175], a[164:167]
  v_mfma_f32_16x16x32_bf16 a[168:171], v[128:131], v[176:179], a[168:171]
  ds_read_b128 v[120:123], v30 offset:3072
  v_mfma_f32_16x16x32_bf16 a[172:175], v[128:131], v[180:183], a[172:175]
  v_accvgpr_read_b32 v88, a128
  v_accvgpr_read_b32 v89, a129
  v_accvgpr_read_b32 v90, a130
  v_mfma_f32_16x16x32_bf16 a[160:163], v[132:135], v[184:187], a[160:163]
  ds_read_b128 v[124:127], v30 offset:29184
  v_accvgpr_read_b32 v91, a131
  v_accvgpr_read_b32 v92, a144
  v_mfma_f32_16x16x32_bf16 a[164:167], v[132:135], v[188:191], a[164:167]
  v_accvgpr_read_b32 v93, a145
  v_accvgpr_read_b32 v94, a146
  v_accvgpr_read_b32 v95, a147
  v_mfma_f32_16x16x32_bf16 a[168:171], v[132:135], v[192:195], a[168:171]
  v_cvt_pk_bf16_f32 v96, v88, v89
  v_cvt_pk_bf16_f32 v97, v90, v91
  v_cvt_pk_bf16_f32 v98, v92, v93
  v_mfma_f32_16x16x32_bf16 a[172:175], v[132:135], v[196:199], a[172:175]
  v_cvt_pk_bf16_f32 v99, v94, v95
  v_mfma_f32_16x16x32_bf16 a[160:163], v[136:139], v[200:203], a[160:163]
  buffer_store_dwordx4 v[96:99], v44, s[12:15], s92 offen offset:0 sc1
  v_mfma_f32_16x16x32_bf16 a[164:167], v[136:139], v[204:207], a[164:167]
  v_accvgpr_read_b32 v100, a132
  v_accvgpr_read_b32 v101, a133
  v_accvgpr_read_b32 v102, a134
  v_mfma_f32_16x16x32_bf16 a[168:171], v[136:139], v[208:211], a[168:171]
  v_accvgpr_read_b32 v103, a135
  v_accvgpr_read_b32 v104, a148
  v_accvgpr_read_b32 v105, a149
  v_mfma_f32_16x16x32_bf16 a[172:175], v[136:139], v[212:215], a[172:175]
  s_waitcnt lgkmcnt(0)
  v_accvgpr_read_b32 v106, a150
  v_accvgpr_read_b32 v107, a151
  v_cvt_pk_bf16_f32 v108, v100, v101
  v_mfma_f32_16x16x32_bf16 a[176:179], v[116:119], v[168:171], a[176:179]
  ds_read_b128 v[128:131], v29 offset:30208
  v_cvt_pk_bf16_f32 v109, v102, v103
  v_cvt_pk_bf16_f32 v110, v104, v105
  v_mfma_f32_16x16x32_bf16 a[180:183], v[116:119], v[172:175], a[180:183]
  v_cvt_pk_bf16_f32 v111, v106, v107
  v_mfma_f32_16x16x32_bf16 a[184:187], v[116:119], v[176:179], a[184:187]
  ds_read_b128 v[132:135], v30 offset:4096
  buffer_store_dwordx4 v[108:111], v44, s[12:15], s92 offen offset:1024 sc1
  v_mfma_f32_16x16x32_bf16 a[188:191], v[116:119], v[180:183], a[188:191]
  v_accvgpr_read_b32 v64, a136
  v_accvgpr_read_b32 v65, a137
  v_accvgpr_read_b32 v66, a138
  v_mfma_f32_16x16x32_bf16 a[176:179], v[120:123], v[184:187], a[176:179]
  ds_read_b128 v[136:139], v30 offset:30208
  v_accvgpr_read_b32 v67, a139
  v_accvgpr_read_b32 v68, a152
  v_mfma_f32_16x16x32_bf16 a[180:183], v[120:123], v[188:191], a[180:183]
  v_accvgpr_read_b32 v69, a153
  v_accvgpr_read_b32 v70, a154
  v_accvgpr_read_b32 v71, a155
  v_mfma_f32_16x16x32_bf16 a[184:187], v[120:123], v[192:195], a[184:187]
  v_cvt_pk_bf16_f32 v72, v64, v65
  v_cvt_pk_bf16_f32 v73, v66, v67
  v_cvt_pk_bf16_f32 v74, v68, v69
  v_mfma_f32_16x16x32_bf16 a[188:191], v[120:123], v[196:199], a[188:191]
  v_cvt_pk_bf16_f32 v75, v70, v71
  v_mfma_f32_16x16x32_bf16 a[176:179], v[124:127], v[200:203], a[176:179]
  buffer_store_dwordx4 v[72:75], v44, s[12:15], s93 offen offset:0 sc1
  v_mfma_f32_16x16x32_bf16 a[180:183], v[124:127], v[204:207], a[180:183]
  v_accvgpr_read_b32 v76, a140
  v_accvgpr_read_b32 v77, a141
  v_accvgpr_read_b32 v78, a142
  v_mfma_f32_16x16x32_bf16 a[184:187], v[124:127], v[208:211], a[184:187]
  v_accvgpr_read_b32 v79, a143
  v_accvgpr_read_b32 v80, a156
  v_accvgpr_read_b32 v81, a157
  v_mfma_f32_16x16x32_bf16 a[188:191], v[124:127], v[212:215], a[188:191]
  s_waitcnt lgkmcnt(0)
  v_accvgpr_read_b32 v82, a158
  v_accvgpr_read_b32 v83, a159
  v_cvt_pk_bf16_f32 v84, v76, v77
  v_mfma_f32_16x16x32_bf16 a[192:195], v[128:131], v[168:171], a[192:195]
  ds_read_b128 v[116:119], v29 offset:31232
  v_cvt_pk_bf16_f32 v85, v78, v79
  v_cvt_pk_bf16_f32 v86, v80, v81
  v_mfma_f32_16x16x32_bf16 a[196:199], v[128:131], v[172:175], a[196:199]
  v_cvt_pk_bf16_f32 v87, v82, v83
  v_mfma_f32_16x16x32_bf16 a[200:203], v[128:131], v[176:179], a[200:203]
  ds_read_b128 v[120:123], v30 offset:5120
  buffer_store_dwordx4 v[84:87], v44, s[12:15], s93 offen offset:1024 sc1
  v_mfma_f32_16x16x32_bf16 a[204:207], v[128:131], v[180:183], a[204:207]
  v_accvgpr_read_b32 v88, a160
  v_accvgpr_read_b32 v89, a161
  v_accvgpr_read_b32 v90, a162
  v_mfma_f32_16x16x32_bf16 a[192:195], v[132:135], v[184:187], a[192:195]
  ds_read_b128 v[124:127], v30 offset:31232
  v_accvgpr_read_b32 v91, a163
  v_accvgpr_read_b32 v92, a176
  v_mfma_f32_16x16x32_bf16 a[196:199], v[132:135], v[188:191], a[196:199]
  v_accvgpr_read_b32 v93, a177
  v_accvgpr_read_b32 v94, a178
  v_accvgpr_read_b32 v95, a179
  v_mfma_f32_16x16x32_bf16 a[200:203], v[132:135], v[192:195], a[200:203]
  v_cvt_pk_bf16_f32 v96, v88, v89
  v_cvt_pk_bf16_f32 v97, v90, v91
  v_cvt_pk_bf16_f32 v98, v92, v93
  v_mfma_f32_16x16x32_bf16 a[204:207], v[132:135], v[196:199], a[204:207]
  v_cvt_pk_bf16_f32 v99, v94, v95
  v_mfma_f32_16x16x32_bf16 a[192:195], v[136:139], v[200:203], a[192:195]
  buffer_store_dwordx4 v[96:99], v44, s[12:15], s92 offen offset:2048 sc1
  v_mfma_f32_16x16x32_bf16 a[196:199], v[136:139], v[204:207], a[196:199]
  v_accvgpr_read_b32 v100, a164
  v_accvgpr_read_b32 v101, a165
  v_accvgpr_read_b32 v102, a166
  v_mfma_f32_16x16x32_bf16 a[200:203], v[136:139], v[208:211], a[200:203]
  v_accvgpr_read_b32 v103, a167
  v_accvgpr_read_b32 v104, a180
  v_accvgpr_read_b32 v105, a181
  v_mfma_f32_16x16x32_bf16 a[204:207], v[136:139], v[212:215], a[204:207]
  s_waitcnt lgkmcnt(0)
  v_accvgpr_read_b32 v106, a182
  v_accvgpr_read_b32 v107, a183
  v_cvt_pk_bf16_f32 v108, v100, v101
  v_mfma_f32_16x16x32_bf16 a[208:211], v[116:119], v[168:171], a[208:211]
  ds_read_b128 v[128:131], v29 offset:32256
  v_cvt_pk_bf16_f32 v109, v102, v103
  v_cvt_pk_bf16_f32 v110, v104, v105
  v_mfma_f32_16x16x32_bf16 a[212:215], v[116:119], v[172:175], a[212:215]
  v_cvt_pk_bf16_f32 v111, v106, v107
  v_mfma_f32_16x16x32_bf16 a[216:219], v[116:119], v[176:179], a[216:219]
  ds_read_b128 v[132:135], v30 offset:6144
  buffer_store_dwordx4 v[108:111], v44, s[12:15], s92 offen offset:3072 sc1
  v_mfma_f32_16x16x32_bf16 a[220:223], v[116:119], v[180:183], a[220:223]
  ds_read_b128 v[116:119], v29 offset:33280
  v_accvgpr_read_b32 v64, a168
  v_accvgpr_read_b32 v65, a169
  v_mfma_f32_16x16x32_bf16 a[208:211], v[120:123], v[184:187], a[208:211]
  ds_read_b128 v[136:139], v30 offset:32256
  v_accvgpr_read_b32 v66, a170
  v_accvgpr_read_b32 v67, a171
  v_mfma_f32_16x16x32_bf16 a[212:215], v[120:123], v[188:191], a[212:215]
  v_accvgpr_read_b32 v68, a184
  v_accvgpr_read_b32 v69, a185
  v_accvgpr_read_b32 v70, a186
  v_mfma_f32_16x16x32_bf16 a[216:219], v[120:123], v[192:195], a[216:219]
  v_accvgpr_read_b32 v71, a187
  v_cvt_pk_bf16_f32 v72, v64, v65
  v_cvt_pk_bf16_f32 v73, v66, v67
  v_mfma_f32_16x16x32_bf16 a[220:223], v[120:123], v[196:199], a[220:223]
  ds_read_b128 v[120:123], v30 offset:7168
  v_cvt_pk_bf16_f32 v74, v68, v69
  v_cvt_pk_bf16_f32 v75, v70, v71
  v_mfma_f32_16x16x32_bf16 a[208:211], v[124:127], v[200:203], a[208:211]
  buffer_store_dwordx4 v[72:75], v44, s[12:15], s93 offen offset:2048 sc1
  v_mfma_f32_16x16x32_bf16 a[212:215], v[124:127], v[204:207], a[212:215]
  v_accvgpr_read_b32 v76, a172
  v_accvgpr_read_b32 v77, a173
  v_accvgpr_read_b32 v78, a174
  v_mfma_f32_16x16x32_bf16 a[216:219], v[124:127], v[208:211], a[216:219]
  v_accvgpr_read_b32 v79, a175
  v_accvgpr_read_b32 v80, a188
  v_accvgpr_read_b32 v81, a189
  v_mfma_f32_16x16x32_bf16 a[220:223], v[124:127], v[212:215], a[220:223]
  s_waitcnt lgkmcnt(1)
  ds_read_b128 v[124:127], v30 offset:33280
  v_accvgpr_read_b32 v82, a190
  v_accvgpr_read_b32 v83, a191
  v_mfma_f32_16x16x32_bf16 a[224:227], v[128:131], v[168:171], a[224:227]
  v_cvt_pk_bf16_f32 v84, v76, v77
  v_cvt_pk_bf16_f32 v85, v78, v79
  v_cvt_pk_bf16_f32 v86, v80, v81
  v_mfma_f32_16x16x32_bf16 a[224:227], v[132:135], v[184:187], a[224:227]
  v_cvt_pk_bf16_f32 v87, v82, v83
  v_mfma_f32_16x16x32_bf16 a[224:227], v[136:139], v[200:203], a[224:227]
  s_waitcnt lgkmcnt(0)
  buffer_store_dwordx4 v[84:87], v44, s[12:15], s93 offen offset:3072 sc1
  v_mfma_f32_16x16x32_bf16 a[240:243], v[116:119], v[168:171], a[240:243]
  v_accvgpr_read_b32 v88, a192
  v_accvgpr_read_b32 v89, a193
  v_accvgpr_read_b32 v90, a194
  v_mfma_f32_16x16x32_bf16 a[240:243], v[120:123], v[184:187], a[240:243]
  v_accvgpr_read_b32 v91, a195
  v_accvgpr_read_b32 v92, a208
  v_accvgpr_read_b32 v93, a209
  v_mfma_f32_16x16x32_bf16 a[240:243], v[124:127], v[200:203], a[240:243]
  v_accvgpr_read_b32 v94, a210
  v_accvgpr_read_b32 v95, a211
  v_cvt_pk_bf16_f32 v96, v88, v89
  v_mfma_f32_16x16x32_bf16 a[228:231], v[128:131], v[172:175], a[228:231]
  v_cvt_pk_bf16_f32 v97, v90, v91
  v_cvt_pk_bf16_f32 v98, v92, v93
  v_cvt_pk_bf16_f32 v99, v94, v95
  v_mfma_f32_16x16x32_bf16 a[228:231], v[132:135], v[188:191], a[228:231]
  buffer_store_dwordx4 v[96:99], v45, s[12:15], s92 offen offset:0 sc1
  v_mfma_f32_16x16x32_bf16 a[228:231], v[136:139], v[204:207], a[228:231]
  v_accvgpr_read_b32 v100, a196
  v_accvgpr_read_b32 v101, a197
  v_accvgpr_read_b32 v102, a198
  v_mfma_f32_16x16x32_bf16 a[244:247], v[116:119], v[172:175], a[244:247]
  v_accvgpr_read_b32 v103, a199
  v_accvgpr_read_b32 v104, a212
  v_accvgpr_read_b32 v105, a213
  v_mfma_f32_16x16x32_bf16 a[244:247], v[120:123], v[188:191], a[244:247]
  v_accvgpr_read_b32 v106, a214
  v_accvgpr_read_b32 v107, a215
  v_cvt_pk_bf16_f32 v108, v100, v101
  v_mfma_f32_16x16x32_bf16 a[244:247], v[124:127], v[204:207], a[244:247]
  v_cvt_pk_bf16_f32 v109, v102, v103
  v_cvt_pk_bf16_f32 v110, v104, v105
  v_cvt_pk_bf16_f32 v111, v106, v107
  v_mfma_f32_16x16x32_bf16 a[232:235], v[128:131], v[176:179], a[232:235]
  buffer_store_dwordx4 v[108:111], v45, s[12:15], s92 offen offset:1024 sc1
  v_mfma_f32_16x16x32_bf16 a[232:235], v[132:135], v[192:195], a[232:235]
  v_accvgpr_read_b32 v64, a200
  v_accvgpr_read_b32 v65, a201
  v_accvgpr_read_b32 v66, a202
  v_mfma_f32_16x16x32_bf16 a[232:235], v[136:139], v[208:211], a[232:235]
  v_accvgpr_read_b32 v67, a203
  v_accvgpr_read_b32 v68, a216
  v_accvgpr_read_b32 v69, a217
  v_mfma_f32_16x16x32_bf16 a[248:251], v[116:119], v[176:179], a[248:251]
  v_accvgpr_read_b32 v70, a218
  v_accvgpr_read_b32 v71, a219
  v_cvt_pk_bf16_f32 v72, v64, v65
  v_mfma_f32_16x16x32_bf16 a[248:251], v[120:123], v[192:195], a[248:251]
  v_cvt_pk_bf16_f32 v73, v66, v67
  v_cvt_pk_bf16_f32 v74, v68, v69
  v_cvt_pk_bf16_f32 v75, v70, v71
  v_mfma_f32_16x16x32_bf16 a[248:251], v[124:127], v[208:211], a[248:251]
  buffer_store_dwordx4 v[72:75], v45, s[12:15], s93 offen offset:0 sc1
  v_mfma_f32_16x16x32_bf16 a[236:239], v[128:131], v[180:183], a[236:239]
  v_accvgpr_read_b32 v76, a204
  v_accvgpr_read_b32 v77, a205
  v_accvgpr_read_b32 v78, a206
  v_mfma_f32_16x16x32_bf16 a[236:239], v[132:135], v[196:199], a[236:239]
  v_accvgpr_read_b32 v79, a207
  v_accvgpr_read_b32 v80, a220
  v_accvgpr_read_b32 v81, a221
  v_mfma_f32_16x16x32_bf16 a[236:239], v[136:139], v[212:215], a[236:239]
  v_accvgpr_read_b32 v82, a222
  v_accvgpr_read_b32 v83, a223
  v_cvt_pk_bf16_f32 v84, v76, v77
  v_mfma_f32_16x16x32_bf16 a[252:255], v[116:119], v[180:183], a[252:255]
  v_cvt_pk_bf16_f32 v85, v78, v79
  v_cvt_pk_bf16_f32 v86, v80, v81
  v_cvt_pk_bf16_f32 v87, v82, v83
  v_mfma_f32_16x16x32_bf16 a[252:255], v[120:123], v[196:199], a[252:255]
  buffer_store_dwordx4 v[84:87], v45, s[12:15], s93 offen offset:1024 sc1
  v_mfma_f32_16x16x32_bf16 a[252:255], v[124:127], v[212:215], a[252:255]
  v_accvgpr_read_b32 v88, a224
  v_accvgpr_read_b32 v89, a225
  v_accvgpr_read_b32 v90, a226
  s_nop 7
  v_accvgpr_read_b32 v91, a227
  v_accvgpr_read_b32 v92, a240
  v_accvgpr_read_b32 v93, a241
  v_accvgpr_read_b32 v94, a242
  v_accvgpr_read_b32 v95, a243
  v_cvt_pk_bf16_f32 v96, v88, v89
  v_cvt_pk_bf16_f32 v97, v90, v91
  v_cvt_pk_bf16_f32 v98, v92, v93
  v_cvt_pk_bf16_f32 v99, v94, v95
  buffer_store_dwordx4 v[96:99], v45, s[12:15], s92 offen offset:2048 sc1
  v_accvgpr_read_b32 v100, a228
  v_accvgpr_read_b32 v101, a229
  v_accvgpr_read_b32 v102, a230
  v_accvgpr_read_b32 v103, a231
  v_accvgpr_read_b32 v104, a244
  v_accvgpr_read_b32 v105, a245
  v_accvgpr_read_b32 v106, a246
  v_accvgpr_read_b32 v107, a247
  v_cvt_pk_bf16_f32 v108, v100, v101
  v_cvt_pk_bf16_f32 v109, v102, v103
  v_cvt_pk_bf16_f32 v110, v104, v105
  v_cvt_pk_bf16_f32 v111, v106, v107
  buffer_store_dwordx4 v[108:111], v45, s[12:15], s92 offen offset:3072 sc1
  v_accvgpr_read_b32 v64, a232
  v_accvgpr_read_b32 v65, a233
  v_accvgpr_read_b32 v66, a234
  v_accvgpr_read_b32 v67, a235
  v_accvgpr_read_b32 v68, a248
  v_accvgpr_read_b32 v69, a249
  v_accvgpr_read_b32 v70, a250
  v_accvgpr_read_b32 v71, a251
  v_cvt_pk_bf16_f32 v72, v64, v65
  v_cvt_pk_bf16_f32 v73, v66, v67
  v_cvt_pk_bf16_f32 v74, v68, v69
  v_cvt_pk_bf16_f32 v75, v70, v71
  buffer_store_dwordx4 v[72:75], v45, s[12:15], s93 offen offset:2048 sc1
  v_accvgpr_read_b32 v76, a236
  v_accvgpr_read_b32 v77, a237
  v_accvgpr_read_b32 v78, a238
  v_accvgpr_read_b32 v79, a239
  v_accvgpr_read_b32 v80, a252
  v_accvgpr_read_b32 v81, a253
  v_accvgpr_read_b32 v82, a254
  v_accvgpr_read_b32 v83, a255
  v_cvt_pk_bf16_f32 v84, v76, v77
  v_cvt_pk_bf16_f32 v85, v78, v79
  v_cvt_pk_bf16_f32 v86, v80, v81
  v_cvt_pk_bf16_f32 v87, v82, v83
  buffer_store_dwordx4 v[84:87], v45, s[12:15], s93 offen offset:3072 sc1
K_tail:
TP_25:
  s_cbranch_execz TR_3
  buffer_load_dword v144, v10, s[20:23], s57 offen offset:0
  buffer_load_dword v145, v11, s[20:23], s57 offen offset:0
  buffer_load_dword v146, v10, s[20:23], s57 offen offset:64
  buffer_load_dword v147, v11, s[20:23], s57 offen offset:64
  buffer_load_dword v148, v10, s[20:23], s57 offen offset:128
  buffer_load_dword v149, v11, s[20:23], s57 offen offset:128
  buffer_load_dword v150, v10, s[20:23], s57 offen offset:192
  buffer_load_dword v151, v11, s[20:23], s57 offen offset:192
  buffer_load_dword v152, v14, s[20:23], s57 offen offset:256
  global_load_ushort v20, v19, s[46:47]
  global_load_ushort v21, v19, s[46:47] offset:32
  v_add_u32 v5, 4096, v15
  v_add_u32 v6, 8192, v15
  v_mov_b32 v4, v15
  s_mov_b32 s62, 0x00003f80
  s_mov_b32 s63, 0x3f800000
  v_mov_b32 v24, 0xbfb8aa3b
  v_mov_b32 v25, 1.0
  s_waitcnt vmcnt(11)
  s_barrier
  buffer_store_dword v9, v8, s[12:15], s94 offen sc1
  s_waitcnt vmcnt(1)
  v_lshlrev_b32 v20, 16, v20
  v_lshlrev_b32 v21, 16, v21
  v_and_b32 v7, 2, v0
  v_cmp_eq_u32 vcc, 0, v7
  v_lshlrev_b32 v84, 16, v144
  v_and_b32 v85, 0xffff0000, v144
  v_lshlrev_b32 v86, 16, v145
  v_and_b32 v87, 0xffff0000, v145
  v_lshlrev_b32 v88, 16, v146
  v_and_b32 v89, 0xffff0000, v146
  v_lshlrev_b32 v90, 16, v147
  v_and_b32 v91, 0xffff0000, v147
  v_lshlrev_b32 v92, 16, v148
  v_and_b32 v93, 0xffff0000, v148
  v_lshlrev_b32 v94, 16, v149
  v_and_b32 v95, 0xffff0000, v149
  v_lshlrev_b32 v96, 16, v150
  v_and_b32 v97, 0xffff0000, v150
  v_lshlrev_b32 v98, 16, v151
  v_and_b32 v99, 0xffff0000, v151
  v_lshlrev_b32 v100, 16, v152
  v_and_b32 v101, 0xffff0000, v152
  v_cndmask_b32 v22, v21, v20, vcc
  s_cmp_lg_u32 s18, 0
  s_cbranch_scc1 W0_P
  buffer_load_dword v31, v47, s[12:15], s59 offen sc1
  s_waitcnt vmcnt(0)
  v_cmp_gt_u32 s[6:7], 1, v31
  s_cmp_lg_u64 s[6:7], 0
  s_cbranch_scc1 SP_pP1
RT_pP1:
W0_P:
  s_barrier
  buffer_load_dword v160, v4, s[12:15], s58 offen offset:0 sc1
  buffer_load_dword v161, v4, s[12:15], s58 offen offset:1024 sc1
  buffer_load_dword v162, v4, s[12:15], s58 offen offset:2048 sc1
  buffer_load_dword v163, v4, s[12:15], s58 offen offset:3072 sc1
  buffer_load_dword v164, v5, s[12:15], s58 offen offset:0 sc1
  buffer_load_dword v165, v5, s[12:15], s58 offen offset:1024 sc1
  buffer_load_dword v166, v5, s[12:15], s58 offen offset:2048 sc1
  buffer_load_dword v167, v5, s[12:15], s58 offen offset:3072 sc1
  buffer_load_dword v168, v6, s[12:15], s58 offen offset:0 sc1
  s_add_u32 s58, s58, 9216
  buffer_load_dword v169, v4, s[12:15], s58 offen offset:0 sc1
  buffer_load_dword v170, v4, s[12:15], s58 offen offset:1024 sc1
  buffer_load_dword v171, v4, s[12:15], s58 offen offset:2048 sc1
  buffer_load_dword v172, v4, s[12:15], s58 offen offset:3072 sc1
  buffer_load_dword v173, v5, s[12:15], s58 offen offset:0 sc1
  buffer_load_dword v174, v5, s[12:15], s58 offen offset:1024 sc1
  buffer_load_dword v175, v5, s[12:15], s58 offen offset:2048 sc1
  buffer_load_dword v176, v5, s[12:15], s58 offen offset:3072 sc1
  buffer_load_dword v177, v6, s[12:15], s58 offen offset:0 sc1
  s_add_u32 s58, s58, 9216
  buffer_load_dword v178, v4, s[12:15], s58 offen offset:0 sc1
  buffer_load_dword v179, v4, s[12:15], s58 offen offset:1024 sc1
  buffer_load_dword v180, v4, s[12:15], s58 offen offset:2048 sc1
  buffer_load_dword v181, v4, s[12:15], s58 offen offset:3072 sc1
  buffer_load_dword v182, v5, s[12:15], s58 offen offset:0 sc1
  buffer_load_dword v183, v5, s[12:15], s58 offen offset:1024 sc1
  buffer_load_dword v184, v5, s[12:15], s58 offen offset:2048 sc1
  buffer_load_dword v185, v5, s[12:15], s58 offen offset:3072 sc1
  buffer_load_dword v186, v6, s[12:15], s58 offen offset:0 sc1
  s_add_u32 s58, s58, 9216
  buffer_load_dword v187, v4, s[12:15], s58 offen offset:0 sc1
  buffer_load_dword v188, v4, s[12:15], s58 offen offset:1024 sc1
  buffer_load_dword v189, v4, s[12:15], s58 offen offset:2048 sc1
  buffer_load_dword v190, v4, s[12:15], s58 offen offset:3072 sc1
  buffer_load_dword v191, v5, s[12:15], s58 offen offset:0 sc1
  buffer_load_dword v192, v5, s[12:15], s58 offen offset:1024 sc1
  buffer_load_dword v193, v5, s[12:15], s58 offen offset:2048 sc1
  buffer_load_dword v194, v5, s[12:15], s58 offen offset:3072 sc1
  buffer_load_dword v195, v6, s[12:15], s58 offen offset:0 sc1
  s_add_u32 s58, s58, 9216
  buffer_load_dword v196, v4, s[12:15], s58 offen offset:0 sc1
  buffer_load_dword v197, v4, s[12:15], s58 offen offset:1024 sc1
  buffer_load_dword v198, v4, s[12:15], s58 offen offset:2048 sc1
  buffer_load_dword v199, v4, s[12:15], s58 offen offset:3072 sc1
  buffer_load_dword v200, v5, s[12:15], s58 offen offset:0 sc1
  buffer_load_dword v201, v5, s[12:15], s58 offen offset:1024 sc1
  buffer_load_dword v202, v5, s[12:15], s58 offen offset:2048 sc1
  buffer_load_dword v203, v5, s[12:15], s58 offen offset:3072 sc1
  buffer_load_dword v204, v6, s[12:15], s58 offen offset:0 sc1
  s_add_u32 s58, s58, 9216
  buffer_load_dword v205, v4, s[12:15], s58 offen offset:0 sc1
  buffer_load_dword v206, v4, s[12:15], s58 offen offset:1024 sc1
  buffer_load_dword v207, v4, s[12:15], s58 offen offset:2048 sc1
  buffer_load_dword v208, v4, s[12:15], s58 offen offset:3072 sc1
  buffer_load_dword v209, v5, s[12:15], s58 offen offset:0 sc1
  buffer_load_dword v210, v5, s[12:15], s58 offen offset:1024 sc1
  buffer_load_dword v211, v5, s[12:15], s58 offen offset:2048 sc1
  buffer_load_dword v212, v5, s[12:15], s58 offen offset:3072 sc1
  buffer_load_dword v213, v6, s[12:15], s58 offen offset:0 sc1
  s_add_u32 s58, s58, 9216
TP_26:
  s_cbranch_execz TR_3
  buffer_load_dword v214, v4, s[12:15], s58 offen offset:0 sc1
  buffer_load_dword v215, v4, s[12:15], s58 offen offset:1024 sc1
  buffer_load_dword v216, v4, s[12:15], s58 offen offset:2048 sc1
  buffer_load_dword v217, v4, s[12:15], s58 offen offset:3072 sc1
  buffer_load_dword v218, v5, s[12:15], s58 offen offset:0 sc1
  buffer_load_dword v219, v5, s[12:15], s58 offen offset:1024 sc1
  buffer_load_dword v220, v5, s[12:15], s58 offen offset:2048 sc1
  buffer_load_dword v221, v5, s[12:15], s58 offen offset:3072 sc1
  buffer_load_dword v222, v6, s[12:15], s58 offen offset:0 sc1
  s_add_u32 s58, s58, 9216
  s_waitcnt vmcnt(54)
  buffer_load_dword v223, v4, s[12:15], s58 offen offset:0 sc1
  buffer_load_dword v224, v4, s[12:15], s58 offen offset:1024 sc1
  buffer_load_dword v225, v4, s[12:15], s58 offen offset:2048 sc1
  buffer_load_dword v226, v4, s[12:15], s58 offen offset:3072 sc1
  buffer_load_dword v227, v5, s[12:15], s58 offen offset:0 sc1
  buffer_load_dword v228, v5, s[12:15], s58 offen offset:1024 sc1
  buffer_load_dword v229, v5, s[12:15], s58 offen offset:2048 sc1
  buffer_load_dword v230, v5, s[12:15], s58 offen offset:3072 sc1
  buffer_load_dword v231, v6, s[12:15], s58 offen offset:0 sc1
  s_add_u32 s58, s58, 9216
  v_dot2_f32_bf16 v104, v160, s62, 0
  v_dot2_f32_bf16 v105, v160, s63, 0
  v_dot2_f32_bf16 v106, v161, s62, 0
  v_dot2_f32_bf16 v107, v161, s63, 0
  v_dot2_f32_bf16 v108, v162, s62, 0
  v_dot2_f32_bf16 v109, v162, s63, 0
  v_dot2_f32_bf16 v110, v163, s62, 0
  v_dot2_f32_bf16 v111, v163, s63, 0
  v_dot2_f32_bf16 v112, v164, s62, 0
  v_dot2_f32_bf16 v113, v164, s63, 0
  v_dot2_f32_bf16 v114, v165, s62, 0
  v_dot2_f32_bf16 v115, v165, s63, 0
  v_dot2_f32_bf16 v116, v166, s62, 0
  v_dot2_f32_bf16 v117, v166, s63, 0
  v_dot2_f32_bf16 v118, v167, s62, 0
  v_dot2_f32_bf16 v119, v167, s63, 0
  v_dot2_f32_bf16 v120, v168, s62, 0
  v_dot2_f32_bf16 v121, v168, s63, 0
  s_waitcnt vmcnt(54)
  v_dot2_f32_bf16 v104, v169, s62, v104
  v_dot2_f32_bf16 v105, v169, s63, v105
  v_dot2_f32_bf16 v106, v170, s62, v106
  v_dot2_f32_bf16 v107, v170, s63, v107
  v_dot2_f32_bf16 v108, v171, s62, v108
  v_dot2_f32_bf16 v109, v171, s63, v109
  v_dot2_f32_bf16 v110, v172, s62, v110
  v_dot2_f32_bf16 v111, v172, s63, v111
  v_dot2_f32_bf16 v112, v173, s62, v112
  v_dot2_f32_bf16 v113, v173, s63, v113
  v_dot2_f32_bf16 v114, v174, s62, v114
  v_dot2_f32_bf16 v115, v174, s63, v115
  v_dot2_f32_bf16 v116, v175, s62, v116
  v_dot2_f32_bf16 v117, v175, s63, v117
  v_dot2_f32_bf16 v118, v176, s62, v118
  v_dot2_f32_bf16 v119, v176, s63, v119
  v_dot2_f32_bf16 v120, v177, s62, v120
  v_dot2_f32_bf16 v121, v177, s63, v121
  s_waitcnt vmcnt(45)
  v_dot2_f32_bf16 v104, v178, s62, v104
  v_dot2_f32_bf16 v105, v178, s63, v105
  v_dot2_f32_bf16 v106, v179, s62, v106
  v_dot2_f32_bf16 v107, v179, s63, v107
  v_dot2_f32_bf16 v108, v180, s62, v108
  v_dot2_f32_bf16 v109, v180, s63, v109
  v_dot2_f32_bf16 v110, v181, s62, v110
  v_dot2_f32_bf16 v111, v181, s63, v111
  v_dot2_f32_bf16 v112, v182, s62, v112
  v_dot2_f32_bf16 v113, v182, s63, v113
  v_dot2_f32_bf16 v114, v183, s62, v114
  v_dot2_f32_bf16 v115, v183, s63, v115
  v_dot2_f32_bf16 v116, v184, s62, v116
  v_dot2_f32_bf16 v117, v184, s63, v117
  v_dot2_f32_bf16 v118, v185, s62, v118
  v_dot2_f32_bf16 v119, v185, s63, v119
  v_dot2_f32_bf16 v120, v186, s62, v120
  v_dot2_f32_bf16 v121, v186, s63, v121
  s_waitcnt vmcnt(36)
  v_dot2_f32_bf16 v104, v187, s62, v104
  v_dot2_f32_bf16 v105, v187, s63, v105
  v_dot2_f32_bf16 v106, v188, s62, v106
  v_dot2_f32_bf16 v107, v188, s63, v107
  v_dot2_f32_bf16 v108, v189, s62, v108
  v_dot2_f32_bf16 v109, v189, s63, v109
  v_dot2_f32_bf16 v110, v190, s62, v110
  v_dot2_f32_bf16 v111, v190, s63, v111
  v_dot2_f32_bf16 v112, v191, s62, v112
  v_dot2_f32_bf16 v113, v191, s63, v113
  v_dot2_f32_bf16 v114, v192, s62, v114
  v_dot2_f32_bf16 v115, v192, s63, v115
  v_dot2_f32_bf16 v116, v193, s62, v116
  v_dot2_f32_bf16 v117, v193, s63, v117
  v_dot2_f32_bf16 v118, v194, s62, v118
  v_dot2_f32_bf16 v119, v194, s63, v119
  v_dot2_f32_bf16 v120, v195, s62, v120
  v_dot2_f32_bf16 v121, v195, s63, v121
  s_waitcnt vmcnt(27)
  v_dot2_f32_bf16 v122, v196, s62, v20
  v_dot2_f32_bf16 v123, v196, s63, v20
  v_dot2_f32_bf16 v124, v197, s62, v21
  v_dot2_f32_bf16 v125, v197, s63, v21
  v_dot2_f32_bf16 v126, v198, s62, v20
  v_dot2_f32_bf16 v127, v198, s63, v20
  v_dot2_f32_bf16 v128, v199, s62, v21
  v_dot2_f32_bf16 v129, v199, s63, v21
  v_dot2_f32_bf16 v130, v200, s62, v20
  v_dot2_f32_bf16 v131, v200, s63, v20
  v_dot2_f32_bf16 v132, v201, s62, v21
  v_dot2_f32_bf16 v133, v201, s63, v21
  v_dot2_f32_bf16 v134, v202, s62, v20
  v_dot2_f32_bf16 v135, v202, s63, v20
  v_dot2_f32_bf16 v136, v203, s62, v21
  v_dot2_f32_bf16 v137, v203, s63, v21
  v_dot2_f32_bf16 v138, v204, s62, v22
  v_dot2_f32_bf16 v139, v204, s63, v22
  s_waitcnt vmcnt(18)
  v_dot2_f32_bf16 v122, v205, s62, v122
  v_dot2_f32_bf16 v123, v205, s63, v123
  v_dot2_f32_bf16 v124, v206, s62, v124
  v_dot2_f32_bf16 v125, v206, s63, v125
  v_dot2_f32_bf16 v126, v207, s62, v126
  v_dot2_f32_bf16 v127, v207, s63, v127
  v_dot2_f32_bf16 v128, v208, s62, v128
  v_dot2_f32_bf16 v129, v208, s63, v129
  v_dot2_f32_bf16 v130, v209, s62, v130
  v_dot2_f32_bf16 v131, v209, s63, v131
  v_dot2_f32_bf16 v132, v210, s62, v132
  v_dot2_f32_bf16 v133, v210, s63, v133
  v_dot2_f32_bf16 v134, v211, s62, v134
  v_dot2_f32_bf16 v135, v211, s63, v135
  v_dot2_f32_bf16 v136, v212, s62, v136
  v_dot2_f32_bf16 v137, v212, s63, v137
  v_dot2_f32_bf16 v138, v213, s62, v138
  v_dot2_f32_bf16 v139, v213, s63, v139
  s_waitcnt vmcnt(9)
  v_dot2_f32_bf16 v122, v214, s62, v122
  v_dot2_f32_bf16 v123, v214, s63, v123
  v_dot2_f32_bf16 v124, v215, s62, v124
  v_dot2_f32_bf16 v125, v215, s63, v125
  v_dot2_f32_bf16 v126, v216, s62, v126
  v_dot2_f32_bf16 v127, v216, s63, v127
  v_dot2_f32_bf16 v128, v217, s62, v128
  v_dot2_f32_bf16 v129, v217, s63, v129
  v_dot2_f32_bf16 v130, v218, s62, v130
  v_dot2_f32_bf16 v131, v218, s63, v131
  v_dot2_f32_bf16 v132, v219, s62, v132
  v_dot2_f32_bf16 v133, v219, s63, v133
  v_dot2_f32_bf16 v134, v220, s62, v134
  v_dot2_f32_bf16 v135, v220, s63, v135
  v_dot2_f32_bf16 v136, v221, s62, v136
  v_dot2_f32_bf16 v137, v221, s63, v137
  v_dot2_f32_bf16 v138, v222, s62, v138
  v_dot2_f32_bf16 v139, v222, s63, v139
  s_waitcnt vmcnt(0)
  v_dot2_f32_bf16 v122, v223, s62, v122
  v_dot2_f32_bf16 v123, v223, s63, v123
  v_dot2_f32_bf16 v124, v224, s62, v124
  v_dot2_f32_bf16 v125, v224, s63, v125
  v_dot2_f32_bf16 v126, v225, s62, v126
  v_dot2_f32_bf16 v127, v225, s63, v127
  v_dot2_f32_bf16 v128, v226, s62, v128
  v_dot2_f32_bf16 v129, v226, s63, v129
  v_dot2_f32_bf16 v130, v227, s62, v130
  v_dot2_f32_bf16 v131, v227, s63, v131
  v_dot2_f32_bf16 v132, v228, s62, v132
  v_dot2_f32_bf16 v133, v228, s63, v133
  v_dot2_f32_bf16 v134, v229, s62, v134
  v_dot2_f32_bf16 v135, v229, s63, v135
  v_dot2_f32_bf16 v136, v230, s62, v136
  v_dot2_f32_bf16 v137, v230, s63, v137
  v_dot2_f32_bf16 v138, v231, s62, v138
  v_dot2_f32_bf16 v139, v231, s63, v139
  s_nop 2
  v_pk_mul_f32 v[64:65], v[122:123], v[24:25] op_sel_hi:[1,0]
  v_pk_mul_f32 v[66:67], v[124:125], v[24:25] op_sel_hi:[1,0]
  v_pk_mul_f32 v[68:69], v[126:127], v[24:25] op_sel_hi:[1,0]
  v_pk_mul_f32 v[70:71], v[128:129], v[24:25] op_sel_hi:[1,0]
  v_pk_mul_f32 v[72:73], v[130:131], v[24:25] op_sel_hi:[1,0]
  v_pk_mul_f32 v[74:75], v[132:133], v[24:25] op_sel_hi:[1,0]
  v_pk_mul_f32 v[76:77], v[134:135], v[24:25] op_sel_hi:[1,0]
  v_pk_mul_f32 v[78:79], v[136:137], v[24:25] op_sel_hi:[1,0]
  v_pk_mul_f32 v[80:81], v[138:139], v[24:25] op_sel_hi:[1,0]
  v_exp_f32 v64, v64
  v_exp_f32 v65, v65
  v_pk_mul_f32 v[104:105], v[104:105], v[122:123]
  v_exp_f32 v66, v66
  v_exp_f32 v67, v67
  v_pk_mul_f32 v[106:107], v[106:107], v[124:125]
  v_exp_f32 v68, v68
  v_exp_f32 v69, v69
  v_pk_mul_f32 v[108:109], v[108:109], v[126:127]
  v_exp_f32 v70, v70
  v_exp_f32 v71, v71
  v_pk_mul_f32 v[110:111], v[110:111], v[128:129]
  v_exp_f32 v72, v72
  v_exp_f32 v73, v73
  v_pk_mul_f32 v[112:113], v[112:113], v[130:131]
  v_exp_f32 v74, v74
  v_exp_f32 v75, v75
  v_pk_mul_f32 v[114:115], v[114:115], v[132:133]
  v_exp_f32 v76, v76
  v_exp_f32 v77, v77
  v_pk_mul_f32 v[116:117], v[116:117], v[134:135]
  v_exp_f32 v78, v78
  v_exp_f32 v79, v79
  v_pk_mul_f32 v[118:119], v[118:119], v[136:137]
  v_exp_f32 v80, v80
  v_exp_f32 v81, v81
  v_pk_mul_f32 v[120:121], v[120:121], v[138:139]
  v_pk_add_f32 v[64:65], v[64:65], v[24:25] op_sel:[0,1] op_sel_hi:[1,1]
  v_pk_add_f32 v[66:67], v[66:67], v[24:25] op_sel:[0,1] op_sel_hi:[1,1]
  v_pk_add_f32 v[68:69], v[68:69], v[24:25] op_sel:[0,1] op_sel_hi:[1,1]
  v_pk_add_f32 v[70:71], v[70:71], v[24:25] op_sel:[0,1] op_sel_hi:[1,1]
  v_pk_add_f32 v[72:73], v[72:73], v[24:25] op_sel:[0,1] op_sel_hi:[1,1]
  v_pk_add_f32 v[74:75], v[74:75], v[24:25] op_sel:[0,1] op_sel_hi:[1,1]
  v_pk_add_f32 v[76:77], v[76:77], v[24:25] op_sel:[0,1] op_sel_hi:[1,1]
  v_pk_add_f32 v[78:79], v[78:79], v[24:25] op_sel:[0,1] op_sel_hi:[1,1]
  v_pk_add_f32 v[80:81], v[80:81], v[24:25] op_sel:[0,1] op_sel_hi:[1,1]
  v_rcp_f32 v64, v64
  v_rcp_f32 v65, v65
  v_rcp_f32 v66, v66
  v_rcp_f32 v67, v67
  v_rcp_f32 v68, v68
  v_rcp_f32 v69, v69
  v_rcp_f32 v70, v70
  v_rcp_f32 v71, v71
  v_rcp_f32 v72, v72
  v_rcp_f32 v73, v73
  v_rcp_f32 v74, v74
  v_rcp_f32 v75, v75
  v_rcp_f32 v76, v76
  v_rcp_f32 v77, v77
  v_rcp_f32 v78, v78
  v_rcp_f32 v79, v79
  v_rcp_f32 v80, v80
  v_rcp_f32 v81, v81
  v_pk_fma_f32 v[64:65], v[64:65], v[104:105], v[84:85]
  v_pk_fma_f32 v[66:67], v[66:67], v[106:107], v[86:87]
  v_pk_fma_f32 v[68:69], v[68:69], v[108:109], v[88:89]
  v_pk_fma_f32 v[70:71], v[70:71], v[110:111], v[90:91]
  v_pk_fma_f32 v[72:73], v[72:73], v[112:113], v[92:93]
  v_pk_fma_f32 v[74:75], v[74:75], v[114:115], v[94:95]
  v_pk_fma_f32 v[76:77], v[76:77], v[116:117], v[96:97]
  v_pk_fma_f32 v[78:79], v[78:79], v[118:119], v[98:99]
  v_pk_fma_f32 v[80:81], v[80:81], v[120:121], v[100:101]
  v_cvt_pk_bf16_f32 v64, v64, v65
  v_cvt_pk_bf16_f32 v66, v66, v67
  v_cvt_pk_bf16_f32 v68, v68, v69
  v_cvt_pk_bf16_f32 v70, v70, v71
  v_cvt_pk_bf16_f32 v72, v72, v73
  v_cvt_pk_bf16_f32 v74, v74, v75
  v_cvt_pk_bf16_f32 v76, v76, v77
  v_cvt_pk_bf16_f32 v78, v78, v79
  v_cvt_pk_bf16_f32 v80, v80, v81
  ds_write_b32 v12, v64 offset:0
  ds_write_b32 v12, v66 offset:4608
  ds_write_b32 v12, v68 offset:64
  ds_write_b32 v12, v70 offset:4672
  ds_write_b32 v12, v72 offset:128
  ds_write_b32 v12, v74 offset:4736
  ds_write_b32 v12, v76 offset:192
  ds_write_b32 v12, v78 offset:4800
  ds_write_b32 v13, v80 offset:192
  v_lshlrev_b32 v4, 4, v0
  s_waitcnt lgkmcnt(0)
  s_barrier
  ds_read_b128 v[84:87], v4 offset:0
  ds_read_b128 v[88:91], v4 offset:4096
  ds_read_b128 v[92:95], v4 offset:8192
  s_waitcnt lgkmcnt(2)
  buffer_store_dwordx4 v[84:87], v16, s[48:51], s57 offen
  s_waitcnt lgkmcnt(1)
  buffer_store_dwordx4 v[88:91], v17, s[48:51], s57 offen
  s_waitcnt lgkmcnt(0)
  buffer_store_dwordx4 v[92:95], v18, s[48:51], s57 offen
  s_endpgm
SP_pH:
  s_mov_b32 s98, 0x80000
SQ_pH:
  s_sleep 4
  buffer_load_dword v193, v192, s[52:55], 0 offen sc1
  s_sub_u32 s98, s98, 1
  s_cbranch_scc1 RT_pH
  s_waitcnt vmcnt(0)
  v_cmp_gt_u32 s[6:7], 4, v193
  s_cmp_lg_u64 s[6:7], 0
  s_cbranch_scc1 SQ_pH
  s_branch RT_pH
SP_pO4:
  s_mov_b32 s98, 0x80000
SQ_pO4:
  s_sleep 4
  buffer_load_dword v25, v24, s[12:15], s54 offen sc1
  s_sub_u32 s98, s98, 1
  s_cbranch_scc1 RT_pO4
  s_waitcnt vmcnt(0)
  v_cmp_gt_u32 s[6:7], 2, v25
  s_cmp_lg_u64 s[6:7], 0
  s_cbranch_scc1 SQ_pO4
  s_branch RT_pO4
SP_pO10:
  s_mov_b32 s98, 0x80000
SQ_pO10:
  s_sleep 4
  buffer_load_dword v25, v24, s[12:15], s55 offen sc1
  s_sub_u32 s98, s98, 1
  s_cbranch_scc1 RT_pO10
  s_waitcnt vmcnt(0)
  v_cmp_gt_u32 s[6:7], 1, v25
  s_cmp_lg_u64 s[6:7], 0
  s_cbranch_scc1 SQ_pO10
  s_branch RT_pO10
SP_pO14:
  s_mov_b32 s98, 0x80000
SQ_pO14:
  s_sleep 4
  buffer_load_dword v25, v24, s[12:15], s54 offen sc1
  s_sub_u32 s98, s98, 1
  s_cbranch_scc1 RT_pO14
  s_waitcnt vmcnt(0)
  v_cmp_gt_u32 s[6:7], 4, v25
  s_cmp_lg_u64 s[6:7], 0
  s_cbranch_scc1 SQ_pO14
  s_branch RT_pO14
SP_pO20:
  s_mov_b32 s98, 0x80000
SQ_pO20:
  s_sleep 4
  buffer_load_dword v25, v24, s[12:15], s55 offen sc1
  s_sub_u32 s98, s98, 1
  s_cbranch_scc1 RT_pO20
  s_waitcnt vmcnt(0)
  v_cmp_gt_u32 s[6:7], 2, v25
  s_cmp_lg_u64 s[6:7], 0
  s_cbranch_scc1 SQ_pO20
  s_branch RT_pO20
SP_pO24:
  s_mov_b32 s98, 0x80000
SQ_pO24:
  s_sleep 4
  buffer_load_dword v25, v24, s[12:15], s55 offen sc1
  s_sub_u32 s98, s98, 1
  s_cbranch_scc1 RT_pO24
  s_waitcnt vmcnt(0)
  v_cmp_gt_u32 s[6:7], 3, v25
  s_cmp_lg_u64 s[6:7], 0
  s_cbranch_scc1 SQ_pO24
  s_branch RT_pO24
SP_pO28:
  s_mov_b32 s98, 0x80000
SQ_pO28:
  s_sleep 4
  buffer_load_dword v25, v24, s[12:15], s55 offen sc1
  s_sub_u32 s98, s98, 1
  s_cbranch_scc1 RT_pO28
  s_waitcnt vmcnt(0)
  v_cmp_gt_u32 s[6:7], 4, v25
  s_cmp_lg_u64 s[6:7], 0
  s_cbranch_scc1 SQ_pO28
  s_branch RT_pO28
SP_pU:
  s_mov_b32 s98, 0x80000
SQ_pU:
  s_sleep 4
  buffer_load_dword v32, v31, s[12:15], s54 offen sc1
  s_sub_u32 s98, s98, 1
  s_cbranch_scc1 RT_pU
  s_waitcnt vmcnt(0)
  v_cmp_gt_u32 s[6:7], 1, v32
  s_cmp_lg_u64 s[6:7], 0
  s_cbranch_scc1 SQ_pU
  s_branch RT_pU
SP_pP1:
  s_mov_b32 s98, 0x80000
SQ_pP1:
  s_sleep 4
  buffer_load_dword v31, v47, s[12:15], s59 offen sc1
  s_sub_u32 s98, s98, 1
  s_cbranch_scc1 RT_pP1
  s_waitcnt vmcnt(0)
  v_cmp_gt_u32 s[6:7], 1, v31
  s_cmp_lg_u64 s[6:7], 0
  s_cbranch_scc1 SQ_pP1
  s_branch RT_pP1
K_skip:
  s_load_dwordx2 s[60:61], s[0:1], 32
  s_sub_u32 s3, s99, 108
  s_mul_i32 s4, s3, 55296
  v_mul_u32_u24 v5, 6554, v2
  v_lshrrev_b32 v5, 16, v5
  v_mul_u32_u24 v6, 10, v5
  v_sub_u32 v6, v2, v6
  v_mul_u32_u24 v5, 9216, v5
  v_lshl_add_u32 v5, v6, 7, v5
  s_and_b32 s6, s2, 3
  s_bfe_u32 s7, s2, 0x10002
  s_lshl1_add_u32 s6, s6, s7
  s_mul_i32 s7, s6, 9
  s_lshr_b32 s7, s7, 1
  s_lshl_b32 s7, s7, 8
  s_add_u32 s4, s4, s7
  v_add_u32 v5, s4, v5
  v_mov_b32 v6, 0x7fff0000
  v_cmp_gt_u32 vcc, 60, v2
  s_mul_i32 s6, s6, 20
  s_add_u32 s6, s6, s3
  v_cndmask_b32 v5, v6, v5, vcc
  s_lshl_b32 s6, s6, 13
  v_lshl_add_u32 v6, v2, 7, s6
K_pfa:
  buffer_load_dword v7, v5, s[36:39], s11 offen
  s_add_u32 s11, s11, 1105920
  s_waitcnt vmcnt(1)
  s_cmp_lt_u32 s11, 18874368
  s_cbranch_scc1 K_pfa
  s_waitcnt lgkmcnt(0)
  s_mov_b32 s62, 4718592
  s_mov_b32 s63, 0x20000
  s_mov_b32 s92, 0
K_pfb:
  buffer_load_dword v7, v6, s[60:63], s92 offen
  s_add_u32 s92, s92, 1310720
  s_waitcnt vmcnt(1)
  s_cmp_lt_u32 s92, 4718592
  s_cbranch_scc1 K_pfb
  s_waitcnt vmcnt(0) lgkmcnt(0)
  s_barrier
  s_add_u32 m0, s56, 75008
  s_nop 0
  buffer_load_dwordx4 v10, s[28:31], s58 offen lds
  buffer_load_dwordx4 v11, s[28:31], s58 offen offset:1024 lds
  s_add_u32 s58, s58, 8192
  s_add_u32 m0, s56, 91648
  s_nop 0
  buffer_load_dwordx4 v10, s[28:31], s58 offen lds
  buffer_load_dwordx4 v11, s[28:31], s58 offen offset:1024 lds
  s_add_u32 s58, s58, 8192
  s_add_u32 m0, s57, 99840
  s_nop 0
  buffer_load_dwordx4 v12, s[32:35], s59 offen lds
  buffer_load_dwordx4 v13, s[32:35], s59 offen offset:1056 lds
  s_add_u32 s59, s59, 8192
  s_add_u32 m0, s56, 108288
  s_nop 0
  buffer_load_dwordx4 v10, s[28:31], s58 offen lds
  buffer_load_dwordx4 v11, s[28:31], s58 offen offset:1024 lds
  s_add_u32 s58, s58, 8192
  s_add_u32 m0, s57, 116480
  s_nop 0
  buffer_load_dwordx4 v12, s[32:35], s59 offen lds
  buffer_load_dwordx4 v13, s[32:35], s59 offen offset:1056 lds
  s_add_u32 s59, s59, 8192
  s_add_u32 m0, s56, 124928
  s_nop 0
  buffer_load_dwordx4 v10, s[28:31], s58 offen lds
  buffer_load_dwordx4 v11, s[28:31], s58 offen offset:1024 lds
  s_add_u32 s58, s58, 8192
  s_add_u32 m0, s57, 133120
  s_nop 0
  buffer_load_dwordx4 v12, s[32:35], s59 offen lds
  buffer_load_dwordx4 v13, s[32:35], s59 offen offset:1056 lds
  s_add_u32 s59, s59, 8192
  s_add_u32 m0, s56, 141568
  s_nop 0
  buffer_load_dwordx4 v10, s[28:31], s58 offen lds
  buffer_load_dwordx4 v11, s[28:31], s58 offen offset:1024 lds
  s_add_u32 s58, s58, 8192
  s_add_u32 m0, s57, 149760
  s_nop 0
  buffer_load_dwordx4 v12, s[32:35], s59 offen lds
  buffer_load_dwordx4 v13, s[32:35], s59 offen offset:1056 lds
  s_add_u32 s59, s59, 8192
  ds_read_b128 v[40:43], v20
  ds_read_b128 v[44:47], v20 offset:64
  s_waitcnt lgkmcnt(0)
  v_fmac_f32 v64, v40, v48
  v_fmac_f32 v65, v41, v48
  v_fmac_f32 v66, v42, v48
  v_fmac_f32 v67, v43, v48
  v_fmac_f32 v80, v44, v48
  v_fmac_f32 v81, v45, v48
  v_fmac_f32 v82, v46, v48
  v_fmac_f32 v83, v47, v48
  v_mul_f32 v64, v64, v49
  v_mul_f32 v65, v65, v49
  v_mul_f32 v66, v66, v49
  v_mul_f32 v67, v67, v49
  v_mul_f32 v80, v80, v49
  v_mul_f32 v81, v81, v49
  v_mul_f32 v82, v82, v49
  v_mul_f32 v83, v83, v49
  v_cvt_pk_bf16_f32 v192, v64, v65
  v_cvt_pk_bf16_f32 v193, v66, v67
  v_cvt_pk_bf16_f32 v194, v80, v81
  v_cvt_pk_bf16_f32 v195, v82, v83
  v_fmac_f32 v68, v40, v50
  v_fmac_f32 v69, v41, v50
  v_fmac_f32 v70, v42, v50
  v_fmac_f32 v71, v43, v50
  v_fmac_f32 v84, v44, v50
  v_fmac_f32 v85, v45, v50
  v_fmac_f32 v86, v46, v50
  v_fmac_f32 v87, v47, v50
  v_mul_f32 v68, v68, v51
  v_mul_f32 v69, v69, v51
  v_mul_f32 v70, v70, v51
  v_mul_f32 v71, v71, v51
  v_mul_f32 v84, v84, v51
  v_mul_f32 v85, v85, v51
  v_mul_f32 v86, v86, v51
  v_mul_f32 v87, v87, v51
  v_cvt_pk_bf16_f32 v208, v68, v69
  v_cvt_pk_bf16_f32 v209, v70, v71
  v_cvt_pk_bf16_f32 v210, v84, v85
  v_cvt_pk_bf16_f32 v211, v86, v87
  v_fmac_f32 v72, v40, v52
  v_fmac_f32 v73, v41, v52
  v_fmac_f32 v74, v42, v52
  v_fmac_f32 v75, v43, v52
  v_fmac_f32 v88, v44, v52
  v_fmac_f32 v89, v45, v52
  v_fmac_f32 v90, v46, v52
  v_fmac_f32 v91, v47, v52
  v_mul_f32 v72, v72, v53
  v_mul_f32 v73, v73, v53
  v_mul_f32 v74, v74, v53
  v_mul_f32 v75, v75, v53
  v_mul_f32 v88, v88, v53
  v_mul_f32 v89, v89, v53
  v_mul_f32 v90, v90, v53
  v_mul_f32 v91, v91, v53
  v_cvt_pk_bf16_f32 v224, v72, v73
  v_cvt_pk_bf16_f32 v225, v74, v75
  v_cvt_pk_bf16_f32 v226, v88, v89
  v_cvt_pk_bf16_f32 v227, v90, v91
  v_fmac_f32 v76, v40, v54
  v_fmac_f32 v77, v41, v54
  v_fmac_f32 v78, v42, v54
  v_fmac_f32 v79, v43, v54
  v_fmac_f32 v92, v44, v54
  v_fmac_f32 v93, v45, v54
  v_fmac_f32 v94, v46, v54
  v_fmac_f32 v95, v47, v54
  v_mul_f32 v76, v76, v55
  v_mul_f32 v77, v77, v55
  v_mul_f32 v78, v78, v55
  v_mul_f32 v79, v79, v55
  v_mul_f32 v92, v92, v55
  v_mul_f32 v93, v93, v55
  v_mul_f32 v94, v94, v55
  v_mul_f32 v95, v95, v55
  v_cvt_pk_bf16_f32 v240, v76, v77
  v_cvt_pk_bf16_f32 v241, v78, v79
  v_cvt_pk_bf16_f32 v242, v92, v93
  v_cvt_pk_bf16_f32 v243, v94, v95
  s_nop 1
  v_permlane16_swap_b32 v192, v194
  v_permlane16_swap_b32 v193, v195
  v_permlane16_swap_b32 v208, v210
  v_permlane16_swap_b32 v209, v211
  v_permlane16_swap_b32 v224, v226
  v_permlane16_swap_b32 v225, v227
  v_permlane16_swap_b32 v240, v242
  v_permlane16_swap_b32 v241, v243
  ds_read_b128 v[56:59], v21
  ds_read_b128 v[60:63], v21 offset:64
  s_waitcnt lgkmcnt(0)
  v_fmac_f32 v96, v56, v48
  v_fmac_f32 v97, v57, v48
  v_fmac_f32 v98, v58, v48
  v_fmac_f32 v99, v59, v48
  v_fmac_f32 v112, v60, v48
  v_fmac_f32 v113, v61, v48
  v_fmac_f32 v114, v62, v48
  v_fmac_f32 v115, v63, v48
  v_mul_f32 v96, v96, v49
  v_mul_f32 v97, v97, v49
  v_mul_f32 v98, v98, v49
  v_mul_f32 v99, v99, v49
  v_mul_f32 v112, v112, v49
  v_mul_f32 v113, v113, v49
  v_mul_f32 v114, v114, v49
  v_mul_f32 v115, v115, v49
  v_cvt_pk_bf16_f32 v196, v96, v97
  v_cvt_pk_bf16_f32 v197, v98, v99
  v_cvt_pk_bf16_f32 v198, v112, v113
  v_cvt_pk_bf16_f32 v199, v114, v115
  v_fmac_f32 v100, v56, v50
  v_fmac_f32 v101, v57, v50
  v_fmac_f32 v102, v58, v50
  v_fmac_f32 v103, v59, v50
  v_fmac_f32 v116, v60, v50
  v_fmac_f32 v117, v61, v50
  v_fmac_f32 v118, v62, v50
  v_fmac_f32 v119, v63, v50
  v_mul_f32 v100, v100, v51
  v_mul_f32 v101, v101, v51
  v_mul_f32 v102, v102, v51
  v_mul_f32 v103, v103, v51
  v_mul_f32 v116, v116, v51
  v_mul_f32 v117, v117, v51
  v_mul_f32 v118, v118, v51
  v_mul_f32 v119, v119, v51
  v_cvt_pk_bf16_f32 v212, v100, v101
  v_cvt_pk_bf16_f32 v213, v102, v103
  v_cvt_pk_bf16_f32 v214, v116, v117
  v_cvt_pk_bf16_f32 v215, v118, v119
  v_fmac_f32 v104, v56, v52
  v_fmac_f32 v105, v57, v52
  v_fmac_f32 v106, v58, v52
  v_fmac_f32 v107, v59, v52
  v_fmac_f32 v120, v60, v52
  v_fmac_f32 v121, v61, v52
  v_fmac_f32 v122, v62, v52
  v_fmac_f32 v123, v63, v52
  v_mul_f32 v104, v104, v53
  v_mul_f32 v105, v105, v53
  v_mul_f32 v106, v106, v53
  v_mul_f32 v107, v107, v53
  v_mul_f32 v120, v120, v53
  v_mul_f32 v121, v121, v53
  v_mul_f32 v122, v122, v53
  v_mul_f32 v123, v123, v53
  v_cvt_pk_bf16_f32 v228, v104, v105
  v_cvt_pk_bf16_f32 v229, v106, v107
  v_cvt_pk_bf16_f32 v230, v120, v121
  v_cvt_pk_bf16_f32 v231, v122, v123
  v_fmac_f32 v108, v56, v54
  v_fmac_f32 v109, v57, v54
  v_fmac_f32 v110, v58, v54
  v_fmac_f32 v111, v59, v54
  v_fmac_f32 v124, v60, v54
  v_fmac_f32 v125, v61, v54
  v_fmac_f32 v126, v62, v54
  v_fmac_f32 v127, v63, v54
  v_mul_f32 v108, v108, v55
  v_mul_f32 v109, v109, v55
  v_mul_f32 v110, v110, v55
  v_mul_f32 v111, v111, v55
  v_mul_f32 v124, v124, v55
  v_mul_f32 v125, v125, v55
  v_mul_f32 v126, v126, v55
  v_mul_f32 v127, v127, v55
  v_cvt_pk_bf16_f32 v244, v108, v109
  v_cvt_pk_bf16_f32 v245, v110, v111
  v_cvt_pk_bf16_f32 v246, v124, v125
  v_cvt_pk_bf16_f32 v247, v126, v127
  s_nop 1
  v_permlane16_swap_b32 v196, v198
  v_permlane16_swap_b32 v197, v199
  v_permlane16_swap_b32 v212, v214
  v_permlane16_swap_b32 v213, v215
  v_permlane16_swap_b32 v228, v230
  v_permlane16_swap_b32 v229, v231
  v_permlane16_swap_b32 v244, v246
  v_permlane16_swap_b32 v245, v247
  ds_read_b128 v[40:43], v22
  ds_read_b128 v[44:47], v22 offset:64
  s_waitcnt lgkmcnt(0)
  v_fmac_f32 v128, v40, v48
  v_fmac_f32 v129, v41, v48
  v_fmac_f32 v130, v42, v48
  v_fmac_f32 v131, v43, v48
  v_fmac_f32 v144, v44, v48
  v_fmac_f32 v145, v45, v48
  v_fmac_f32 v146, v46, v48
  v_fmac_f32 v147, v47, v48
  v_mul_f32 v128, v128, v49
  v_mul_f32 v129, v129, v49
  v_mul_f32 v130, v130, v49
  v_mul_f32 v131, v131, v49
  v_mul_f32 v144, v144, v49
  v_mul_f32 v145, v145, v49
  v_mul_f32 v146, v146, v49
  v_mul_f32 v147, v147, v49
  v_cvt_pk_bf16_f32 v200, v128, v129
  v_cvt_pk_bf16_f32 v201, v130, v131
  v_cvt_pk_bf16_f32 v202, v144, v145
  v_cvt_pk_bf16_f32 v203, v146, v147
  v_fmac_f32 v132, v40, v50
  v_fmac_f32 v133, v41, v50
  v_fmac_f32 v134, v42, v50
  v_fmac_f32 v135, v43, v50
  v_fmac_f32 v148, v44, v50
  v_fmac_f32 v149, v45, v50
  v_fmac_f32 v150, v46, v50
  v_fmac_f32 v151, v47, v50
  v_mul_f32 v132, v132, v51
  v_mul_f32 v133, v133, v51
  v_mul_f32 v134, v134, v51
  v_mul_f32 v135, v135, v51
  v_mul_f32 v148, v148, v51
  v_mul_f32 v149, v149, v51
  v_mul_f32 v150, v150, v51
  v_mul_f32 v151, v151, v51
  v_cvt_pk_bf16_f32 v216, v132, v133
  v_cvt_pk_bf16_f32 v217, v134, v135
  v_cvt_pk_bf16_f32 v218, v148, v149
  v_cvt_pk_bf16_f32 v219, v150, v151
  v_fmac_f32 v136, v40, v52
  v_fmac_f32 v137, v41, v52
  v_fmac_f32 v138, v42, v52
  v_fmac_f32 v139, v43, v52
  v_fmac_f32 v152, v44, v52
  v_fmac_f32 v153, v45, v52
  v_fmac_f32 v154, v46, v52
  v_fmac_f32 v155, v47, v52
  v_mul_f32 v136, v136, v53
  v_mul_f32 v137, v137, v53
  v_mul_f32 v138, v138, v53
  v_mul_f32 v139, v139, v53
  v_mul_f32 v152, v152, v53
  v_mul_f32 v153, v153, v53
  v_mul_f32 v154, v154, v53
  v_mul_f32 v155, v155, v53
  v_cvt_pk_bf16_f32 v232, v136, v137
  v_cvt_pk_bf16_f32 v233, v138, v139
  v_cvt_pk_bf16_f32 v234, v152, v153
  v_cvt_pk_bf16_f32 v235, v154, v155
  v_fmac_f32 v140, v40, v54
  v_fmac_f32 v141, v41, v54
  v_fmac_f32 v142, v42, v54
  v_fmac_f32 v143, v43, v54
  v_fmac_f32 v156, v44, v54
  v_fmac_f32 v157, v45, v54
  v_fmac_f32 v158, v46, v54
  v_fmac_f32 v159, v47, v54
  v_mul_f32 v140, v140, v55
  v_mul_f32 v141, v141, v55
  v_mul_f32 v142, v142, v55
  v_mul_f32 v143, v143, v55
  v_mul_f32 v156, v156, v55
  v_mul_f32 v157, v157, v55
  v_mul_f32 v158, v158, v55
  v_mul_f32 v159, v159, v55
  v_cvt_pk_bf16_f32 v248, v140, v141
  v_cvt_pk_bf16_f32 v249, v142, v143
  v_cvt_pk_bf16_f32 v250, v156, v157
  v_cvt_pk_bf16_f32 v251, v158, v159
  s_nop 1
  v_permlane16_swap_b32 v200, v202
  v_permlane16_swap_b32 v201, v203
  v_permlane16_swap_b32 v216, v218
  v_permlane16_swap_b32 v217, v219
  v_permlane16_swap_b32 v232, v234
  v_permlane16_swap_b32 v233, v235
  v_permlane16_swap_b32 v248, v250
  v_permlane16_swap_b32 v249, v251
  ds_read_b128 v[56:59], v23
  ds_read_b128 v[60:63], v23 offset:64
  s_waitcnt lgkmcnt(0)
  v_fmac_f32 v160, v56, v48
  v_fmac_f32 v161, v57, v48
  v_fmac_f32 v162, v58, v48
  v_fmac_f32 v163, v59, v48
  v_fmac_f32 v176, v60, v48
  v_fmac_f32 v177, v61, v48
  v_fmac_f32 v178, v62, v48
  v_fmac_f32 v179, v63, v48
  v_mul_f32 v160, v160, v49
  v_mul_f32 v161, v161, v49
  v_mul_f32 v162, v162, v49
  v_mul_f32 v163, v163, v49
  v_mul_f32 v176, v176, v49
  v_mul_f32 v177, v177, v49
  v_mul_f32 v178, v178, v49
  v_mul_f32 v179, v179, v49
  v_cvt_pk_bf16_f32 v204, v160, v161
  v_cvt_pk_bf16_f32 v205, v162, v163
  v_cvt_pk_bf16_f32 v206, v176, v177
  v_cvt_pk_bf16_f32 v207, v178, v179
  v_fmac_f32 v164, v56, v50
  v_fmac_f32 v165, v57, v50
  v_fmac_f32 v166, v58, v50
  v_fmac_f32 v167, v59, v50
  v_fmac_f32 v180, v60, v50
  v_fmac_f32 v181, v61, v50
  v_fmac_f32 v182, v62, v50
  v_fmac_f32 v183, v63, v50
  v_mul_f32 v164, v164, v51
  v_mul_f32 v165, v165, v51
  v_mul_f32 v166, v166, v51
  v_mul_f32 v167, v167, v51
  v_mul_f32 v180, v180, v51
  v_mul_f32 v181, v181, v51
  v_mul_f32 v182, v182, v51
  v_mul_f32 v183, v183, v51
  v_cvt_pk_bf16_f32 v220, v164, v165
  v_cvt_pk_bf16_f32 v221, v166, v167
  v_cvt_pk_bf16_f32 v222, v180, v181
  v_cvt_pk_bf16_f32 v223, v182, v183
  v_fmac_f32 v168, v56, v52
  v_fmac_f32 v169, v57, v52
  v_fmac_f32 v170, v58, v52
  v_fmac_f32 v171, v59, v52
  v_fmac_f32 v184, v60, v52
  v_fmac_f32 v185, v61, v52
  v_fmac_f32 v186, v62, v52
  v_fmac_f32 v187, v63, v52
  v_mul_f32 v168, v168, v53
  v_mul_f32 v169, v169, v53
  v_mul_f32 v170, v170, v53
  v_mul_f32 v171, v171, v53
  v_mul_f32 v184, v184, v53
  v_mul_f32 v185, v185, v53
  v_mul_f32 v186, v186, v53
  v_mul_f32 v187, v187, v53
  v_cvt_pk_bf16_f32 v236, v168, v169
  v_cvt_pk_bf16_f32 v237, v170, v171
  v_cvt_pk_bf16_f32 v238, v184, v185
  v_cvt_pk_bf16_f32 v239, v186, v187
  v_fmac_f32 v172, v56, v54
  v_fmac_f32 v173, v57, v54
  v_fmac_f32 v174, v58, v54
  v_fmac_f32 v175, v59, v54
  v_fmac_f32 v188, v60, v54
  v_fmac_f32 v189, v61, v54
  v_fmac_f32 v190, v62, v54
  v_fmac_f32 v191, v63, v54
  v_mul_f32 v172, v172, v55
  v_mul_f32 v173, v173, v55
  v_mul_f32 v174, v174, v55
  v_mul_f32 v175, v175, v55
  v_mul_f32 v188, v188, v55
  v_mul_f32 v189, v189, v55
  v_mul_f32 v190, v190, v55
  v_mul_f32 v191, v191, v55
  v_cvt_pk_bf16_f32 v252, v172, v173
  v_cvt_pk_bf16_f32 v253, v174, v175
  v_cvt_pk_bf16_f32 v254, v188, v189
  v_cvt_pk_bf16_f32 v255, v190, v191
  s_nop 1
  v_permlane16_swap_b32 v204, v206
  v_permlane16_swap_b32 v205, v207
  v_permlane16_swap_b32 v220, v222
  v_permlane16_swap_b32 v221, v223
  v_permlane16_swap_b32 v236, v238
  v_permlane16_swap_b32 v237, v239
  v_permlane16_swap_b32 v252, v254
  v_permlane16_swap_b32 v253, v255
  v_add_u32 v48, 49920, v14
  v_add_u32 v49, 49920, v15
  v_add_u32 v50, 49920, v16
  v_add_u32 v51, 49920, v17
  v_add_u32 v52, 49920, v18
  s_branch K_core
K_fallback:
  s_waitcnt vmcnt(0) lgkmcnt(0)
  s_mul_i32 s56, s18, 8448
  s_add_u32 s56, s56, 104448
  v_lshrrev_b32 v4, 4, v2
  v_and_b32 v5, 15, v2
  v_add_u32 v6, 0, v4
  v_xor_b32 v7, v6, v5
  v_lshlrev_b32 v7, 4, v7
  v_lshl_add_u32 v48, v6, 8, v7
  v_add_u32 v6, 4, v4
  v_xor_b32 v7, v6, v5
  v_lshlrev_b32 v7, 4, v7
  v_lshl_add_u32 v49, v6, 8, v7
  v_add_u32 v6, 8, v4
  v_xor_b32 v7, v6, v5
  v_lshlrev_b32 v7, 4, v7
  v_lshl_add_u32 v50, v6, 8, v7
  v_add_u32 v6, 12, v4
  v_xor_b32 v7, v6, v5
  v_lshlrev_b32 v7, 4, v7
  v_lshl_add_u32 v51, v6, 8, v7
  v_lshlrev_b32 v6, 11, v4
  v_lshl_add_u32 v52, v5, 4, v6
  s_sub_u32 s3, s56, 58368
  v_add_u32 v53, s3, v14
  v_add_u32 v54, s3, v15
  v_add_u32 v55, s3, v16
  v_add_u32 v56, s3, v17
  v_add_u32 v57, s56, v19
  s_lshr_b32 s57, s19, 1
  s_lshl_b32 s57, s57, 19
  s_add_u32 s57, s57, 393216
  v_mov_b32 v40, 0xff800000
  v_mov_b32 v41, 0xff800000
  v_mov_b32 v42, 0xff800000
  v_mov_b32 v43, 0xff800000
  s_mov_b32 s58, s57
  s_mov_b32 s59, 16
FB_l1:
  s_add_u32 m0, s56, 0
  s_add_u32 s3, s58, 0
  buffer_load_dwordx4 v48, s[28:31], s3 offen lds
  s_add_u32 m0, s56, 1024
  s_add_u32 s3, s58, 0
  buffer_load_dwordx4 v49, s[28:31], s3 offen lds
  s_add_u32 m0, s56, 2048
  s_add_u32 s3, s58, 0
  buffer_load_dwordx4 v50, s[28:31], s3 offen lds
  s_add_u32 m0, s56, 3072
  s_add_u32 s3, s58, 0
  buffer_load_dwordx4 v51, s[28:31], s3 offen lds
  s_add_u32 m0, s56, 4096
  s_add_u32 s3, s58, 4096
  buffer_load_dwordx4 v48, s[28:31], s3 offen lds
  s_add_u32 m0, s56, 5120
  s_add_u32 s3, s58, 4096
  buffer_load_dwordx4 v49, s[28:31], s3 offen lds
  s_add_u32 m0, s56, 6144
  s_add_u32 s3, s58, 4096
  buffer_load_dwordx4 v50, s[28:31], s3 offen lds
  s_add_u32 m0, s56, 7168
  s_add_u32 s3, s58, 4096
  buffer_load_dwordx4 v51, s[28:31], s3 offen lds
  s_waitcnt vmcnt(0)
  ds_read_b128 a[128:131], v53 offset:0
  ds_read_b128 a[132:135], v54 offset:0
  ds_read_b128 a[136:139], v55 offset:0
  ds_read_b128 a[140:143], v56 offset:0
  ds_read_b128 a[144:147], v53 offset:4096
  ds_read_b128 a[148:151], v54 offset:4096
  ds_read_b128 a[152:155], v55 offset:4096
  ds_read_b128 a[156:159], v56 offset:4096
  s_waitcnt lgkmcnt(0)
  v_mfma_f32_16x16x32_bf16 v[116:119], a[128:131], v[192:195], 0
  v_mfma_f32_16x16x32_bf16 v[120:123], a[128:131], v[208:211], 0
  v_mfma_f32_16x16x32_bf16 v[124:127], a[128:131], v[224:227], 0
  v_mfma_f32_16x16x32_bf16 v[128:131], a[128:131], v[240:243], 0
  v_mfma_f32_16x16x32_bf16 v[116:119], a[132:135], v[196:199], v[116:119]
  v_mfma_f32_16x16x32_bf16 v[120:123], a[132:135], v[212:215], v[120:123]
  v_mfma_f32_16x16x32_bf16 v[124:127], a[132:135], v[228:231], v[124:127]
  v_mfma_f32_16x16x32_bf16 v[128:131], a[132:135], v[244:247], v[128:131]
  v_mfma_f32_16x16x32_bf16 v[116:119], a[136:139], v[200:203], v[116:119]
  v_mfma_f32_16x16x32_bf16 v[120:123], a[136:139], v[216:219], v[120:123]
  v_mfma_f32_16x16x32_bf16 v[124:127], a[136:139], v[232:235], v[124:127]
  v_mfma_f32_16x16x32_bf16 v[128:131], a[136:139], v[248:251], v[128:131]
  v_mfma_f32_16x16x32_bf16 v[116:119], a[140:143], v[204:207], v[116:119]
  v_mfma_f32_16x16x32_bf16 v[120:123], a[140:143], v[220:223], v[120:123]
  v_mfma_f32_16x16x32_bf16 v[124:127], a[140:143], v[236:239], v[124:127]
  v_mfma_f32_16x16x32_bf16 v[128:131], a[140:143], v[252:255], v[128:131]
  v_mfma_f32_16x16x32_bf16 v[132:135], a[144:147], v[192:195], 0
  v_mfma_f32_16x16x32_bf16 v[136:139], a[144:147], v[208:211], 0
  v_mfma_f32_16x16x32_bf16 v[140:143], a[144:147], v[224:227], 0
  v_mfma_f32_16x16x32_bf16 v[144:147], a[144:147], v[240:243], 0
  v_mfma_f32_16x16x32_bf16 v[132:135], a[148:151], v[196:199], v[132:135]
  v_mfma_f32_16x16x32_bf16 v[136:139], a[148:151], v[212:215], v[136:139]
  v_mfma_f32_16x16x32_bf16 v[140:143], a[148:151], v[228:231], v[140:143]
  v_mfma_f32_16x16x32_bf16 v[144:147], a[148:151], v[244:247], v[144:147]
  v_mfma_f32_16x16x32_bf16 v[132:135], a[152:155], v[200:203], v[132:135]
  v_mfma_f32_16x16x32_bf16 v[136:139], a[152:155], v[216:219], v[136:139]
  v_mfma_f32_16x16x32_bf16 v[140:143], a[152:155], v[232:235], v[140:143]
  v_mfma_f32_16x16x32_bf16 v[144:147], a[152:155], v[248:251], v[144:147]
  v_mfma_f32_16x16x32_bf16 v[132:135], a[156:159], v[204:207], v[132:135]
  v_mfma_f32_16x16x32_bf16 v[136:139], a[156:159], v[220:223], v[136:139]
  v_mfma_f32_16x16x32_bf16 v[140:143], a[156:159], v[236:239], v[140:143]
  v_mfma_f32_16x16x32_bf16 v[144:147], a[156:159], v[252:255], v[144:147]
  s_nop 7
  v_max3_f32 v40, v40, v116, v117
  v_max3_f32 v40, v40, v118, v119
  v_max3_f32 v40, v40, v132, v133
  v_max3_f32 v40, v40, v134, v135
  v_max3_f32 v41, v41, v120, v121
  v_max3_f32 v41, v41, v122, v123
  v_max3_f32 v41, v41, v136, v137
  v_max3_f32 v41, v41, v138, v139
  v_max3_f32 v42, v42, v124, v125
  v_max3_f32 v42, v42, v126, v127
  v_max3_f32 v42, v42, v140, v141
  v_max3_f32 v42, v42, v142, v143
  v_max3_f32 v43, v43, v128, v129
  v_max3_f32 v43, v43, v130, v131
  v_max3_f32 v43, v43, v144, v145
  v_max3_f32 v43, v43, v146, v147
  s_add_u32 s58, s58, 8192
  s_sub_u32 s59, s59, 1
  s_cmp_lg_u32 s59, 0
  s_cbranch_scc1 FB_l1
  v_mov_b32 v44, v40
  v_mov_b32 v45, v41
  v_mov_b32 v46, v42
  v_mov_b32 v47, v43
  s_nop 0
  v_permlane16_swap_b32 v40, v44
  v_permlane16_swap_b32 v41, v45
  v_permlane16_swap_b32 v42, v46
  v_permlane16_swap_b32 v43, v47
  v_max_f32 v40, v40, v44
  v_max_f32 v41, v41, v45
  v_max_f32 v42, v42, v46
  v_max_f32 v43, v43, v47
  v_mov_b32 v44, v40
  v_mov_b32 v45, v41
  v_mov_b32 v46, v42
  v_mov_b32 v47, v43
  s_nop 0
  v_permlane32_swap_b32 v40, v44
  v_permlane32_swap_b32 v41, v45
  v_permlane32_swap_b32 v42, v46
  v_permlane32_swap_b32 v43, v47
  v_max_f32 v40, v40, v44
  v_max_f32 v41, v41, v45
  v_max_f32 v42, v42, v46
  v_max_f32 v43, v43, v47
  v_sub_f32 v160, 0xc2000000, v40
  v_sub_f32 v161, 0xc2000000, v40
  v_sub_f32 v162, 0xc2000000, v40
  v_sub_f32 v163, 0xc2000000, v40
  v_sub_f32 v164, 0xc2000000, v41
  v_sub_f32 v165, 0xc2000000, v41
  v_sub_f32 v166, 0xc2000000, v41
  v_sub_f32 v167, 0xc2000000, v41
  v_sub_f32 v168, 0xc2000000, v42
  v_sub_f32 v169, 0xc2000000, v42
  v_sub_f32 v170, 0xc2000000, v42
  v_sub_f32 v171, 0xc2000000, v42
  v_sub_f32 v172, 0xc2000000, v43
  v_sub_f32 v173, 0xc2000000, v43
  v_sub_f32 v174, 0xc2000000, v43
  v_sub_f32 v175, 0xc2000000, v43
  v_mov_b32 v60, 0
  v_mov_b32 v61, 0
  v_mov_b32 v62, 0
  v_mov_b32 v63, 0
  v_accvgpr_write_b32 a0, 0
  v_accvgpr_write_b32 a1, 0
  v_accvgpr_write_b32 a2, 0
  v_accvgpr_write_b32 a3, 0
  v_accvgpr_write_b32 a4, 0
  v_accvgpr_write_b32 a5, 0
  v_accvgpr_write_b32 a6, 0
  v_accvgpr_write_b32 a7, 0
  v_accvgpr_write_b32 a8, 0
  v_accvgpr_write_b32 a9, 0
  v_accvgpr_write_b32 a10, 0
  v_accvgpr_write_b32 a11, 0
  v_accvgpr_write_b32 a12, 0
  v_accvgpr_write_b32 a13, 0
  v_accvgpr_write_b32 a14, 0
  v_accvgpr_write_b32 a15, 0
  v_accvgpr_write_b32 a16, 0
  v_accvgpr_write_b32 a17, 0
  v_accvgpr_write_b32 a18, 0
  v_accvgpr_write_b32 a19, 0
  v_accvgpr_write_b32 a20, 0
  v_accvgpr_write_b32 a21, 0
  v_accvgpr_write_b32 a22, 0
  v_accvgpr_write_b32 a23, 0
  v_accvgpr_write_b32 a24, 0
  v_accvgpr_write_b32 a25, 0
  v_accvgpr_write_b32 a26, 0
  v_accvgpr_write_b32 a27, 0
  v_accvgpr_write_b32 a28, 0
  v_accvgpr_write_b32 a29, 0
  v_accvgpr_write_b32 a30, 0
  v_accvgpr_write_b32 a31, 0
  v_accvgpr_write_b32 a32, 0
  v_accvgpr_write_b32 a33, 0
  v_accvgpr_write_b32 a34, 0
  v_accvgpr_write_b32 a35, 0
  v_accvgpr_write_b32 a36, 0
  v_accvgpr_write_b32 a37, 0
  v_accvgpr_write_b32 a38, 0
  v_accvgpr_write_b32 a39, 0
  v_accvgpr_write_b32 a40, 0
  v_accvgpr_write_b32 a41, 0
  v_accvgpr_write_b32 a42, 0
  v_accvgpr_write_b32 a43, 0
  v_accvgpr_write_b32 a44, 0
  v_accvgpr_write_b32 a45, 0
  v_accvgpr_write_b32 a46, 0
  v_accvgpr_write_b32 a47, 0
  v_accvgpr_write_b32 a48, 0
  v_accvgpr_write_b32 a49, 0
  v_accvgpr_write_b32 a50, 0
  v_accvgpr_write_b32 a51, 0
  v_accvgpr_write_b32 a52, 0
  v_accvgpr_write_b32 a53, 0
  v_accvgpr_write_b32 a54, 0
  v_accvgpr_write_b32 a55, 0
  v_accvgpr_write_b32 a56, 0
  v_accvgpr_write_b32 a57, 0
  v_accvgpr_write_b32 a58, 0
  v_accvgpr_write_b32 a59, 0
  v_accvgpr_write_b32 a60, 0
  v_accvgpr_write_b32 a61, 0
  v_accvgpr_write_b32 a62, 0
  v_accvgpr_write_b32 a63, 0
  v_accvgpr_write_b32 a64, 0
  v_accvgpr_write_b32 a65, 0
  v_accvgpr_write_b32 a66, 0
  v_accvgpr_write_b32 a67, 0
  v_accvgpr_write_b32 a68, 0
  v_accvgpr_write_b32 a69, 0
  v_accvgpr_write_b32 a70, 0
  v_accvgpr_write_b32 a71, 0
  v_accvgpr_write_b32 a72, 0
  v_accvgpr_write_b32 a73, 0
  v_accvgpr_write_b32 a74, 0
  v_accvgpr_write_b32 a75, 0
  v_accvgpr_write_b32 a76, 0
  v_accvgpr_write_b32 a77, 0
  v_accvgpr_write_b32 a78, 0
  v_accvgpr_write_b32 a79, 0
  v_accvgpr_write_b32 a80, 0
  v_accvgpr_write_b32 a81, 0
  v_accvgpr_write_b32 a82, 0
  v_accvgpr_write_b32 a83, 0
  v_accvgpr_write_b32 a84, 0
  v_accvgpr_write_b32 a85, 0
  v_accvgpr_write_b32 a86, 0
  v_accvgpr_write_b32 a87, 0
  v_accvgpr_write_b32 a88, 0
  v_accvgpr_write_b32 a89, 0
  v_accvgpr_write_b32 a90, 0
  v_accvgpr_write_b32 a91, 0
  v_accvgpr_write_b32 a92, 0
  v_accvgpr_write_b32 a93, 0
  v_accvgpr_write_b32 a94, 0
  v_accvgpr_write_b32 a95, 0
  v_accvgpr_write_b32 a96, 0
  v_accvgpr_write_b32 a97, 0
  v_accvgpr_write_b32 a98, 0
  v_accvgpr_write_b32 a99, 0
  v_accvgpr_write_b32 a100, 0
  v_accvgpr_write_b32 a101, 0
  v_accvgpr_write_b32 a102, 0
  v_accvgpr_write_b32 a103, 0
  v_accvgpr_write_b32 a104, 0
  v_accvgpr_write_b32 a105, 0
  v_accvgpr_write_b32 a106, 0
  v_accvgpr_write_b32 a107, 0
  v_accvgpr_write_b32 a108, 0
  v_accvgpr_write_b32 a109, 0
  v_accvgpr_write_b32 a110, 0
  v_accvgpr_write_b32 a111, 0
  v_accvgpr_write_b32 a112, 0
  v_accvgpr_write_b32 a113, 0
  v_accvgpr_write_b32 a114, 0
  v_accvgpr_write_b32 a115, 0
  v_accvgpr_write_b32 a116, 0
  v_accvgpr_write_b32 a117, 0
  v_accvgpr_write_b32 a118, 0
  v_accvgpr_write_b32 a119, 0
  v_accvgpr_write_b32 a120, 0
  v_accvgpr_write_b32 a121, 0
  v_accvgpr_write_b32 a122, 0
  v_accvgpr_write_b32 a123, 0
  v_accvgpr_write_b32 a124, 0
  v_accvgpr_write_b32 a125, 0
  v_accvgpr_write_b32 a126, 0
  v_accvgpr_write_b32 a127, 0
  s_mov_b32 s58, s57
  s_mov_b32 s59, 16
FB_l2:
  s_add_u32 m0, s56, 0
  s_add_u32 s3, s58, 0
  buffer_load_dwordx4 v48, s[28:31], s3 offen lds
  s_add_u32 m0, s56, 1024
  s_add_u32 s3, s58, 0
  buffer_load_dwordx4 v49, s[28:31], s3 offen lds
  s_add_u32 m0, s56, 2048
  s_add_u32 s3, s58, 0
  buffer_load_dwordx4 v50, s[28:31], s3 offen lds
  s_add_u32 m0, s56, 3072
  s_add_u32 s3, s58, 0
  buffer_load_dwordx4 v51, s[28:31], s3 offen lds
  s_add_u32 m0, s56, 4096
  s_add_u32 s3, s58, 4096
  buffer_load_dwordx4 v48, s[28:31], s3 offen lds
  s_add_u32 m0, s56, 5120
  s_add_u32 s3, s58, 4096
  buffer_load_dwordx4 v49, s[28:31], s3 offen lds
  s_add_u32 m0, s56, 6144
  s_add_u32 s3, s58, 4096
  buffer_load_dwordx4 v50, s[28:31], s3 offen lds
  s_add_u32 m0, s56, 7168
  s_add_u32 s3, s58, 4096
  buffer_load_dwordx4 v51, s[28:31], s3 offen lds
  s_waitcnt vmcnt(0)
  ds_read_b128 a[128:131], v53 offset:0
  ds_read_b128 a[132:135], v54 offset:0
  ds_read_b128 a[136:139], v55 offset:0
  ds_read_b128 a[140:143], v56 offset:0
  ds_read_b128 a[144:147], v53 offset:4096
  ds_read_b128 a[148:151], v54 offset:4096
  ds_read_b128 a[152:155], v55 offset:4096
  ds_read_b128 a[156:159], v56 offset:4096
  s_waitcnt lgkmcnt(0)
  v_mfma_f32_16x16x32_bf16 v[116:119], a[128:131], v[192:195], v[160:163]
  v_mfma_f32_16x16x32_bf16 v[120:123], a[128:131], v[208:211], v[164:167]
  v_mfma_f32_16x16x32_bf16 v[124:127], a[128:131], v[224:227], v[168:171]
  v_mfma_f32_16x16x32_bf16 v[128:131], a[128:131], v[240:243], v[172:175]
  v_mfma_f32_16x16x32_bf16 v[116:119], a[132:135], v[196:199], v[116:119]
  v_mfma_f32_16x16x32_bf16 v[120:123], a[132:135], v[212:215], v[120:123]
  v_mfma_f32_16x16x32_bf16 v[124:127], a[132:135], v[228:231], v[124:127]
  v_mfma_f32_16x16x32_bf16 v[128:131], a[132:135], v[244:247], v[128:131]
  v_mfma_f32_16x16x32_bf16 v[116:119], a[136:139], v[200:203], v[116:119]
  v_mfma_f32_16x16x32_bf16 v[120:123], a[136:139], v[216:219], v[120:123]
  v_mfma_f32_16x16x32_bf16 v[124:127], a[136:139], v[232:235], v[124:127]
  v_mfma_f32_16x16x32_bf16 v[128:131], a[136:139], v[248:251], v[128:131]
  v_mfma_f32_16x16x32_bf16 v[116:119], a[140:143], v[204:207], v[116:119]
  v_mfma_f32_16x16x32_bf16 v[120:123], a[140:143], v[220:223], v[120:123]
  v_mfma_f32_16x16x32_bf16 v[124:127], a[140:143], v[236:239], v[124:127]
  v_mfma_f32_16x16x32_bf16 v[128:131], a[140:143], v[252:255], v[128:131]
  v_mfma_f32_16x16x32_bf16 v[132:135], a[144:147], v[192:195], v[160:163]
  v_mfma_f32_16x16x32_bf16 v[136:139], a[144:147], v[208:211], v[164:167]
  v_mfma_f32_16x16x32_bf16 v[140:143], a[144:147], v[224:227], v[168:171]
  v_mfma_f32_16x16x32_bf16 v[144:147], a[144:147], v[240:243], v[172:175]
  v_mfma_f32_16x16x32_bf16 v[132:135], a[148:151], v[196:199], v[132:135]
  v_mfma_f32_16x16x32_bf16 v[136:139], a[148:151], v[212:215], v[136:139]
  v_mfma_f32_16x16x32_bf16 v[140:143], a[148:151], v[228:231], v[140:143]
  v_mfma_f32_16x16x32_bf16 v[144:147], a[148:151], v[244:247], v[144:147]
  v_mfma_f32_16x16x32_bf16 v[132:135], a[152:155], v[200:203], v[132:135]
  v_mfma_f32_16x16x32_bf16 v[136:139], a[152:155], v[216:219], v[136:139]
  v_mfma_f32_16x16x32_bf16 v[140:143], a[152:155], v[232:235], v[140:143]
  v_mfma_f32_16x16x32_bf16 v[144:147], a[152:155], v[248:251], v[144:147]
  v_mfma_f32_16x16x32_bf16 v[132:135], a[156:159], v[204:207], v[132:135]
  v_mfma_f32_16x16x32_bf16 v[136:139], a[156:159], v[220:223], v[136:139]
  v_mfma_f32_16x16x32_bf16 v[140:143], a[156:159], v[236:239], v[140:143]
  v_mfma_f32_16x16x32_bf16 v[144:147], a[156:159], v[252:255], v[144:147]
  s_add_u32 m0, s56, 0
  s_add_u32 s3, s58, 0
  buffer_load_dwordx4 v52, s[32:35], s3 offen lds
  s_add_u32 m0, s56, 1056
  s_add_u32 s3, s58, 256
  buffer_load_dwordx4 v52, s[32:35], s3 offen lds
  s_add_u32 m0, s56, 2112
  s_add_u32 s3, s58, 512
  buffer_load_dwordx4 v52, s[32:35], s3 offen lds
  s_add_u32 m0, s56, 3168
  s_add_u32 s3, s58, 768
  buffer_load_dwordx4 v52, s[32:35], s3 offen lds
  s_add_u32 m0, s56, 4224
  s_add_u32 s3, s58, 1024
  buffer_load_dwordx4 v52, s[32:35], s3 offen lds
  s_add_u32 m0, s56, 5280
  s_add_u32 s3, s58, 1280
  buffer_load_dwordx4 v52, s[32:35], s3 offen lds
  s_add_u32 m0, s56, 6336
  s_add_u32 s3, s58, 1536
  buffer_load_dwordx4 v52, s[32:35], s3 offen lds
  s_add_u32 m0, s56, 7392
  s_add_u32 s3, s58, 1792
  buffer_load_dwordx4 v52, s[32:35], s3 offen lds
  v_exp_f32 v116, v116
  v_exp_f32 v117, v117
  v_exp_f32 v118, v118
  v_exp_f32 v119, v119
  v_exp_f32 v120, v120
  v_exp_f32 v121, v121
  v_exp_f32 v122, v122
  v_exp_f32 v123, v123
  v_exp_f32 v124, v124
  v_exp_f32 v125, v125
  v_exp_f32 v126, v126
  v_exp_f32 v127, v127
  v_exp_f32 v128, v128
  v_exp_f32 v129, v129
  v_exp_f32 v130, v130
  v_exp_f32 v131, v131
  v_exp_f32 v132, v132
  v_exp_f32 v133, v133
  v_exp_f32 v134, v134
  v_exp_f32 v135, v135
  v_exp_f32 v136, v136
  v_exp_f32 v137, v137
  v_exp_f32 v138, v138
  v_exp_f32 v139, v139
  v_exp_f32 v140, v140
  v_exp_f32 v141, v141
  v_exp_f32 v142, v142
  v_exp_f32 v143, v143
  v_exp_f32 v144, v144
  v_exp_f32 v145, v145
  v_exp_f32 v146, v146
  v_exp_f32 v147, v147
  v_add_f32 v60, v60, v116
  v_add_f32 v60, v60, v117
  v_add_f32 v60, v60, v118
  v_add_f32 v60, v60, v119
  v_add_f32 v61, v61, v120
  v_add_f32 v61, v61, v121
  v_add_f32 v61, v61, v122
  v_add_f32 v61, v61, v123
  v_add_f32 v62, v62, v124
  v_add_f32 v62, v62, v125
  v_add_f32 v62, v62, v126
  v_add_f32 v62, v62, v127
  v_add_f32 v63, v63, v128
  v_add_f32 v63, v63, v129
  v_add_f32 v63, v63, v130
  v_add_f32 v63, v63, v131
  v_add_f32 v60, v60, v132
  v_add_f32 v60, v60, v133
  v_add_f32 v60, v60, v134
  v_add_f32 v60, v60, v135
  v_add_f32 v61, v61, v136
  v_add_f32 v61, v61, v137
  v_add_f32 v61, v61, v138
  v_add_f32 v61, v61, v139
  v_add_f32 v62, v62, v140
  v_add_f32 v62, v62, v141
  v_add_f32 v62, v62, v142
  v_add_f32 v62, v62, v143
  v_add_f32 v63, v63, v144
  v_add_f32 v63, v63, v145
  v_add_f32 v63, v63, v146
  v_add_f32 v63, v63, v147
  v_cvt_pk_bf16_f32 v148, v116, v117
  v_cvt_pk_bf16_f32 v149, v118, v119
  v_cvt_pk_bf16_f32 v152, v120, v121
  v_cvt_pk_bf16_f32 v153, v122, v123
  v_cvt_pk_bf16_f32 v156, v124, v125
  v_cvt_pk_bf16_f32 v157, v126, v127
  v_cvt_pk_bf16_f32 v180, v128, v129
  v_cvt_pk_bf16_f32 v181, v130, v131
  v_cvt_pk_bf16_f32 v150, v132, v133
  v_cvt_pk_bf16_f32 v151, v134, v135
  v_cvt_pk_bf16_f32 v154, v136, v137
  v_cvt_pk_bf16_f32 v155, v138, v139
  v_cvt_pk_bf16_f32 v158, v140, v141
  v_cvt_pk_bf16_f32 v159, v142, v143
  v_cvt_pk_bf16_f32 v182, v144, v145
  v_cvt_pk_bf16_f32 v183, v146, v147
  s_waitcnt vmcnt(0)
  ds_read_b64_tr_b16 a[160:161], v57 offset:0
  ds_read_b64_tr_b16 a[162:163], v57 offset:512
  ds_read_b64_tr_b16 a[164:165], v57 offset:32
  ds_read_b64_tr_b16 a[166:167], v57 offset:544
  ds_read_b64_tr_b16 a[168:169], v57 offset:64
  ds_read_b64_tr_b16 a[170:171], v57 offset:576
  ds_read_b64_tr_b16 a[172:173], v57 offset:96
  ds_read_b64_tr_b16 a[174:175], v57 offset:608
  ds_read_b64_tr_b16 a[176:177], v57 offset:128
  ds_read_b64_tr_b16 a[178:179], v57 offset:640
  ds_read_b64_tr_b16 a[180:181], v57 offset:160
  ds_read_b64_tr_b16 a[182:183], v57 offset:672
  ds_read_b64_tr_b16 a[184:185], v57 offset:192
  ds_read_b64_tr_b16 a[186:187], v57 offset:704
  ds_read_b64_tr_b16 a[188:189], v57 offset:224
  ds_read_b64_tr_b16 a[190:191], v57 offset:736
  s_waitcnt lgkmcnt(0)
  v_mfma_f32_16x16x32_bf16 a[0:3], a[160:163], v[148:151], a[0:3]
  v_mfma_f32_16x16x32_bf16 a[4:7], a[160:163], v[152:155], a[4:7]
  v_mfma_f32_16x16x32_bf16 a[8:11], a[160:163], v[156:159], a[8:11]
  v_mfma_f32_16x16x32_bf16 a[12:15], a[160:163], v[180:183], a[12:15]
  v_mfma_f32_16x16x32_bf16 a[16:19], a[164:167], v[148:151], a[16:19]
  v_mfma_f32_16x16x32_bf16 a[20:23], a[164:167], v[152:155], a[20:23]
  v_mfma_f32_16x16x32_bf16 a[24:27], a[164:167], v[156:159], a[24:27]
  v_mfma_f32_16x16x32_bf16 a[28:31], a[164:167], v[180:183], a[28:31]
  v_mfma_f32_16x16x32_bf16 a[32:35], a[168:171], v[148:151], a[32:35]
  v_mfma_f32_16x16x32_bf16 a[36:39], a[168:171], v[152:155], a[36:39]
  v_mfma_f32_16x16x32_bf16 a[40:43], a[168:171], v[156:159], a[40:43]
  v_mfma_f32_16x16x32_bf16 a[44:47], a[168:171], v[180:183], a[44:47]
  v_mfma_f32_16x16x32_bf16 a[48:51], a[172:175], v[148:151], a[48:51]
  v_mfma_f32_16x16x32_bf16 a[52:55], a[172:175], v[152:155], a[52:55]
  v_mfma_f32_16x16x32_bf16 a[56:59], a[172:175], v[156:159], a[56:59]
  v_mfma_f32_16x16x32_bf16 a[60:63], a[172:175], v[180:183], a[60:63]
  v_mfma_f32_16x16x32_bf16 a[64:67], a[176:179], v[148:151], a[64:67]
  v_mfma_f32_16x16x32_bf16 a[68:71], a[176:179], v[152:155], a[68:71]
  v_mfma_f32_16x16x32_bf16 a[72:75], a[176:179], v[156:159], a[72:75]
  v_mfma_f32_16x16x32_bf16 a[76:79], a[176:179], v[180:183], a[76:79]
  v_mfma_f32_16x16x32_bf16 a[80:83], a[180:183], v[148:151], a[80:83]
  v_mfma_f32_16x16x32_bf16 a[84:87], a[180:183], v[152:155], a[84:87]
  v_mfma_f32_16x16x32_bf16 a[88:91], a[180:183], v[156:159], a[88:91]
  v_mfma_f32_16x16x32_bf16 a[92:95], a[180:183], v[180:183], a[92:95]
  v_mfma_f32_16x16x32_bf16 a[96:99], a[184:187], v[148:151], a[96:99]
  v_mfma_f32_16x16x32_bf16 a[100:103], a[184:187], v[152:155], a[100:103]
  v_mfma_f32_16x16x32_bf16 a[104:107], a[184:187], v[156:159], a[104:107]
  v_mfma_f32_16x16x32_bf16 a[108:111], a[184:187], v[180:183], a[108:111]
  v_mfma_f32_16x16x32_bf16 a[112:115], a[188:191], v[148:151], a[112:115]
  v_mfma_f32_16x16x32_bf16 a[116:119], a[188:191], v[152:155], a[116:119]
  v_mfma_f32_16x16x32_bf16 a[120:123], a[188:191], v[156:159], a[120:123]
  v_mfma_f32_16x16x32_bf16 a[124:127], a[188:191], v[180:183], a[124:127]
  s_add_u32 s58, s58, 8192
  s_sub_u32 s59, s59, 1
  s_cmp_lg_u32 s59, 0
  s_cbranch_scc1 FB_l2
  v_mov_b32 v44, v60
  v_mov_b32 v45, v61
  v_mov_b32 v46, v62
  v_mov_b32 v47, v63
  s_nop 1
  v_permlane16_swap_b32 v60, v44
  v_permlane16_swap_b32 v61, v45
  v_permlane16_swap_b32 v62, v46
  v_permlane16_swap_b32 v63, v47
  v_add_f32 v60, v60, v44
  v_add_f32 v61, v61, v45
  v_add_f32 v62, v62, v46
  v_add_f32 v63, v63, v47
  v_mov_b32 v44, v60
  v_mov_b32 v45, v61
  v_mov_b32 v46, v62
  v_mov_b32 v47, v63
  s_nop 1
  v_permlane32_swap_b32 v60, v44
  v_permlane32_swap_b32 v61, v45
  v_permlane32_swap_b32 v62, v46
  v_permlane32_swap_b32 v63, v47
  v_add_f32 v60, v60, v44
  v_add_f32 v61, v61, v45
  v_add_f32 v62, v62, v46
  v_add_f32 v63, v63, v47
  s_setpc_b64 s[6:7]
K_end:
  s_endpgm
.section .rodata,"a"
.p2align 6
.amdhsa_kernel recurrent_scan__sliding_block_cached__mixer_token_mlp__prompt_kernel
  .amdhsa_next_free_vgpr 512
  .amdhsa_next_free_sgpr 102
  .amdhsa_accum_offset 256
  .amdhsa_group_segment_fixed_size 0
  .amdhsa_kernarg_size 104
  .amdhsa_user_sgpr_count 2
  .amdhsa_user_sgpr_kernarg_segment_ptr 1
  .amdhsa_system_sgpr_workgroup_id_x 1
  .amdhsa_float_denorm_mode_32 3
.end_amdhsa_kernel
```
